```python
import torch

def _softmax(x, axis=-1):
    return torch.softmax(x, dim=axis)

def _gelu(x):
    return torch.nn.functional.gelu(x, approximate='tanh')

def _silu(x):
    return torch.nn.functional.silu(x)

def _sigmoid(x):
    return torch.sigmoid(x)

def _layernorm(x, axis=-1, eps=1e-05):
    m = x.mean(dim=axis, keepdim=True)
    v = x.var(dim=axis, keepdim=True, unbiased=False)
    return (x - m) / torch.sqrt(v + eps)

def _scatter_add(tgt, idx, src, axis=0):
    return tgt.clone().index_add_(axis, idx, src)

def _segment_sum(src, seg, n):
    out = torch.zeros((n,) + src.shape[1:], dtype=src.dtype)
    return out.index_add_(0, seg, src)

def _pad(x, pw):
    flat = tuple((v for pair in reversed(pw) for v in pair))
    return torch.nn.functional.pad(x, flat)
kernel_name = 'concat_heads__memory_aug_recurrent_mem_tr__mha_block__prompt'

def setup_inputs():

    _w = lambda a: (lambda t: t.to(torch.bfloat16) if t.is_floating_point() else t)(torch.as_tensor(a))

    def _A_setup():
        B, S, Dm = (1, 2048, 1024)
        H, Dh = (32, 128)
        M, seg = (8, 32)
        seg = min(seg, S)
        S = S // seg * seg
        return {'x': _w((lambda *s: torch.randn(*s, dtype=torch.bfloat16) * 0.05)(B, S, Dm)), 'mem0': _w((lambda *s: torch.randn(*s, dtype=torch.bfloat16) * 1.6)(B, M, Dm)), 'Wq': _w((lambda *s: torch.randn(*s, dtype=torch.bfloat16) * 0.8)(Dm, H, Dh) * Dm ** (-0.5)), 'Wk': _w((lambda *s: torch.randn(*s, dtype=torch.bfloat16) * 0.8)(Dm, H, Dh) * Dm ** (-0.5)), 'Wv': _w((lambda *s: torch.randn(*s, dtype=torch.bfloat16) * 1.6)(Dm, H, Dh) * Dm ** (-0.5)), 'Wo': _w((lambda *s: torch.randn(*s, dtype=torch.bfloat16) * 1.6)(H, Dh, Dm) * (H * Dh) ** (-0.5)), 'seg_len': seg}
    _A_in = _A_setup()

    def _B_setup():
        B, S, D, H = (1, 2048, 1024, 32)
        return {'x': _w((lambda *s: torch.randn(*s, dtype=torch.bfloat16) * 0.2)(B, S, D)), 'wqkv': _w((lambda *s: torch.randn(*s, dtype=torch.bfloat16) * 0.2)(D, 3 * D)), 'wo': _w((lambda *s: torch.randn(*s, dtype=torch.bfloat16) * 0.05)(D, D))}
    _B_in = _B_setup()
    return {'A_x': _A_in['x'], 'A_mem0': _A_in['mem0'], 'A_Wq': _A_in['Wq'], 'A_Wk': _A_in['Wk'], 'A_Wv': _A_in['Wv'], 'A_Wo': _A_in['Wo'], 'A_seg_len': _A_in['seg_len'], 'B_x': _B_in['x'], 'B_wqkv': _B_in['wqkv'], 'B_wo': _B_in['wo']}

def reference(A_x, A_mem0, A_Wq, A_Wk, A_Wv, A_Wo, A_seg_len, B_x, B_wqkv, B_wo):

    def _A_ref(x, mem0, Wq, Wk, Wv, Wo, seg_len):
        B, S, Dm = x.shape
        H, Dh = (Wq.shape[1], Wq.shape[2])
        M = mem0.shape[1]
        scale = Dh ** (-0.5)
        n_seg = S // seg_len
        L = M + seg_len
        idx = torch.arange(L)
        mask = (idx[:, None] < M) | (idx[:, None] >= idx[None, :])
        mem = mem0
        outs = []
        for s in range(n_seg):
            xs = x[:, s * seg_len:(s + 1) * seg_len, :].clone()
            h = torch.concatenate([mem, xs], axis=1)
            q = torch.einsum('btd,dhe->bhte', h, Wq)
            k = torch.einsum('btd,dhe->bhte', h, Wk)
            v = torch.einsum('btd,dhe->bhte', h, Wv)
            scores = torch.einsum('bhqe,bhke->bhqk', q, k) * scale
            scores = torch.where(mask[None, None], scores, -1000000000.0)
            p = _softmax(scores, axis=-1)
            o = torch.einsum('bhqk,bhke->bhqe', p, v)
            o = torch.einsum('bhte,hed->btd', o, Wo)
            mem = o[:, :M, :].clone()
            outs.append(o[:, M:, :])
        return torch.concatenate(outs, axis=1)

    def _B_ref(x, wqkv, wo):
        B, S, D = x.shape
        H = 32
        Dh = D // H
        qkv = (lambda x, *d: x.permute(*d))((x @ wqkv).reshape(B, S, 3, H, Dh), 2, 0, 3, 1, 4)
        q, k, v = (qkv[0], qkv[1], qkv[2])
        scores = torch.einsum('bhqd,bhkd->bhqk', q, k) * Dh ** (-0.5)
        p = _softmax(scores, axis=-1)
        o = torch.einsum('bhqk,bhkd->bhqd', p, v)
        return (lambda x, *d: x.permute(*d))(o, 0, 2, 1, 3).reshape(B, S, D) @ wo
    a = _A_ref(A_x, A_mem0, A_Wq, A_Wk, A_Wv, A_Wo, A_seg_len)
    b = _B_ref(B_x, B_wqkv, B_wo)
    return torch.concatenate([a, b], axis=-1)
```

```asm
; @launch grid=(256,1,1) block=(512,1,1) lds=147520
.amdgcn_target "amdgcn-amd-amdhsa--gfx950"
.text
.globl concat_heads__memory_aug_recurrent_mem_tr__mha_block__prompt_kernel
.p2align 8
.type concat_heads__memory_aug_recurrent_mem_tr__mha_block__prompt_kernel,@function
concat_heads__memory_aug_recurrent_mem_tr__mha_block__prompt_kernel:
    s_cmp_ge_u32 s2, 256
    s_cbranch_scc1 C_DONE
    s_load_dwordx16 s[60:75], s[0:1], 0
    s_load_dwordx8 s[76:83], s[0:1], 64
    s_load_dwordx2 s[84:85], s[0:1], 96
    v_lshrrev_b32 v1, 6, v0
    s_nop 0
    v_readfirstlane_b32 s34, v1
    s_waitcnt lgkmcnt(0)
    s_mov_b32 s8, s84
    s_and_b32 s9, s85, 0xffff
    s_mov_b32 s10, 0x10000000
    s_mov_b32 s11, 0x20000
    s_getreg_b32 s40, hwreg(HW_REG_XCC_ID)
    s_and_b32 s40, s40, 7
    s_lshl_b32 s41, s40, 2
    s_lshr_b32 s40, 0x73625140, s41
    s_and_b32 s40, s40, 7
    s_lshr_b32 s41, s2, 3
    s_lshl_b32 s51, s40, 5
    s_add_u32 s51, s51, s41
    s_cmp_lg_u32 s34, 4
    s_cbranch_scc1 R_NOT4
    s_lshl_b32 s43, s2, 7
    s_add_u32 s43, s43, 98566144
    v_mov_b32 v40, 0
    s_mov_b64 exec, 1
    buffer_store_dword v40, off, s[8:11], s43 sc1
    s_mov_b64 exec, -1
R_NOT4:
    s_barrier
    s_lshl_b32 s72, 1, s41
    s_mov_b32 s73, 0x100
    s_mov_b32 s2, 0
    s_branch R_GO
R_RESTART:
    s_mov_b32 s51, s40
    s_lshl_b32 s40, s34, 6
    v_and_b32 v0, 63, v0
    v_add_u32 v0, s40, v0
    s_waitcnt vmcnt(0) lgkmcnt(0)
    s_barrier
R_GO:
    s_bfe_u32 s32, s51, 0x30005
    s_and_b32 s33, s51, 31
    s_cmp_ge_u32 s32, 4
    s_cbranch_scc1 C_BULK
    s_bitcmp1_b32 s51, 8
    s_cbranch_scc1 C_SLOW
    v_lshrrev_b32 v1, 6, v0
    v_and_b32 v0, 63, v0
    v_readfirstlane_b32 s34, v1
    s_mov_b32 s42, 0
    s_mov_b32 s43, 0x00ff00ff
    s_mov_b32 s54, 0
    s_mov_b32 s55, -1
    s_mov_b32 s35, 0
    s_mov_b32 s36, 92274688
    s_mov_b32 s37, 92798976
    s_mov_b32 s38, 93323264
    s_lshr_b32 s27, s35, 3
    s_lshl_b32 s27, s27, 22
    s_and_b32 s28, s35, 7
    s_lshl_b32 s28, s28, 18
    s_add_u32 s27, s27, s28
    v_bfe_u32 v1, v0, 3, 1
    v_lshlrev_b32 v1, 9, v1
    v_lshrrev_b32 v2, 4, v0
    v_lshl_add_u32 v1, v2, 7, v1
    v_and_b32 v2, 7, v0
    v_lshl_add_u32 v1, v2, 4, v1
    v_lshlrev_b32 v2, 4, v0
    s_lshl_b32 s47, s32, 5
    s_add_u32 s47, s47, s33
    s_xor_b32 s47, s47, 8
    s_cmp_ge_u32 s34, 4
    s_cbranch_scc1 CF_WO
    s_lshl_b32 s48, s47, 6
    s_lshl_b32 s45, s34, 21
    s_add_u32 s48, s48, s45
    s_xor_b32 s50, s48, 128
    s_barrier
    s_mov_b32 s12, s66
    s_and_b32 s13, s67, 0xffff
    s_mov_b32 s14, 0x800000
    s_mov_b32 s15, 0x20000
    v_lshrrev_b32 v4, 2, v0
    s_mov_b32 s45, 8192
    v_mul_lo_u32 v4, v4, s45
    v_and_b32 v6, 3, v0
    v_lshl_add_u32 v4, v6, 4, v4
    s_mov_b32 s46, s48
    buffer_load_dwordx4 v[64:67], v4, s[12:15], s46 offen
    s_add_u32 s46, s46, 131072
    buffer_load_dwordx4 v[68:71], v4, s[12:15], s46 offen
    s_add_u32 s46, s46, 131072
    buffer_load_dwordx4 v[72:75], v4, s[12:15], s46 offen
    s_add_u32 s46, s46, 131072
    buffer_load_dwordx4 v[76:79], v4, s[12:15], s46 offen
    s_add_u32 s46, s46, 131072
    buffer_load_dwordx4 v[80:83], v4, s[12:15], s46 offen
    s_add_u32 s46, s46, 131072
    buffer_load_dwordx4 v[84:87], v4, s[12:15], s46 offen
    s_add_u32 s46, s46, 131072
    buffer_load_dwordx4 v[88:91], v4, s[12:15], s46 offen
    s_add_u32 s46, s46, 131072
    buffer_load_dwordx4 v[92:95], v4, s[12:15], s46 offen
    s_add_u32 s46, s46, 131072
    buffer_load_dwordx4 v[96:99], v4, s[12:15], s46 offen
    s_add_u32 s46, s46, 131072
    buffer_load_dwordx4 v[100:103], v4, s[12:15], s46 offen
    s_add_u32 s46, s46, 131072
    buffer_load_dwordx4 v[104:107], v4, s[12:15], s46 offen
    s_add_u32 s46, s46, 131072
    buffer_load_dwordx4 v[108:111], v4, s[12:15], s46 offen
    s_add_u32 s46, s46, 131072
    buffer_load_dwordx4 v[112:115], v4, s[12:15], s46 offen
    s_add_u32 s46, s46, 131072
    buffer_load_dwordx4 v[116:119], v4, s[12:15], s46 offen
    s_add_u32 s46, s46, 131072
    buffer_load_dwordx4 v[120:123], v4, s[12:15], s46 offen
    s_add_u32 s46, s46, 131072
    buffer_load_dwordx4 v[124:127], v4, s[12:15], s46 offen
    s_mov_b32 s12, s68
    s_and_b32 s13, s69, 0xffff
    s_mov_b32 s14, 0x800000
    s_mov_b32 s15, 0x20000
    v_lshrrev_b32 v4, 2, v0
    s_mov_b32 s45, 8192
    v_mul_lo_u32 v4, v4, s45
    v_and_b32 v6, 3, v0
    v_lshl_add_u32 v4, v6, 4, v4
    s_mov_b32 s46, s50
    buffer_load_dwordx4 v[128:131], v4, s[12:15], s46 offen
    s_add_u32 s46, s46, 131072
    buffer_load_dwordx4 v[132:135], v4, s[12:15], s46 offen
    s_add_u32 s46, s46, 131072
    buffer_load_dwordx4 v[136:139], v4, s[12:15], s46 offen
    s_add_u32 s46, s46, 131072
    buffer_load_dwordx4 v[140:143], v4, s[12:15], s46 offen
    s_add_u32 s46, s46, 131072
    buffer_load_dwordx4 v[144:147], v4, s[12:15], s46 offen
    s_add_u32 s46, s46, 131072
    buffer_load_dwordx4 v[148:151], v4, s[12:15], s46 offen
    s_add_u32 s46, s46, 131072
    buffer_load_dwordx4 v[152:155], v4, s[12:15], s46 offen
    s_add_u32 s46, s46, 131072
    buffer_load_dwordx4 v[156:159], v4, s[12:15], s46 offen
    s_add_u32 s46, s46, 131072
    buffer_load_dwordx4 v[160:163], v4, s[12:15], s46 offen
    s_add_u32 s46, s46, 131072
    buffer_load_dwordx4 v[164:167], v4, s[12:15], s46 offen
    s_add_u32 s46, s46, 131072
    buffer_load_dwordx4 v[168:171], v4, s[12:15], s46 offen
    s_add_u32 s46, s46, 131072
    buffer_load_dwordx4 v[172:175], v4, s[12:15], s46 offen
    s_add_u32 s46, s46, 131072
    buffer_load_dwordx4 v[176:179], v4, s[12:15], s46 offen
    s_add_u32 s46, s46, 131072
    buffer_load_dwordx4 v[180:183], v4, s[12:15], s46 offen
    s_add_u32 s46, s46, 131072
    buffer_load_dwordx4 v[184:187], v4, s[12:15], s46 offen
    s_add_u32 s46, s46, 131072
    buffer_load_dwordx4 v[188:191], v4, s[12:15], s46 offen
    s_mov_b32 s12, s64
    s_and_b32 s13, s65, 0xffff
    s_mov_b32 s14, 0x800000
    s_mov_b32 s15, 0x20000
    v_lshrrev_b32 v4, 2, v0
    s_mov_b32 s45, 8192
    v_mul_lo_u32 v4, v4, s45
    v_and_b32 v6, 3, v0
    v_lshl_add_u32 v4, v6, 4, v4
    s_mov_b32 s46, s48
    buffer_load_dwordx4 v[192:195], v4, s[12:15], s46 offen
    s_add_u32 s46, s46, 131072
    buffer_load_dwordx4 v[196:199], v4, s[12:15], s46 offen
    s_add_u32 s46, s46, 131072
    buffer_load_dwordx4 v[200:203], v4, s[12:15], s46 offen
    s_add_u32 s46, s46, 131072
    buffer_load_dwordx4 v[204:207], v4, s[12:15], s46 offen
    s_add_u32 s46, s46, 131072
    buffer_load_dwordx4 v[208:211], v4, s[12:15], s46 offen
    s_add_u32 s46, s46, 131072
    buffer_load_dwordx4 v[212:215], v4, s[12:15], s46 offen
    s_add_u32 s46, s46, 131072
    buffer_load_dwordx4 v[216:219], v4, s[12:15], s46 offen
    s_add_u32 s46, s46, 131072
    buffer_load_dwordx4 v[220:223], v4, s[12:15], s46 offen
    s_add_u32 s46, s46, 131072
    buffer_load_dwordx4 v[224:227], v4, s[12:15], s46 offen
    s_add_u32 s46, s46, 131072
    buffer_load_dwordx4 v[228:231], v4, s[12:15], s46 offen
    s_add_u32 s46, s46, 131072
    buffer_load_dwordx4 v[232:235], v4, s[12:15], s46 offen
    s_add_u32 s46, s46, 131072
    buffer_load_dwordx4 v[236:239], v4, s[12:15], s46 offen
    s_add_u32 s46, s46, 131072
    buffer_load_dwordx4 v[240:243], v4, s[12:15], s46 offen
    s_add_u32 s46, s46, 131072
    buffer_load_dwordx4 v[244:247], v4, s[12:15], s46 offen
    s_add_u32 s46, s46, 131072
    buffer_load_dwordx4 v[248:251], v4, s[12:15], s46 offen
    s_add_u32 s46, s46, 131072
    buffer_load_dwordx4 v[252:255], v4, s[12:15], s46 offen
    s_lshl_b32 s45, s34, 14
    v_lshlrev_b32 v5, 4, v0
    v_add_u32 v5, s45, v5
    v_lshrrev_b32 v4, 4, v0
    v_lshlrev_b32 v4, 9, v4
    v_bfe_u32 v6, v0, 2, 1
    v_lshl_add_u32 v4, v6, 6, v4
    v_bfe_u32 v6, v0, 3, 1
    v_lshl_add_u32 v4, v6, 8, v4
    v_and_b32 v6, 3, v0
    v_lshl_add_u32 v4, v6, 4, v4
    v_add_u32 v4, s45, v4
    s_waitcnt vmcnt(32)
    ds_write_b128 v5, v[64:67] offset:0
    ds_write_b128 v5, v[68:71] offset:1024
    ds_write_b128 v5, v[72:75] offset:2048
    ds_write_b128 v5, v[76:79] offset:3072
    ds_write_b128 v5, v[80:83] offset:4096
    ds_write_b128 v5, v[84:87] offset:5120
    ds_write_b128 v5, v[88:91] offset:6144
    ds_write_b128 v5, v[92:95] offset:7168
    ds_write_b128 v5, v[96:99] offset:8192
    ds_write_b128 v5, v[100:103] offset:9216
    ds_write_b128 v5, v[104:107] offset:10240
    ds_write_b128 v5, v[108:111] offset:11264
    ds_write_b128 v5, v[112:115] offset:12288
    ds_write_b128 v5, v[116:119] offset:13312
    ds_write_b128 v5, v[120:123] offset:14336
    ds_write_b128 v5, v[124:127] offset:15360
    s_waitcnt lgkmcnt(0)
    ds_read_b64_tr_b16 v[64:65], v4 offset:0
    ds_read_b64_tr_b16 v[66:67], v4 offset:128
    ds_read_b64_tr_b16 v[72:73], v4 offset:8
    ds_read_b64_tr_b16 v[74:75], v4 offset:136
    ds_read_b64_tr_b16 v[68:69], v4 offset:2048
    ds_read_b64_tr_b16 v[70:71], v4 offset:2176
    ds_read_b64_tr_b16 v[76:77], v4 offset:2056
    ds_read_b64_tr_b16 v[78:79], v4 offset:2184
    s_waitcnt lgkmcnt(0)
    ds_read_b64_tr_b16 v[80:81], v4 offset:4096
    ds_read_b64_tr_b16 v[82:83], v4 offset:4224
    ds_read_b64_tr_b16 v[88:89], v4 offset:4104
    ds_read_b64_tr_b16 v[90:91], v4 offset:4232
    ds_read_b64_tr_b16 v[84:85], v4 offset:6144
    ds_read_b64_tr_b16 v[86:87], v4 offset:6272
    ds_read_b64_tr_b16 v[92:93], v4 offset:6152
    ds_read_b64_tr_b16 v[94:95], v4 offset:6280
    s_waitcnt lgkmcnt(0)
    ds_read_b64_tr_b16 v[96:97], v4 offset:8192
    ds_read_b64_tr_b16 v[98:99], v4 offset:8320
    ds_read_b64_tr_b16 v[104:105], v4 offset:8200
    ds_read_b64_tr_b16 v[106:107], v4 offset:8328
    ds_read_b64_tr_b16 v[100:101], v4 offset:10240
    ds_read_b64_tr_b16 v[102:103], v4 offset:10368
    ds_read_b64_tr_b16 v[108:109], v4 offset:10248
    ds_read_b64_tr_b16 v[110:111], v4 offset:10376
    s_waitcnt lgkmcnt(0)
    ds_read_b64_tr_b16 v[112:113], v4 offset:12288
    ds_read_b64_tr_b16 v[114:115], v4 offset:12416
    ds_read_b64_tr_b16 v[120:121], v4 offset:12296
    ds_read_b64_tr_b16 v[122:123], v4 offset:12424
    ds_read_b64_tr_b16 v[116:117], v4 offset:14336
    ds_read_b64_tr_b16 v[118:119], v4 offset:14464
    ds_read_b64_tr_b16 v[124:125], v4 offset:14344
    ds_read_b64_tr_b16 v[126:127], v4 offset:14472
    s_waitcnt lgkmcnt(0)
    s_waitcnt vmcnt(16)
    ds_write_b128 v5, v[128:131] offset:0
    ds_write_b128 v5, v[132:135] offset:1024
    ds_write_b128 v5, v[136:139] offset:2048
    ds_write_b128 v5, v[140:143] offset:3072
    ds_write_b128 v5, v[144:147] offset:4096
    ds_write_b128 v5, v[148:151] offset:5120
    ds_write_b128 v5, v[152:155] offset:6144
    ds_write_b128 v5, v[156:159] offset:7168
    ds_write_b128 v5, v[160:163] offset:8192
    ds_write_b128 v5, v[164:167] offset:9216
    ds_write_b128 v5, v[168:171] offset:10240
    ds_write_b128 v5, v[172:175] offset:11264
    ds_write_b128 v5, v[176:179] offset:12288
    ds_write_b128 v5, v[180:183] offset:13312
    ds_write_b128 v5, v[184:187] offset:14336
    ds_write_b128 v5, v[188:191] offset:15360
    s_waitcnt lgkmcnt(0)
    ds_read_b64_tr_b16 v[128:129], v4 offset:0
    ds_read_b64_tr_b16 v[130:131], v4 offset:128
    ds_read_b64_tr_b16 v[136:137], v4 offset:8
    ds_read_b64_tr_b16 v[138:139], v4 offset:136
    ds_read_b64_tr_b16 v[132:133], v4 offset:2048
    ds_read_b64_tr_b16 v[134:135], v4 offset:2176
    ds_read_b64_tr_b16 v[140:141], v4 offset:2056
    ds_read_b64_tr_b16 v[142:143], v4 offset:2184
    s_waitcnt lgkmcnt(0)
    ds_read_b64_tr_b16 v[144:145], v4 offset:4096
    ds_read_b64_tr_b16 v[146:147], v4 offset:4224
    ds_read_b64_tr_b16 v[152:153], v4 offset:4104
    ds_read_b64_tr_b16 v[154:155], v4 offset:4232
    ds_read_b64_tr_b16 v[148:149], v4 offset:6144
    ds_read_b64_tr_b16 v[150:151], v4 offset:6272
    ds_read_b64_tr_b16 v[156:157], v4 offset:6152
    ds_read_b64_tr_b16 v[158:159], v4 offset:6280
    s_waitcnt lgkmcnt(0)
    ds_read_b64_tr_b16 v[160:161], v4 offset:8192
    ds_read_b64_tr_b16 v[162:163], v4 offset:8320
    ds_read_b64_tr_b16 v[168:169], v4 offset:8200
    ds_read_b64_tr_b16 v[170:171], v4 offset:8328
    ds_read_b64_tr_b16 v[164:165], v4 offset:10240
    ds_read_b64_tr_b16 v[166:167], v4 offset:10368
    ds_read_b64_tr_b16 v[172:173], v4 offset:10248
    ds_read_b64_tr_b16 v[174:175], v4 offset:10376
    s_waitcnt lgkmcnt(0)
    ds_read_b64_tr_b16 v[176:177], v4 offset:12288
    ds_read_b64_tr_b16 v[178:179], v4 offset:12416
    ds_read_b64_tr_b16 v[184:185], v4 offset:12296
    ds_read_b64_tr_b16 v[186:187], v4 offset:12424
    ds_read_b64_tr_b16 v[180:181], v4 offset:14336
    ds_read_b64_tr_b16 v[182:183], v4 offset:14464
    ds_read_b64_tr_b16 v[188:189], v4 offset:14344
    ds_read_b64_tr_b16 v[190:191], v4 offset:14472
    s_waitcnt lgkmcnt(0)
    s_waitcnt vmcnt(0)
    ds_write_b128 v5, v[192:195] offset:0
    ds_write_b128 v5, v[196:199] offset:1024
    ds_write_b128 v5, v[200:203] offset:2048
    ds_write_b128 v5, v[204:207] offset:3072
    ds_write_b128 v5, v[208:211] offset:4096
    ds_write_b128 v5, v[212:215] offset:5120
    ds_write_b128 v5, v[216:219] offset:6144
    ds_write_b128 v5, v[220:223] offset:7168
    ds_write_b128 v5, v[224:227] offset:8192
    ds_write_b128 v5, v[228:231] offset:9216
    ds_write_b128 v5, v[232:235] offset:10240
    ds_write_b128 v5, v[236:239] offset:11264
    ds_write_b128 v5, v[240:243] offset:12288
    ds_write_b128 v5, v[244:247] offset:13312
    ds_write_b128 v5, v[248:251] offset:14336
    ds_write_b128 v5, v[252:255] offset:15360
    s_waitcnt lgkmcnt(0)
    ds_read_b64_tr_b16 v[192:193], v4 offset:0
    ds_read_b64_tr_b16 v[194:195], v4 offset:128
    ds_read_b64_tr_b16 v[200:201], v4 offset:8
    ds_read_b64_tr_b16 v[202:203], v4 offset:136
    ds_read_b64_tr_b16 v[196:197], v4 offset:2048
    ds_read_b64_tr_b16 v[198:199], v4 offset:2176
    ds_read_b64_tr_b16 v[204:205], v4 offset:2056
    ds_read_b64_tr_b16 v[206:207], v4 offset:2184
    s_waitcnt lgkmcnt(0)
    ds_read_b64_tr_b16 v[208:209], v4 offset:4096
    ds_read_b64_tr_b16 v[210:211], v4 offset:4224
    ds_read_b64_tr_b16 v[216:217], v4 offset:4104
    ds_read_b64_tr_b16 v[218:219], v4 offset:4232
    ds_read_b64_tr_b16 v[212:213], v4 offset:6144
    ds_read_b64_tr_b16 v[214:215], v4 offset:6272
    ds_read_b64_tr_b16 v[220:221], v4 offset:6152
    ds_read_b64_tr_b16 v[222:223], v4 offset:6280
    s_waitcnt lgkmcnt(0)
    ds_read_b64_tr_b16 v[224:225], v4 offset:8192
    ds_read_b64_tr_b16 v[226:227], v4 offset:8320
    ds_read_b64_tr_b16 v[232:233], v4 offset:8200
    ds_read_b64_tr_b16 v[234:235], v4 offset:8328
    ds_read_b64_tr_b16 v[228:229], v4 offset:10240
    ds_read_b64_tr_b16 v[230:231], v4 offset:10368
    ds_read_b64_tr_b16 v[236:237], v4 offset:10248
    ds_read_b64_tr_b16 v[238:239], v4 offset:10376
    s_waitcnt lgkmcnt(0)
    ds_read_b64_tr_b16 v[240:241], v4 offset:12288
    ds_read_b64_tr_b16 v[242:243], v4 offset:12416
    ds_read_b64_tr_b16 v[248:249], v4 offset:12296
    ds_read_b64_tr_b16 v[250:251], v4 offset:12424
    ds_read_b64_tr_b16 v[244:245], v4 offset:14336
    ds_read_b64_tr_b16 v[246:247], v4 offset:14464
    ds_read_b64_tr_b16 v[252:253], v4 offset:14344
    ds_read_b64_tr_b16 v[254:255], v4 offset:14472
    s_waitcnt lgkmcnt(0)
    s_barrier
    s_bitcmp1_b32 s2, 31
    s_cbranch_scc1 VDCF_0_OK
    v_mov_b32 v4, 147456
    ds_read_b32 v5, v4
    s_bitset1_b32 s2, 31
    s_waitcnt lgkmcnt(0)
    v_readfirstlane_b32 s40, v5
    s_cmp_lg_u32 s40, 0
    s_cbranch_scc1 R_RESTART
VDCF_0_OK:
    s_mov_b32 s40, 0x00ff00ff
    s_mov_b32 s41, 0x00ff00ff
    s_lshl_b32 s45, s32, 14
    s_lshl_b32 s46, s34, 12
    s_add_u32 s45, s45, s46
    v_add_u32 v3, s45, v2
    s_lshl_b32 s45, s34, 10
    v_add_u32 v4, s45, v2
    v_lshrrev_b32 v6, 4, v0
    v_mul_u32_u24 v6, 576, v6
    v_bfe_u32 v7, v0, 2, 2
    v_lshl_add_u32 v6, v7, 5, v6
    v_and_b32 v7, 3, v0
    v_lshl_add_u32 v6, v7, 2, v6
    s_mul_i32 s45, s34, 2304
    v_add_u32 v6, s45, v6
    v_mov_b32 v7, 0xeeee
    v_mov_b32 v1, 0x4444
    v_cndmask_b32 v7, v7, v1, s[40:41]
    v_mov_b32 v40, 0
    v_mov_b32 v41, 0
    v_mov_b32 v42, 0
    v_mov_b32 v43, 0
    v_mov_b32 v44, 0
    v_mov_b32 v45, 0
    v_mov_b32 v46, 0
    v_mov_b32 v47, 0
    v_mov_b32 v48, 0
    v_mov_b32 v49, 0
    v_mov_b32 v50, 0
    v_mov_b32 v51, 0
    v_mov_b32 v52, 0
    v_mov_b32 v53, 0
    v_mov_b32 v54, 0
    v_mov_b32 v55, 0
    v_mov_b32 v56, 0
    v_mov_b32 v57, 0
    v_mov_b32 v58, 0
    v_mov_b32 v59, 0
    v_mov_b32 v60, 0
    v_mov_b32 v61, 0
    v_mov_b32 v62, 0
    v_mov_b32 v63, 0
CF_Q_LOOP:
    s_barrier
    s_sleep 2
    s_mov_b32 s44, 0
CF_QP_R0:
    buffer_load_dwordx4 v[8:11], v3, s[8:11], s36 offen offset:0 sc1
    buffer_load_dwordx4 v[12:15], v3, s[8:11], s36 offen offset:1024 sc1
    buffer_load_dwordx4 v[16:19], v3, s[8:11], s36 offen offset:2048 sc1
    buffer_load_dwordx4 v[20:23], v3, s[8:11], s36 offen offset:3072 sc1
    s_add_u32 s44, s44, 1
    s_cmp_gt_u32 s44, 60000
    s_cbranch_scc1 C_DONE
    s_waitcnt vmcnt(3)
    v_max3_u32 v5, v8, v9, v10
    v_max_u32 v5, v5, v11
    v_cmp_eq_u32 vcc, -1, v5
    s_cbranch_vccnz CF_QP_R0
    v_smfmac_f32_16x16x64_bf16 v[40:43], v[8:11], v[192:199], v7
    s_waitcnt vmcnt(2)
    v_smfmac_f32_16x16x64_bf16 v[48:51], v[8:11], v[64:71], v7
    v_max3_u32 v5, v12, v13, v14
    v_smfmac_f32_16x16x64_bf16 v[44:47], v[8:11], v[200:207], v7
    v_max_u32 v5, v5, v15
    v_cmp_eq_u32 vcc, -1, v5
    v_smfmac_f32_16x16x64_bf16 v[52:55], v[8:11], v[72:79], v7
    s_cbranch_vccnz CF_QP_R1
CF_QP_B1:
    v_smfmac_f32_16x16x64_bf16 v[40:43], v[12:15], v[208:215], v7
    s_waitcnt vmcnt(1)
    v_smfmac_f32_16x16x64_bf16 v[48:51], v[12:15], v[80:87], v7
    v_max3_u32 v5, v16, v17, v18
    v_smfmac_f32_16x16x64_bf16 v[44:47], v[12:15], v[216:223], v7
    v_max_u32 v5, v5, v19
    v_cmp_eq_u32 vcc, -1, v5
    v_smfmac_f32_16x16x64_bf16 v[52:55], v[12:15], v[88:95], v7
    s_cbranch_vccnz CF_QP_R2
CF_QP_B2:
    v_smfmac_f32_16x16x64_bf16 v[40:43], v[16:19], v[224:231], v7
    s_waitcnt vmcnt(0)
    v_smfmac_f32_16x16x64_bf16 v[48:51], v[16:19], v[96:103], v7
    v_max3_u32 v5, v20, v21, v22
    v_smfmac_f32_16x16x64_bf16 v[44:47], v[16:19], v[232:239], v7
    v_max_u32 v5, v5, v23
    v_cmp_eq_u32 vcc, -1, v5
    v_smfmac_f32_16x16x64_bf16 v[52:55], v[16:19], v[104:111], v7
    s_cbranch_vccnz CF_QP_R3
CF_QP_B3:
    v_smfmac_f32_16x16x64_bf16 v[40:43], v[20:23], v[240:247], v7
    v_smfmac_f32_16x16x64_bf16 v[48:51], v[20:23], v[112:119], v7
    v_smfmac_f32_16x16x64_bf16 v[44:47], v[20:23], v[248:255], v7
    v_smfmac_f32_16x16x64_bf16 v[52:55], v[20:23], v[120:127], v7
    s_nop 5
    v_permlane32_swap_b32 v40, v48
    v_permlane32_swap_b32 v41, v49
    v_permlane32_swap_b32 v42, v50
    v_permlane32_swap_b32 v43, v51
    v_permlane32_swap_b32 v44, v52
    v_permlane32_swap_b32 v45, v53
    v_permlane32_swap_b32 v46, v54
    v_permlane32_swap_b32 v47, v55
    v_add_f32 v40, v40, v48
    v_add_f32 v44, v44, v52
    ds_write2_b32 v6, v40, v44 offset0:0 offset1:4
    v_add_f32 v41, v41, v49
    v_add_f32 v45, v45, v53
    ds_write2_b32 v6, v41, v45 offset0:36 offset1:40
    v_add_f32 v42, v42, v50
    v_add_f32 v46, v46, v54
    ds_write2_b32 v6, v42, v46 offset0:72 offset1:76
    v_add_f32 v43, v43, v51
    v_add_f32 v47, v47, v55
    ds_write2_b32 v6, v43, v47 offset0:108 offset1:112
    v_smfmac_f32_16x16x64_bf16 v[56:59], v[8:11], v[128:135], v7
    v_smfmac_f32_16x16x64_bf16 v[60:63], v[8:11], v[136:143], v7
    s_waitcnt lgkmcnt(0)
    s_barrier
    v_smfmac_f32_16x16x64_bf16 v[56:59], v[12:15], v[144:151], v7
    v_smfmac_f32_16x16x64_bf16 v[60:63], v[12:15], v[152:159], v7
    v_smfmac_f32_16x16x64_bf16 v[56:59], v[16:19], v[160:167], v7
    v_smfmac_f32_16x16x64_bf16 v[60:63], v[16:19], v[168:175], v7
    v_smfmac_f32_16x16x64_bf16 v[56:59], v[20:23], v[176:183], v7
    v_smfmac_f32_16x16x64_bf16 v[60:63], v[20:23], v[184:191], v7
    s_nop 7
    v_permlane32_swap_b32 v56, v60
    v_permlane32_swap_b32 v57, v61
    v_permlane32_swap_b32 v58, v62
    v_permlane32_swap_b32 v59, v63
    v_add_f32 v56, v56, v60
    v_add_f32 v57, v57, v61
    v_add_f32 v58, v58, v62
    v_add_f32 v59, v59, v63
    ds_write_b128 v4, v[56:59] offset:9216
    s_waitcnt lgkmcnt(0)
    s_barrier
    s_cmp_eq_u32 s35, 63
    s_cbranch_scc1 C_FIN
    s_barrier
    s_barrier
    s_sleep 4
    v_mov_b32 v40, 0
    v_mov_b32 v41, 0
    v_mov_b32 v42, 0
    v_mov_b32 v43, 0
    v_mov_b32 v44, 0
    v_mov_b32 v45, 0
    v_mov_b32 v46, 0
    v_mov_b32 v47, 0
    v_mov_b32 v48, 0
    v_mov_b32 v49, 0
    v_mov_b32 v50, 0
    v_mov_b32 v51, 0
    v_mov_b32 v52, 0
    v_mov_b32 v53, 0
    v_mov_b32 v54, 0
    v_mov_b32 v55, 0
    v_mov_b32 v56, 0
    v_mov_b32 v57, 0
    v_mov_b32 v58, 0
    v_mov_b32 v59, 0
    v_mov_b32 v60, 0
    v_mov_b32 v61, 0
    v_mov_b32 v62, 0
    v_mov_b32 v63, 0
    s_mov_b32 s36, s37
    s_mov_b32 s37, s38
    s_add_u32 s38, s38, 524288
    s_cmp_eq_u32 s38, 94371840
    s_cselect_b32 s38, 92274688, s38
    s_add_u32 s35, s35, 1
    s_lshr_b32 s27, s35, 3
    s_lshl_b32 s27, s27, 22
    s_and_b32 s28, s35, 7
    s_lshl_b32 s28, s28, 18
    s_add_u32 s27, s27, s28
    s_branch CF_Q_LOOP
CF_QP_R1:
    buffer_load_dwordx4 v[12:15], v3, s[8:11], s36 offen offset:1024 sc1
    buffer_load_dwordx4 v[16:19], v3, s[8:11], s36 offen offset:2048 sc1
    buffer_load_dwordx4 v[20:23], v3, s[8:11], s36 offen offset:3072 sc1
    s_add_u32 s44, s44, 1
    s_cmp_gt_u32 s44, 60000
    s_cbranch_scc1 C_DONE
    s_waitcnt vmcnt(2)
    v_max3_u32 v5, v12, v13, v14
    v_max_u32 v5, v5, v15
    v_cmp_eq_u32 vcc, -1, v5
    s_cbranch_vccnz CF_QP_R1
    s_branch CF_QP_B1
CF_QP_R2:
    buffer_load_dwordx4 v[16:19], v3, s[8:11], s36 offen offset:2048 sc1
    buffer_load_dwordx4 v[20:23], v3, s[8:11], s36 offen offset:3072 sc1
    s_add_u32 s44, s44, 1
    s_cmp_gt_u32 s44, 60000
    s_cbranch_scc1 C_DONE
    s_waitcnt vmcnt(1)
    v_max3_u32 v5, v16, v17, v18
    v_max_u32 v5, v5, v19
    v_cmp_eq_u32 vcc, -1, v5
    s_cbranch_vccnz CF_QP_R2
    s_branch CF_QP_B2
CF_QP_R3:
    buffer_load_dwordx4 v[20:23], v3, s[8:11], s36 offen offset:3072 sc1
    s_add_u32 s44, s44, 1
    s_cmp_gt_u32 s44, 60000
    s_cbranch_scc1 C_DONE
    s_waitcnt vmcnt(0)
    v_max3_u32 v5, v20, v21, v22
    v_max_u32 v5, v5, v23
    v_cmp_eq_u32 vcc, -1, v5
    s_cbranch_vccnz CF_QP_R3
    s_branch CF_QP_B3
CF_WO:
    v_lshrrev_b32 v6, 4, v0
    v_lshlrev_b32 v6, 7, v6
    v_and_b32 v7, 7, v0
    v_lshl_add_u32 v6, v7, 4, v6
    v_lshrrev_b32 v7, 5, v0
    v_lshlrev_b32 v7, 8, v7
    v_and_b32 v8, 15, v0
    v_lshl_add_u32 v7, v8, 4, v7
    v_bfe_u32 v8, v0, 4, 1
    v_lshl_add_u32 v7, v8, 3, v7
    s_xor_b32 s45, s47, 2
    s_lshl_b32 s45, s45, 9
    v_add_u32 v6, s45, v6
    s_xor_b32 s45, s47, 8
    s_lshl_b32 s45, s45, 9
    v_add_u32 v7, s45, v7
    s_lshl_b32 s45, s32, 10
    s_lshr_b32 s46, s33, 1
    s_lshl_b32 s46, s46, 14
    s_add_u32 s45, s45, s46
    s_and_b32 s46, s33, 1
    s_lshl_b32 s46, s46, 12
    s_add_u32 s45, s45, s46
    s_add_u32 s45, s45, 134217728
    v_add_u32 v8, s45, v2
    s_mul_i32 s45, s47, 1280
    s_add_u32 s45, s45, 131072
    v_add_u32 v9, s45, v2
    v_mov_b32 v12, -1
    v_mov_b32 v13, -1
    v_mov_b32 v14, -1
    v_mov_b32 v15, -1
    s_cmp_lg_u32 s34, 4
    s_cbranch_scc1 CF_NI
    s_mov_b32 s46, 92274688
    buffer_store_dwordx4 v[12:15], v9, s[8:11], s46 offen
    buffer_store_dwordx2 v[12:13], v7, s[8:11], s46 offen offset:0
    s_add_u32 s45, s46, 65536
    buffer_store_dwordx2 v[12:13], v7, s[8:11], s45 offen
    s_mov_b64 exec, 0xffff
    buffer_store_dwordx4 v[12:15], v9, s[8:11], s46 offen offset:1024
    s_mov_b64 exec, -1
    s_mov_b32 s46, 92798976
    buffer_store_dwordx4 v[12:15], v9, s[8:11], s46 offen
    buffer_store_dwordx2 v[12:13], v7, s[8:11], s46 offen offset:0
    s_add_u32 s45, s46, 65536
    buffer_store_dwordx2 v[12:13], v7, s[8:11], s45 offen
    s_mov_b64 exec, 0xffff
    buffer_store_dwordx4 v[12:15], v9, s[8:11], s46 offen offset:1024
    s_mov_b64 exec, -1
    s_mov_b32 s46, 93323264
    buffer_store_dwordx4 v[12:15], v9, s[8:11], s46 offen
    buffer_store_dwordx2 v[12:13], v7, s[8:11], s46 offen offset:0
    s_add_u32 s45, s46, 65536
    buffer_store_dwordx2 v[12:13], v7, s[8:11], s45 offen
    s_mov_b64 exec, 0xffff
    buffer_store_dwordx4 v[12:15], v9, s[8:11], s46 offen offset:1024
    s_mov_b64 exec, -1
    s_mov_b32 s46, 93847552
    buffer_store_dwordx4 v[12:15], v9, s[8:11], s46 offen
    buffer_store_dwordx2 v[12:13], v7, s[8:11], s46 offen offset:0
    s_add_u32 s45, s46, 65536
    buffer_store_dwordx2 v[12:13], v7, s[8:11], s45 offen
    s_mov_b64 exec, 0xffff
    buffer_store_dwordx4 v[12:15], v9, s[8:11], s46 offen offset:1024
    s_mov_b64 exec, -1
    s_mov_b32 s12, s62
    s_and_b32 s13, s63, 0xffff
    s_mov_b32 s14, 0x4000
    s_mov_b32 s15, 0x20000
    v_and_b32 v10, 7, v0
    v_lshlrev_b32 v10, 11, v10
    v_lshrrev_b32 v11, 4, v0
    v_lshl_add_u32 v10, v11, 4, v10
    v_bfe_u32 v11, v0, 3, 1
    v_lshl_add_u32 v10, v11, 3, v10
    s_lshl_b32 s45, s33, 6
    buffer_load_dwordx2 v[16:17], v10, s[12:15], s45 offen
CF_NI:
    s_cmp_lg_u32 s34, 7
    s_cbranch_scc1 CF_NOPROBE0
    s_and_b32 s96, s47, 7
    s_lshl_b32 s96, s96, 9
    s_lshr_b32 s97, s47, 3
    s_lshl_b32 s97, s97, 14
    s_add_u32 s96, s96, s97
    s_add_u32 s96, s96, 167772160
    v_and_b32 v26, 3, v0
    v_lshlrev_b32 v26, 12, v26
    v_bfe_u32 v27, v0, 2, 2
    v_lshl_add_u32 v26, v27, 7, v26
    s_mov_b64 exec, 0xffff
    buffer_store_dword v26, v26, s[8:11], s96 offen sc1
    s_mov_b64 exec, -1
CF_NOPROBE0:
    s_barrier
    s_cmp_lg_u32 s34, 7
    s_cbranch_scc1 CF_NOPROBE1
    s_and_b32 s96, s47, 7
    s_lshl_b32 s96, s96, 9
    s_lshr_b32 s97, s47, 3
    s_lshl_b32 s97, s97, 14
    s_add_u32 s96, s96, s97
    s_add_u32 s96, s96, 167772160
    s_waitcnt vmcnt(0)
    s_add_u32 s96, s84, s96
    s_addc_u32 s97, s85, 0
    s_load_dword s92, s[96:97], 0x40
    s_load_dword s92, s[96:97], 0x1040
    s_load_dword s92, s[96:97], 0x2040
    s_load_dword s92, s[96:97], 0x3040
    s_mov_b32 s94, -1
    s_mov_b32 s95, -1
    s_waitcnt lgkmcnt(0)
    s_memtime s[90:91]
    s_waitcnt lgkmcnt(0)
    s_load_dword s92, s[96:97], 0x80
    s_waitcnt lgkmcnt(0)
    s_memtime s[92:93]
    s_waitcnt lgkmcnt(0)
    s_sub_u32 s92, s92, s90
    s_min_u32 s94, s94, s92
    s_memtime s[90:91]
    s_waitcnt lgkmcnt(0)
    s_load_dword s92, s[96:97], 0x2080
    s_waitcnt lgkmcnt(0)
    s_memtime s[92:93]
    s_waitcnt lgkmcnt(0)
    s_sub_u32 s92, s92, s90
    s_min_u32 s95, s95, s92
    s_memtime s[90:91]
    s_waitcnt lgkmcnt(0)
    s_load_dword s92, s[96:97], 0x3080
    s_waitcnt lgkmcnt(0)
    s_memtime s[92:93]
    s_waitcnt lgkmcnt(0)
    s_sub_u32 s92, s92, s90
    s_min_u32 s95, s95, s92
    s_memtime s[90:91]
    s_waitcnt lgkmcnt(0)
    s_load_dword s92, s[96:97], 0x1080
    s_waitcnt lgkmcnt(0)
    s_memtime s[92:93]
    s_waitcnt lgkmcnt(0)
    s_sub_u32 s92, s92, s90
    s_min_u32 s94, s94, s92
    s_memtime s[90:91]
    s_waitcnt lgkmcnt(0)
    s_load_dword s92, s[96:97], 0x100
    s_waitcnt lgkmcnt(0)
    s_memtime s[92:93]
    s_waitcnt lgkmcnt(0)
    s_sub_u32 s92, s92, s90
    s_min_u32 s94, s94, s92
    s_memtime s[90:91]
    s_waitcnt lgkmcnt(0)
    s_load_dword s92, s[96:97], 0x2100
    s_waitcnt lgkmcnt(0)
    s_memtime s[92:93]
    s_waitcnt lgkmcnt(0)
    s_sub_u32 s92, s92, s90
    s_min_u32 s95, s95, s92
    s_memtime s[90:91]
    s_waitcnt lgkmcnt(0)
    s_load_dword s92, s[96:97], 0x3100
    s_waitcnt lgkmcnt(0)
    s_memtime s[92:93]
    s_waitcnt lgkmcnt(0)
    s_sub_u32 s92, s92, s90
    s_min_u32 s95, s95, s92
    s_memtime s[90:91]
    s_waitcnt lgkmcnt(0)
    s_load_dword s92, s[96:97], 0x1100
    s_waitcnt lgkmcnt(0)
    s_memtime s[92:93]
    s_waitcnt lgkmcnt(0)
    s_sub_u32 s92, s92, s90
    s_min_u32 s94, s94, s92
    s_cmp_lt_u32 s95, s94
    s_cselect_b32 s29, 1, 0
    s_getreg_b32 s90, hwreg(HW_REG_XCC_ID)
    s_and_b32 s90, s90, 7
    s_lshl_b32 s91, s90, 2
    s_lshr_b32 s90, 0x73625140, s91
    s_and_b32 s90, s90, 7
    s_lshl_b32 s90, s90, 2
    s_add_u32 s90, s90, 64
    s_lshl_b32 s29, s29, 8
    s_add_u32 s29, s29, 1
    s_atomic_add s29, s[82:83], s90
CF_NOPROBE1:
    s_cmp_lg_u32 s34, 4
    s_cbranch_scc1 CLCF_
    s_bitcmp1_b32 s2, 30
    s_cbranch_scc1 CLCF_
    s_getreg_b32 s40, hwreg(HW_REG_XCC_ID)
    s_and_b32 s40, s40, 7
    s_lshl_b32 s41, s40, 2
    s_lshr_b32 s40, 0x73625140, s41
    s_and_b32 s40, s40, 7
    s_lshl_b32 s40, s40, 3
    s_bitset1_b32 s2, 30
    s_waitcnt vmcnt(0)
    s_atomic_add_x2 s[72:73], s[82:83], s40 glc
CLCF_:
    s_lshl_b32 s48, s32, 21
    s_sub_u32 s45, s34, 4
    s_lshl_b32 s45, s45, 19
    s_add_u32 s48, s48, s45
    s_lshl_b32 s45, s33, 6
    s_add_u32 s48, s48, s45
    s_mov_b32 s12, s70
    s_and_b32 s13, s71, 0xffff
    s_mov_b32 s14, 0x800000
    s_mov_b32 s15, 0x20000
    v_lshrrev_b32 v20, 2, v0
    s_mov_b32 s45, 2048
    v_mul_lo_u32 v20, v20, s45
    v_and_b32 v22, 3, v0
    v_lshl_add_u32 v20, v22, 4, v20
    s_mov_b32 s46, s48
    buffer_load_dwordx4 v[192:195], v20, s[12:15], s46 offen
    s_add_u32 s46, s46, 32768
    buffer_load_dwordx4 v[196:199], v20, s[12:15], s46 offen
    s_add_u32 s46, s46, 32768
    buffer_load_dwordx4 v[200:203], v20, s[12:15], s46 offen
    s_add_u32 s46, s46, 32768
    buffer_load_dwordx4 v[204:207], v20, s[12:15], s46 offen
    s_add_u32 s46, s46, 32768
    buffer_load_dwordx4 v[208:211], v20, s[12:15], s46 offen
    s_add_u32 s46, s46, 32768
    buffer_load_dwordx4 v[212:215], v20, s[12:15], s46 offen
    s_add_u32 s46, s46, 32768
    buffer_load_dwordx4 v[216:219], v20, s[12:15], s46 offen
    s_add_u32 s46, s46, 32768
    buffer_load_dwordx4 v[220:223], v20, s[12:15], s46 offen
    s_add_u32 s46, s46, 32768
    buffer_load_dwordx4 v[224:227], v20, s[12:15], s46 offen
    s_add_u32 s46, s46, 32768
    buffer_load_dwordx4 v[228:231], v20, s[12:15], s46 offen
    s_add_u32 s46, s46, 32768
    buffer_load_dwordx4 v[232:235], v20, s[12:15], s46 offen
    s_add_u32 s46, s46, 32768
    buffer_load_dwordx4 v[236:239], v20, s[12:15], s46 offen
    s_add_u32 s46, s46, 32768
    buffer_load_dwordx4 v[240:243], v20, s[12:15], s46 offen
    s_add_u32 s46, s46, 32768
    buffer_load_dwordx4 v[244:247], v20, s[12:15], s46 offen
    s_add_u32 s46, s46, 32768
    buffer_load_dwordx4 v[248:251], v20, s[12:15], s46 offen
    s_add_u32 s46, s46, 32768
    buffer_load_dwordx4 v[252:255], v20, s[12:15], s46 offen
    s_lshl_b32 s45, s34, 14
    v_lshlrev_b32 v21, 4, v0
    v_add_u32 v21, s45, v21
    v_lshrrev_b32 v20, 4, v0
    v_lshlrev_b32 v20, 9, v20
    v_bfe_u32 v22, v0, 2, 2
    v_lshl_add_u32 v20, v22, 6, v20
    v_and_b32 v22, 3, v0
    v_lshl_add_u32 v20, v22, 4, v20
    v_add_u32 v20, s45, v20
    s_waitcnt vmcnt(0)
    ds_write_b128 v21, v[192:195] offset:0
    ds_write_b128 v21, v[196:199] offset:1024
    ds_write_b128 v21, v[200:203] offset:2048
    ds_write_b128 v21, v[204:207] offset:3072
    ds_write_b128 v21, v[208:211] offset:4096
    ds_write_b128 v21, v[212:215] offset:5120
    ds_write_b128 v21, v[216:219] offset:6144
    ds_write_b128 v21, v[220:223] offset:7168
    ds_write_b128 v21, v[224:227] offset:8192
    ds_write_b128 v21, v[228:231] offset:9216
    ds_write_b128 v21, v[232:235] offset:10240
    ds_write_b128 v21, v[236:239] offset:11264
    ds_write_b128 v21, v[240:243] offset:12288
    ds_write_b128 v21, v[244:247] offset:13312
    ds_write_b128 v21, v[248:251] offset:14336
    ds_write_b128 v21, v[252:255] offset:15360
    s_waitcnt lgkmcnt(0)
    ds_read_b64_tr_b16 v[192:193], v20 offset:0
    ds_read_b64_tr_b16 v[194:195], v20 offset:256
    ds_read_b64_tr_b16 v[196:197], v20 offset:8
    ds_read_b64_tr_b16 v[198:199], v20 offset:264
    ds_read_b64_tr_b16 v[200:201], v20 offset:2048
    ds_read_b64_tr_b16 v[202:203], v20 offset:2304
    ds_read_b64_tr_b16 v[204:205], v20 offset:2056
    ds_read_b64_tr_b16 v[206:207], v20 offset:2312
    s_waitcnt lgkmcnt(0)
    ds_read_b64_tr_b16 v[208:209], v20 offset:4096
    ds_read_b64_tr_b16 v[210:211], v20 offset:4352
    ds_read_b64_tr_b16 v[212:213], v20 offset:4104
    ds_read_b64_tr_b16 v[214:215], v20 offset:4360
    ds_read_b64_tr_b16 v[216:217], v20 offset:6144
    ds_read_b64_tr_b16 v[218:219], v20 offset:6400
    ds_read_b64_tr_b16 v[220:221], v20 offset:6152
    ds_read_b64_tr_b16 v[222:223], v20 offset:6408
    s_waitcnt lgkmcnt(0)
    ds_read_b64_tr_b16 v[224:225], v20 offset:8192
    ds_read_b64_tr_b16 v[226:227], v20 offset:8448
    ds_read_b64_tr_b16 v[228:229], v20 offset:8200
    ds_read_b64_tr_b16 v[230:231], v20 offset:8456
    ds_read_b64_tr_b16 v[232:233], v20 offset:10240
    ds_read_b64_tr_b16 v[234:235], v20 offset:10496
    ds_read_b64_tr_b16 v[236:237], v20 offset:10248
    ds_read_b64_tr_b16 v[238:239], v20 offset:10504
    s_waitcnt lgkmcnt(0)
    ds_read_b64_tr_b16 v[240:241], v20 offset:12288
    ds_read_b64_tr_b16 v[242:243], v20 offset:12544
    ds_read_b64_tr_b16 v[244:245], v20 offset:12296
    ds_read_b64_tr_b16 v[246:247], v20 offset:12552
    ds_read_b64_tr_b16 v[248:249], v20 offset:14336
    ds_read_b64_tr_b16 v[250:251], v20 offset:14592
    ds_read_b64_tr_b16 v[252:253], v20 offset:14344
    ds_read_b64_tr_b16 v[254:255], v20 offset:14600
    s_waitcnt lgkmcnt(0)
    s_cmp_lg_u32 s34, 4
    s_cbranch_scc1 VCF__DONE
    s_bitcmp1_b32 s2, 31
    s_cbranch_scc1 VCF__DONE
    s_getreg_b32 s86, hwreg(HW_REG_XCC_ID)
    s_and_b32 s86, s86, 7
    s_lshl_b32 s92, s86, 2
    s_lshr_b32 s86, 0x73625140, s92
    s_and_b32 s86, s86, 7
    v_and_b32 v42, 15, v0
    v_lshlrev_b32 v42, 2, v42
    s_mov_b32 s93, 0
VCF__POLL:
    global_load_dword v43, v42, s[82:83] sc1
    s_add_u32 s93, s93, 1
    s_cmp_gt_u32 s93, 60000
    s_cbranch_scc1 C_DONE
    s_mov_b32 s88, 0
    s_mov_b32 s89, 0
    s_mov_b32 s90, 0
    s_mov_b32 s91, 0
    s_waitcnt vmcnt(0)
    v_readlane_b32 s92, v43, 1
    s_cmp_lg_u32 s92, 0x2000
    s_cselect_b32 s91, 1, s91
    s_lshr_b32 s92, s92, 8
    s_add_u32 s88, s88, s92
    s_cmp_lg_u32 s92, 32
    s_cselect_b32 s90, 1, s90
    s_cmp_gt_u32 s86, 0
    s_cselect_b32 s92, s92, 0
    s_add_u32 s89, s89, s92
    v_readlane_b32 s92, v43, 0
    s_cmp_lg_u32 s92, -1
    s_cselect_b32 s91, 1, s91
    v_readlane_b32 s92, v43, 3
    s_cmp_lg_u32 s92, 0x2000
    s_cselect_b32 s91, 1, s91
    s_lshr_b32 s92, s92, 8
    s_add_u32 s88, s88, s92
    s_cmp_lg_u32 s92, 32
    s_cselect_b32 s90, 1, s90
    s_cmp_gt_u32 s86, 1
    s_cselect_b32 s92, s92, 0
    s_add_u32 s89, s89, s92
    v_readlane_b32 s92, v43, 2
    s_cmp_lg_u32 s92, -1
    s_cselect_b32 s91, 1, s91
    v_readlane_b32 s92, v43, 5
    s_cmp_lg_u32 s92, 0x2000
    s_cselect_b32 s91, 1, s91
    s_lshr_b32 s92, s92, 8
    s_add_u32 s88, s88, s92
    s_cmp_lg_u32 s92, 32
    s_cselect_b32 s90, 1, s90
    s_cmp_gt_u32 s86, 2
    s_cselect_b32 s92, s92, 0
    s_add_u32 s89, s89, s92
    v_readlane_b32 s92, v43, 4
    s_cmp_lg_u32 s92, -1
    s_cselect_b32 s91, 1, s91
    v_readlane_b32 s92, v43, 7
    s_cmp_lg_u32 s92, 0x2000
    s_cselect_b32 s91, 1, s91
    s_lshr_b32 s92, s92, 8
    s_add_u32 s88, s88, s92
    s_cmp_lg_u32 s92, 32
    s_cselect_b32 s90, 1, s90
    s_cmp_gt_u32 s86, 3
    s_cselect_b32 s92, s92, 0
    s_add_u32 s89, s89, s92
    v_readlane_b32 s92, v43, 6
    s_cmp_lg_u32 s92, -1
    s_cselect_b32 s91, 1, s91
    v_readlane_b32 s92, v43, 9
    s_cmp_lg_u32 s92, 0x2000
    s_cselect_b32 s91, 1, s91
    s_lshr_b32 s92, s92, 8
    s_add_u32 s88, s88, s92
    s_cmp_lg_u32 s92, 32
    s_cselect_b32 s90, 1, s90
    s_cmp_gt_u32 s86, 4
    s_cselect_b32 s92, s92, 0
    s_add_u32 s89, s89, s92
    v_readlane_b32 s92, v43, 8
    s_cmp_lg_u32 s92, -1
    s_cselect_b32 s91, 1, s91
    v_readlane_b32 s92, v43, 11
    s_cmp_lg_u32 s92, 0x2000
    s_cselect_b32 s91, 1, s91
    s_lshr_b32 s92, s92, 8
    s_add_u32 s88, s88, s92
    s_cmp_lg_u32 s92, 32
    s_cselect_b32 s90, 1, s90
    s_cmp_gt_u32 s86, 5
    s_cselect_b32 s92, s92, 0
    s_add_u32 s89, s89, s92
    v_readlane_b32 s92, v43, 10
    s_cmp_lg_u32 s92, -1
    s_cselect_b32 s91, 1, s91
    v_readlane_b32 s92, v43, 13
    s_cmp_lg_u32 s92, 0x2000
    s_cselect_b32 s91, 1, s91
    s_lshr_b32 s92, s92, 8
    s_add_u32 s88, s88, s92
    s_cmp_lg_u32 s92, 32
    s_cselect_b32 s90, 1, s90
    s_cmp_gt_u32 s86, 6
    s_cselect_b32 s92, s92, 0
    s_add_u32 s89, s89, s92
    v_readlane_b32 s92, v43, 12
    s_cmp_lg_u32 s92, -1
    s_cselect_b32 s91, 1, s91
    v_readlane_b32 s92, v43, 15
    s_cmp_lg_u32 s92, 0x2000
    s_cselect_b32 s91, 1, s91
    s_lshr_b32 s92, s92, 8
    s_add_u32 s88, s88, s92
    s_cmp_lg_u32 s92, 32
    s_cselect_b32 s90, 1, s90
    s_cmp_gt_u32 s86, 7
    s_cselect_b32 s92, s92, 0
    s_add_u32 s89, s89, s92
    v_readlane_b32 s92, v43, 14
    s_cmp_lg_u32 s92, -1
    s_cselect_b32 s91, 1, s91
    s_cmp_lg_u32 s88, 256
    s_cbranch_scc1 VCF__POLL
    s_waitcnt lgkmcnt(0)
    s_lshr_b32 s87, s73, 8
    s_add_u32 s89, s89, s87
    s_lshl_b32 s92, s90, 8
    s_or_b32 s89, s89, s92
    s_or_b32 s89, s89, 0x8000
    s_or_b32 s91, s91, s90
    s_cselect_b32 s89, s89, 0
    v_mov_b32 v42, 147456
    v_mov_b32 v43, s89
    ds_write_b32 v42, v43
    s_waitcnt lgkmcnt(0)
VCF__DONE:
    s_barrier
    s_bitcmp1_b32 s2, 31
    s_cbranch_scc1 VDCF_4_OK
    v_mov_b32 v4, 147456
    ds_read_b32 v5, v4
    s_bitset1_b32 s2, 31
    s_waitcnt lgkmcnt(0)
    v_readfirstlane_b32 s40, v5
    s_cmp_lg_u32 s40, 0
    s_cbranch_scc1 R_RESTART
VDCF_4_OK:
    s_mov_b32 s40, 0x00ff00ff
    s_mov_b32 s41, 0x00ff00ff
    s_lshl_b32 s45, s32, 14
    s_sub_u32 s46, s34, 4
    s_lshl_b32 s46, s46, 12
    s_add_u32 s45, s45, s46
    s_add_u32 s45, s45, 65536
    v_add_u32 v3, s45, v1
    s_sub_u32 s45, s34, 4
    s_lshl_b32 s45, s45, 10
    v_add_u32 v4, s45, v2
    v_mov_b32 v48, 0
    v_mov_b32 v49, 0
    v_mov_b32 v50, 0
    v_mov_b32 v51, 0
    v_mov_b32 v52, 0
    v_mov_b32 v53, 0
    v_mov_b32 v54, 0
    v_mov_b32 v55, 0
    s_cmp_eq_u32 s34, 4
    s_cbranch_scc1 CF_W4
    s_cmp_eq_u32 s34, 5
    s_cbranch_scc1 CF_W5
    s_cmp_eq_u32 s34, 6
    s_cbranch_scc1 CF_W6
    s_lshl_b32 s45, s47, 18
    s_add_u32 s45, s45, 4096
    s_add_u32 s22, s84, s45
    s_addc_u32 s23, s85, 0
    s_setprio 2
    s_barrier
CF_W7_LOOP:
    s_add_u32 s45, s35, 2
    s_lshl_b32 s45, s45, 4
    s_and_b32 s45, s45, 0x380
    s_add_u32 s45, s45, 98566144
    s_load_dword s31, s[84:85], s45
    s_sleep 3
    s_cmp_ge_u32 s35, 63
    s_cbranch_scc1 CF_NWk0
    s_load_dword s20, s[22:23], 0x0
    s_load_dword s20, s[22:23], 0x40
    s_load_dword s20, s[22:23], 0x80
    s_load_dword s20, s[22:23], 0xc0
    s_load_dword s20, s[22:23], 0x100
    s_load_dword s20, s[22:23], 0x140
    s_load_dword s20, s[22:23], 0x180
    s_load_dword s20, s[22:23], 0x1c0
    s_load_dword s20, s[22:23], 0x200
    s_load_dword s20, s[22:23], 0x240
    s_load_dword s20, s[22:23], 0x280
CF_NWk0:
    s_barrier
    s_barrier
    buffer_store_dwordx4 v[12:15], v9, s[8:11], s38 offen
    buffer_store_dwordx2 v[12:13], v7, s[8:11], s38 offen offset:0
    s_add_u32 s45, s38, 65536
    buffer_store_dwordx2 v[12:13], v7, s[8:11], s45 offen
    s_mov_b64 exec, 0xffff
    buffer_store_dwordx4 v[12:15], v9, s[8:11], s38 offen offset:1024
    s_mov_b64 exec, -1
    s_cmp_eq_u32 s35, 63
    s_cbranch_scc1 C_FIN
    s_cmp_ge_u32 s35, 63
    s_cbranch_scc1 CF_NWk1
    s_load_dword s20, s[22:23], 0x2c0
    s_load_dword s20, s[22:23], 0x300
    s_load_dword s20, s[22:23], 0x340
    s_load_dword s20, s[22:23], 0x380
    s_load_dword s20, s[22:23], 0x3c0
    s_load_dword s20, s[22:23], 0x400
    s_load_dword s20, s[22:23], 0x440
    s_load_dword s20, s[22:23], 0x480
    s_load_dword s20, s[22:23], 0x4c0
    s_load_dword s20, s[22:23], 0x500
    s_load_dword s20, s[22:23], 0x540
    s_add_u32 s22, s22, 4096
    s_addc_u32 s23, s23, 0
CF_NWk1:
    s_barrier
    s_sleep 2
    s_mov_b32 s44, 0
CF_OP7_R0:
    buffer_load_dwordx4 v[16:19], v3, s[8:11], s36 offen offset:0 sc1
    buffer_load_dwordx4 v[20:23], v3, s[8:11], s36 offen offset:1024 sc1
    buffer_load_dwordx4 v[24:27], v3, s[8:11], s36 offen offset:2048 sc1
    buffer_load_dwordx4 v[28:31], v3, s[8:11], s36 offen offset:3072 sc1
    s_add_u32 s44, s44, 1
    s_cmp_gt_u32 s44, 60000
    s_cbranch_scc1 C_DONE
    s_waitcnt vmcnt(3)
    v_max3_u32 v5, v16, v17, v18
    v_max_u32 v5, v5, v19
    v_cmp_eq_u32 vcc, -1, v5
    s_cbranch_vccnz CF_OP7_R0
    v_mfma_f32_16x16x32_bf16 v[48:51], v[192:195], v[16:19], v[48:51]
    v_mov_b32_dpp v32, v16 row_ror:8 row_mask:0xf bank_mask:0xf
    v_mov_b32_dpp v33, v17 row_ror:8 row_mask:0xf bank_mask:0xf
    v_mov_b32_dpp v34, v18 row_ror:8 row_mask:0xf bank_mask:0xf
    v_mov_b32_dpp v35, v19 row_ror:8 row_mask:0xf bank_mask:0xf
    s_waitcnt vmcnt(2)
    v_mfma_f32_16x16x32_bf16 v[52:55], v[204:207], v[16:19], v[52:55]
    v_max3_u32 v5, v20, v21, v22
    v_mfma_f32_16x16x32_bf16 v[48:51], v[200:203], v[32:35], v[48:51]
    v_max_u32 v5, v5, v23
    v_cmp_eq_u32 vcc, -1, v5
    v_mfma_f32_16x16x32_bf16 v[52:55], v[196:199], v[32:35], v[52:55]
    s_cbranch_vccnz CF_OP7_R1
CF_OP7_B1:
    v_mfma_f32_16x16x32_bf16 v[48:51], v[208:211], v[20:23], v[48:51]
    v_mov_b32_dpp v32, v20 row_ror:8 row_mask:0xf bank_mask:0xf
    v_mov_b32_dpp v33, v21 row_ror:8 row_mask:0xf bank_mask:0xf
    v_mov_b32_dpp v34, v22 row_ror:8 row_mask:0xf bank_mask:0xf
    v_mov_b32_dpp v35, v23 row_ror:8 row_mask:0xf bank_mask:0xf
    s_waitcnt vmcnt(1)
    v_mfma_f32_16x16x32_bf16 v[52:55], v[220:223], v[20:23], v[52:55]
    v_max3_u32 v5, v24, v25, v26
    v_mfma_f32_16x16x32_bf16 v[48:51], v[216:219], v[32:35], v[48:51]
    v_max_u32 v5, v5, v27
    v_cmp_eq_u32 vcc, -1, v5
    v_mfma_f32_16x16x32_bf16 v[52:55], v[212:215], v[32:35], v[52:55]
    s_cbranch_vccnz CF_OP7_R2
CF_OP7_B2:
    v_mfma_f32_16x16x32_bf16 v[48:51], v[224:227], v[24:27], v[48:51]
    v_mov_b32_dpp v32, v24 row_ror:8 row_mask:0xf bank_mask:0xf
    v_mov_b32_dpp v33, v25 row_ror:8 row_mask:0xf bank_mask:0xf
    v_mov_b32_dpp v34, v26 row_ror:8 row_mask:0xf bank_mask:0xf
    v_mov_b32_dpp v35, v27 row_ror:8 row_mask:0xf bank_mask:0xf
    s_waitcnt vmcnt(0)
    v_mfma_f32_16x16x32_bf16 v[52:55], v[236:239], v[24:27], v[52:55]
    v_max3_u32 v5, v28, v29, v30
    v_mfma_f32_16x16x32_bf16 v[48:51], v[232:235], v[32:35], v[48:51]
    v_max_u32 v5, v5, v31
    v_cmp_eq_u32 vcc, -1, v5
    v_mfma_f32_16x16x32_bf16 v[52:55], v[228:231], v[32:35], v[52:55]
    s_cbranch_vccnz CF_OP7_R3
CF_OP7_B3:
    v_mfma_f32_16x16x32_bf16 v[48:51], v[240:243], v[28:31], v[48:51]
    v_mov_b32_dpp v32, v28 row_ror:8 row_mask:0xf bank_mask:0xf
    v_mov_b32_dpp v33, v29 row_ror:8 row_mask:0xf bank_mask:0xf
    v_mov_b32_dpp v34, v30 row_ror:8 row_mask:0xf bank_mask:0xf
    v_mov_b32_dpp v35, v31 row_ror:8 row_mask:0xf bank_mask:0xf
    v_mfma_f32_16x16x32_bf16 v[52:55], v[252:255], v[28:31], v[52:55]
    s_nop 0
    v_mfma_f32_16x16x32_bf16 v[48:51], v[248:251], v[32:35], v[48:51]
    v_mfma_f32_16x16x32_bf16 v[52:55], v[244:247], v[32:35], v[52:55]
    s_nop 7
    v_cndmask_b32 v48, v52, v48, s[40:41]
    v_cndmask_b32 v49, v53, v49, s[40:41]
    v_cndmask_b32 v50, v54, v50, s[40:41]
    v_cndmask_b32 v51, v55, v51, s[40:41]
    ds_write_b128 v4, v[48:51] offset:16384
    s_waitcnt lgkmcnt(0)
    s_barrier
    s_add_u32 s45, s35, 2
    s_and_b32 s46, s45, 0x47
    s_cbranch_scc1 CF_W7_NG
    s_cmp_eq_u32 s31, 64
    s_cbranch_scc1 CF_W7_NG
    s_lshl_b32 s45, s45, 4
    s_add_u32 s45, s45, 98566144
    s_mov_b32 s44, 0
CF_W7_G:
    buffer_load_dword v5, off, s[8:11], s45 sc1
    s_add_u32 s44, s44, 1
    s_cmp_gt_u32 s44, 60000
    s_cbranch_scc1 C_DONE
    s_waitcnt vmcnt(0)
    v_cmp_eq_u32 vcc, 64, v5
    s_cbranch_vccnz CF_W7_G_OK
    s_sleep 8
    s_branch CF_W7_G
CF_W7_G_OK:
CF_W7_NG:
    v_mov_b32 v48, 0
    v_mov_b32 v49, 0
    v_mov_b32 v50, 0
    v_mov_b32 v51, 0
    v_mov_b32 v52, 0
    v_mov_b32 v53, 0
    v_mov_b32 v54, 0
    v_mov_b32 v55, 0
    s_mov_b32 s36, s37
    s_mov_b32 s37, s38
    s_add_u32 s38, s38, 524288
    s_cmp_eq_u32 s38, 94371840
    s_cselect_b32 s38, 92274688, s38
    s_add_u32 s35, s35, 1
    s_lshr_b32 s27, s35, 3
    s_lshl_b32 s27, s27, 22
    s_and_b32 s28, s35, 7
    s_lshl_b32 s28, s28, 18
    s_add_u32 s27, s27, s28
    s_barrier
    s_branch CF_W7_LOOP
CF_OP7_R1:
    buffer_load_dwordx4 v[20:23], v3, s[8:11], s36 offen offset:1024 sc1
    buffer_load_dwordx4 v[24:27], v3, s[8:11], s36 offen offset:2048 sc1
    buffer_load_dwordx4 v[28:31], v3, s[8:11], s36 offen offset:3072 sc1
    s_add_u32 s44, s44, 1
    s_cmp_gt_u32 s44, 60000
    s_cbranch_scc1 C_DONE
    s_waitcnt vmcnt(2)
    v_max3_u32 v5, v20, v21, v22
    v_max_u32 v5, v5, v23
    v_cmp_eq_u32 vcc, -1, v5
    s_cbranch_vccnz CF_OP7_R1
    s_branch CF_OP7_B1
CF_OP7_R2:
    buffer_load_dwordx4 v[24:27], v3, s[8:11], s36 offen offset:2048 sc1
    buffer_load_dwordx4 v[28:31], v3, s[8:11], s36 offen offset:3072 sc1
    s_add_u32 s44, s44, 1
    s_cmp_gt_u32 s44, 60000
    s_cbranch_scc1 C_DONE
    s_waitcnt vmcnt(1)
    v_max3_u32 v5, v24, v25, v26
    v_max_u32 v5, v5, v27
    v_cmp_eq_u32 vcc, -1, v5
    s_cbranch_vccnz CF_OP7_R2
    s_branch CF_OP7_B2
CF_OP7_R3:
    buffer_load_dwordx4 v[28:31], v3, s[8:11], s36 offen offset:3072 sc1
    s_add_u32 s44, s44, 1
    s_cmp_gt_u32 s44, 60000
    s_cbranch_scc1 C_DONE
    s_waitcnt vmcnt(0)
    v_max3_u32 v5, v28, v29, v30
    v_max_u32 v5, v5, v31
    v_cmp_eq_u32 vcc, -1, v5
    s_cbranch_vccnz CF_OP7_R3
    s_branch CF_OP7_B3
CF_W6:
    s_add_u32 s45, s32, 1
    s_and_b32 s45, s45, 3
    s_lshl_b32 s45, s45, 10
    s_lshr_b32 s46, s33, 1
    s_lshl_b32 s46, s46, 14
    s_add_u32 s45, s45, s46
    s_and_b32 s46, s33, 1
    s_lshl_b32 s46, s46, 12
    s_add_u32 s45, s45, s46
    s_add_u32 s45, s45, 134217728
    v_add_u32 v60, s45, v2
    s_add_u32 s45, s32, 2
    s_and_b32 s45, s45, 3
    s_lshl_b32 s45, s45, 10
    s_lshr_b32 s46, s33, 1
    s_lshl_b32 s46, s46, 14
    s_add_u32 s45, s45, s46
    s_and_b32 s46, s33, 1
    s_lshl_b32 s46, s46, 12
    s_add_u32 s45, s45, s46
    s_add_u32 s45, s45, 134217728
    v_add_u32 v61, s45, v2
    s_add_u32 s45, s32, 3
    s_and_b32 s45, s45, 3
    s_lshl_b32 s45, s45, 10
    s_lshr_b32 s46, s33, 1
    s_lshl_b32 s46, s46, 14
    s_add_u32 s45, s45, s46
    s_and_b32 s46, s33, 1
    s_lshl_b32 s46, s46, 12
    s_add_u32 s45, s45, s46
    s_add_u32 s45, s45, 134217728
    v_add_u32 v62, s45, v2
    s_lshl_b32 s45, s47, 18
    s_add_u32 s45, s45, 6912
    s_add_u32 s22, s84, s45
    s_addc_u32 s23, s85, 0
    s_setprio 2
    s_barrier
    v_mov_b32 v24, 131072
    ds_read_b32 v25, v24
    s_waitcnt lgkmcnt(0)
    v_add_u32 v60, v60, v25
    v_add_u32 v61, v61, v25
    v_add_u32 v62, v62, v25
CF_W6_LOOP:
    s_sleep 3
    s_cmp_ge_u32 s35, 63
    s_cbranch_scc1 CF_NWv10
    s_load_dword s20, s[22:23], 0x0
    s_load_dword s20, s[22:23], 0x40
    s_load_dword s20, s[22:23], 0x80
    s_load_dword s20, s[22:23], 0xc0
    s_load_dword s20, s[22:23], 0x100
    s_load_dword s20, s[22:23], 0x140
    s_load_dword s20, s[22:23], 0x180
    s_load_dword s20, s[22:23], 0x1c0
    s_load_dword s20, s[22:23], 0x200
    s_load_dword s20, s[22:23], 0x240
CF_NWv10:
    s_barrier
    s_barrier
    s_cmp_eq_u32 s35, 63
    s_cbranch_scc1 C_FIN
    s_cmp_ge_u32 s35, 63
    s_cbranch_scc1 CF_NWv11
    s_load_dword s20, s[22:23], 0x280
    s_load_dword s20, s[22:23], 0x2c0
    s_load_dword s20, s[22:23], 0x300
    s_load_dword s20, s[22:23], 0x340
    s_load_dword s20, s[22:23], 0x380
    s_load_dword s20, s[22:23], 0x3c0
    s_load_dword s20, s[22:23], 0x400
    s_load_dword s20, s[22:23], 0x440
    s_load_dword s20, s[22:23], 0x480
    s_load_dword s20, s[22:23], 0x4c0
    s_add_u32 s22, s22, 4096
    s_addc_u32 s23, s23, 0
CF_NWv11:
    s_barrier
    s_sleep 2
    s_mov_b32 s44, 0
CF_OP6_R0:
    buffer_load_dwordx4 v[16:19], v3, s[8:11], s36 offen offset:0 sc1
    buffer_load_dwordx4 v[20:23], v3, s[8:11], s36 offen offset:1024 sc1
    buffer_load_dwordx4 v[24:27], v3, s[8:11], s36 offen offset:2048 sc1
    buffer_load_dwordx4 v[28:31], v3, s[8:11], s36 offen offset:3072 sc1
    s_add_u32 s44, s44, 1
    s_cmp_gt_u32 s44, 60000
    s_cbranch_scc1 C_DONE
    s_waitcnt vmcnt(3)
    v_max3_u32 v5, v16, v17, v18
    v_max_u32 v5, v5, v19
    v_cmp_eq_u32 vcc, -1, v5
    s_cbranch_vccnz CF_OP6_R0
    v_mfma_f32_16x16x32_bf16 v[48:51], v[192:195], v[16:19], v[48:51]
    v_mov_b32_dpp v32, v16 row_ror:8 row_mask:0xf bank_mask:0xf
    v_mov_b32_dpp v33, v17 row_ror:8 row_mask:0xf bank_mask:0xf
    v_mov_b32_dpp v34, v18 row_ror:8 row_mask:0xf bank_mask:0xf
    v_mov_b32_dpp v35, v19 row_ror:8 row_mask:0xf bank_mask:0xf
    s_waitcnt vmcnt(2)
    v_mfma_f32_16x16x32_bf16 v[52:55], v[204:207], v[16:19], v[52:55]
    v_max3_u32 v5, v20, v21, v22
    v_mfma_f32_16x16x32_bf16 v[48:51], v[200:203], v[32:35], v[48:51]
    v_max_u32 v5, v5, v23
    v_cmp_eq_u32 vcc, -1, v5
    v_mfma_f32_16x16x32_bf16 v[52:55], v[196:199], v[32:35], v[52:55]
    s_cbranch_vccnz CF_OP6_R1
CF_OP6_B1:
    v_mfma_f32_16x16x32_bf16 v[48:51], v[208:211], v[20:23], v[48:51]
    v_mov_b32_dpp v32, v20 row_ror:8 row_mask:0xf bank_mask:0xf
    v_mov_b32_dpp v33, v21 row_ror:8 row_mask:0xf bank_mask:0xf
    v_mov_b32_dpp v34, v22 row_ror:8 row_mask:0xf bank_mask:0xf
    v_mov_b32_dpp v35, v23 row_ror:8 row_mask:0xf bank_mask:0xf
    s_waitcnt vmcnt(1)
    v_mfma_f32_16x16x32_bf16 v[52:55], v[220:223], v[20:23], v[52:55]
    v_max3_u32 v5, v24, v25, v26
    v_mfma_f32_16x16x32_bf16 v[48:51], v[216:219], v[32:35], v[48:51]
    v_max_u32 v5, v5, v27
    v_cmp_eq_u32 vcc, -1, v5
    v_mfma_f32_16x16x32_bf16 v[52:55], v[212:215], v[32:35], v[52:55]
    s_cbranch_vccnz CF_OP6_R2
CF_OP6_B2:
    v_mfma_f32_16x16x32_bf16 v[48:51], v[224:227], v[24:27], v[48:51]
    v_mov_b32_dpp v32, v24 row_ror:8 row_mask:0xf bank_mask:0xf
    v_mov_b32_dpp v33, v25 row_ror:8 row_mask:0xf bank_mask:0xf
    v_mov_b32_dpp v34, v26 row_ror:8 row_mask:0xf bank_mask:0xf
    v_mov_b32_dpp v35, v27 row_ror:8 row_mask:0xf bank_mask:0xf
    s_waitcnt vmcnt(0)
    v_mfma_f32_16x16x32_bf16 v[52:55], v[236:239], v[24:27], v[52:55]
    v_max3_u32 v5, v28, v29, v30
    v_mfma_f32_16x16x32_bf16 v[48:51], v[232:235], v[32:35], v[48:51]
    v_max_u32 v5, v5, v31
    v_cmp_eq_u32 vcc, -1, v5
    v_mfma_f32_16x16x32_bf16 v[52:55], v[228:231], v[32:35], v[52:55]
    s_cbranch_vccnz CF_OP6_R3
CF_OP6_B3:
    v_mfma_f32_16x16x32_bf16 v[48:51], v[240:243], v[28:31], v[48:51]
    v_mov_b32_dpp v32, v28 row_ror:8 row_mask:0xf bank_mask:0xf
    v_mov_b32_dpp v33, v29 row_ror:8 row_mask:0xf bank_mask:0xf
    v_mov_b32_dpp v34, v30 row_ror:8 row_mask:0xf bank_mask:0xf
    v_mov_b32_dpp v35, v31 row_ror:8 row_mask:0xf bank_mask:0xf
    v_mfma_f32_16x16x32_bf16 v[52:55], v[252:255], v[28:31], v[52:55]
    s_nop 0
    v_mfma_f32_16x16x32_bf16 v[48:51], v[248:251], v[32:35], v[48:51]
    v_mfma_f32_16x16x32_bf16 v[52:55], v[244:247], v[32:35], v[52:55]
    s_nop 7
    v_cndmask_b32 v48, v52, v48, s[40:41]
    v_cndmask_b32 v49, v53, v49, s[40:41]
    v_cndmask_b32 v50, v54, v50, s[40:41]
    v_cndmask_b32 v51, v55, v51, s[40:41]
    ds_write_b128 v4, v[48:51] offset:16384
    s_waitcnt lgkmcnt(0)
    s_barrier
    ds_read_b128 v[32:35], v2 offset:16384
    ds_read_b128 v[36:39], v2 offset:17408
    ds_read_b128 v[40:43], v2 offset:19456
    s_waitcnt lgkmcnt(1)
    v_pk_add_f32 v[48:49], v[48:49], v[32:33]
    v_pk_add_f32 v[50:51], v[50:51], v[34:35]
    s_waitcnt lgkmcnt(0)
    v_pk_add_f32 v[36:37], v[36:37], v[40:41]
    v_pk_add_f32 v[38:39], v[38:39], v[42:43]
    v_pk_add_f32 v[48:49], v[48:49], v[36:37]
    v_pk_add_f32 v[50:51], v[50:51], v[38:39]
    s_sleep 12
    s_mov_b32 s44, 0
CF_PP:
    buffer_load_dwordx4 v[16:19], v60, s[8:11], s27 offen sc1
    buffer_load_dwordx4 v[20:23], v61, s[8:11], s27 offen sc1
    buffer_load_dwordx4 v[24:27], v62, s[8:11], s27 offen sc1
    s_waitcnt vmcnt(2)
    v_pk_add_f32 v[36:37], v[48:49], v[16:17]
    v_pk_add_f32 v[38:39], v[50:51], v[18:19]
    s_waitcnt vmcnt(1)
    v_pk_add_f32 v[36:37], v[36:37], v[20:21]
    v_pk_add_f32 v[38:39], v[38:39], v[22:23]
    s_waitcnt vmcnt(0)
    v_pk_add_f32 v[36:37], v[36:37], v[24:25]
    v_pk_add_f32 v[38:39], v[38:39], v[26:27]
    v_pk_add_f32 v[34:35], v[36:37], v[38:39]
    v_cvt_pk_bf16_f32 v32, v36, v37
    v_cmp_u_f32 vcc, v34, v35
    v_cvt_pk_bf16_f32 v33, v38, v39
    s_cbranch_vccnz CF_PP_X
CF_PP_OK:
    v_min_u32 v32, -2, v32
    v_min_u32 v33, -2, v33
    buffer_store_dwordx2 v[32:33], v7, s[8:11], s37 offen offset:0
    s_barrier
    v_mov_b32 v48, 0
    v_mov_b32 v49, 0
    v_mov_b32 v50, 0
    v_mov_b32 v51, 0
    v_mov_b32 v52, 0
    v_mov_b32 v53, 0
    v_mov_b32 v54, 0
    v_mov_b32 v55, 0
    s_mov_b32 s36, s37
    s_mov_b32 s37, s38
    s_add_u32 s38, s38, 524288
    s_cmp_eq_u32 s38, 94371840
    s_cselect_b32 s38, 92274688, s38
    s_add_u32 s35, s35, 1
    s_lshr_b32 s27, s35, 3
    s_lshl_b32 s27, s27, 22
    s_and_b32 s28, s35, 7
    s_lshl_b32 s28, s28, 18
    s_add_u32 s27, s27, s28
    s_branch CF_W6_LOOP
CF_OP6_R1:
    buffer_load_dwordx4 v[20:23], v3, s[8:11], s36 offen offset:1024 sc1
    buffer_load_dwordx4 v[24:27], v3, s[8:11], s36 offen offset:2048 sc1
    buffer_load_dwordx4 v[28:31], v3, s[8:11], s36 offen offset:3072 sc1
    s_add_u32 s44, s44, 1
    s_cmp_gt_u32 s44, 60000
    s_cbranch_scc1 C_DONE
    s_waitcnt vmcnt(2)
    v_max3_u32 v5, v20, v21, v22
    v_max_u32 v5, v5, v23
    v_cmp_eq_u32 vcc, -1, v5
    s_cbranch_vccnz CF_OP6_R1
    s_branch CF_OP6_B1
CF_OP6_R2:
    buffer_load_dwordx4 v[24:27], v3, s[8:11], s36 offen offset:2048 sc1
    buffer_load_dwordx4 v[28:31], v3, s[8:11], s36 offen offset:3072 sc1
    s_add_u32 s44, s44, 1
    s_cmp_gt_u32 s44, 60000
    s_cbranch_scc1 C_DONE
    s_waitcnt vmcnt(1)
    v_max3_u32 v5, v24, v25, v26
    v_max_u32 v5, v5, v27
    v_cmp_eq_u32 vcc, -1, v5
    s_cbranch_vccnz CF_OP6_R2
    s_branch CF_OP6_B2
CF_OP6_R3:
    buffer_load_dwordx4 v[28:31], v3, s[8:11], s36 offen offset:3072 sc1
    s_add_u32 s44, s44, 1
    s_cmp_gt_u32 s44, 60000
    s_cbranch_scc1 C_DONE
    s_waitcnt vmcnt(0)
    v_max3_u32 v5, v28, v29, v30
    v_max_u32 v5, v5, v31
    v_cmp_eq_u32 vcc, -1, v5
    s_cbranch_vccnz CF_OP6_R3
    s_branch CF_OP6_B3
CF_PP_X:
    s_add_u32 s44, s44, 1
    s_and_b32 s45, s44, 15
    s_cbranch_scc1 CF_PP
    s_cmp_gt_u32 s44, 60000
    s_cbranch_scc1 C_DONE
    v_max3_u32 v5, v16, v17, v18
    v_max3_u32 v5, v5, v19, v20
    v_max3_u32 v5, v5, v21, v22
    v_max3_u32 v5, v5, v23, v24
    v_max3_u32 v5, v5, v25, v26
    v_max_u32 v5, v5, v27
    v_cmp_eq_u32 vcc, -1, v5
    s_cbranch_vccnz CF_PP
    s_branch CF_PP_OK
CF_W4:
    s_bitcmp1_b32 s51, 15
    s_cbranch_scc0 CF_RDY_OK
    v_mov_b32 v24, 96
    v_mov_b32 v25, 1
    s_mov_b64 exec, 1
    global_atomic_add v24, v25, s[82:83]
    s_mov_b32 s44, 0
CF_RDY:
    s_add_u32 s44, s44, 1
    s_cmp_gt_u32 s44, 60000
    s_cbranch_scc1 C_DONE
    s_sleep 8
    global_load_dword v25, v24, s[82:83] sc1
    s_waitcnt vmcnt(0)
    v_cmp_ne_u32 vcc, 128, v25
    s_cbranch_vccnz CF_RDY
    s_mov_b64 exec, -1
CF_RDY_OK:
    s_getreg_b32 s29, hwreg(HW_REG_XCC_ID)
    s_and_b32 s29, s29, 7
    s_lshl_b32 s30, s29, 2
    s_lshr_b32 s29, 0x73625140, s30
    s_and_b32 s29, s29, 7
    s_lshl_b32 s29, s29, 2
    s_add_u32 s29, s29, 64
    s_load_dword s30, s[82:83], s29
    s_waitcnt lgkmcnt(0)
    s_lshr_b32 s29, s30, 7
    s_and_b32 s29, s29, 0x1fe
    s_and_b32 s30, s30, 0xff
    s_cmp_gt_u32 s29, s30
    s_cselect_b32 s29, 0x2000, 0
    v_mov_b32 v25, s29
    v_mov_b32 v24, 131072
    ds_write_b32 v24, v25
    v_xor_b32 v26, 0x2000, v25
    v_add_u32 v56, v8, v26
    v_add_u32 v8, v8, v25
    s_waitcnt lgkmcnt(0)
    v_min_u32 v16, -2, v16
    v_min_u32 v17, -2, v17
    buffer_store_dwordx2 v[16:17], v7, s[8:11], s36 offen offset:0
    v_bfe_u32 v10, v0, 2, 2
    v_lshlrev_b32 v10, 3, v10
    v_and_b32 v11, 3, v0
    v_add_u32 v10, v10, v11
    v_lshrrev_b32 v11, 4, v0
    v_lshlrev_b32 v11, 4, v11
    s_lshl_b32 s52, s47, 16
    s_add_u32 s52, s52, 67108864
    v_and_b32 v60, 7, v0
    v_lshlrev_b32 v60, 4, v60
    v_lshl_add_u32 v60, v11, 3, v60
    v_lshlrev_b32 v61, 4, v10
    v_bfe_u32 v62, v0, 4, 1
    v_lshl_add_u32 v61, v62, 3, v61
    s_setprio 2
    s_lshl_b32 s45, s47, 18
    s_add_u32 s45, s45, 5504
    s_add_u32 s22, s84, s45
    s_addc_u32 s23, s85, 0
    s_barrier
CF_W4_LOOP:
    s_cmp_eq_u32 s35, 0
    s_cbranch_scc1 CF_W4_NV
    s_waitcnt vmcnt(0)
    s_lshl_b32 s45, s32, 7
    s_add_u32 s45, s45, 98569216
    s_mov_b32 s21, 1
    s_atomic_add s21, s[84:85], s45
CF_W4_NV:
    s_sleep 3
    s_cmp_ge_u32 s35, 63
    s_cbranch_scc1 CF_NWv00
    s_load_dword s20, s[22:23], 0x0
    s_load_dword s20, s[22:23], 0x40
    s_load_dword s20, s[22:23], 0x80
    s_load_dword s20, s[22:23], 0xc0
    s_load_dword s20, s[22:23], 0x100
    s_load_dword s20, s[22:23], 0x140
    s_load_dword s20, s[22:23], 0x180
    s_load_dword s20, s[22:23], 0x1c0
    s_load_dword s20, s[22:23], 0x200
    s_load_dword s20, s[22:23], 0x240
    s_load_dword s20, s[22:23], 0x280
CF_NWv00:
    s_barrier
    s_barrier
    s_cmp_eq_u32 s35, 63
    s_cbranch_scc1 C_FIN
    s_cmp_ge_u32 s35, 63
    s_cbranch_scc1 CF_NWv01
    s_load_dword s20, s[22:23], 0x2c0
    s_load_dword s20, s[22:23], 0x300
    s_load_dword s20, s[22:23], 0x340
    s_load_dword s20, s[22:23], 0x380
    s_load_dword s20, s[22:23], 0x3c0
    s_load_dword s20, s[22:23], 0x400
    s_load_dword s20, s[22:23], 0x440
    s_load_dword s20, s[22:23], 0x480
    s_load_dword s20, s[22:23], 0x4c0
    s_load_dword s20, s[22:23], 0x500
    s_load_dword s20, s[22:23], 0x540
    s_add_u32 s22, s22, 4096
    s_addc_u32 s23, s23, 0
CF_NWv01:
    s_barrier
    ds_read_b128 v[64:67], v2 offset:20480
    s_sleep 2
    s_mov_b32 s44, 0
CF_OP4_R0:
    buffer_load_dwordx4 v[16:19], v3, s[8:11], s36 offen offset:0 sc1
    buffer_load_dwordx4 v[20:23], v3, s[8:11], s36 offen offset:1024 sc1
    buffer_load_dwordx4 v[24:27], v3, s[8:11], s36 offen offset:2048 sc1
    buffer_load_dwordx4 v[28:31], v3, s[8:11], s36 offen offset:3072 sc1
    s_add_u32 s44, s44, 1
    s_cmp_gt_u32 s44, 60000
    s_cbranch_scc1 C_DONE
    s_waitcnt vmcnt(3)
    v_max3_u32 v5, v16, v17, v18
    v_max_u32 v5, v5, v19
    v_cmp_eq_u32 vcc, -1, v5
    s_cbranch_vccnz CF_OP4_R0
    v_mfma_f32_16x16x32_bf16 v[48:51], v[192:195], v[16:19], v[48:51]
    v_mov_b32_dpp v32, v16 row_ror:8 row_mask:0xf bank_mask:0xf
    v_mov_b32_dpp v33, v17 row_ror:8 row_mask:0xf bank_mask:0xf
    v_mov_b32_dpp v34, v18 row_ror:8 row_mask:0xf bank_mask:0xf
    v_mov_b32_dpp v35, v19 row_ror:8 row_mask:0xf bank_mask:0xf
    s_waitcnt vmcnt(2)
    v_mfma_f32_16x16x32_bf16 v[52:55], v[204:207], v[16:19], v[52:55]
    v_max3_u32 v5, v20, v21, v22
    v_mfma_f32_16x16x32_bf16 v[48:51], v[200:203], v[32:35], v[48:51]
    v_max_u32 v5, v5, v23
    v_cmp_eq_u32 vcc, -1, v5
    v_mfma_f32_16x16x32_bf16 v[52:55], v[196:199], v[32:35], v[52:55]
    s_cbranch_vccnz CF_OP4_R1
CF_OP4_B1:
    v_mfma_f32_16x16x32_bf16 v[48:51], v[208:211], v[20:23], v[48:51]
    v_mov_b32_dpp v32, v20 row_ror:8 row_mask:0xf bank_mask:0xf
    v_mov_b32_dpp v33, v21 row_ror:8 row_mask:0xf bank_mask:0xf
    v_mov_b32_dpp v34, v22 row_ror:8 row_mask:0xf bank_mask:0xf
    v_mov_b32_dpp v35, v23 row_ror:8 row_mask:0xf bank_mask:0xf
    s_waitcnt vmcnt(1)
    v_mfma_f32_16x16x32_bf16 v[52:55], v[220:223], v[20:23], v[52:55]
    v_max3_u32 v5, v24, v25, v26
    v_mfma_f32_16x16x32_bf16 v[48:51], v[216:219], v[32:35], v[48:51]
    v_max_u32 v5, v5, v27
    v_cmp_eq_u32 vcc, -1, v5
    v_mfma_f32_16x16x32_bf16 v[52:55], v[212:215], v[32:35], v[52:55]
    s_cbranch_vccnz CF_OP4_R2
CF_OP4_B2:
    v_mfma_f32_16x16x32_bf16 v[48:51], v[224:227], v[24:27], v[48:51]
    v_mov_b32_dpp v32, v24 row_ror:8 row_mask:0xf bank_mask:0xf
    v_mov_b32_dpp v33, v25 row_ror:8 row_mask:0xf bank_mask:0xf
    v_mov_b32_dpp v34, v26 row_ror:8 row_mask:0xf bank_mask:0xf
    v_mov_b32_dpp v35, v27 row_ror:8 row_mask:0xf bank_mask:0xf
    s_waitcnt vmcnt(0)
    v_mfma_f32_16x16x32_bf16 v[52:55], v[236:239], v[24:27], v[52:55]
    v_max3_u32 v5, v28, v29, v30
    v_mfma_f32_16x16x32_bf16 v[48:51], v[232:235], v[32:35], v[48:51]
    v_max_u32 v5, v5, v31
    v_cmp_eq_u32 vcc, -1, v5
    v_mfma_f32_16x16x32_bf16 v[52:55], v[228:231], v[32:35], v[52:55]
    s_cbranch_vccnz CF_OP4_R3
CF_OP4_B3:
    v_mfma_f32_16x16x32_bf16 v[48:51], v[240:243], v[28:31], v[48:51]
    v_mov_b32_dpp v32, v28 row_ror:8 row_mask:0xf bank_mask:0xf
    v_mov_b32_dpp v33, v29 row_ror:8 row_mask:0xf bank_mask:0xf
    v_mov_b32_dpp v34, v30 row_ror:8 row_mask:0xf bank_mask:0xf
    v_mov_b32_dpp v35, v31 row_ror:8 row_mask:0xf bank_mask:0xf
    v_mfma_f32_16x16x32_bf16 v[52:55], v[252:255], v[28:31], v[52:55]
    s_nop 0
    v_mfma_f32_16x16x32_bf16 v[48:51], v[248:251], v[32:35], v[48:51]
    v_mfma_f32_16x16x32_bf16 v[52:55], v[244:247], v[32:35], v[52:55]
    s_nop 7
    v_cndmask_b32 v48, v52, v48, s[40:41]
    v_cndmask_b32 v49, v53, v49, s[40:41]
    v_cndmask_b32 v50, v54, v50, s[40:41]
    v_cndmask_b32 v51, v55, v51, s[40:41]
    ds_write_b128 v4, v[48:51] offset:16384
    s_waitcnt lgkmcnt(0)
    s_barrier
    ds_read_b128 v[32:35], v2 offset:17408
    ds_read_b128 v[36:39], v2 offset:18432
    ds_read_b128 v[40:43], v2 offset:19456
    s_waitcnt lgkmcnt(1)
    v_pk_add_f32 v[48:49], v[48:49], v[32:33]
    v_pk_add_f32 v[50:51], v[50:51], v[34:35]
    s_waitcnt lgkmcnt(0)
    v_pk_add_f32 v[36:37], v[36:37], v[40:41]
    v_pk_add_f32 v[38:39], v[38:39], v[42:43]
    v_pk_add_f32 v[48:49], v[48:49], v[36:37]
    v_pk_add_f32 v[50:51], v[50:51], v[38:39]
    buffer_store_dwordx4 v[48:51], v56, s[8:11], s27 offen sc1
    buffer_store_dwordx4 v[48:51], v8, s[8:11], s27 offen sc1
    buffer_store_dwordx4 v[64:67], v2, s[8:11], s52 offen sc1
    s_add_u32 s52, s52, 1024
    s_mov_b32 s36, s37
    s_mov_b32 s37, s38
    s_add_u32 s38, s38, 524288
    s_cmp_eq_u32 s38, 94371840
    s_cselect_b32 s38, 92274688, s38
    s_add_u32 s35, s35, 1
    s_lshr_b32 s27, s35, 3
    s_lshl_b32 s27, s27, 22
    s_and_b32 s28, s35, 7
    s_lshl_b32 s28, s28, 18
    s_add_u32 s27, s27, s28
    v_mov_b32 v48, 0
    v_mov_b32 v49, 0
    v_mov_b32 v50, 0
    v_mov_b32 v51, 0
    v_mov_b32 v52, 0
    v_mov_b32 v53, 0
    v_mov_b32 v54, 0
    v_mov_b32 v55, 0
    s_barrier
    s_branch CF_W4_LOOP
CF_OP4_R1:
    buffer_load_dwordx4 v[20:23], v3, s[8:11], s36 offen offset:1024 sc1
    buffer_load_dwordx4 v[24:27], v3, s[8:11], s36 offen offset:2048 sc1
    buffer_load_dwordx4 v[28:31], v3, s[8:11], s36 offen offset:3072 sc1
    s_add_u32 s44, s44, 1
    s_cmp_gt_u32 s44, 60000
    s_cbranch_scc1 C_DONE
    s_waitcnt vmcnt(2)
    v_max3_u32 v5, v20, v21, v22
    v_max_u32 v5, v5, v23
    v_cmp_eq_u32 vcc, -1, v5
    s_cbranch_vccnz CF_OP4_R1
    s_branch CF_OP4_B1
CF_OP4_R2:
    buffer_load_dwordx4 v[24:27], v3, s[8:11], s36 offen offset:2048 sc1
    buffer_load_dwordx4 v[28:31], v3, s[8:11], s36 offen offset:3072 sc1
    s_add_u32 s44, s44, 1
    s_cmp_gt_u32 s44, 60000
    s_cbranch_scc1 C_DONE
    s_waitcnt vmcnt(1)
    v_max3_u32 v5, v24, v25, v26
    v_max_u32 v5, v5, v27
    v_cmp_eq_u32 vcc, -1, v5
    s_cbranch_vccnz CF_OP4_R2
    s_branch CF_OP4_B2
CF_OP4_R3:
    buffer_load_dwordx4 v[28:31], v3, s[8:11], s36 offen offset:3072 sc1
    s_add_u32 s44, s44, 1
    s_cmp_gt_u32 s44, 60000
    s_cbranch_scc1 C_DONE
    s_waitcnt vmcnt(0)
    v_max3_u32 v5, v28, v29, v30
    v_max_u32 v5, v5, v31
    v_cmp_eq_u32 vcc, -1, v5
    s_cbranch_vccnz CF_OP4_R3
    s_branch CF_OP4_B3
CF_W5:
    v_bfe_u32 v10, v0, 2, 2
    v_lshlrev_b32 v10, 3, v10
    v_and_b32 v11, 3, v0
    v_add_u32 v10, v10, v11
    v_lshrrev_b32 v11, 4, v0
    v_lshlrev_b32 v11, 4, v11
    s_lshl_b32 s52, s47, 16
    s_add_u32 s52, s52, 67108864
    v_and_b32 v60, 7, v0
    v_lshlrev_b32 v60, 4, v60
    v_lshl_add_u32 v60, v11, 3, v60
    v_lshlrev_b32 v61, 4, v10
    v_bfe_u32 v62, v0, 4, 1
    v_lshl_add_u32 v61, v62, 3, v61
    v_lshlrev_b32 v56, 5, v11
    v_lshl_add_u32 v56, v10, 4, v56
    s_lshl_b32 s50, s47, 18
    s_add_u32 s50, s50, 0
    v_bfe_u32 v62, v0, 4, 1
    v_lshlrev_b32 v62, 7, v62
    v_and_b32 v63, 7, v0
    v_lshl_add_u32 v62, v63, 4, v62
    v_add_u32 v62, 0x400, v62
    s_mul_i32 s45, s47, 1280
    s_add_u32 s45, s45, 131072
    v_add_u32 v63, s45, v62
    s_add_u32 s45, s47, 1
    s_and_b32 s45, s45, 3
    s_and_b32 s46, s47, 0xfc
    s_add_u32 s45, s45, s46
    s_mul_i32 s45, s45, 1280
    s_add_u32 s45, s45, 131072
    v_add_u32 v184, s45, v2
    v_add_u32 v187, s45, v62
    s_add_u32 s45, s47, 2
    s_and_b32 s45, s45, 3
    s_and_b32 s46, s47, 0xfc
    s_add_u32 s45, s45, s46
    s_mul_i32 s45, s45, 1280
    s_add_u32 s45, s45, 131072
    v_add_u32 v185, s45, v2
    v_add_u32 v188, s45, v62
    s_add_u32 s45, s47, 3
    s_and_b32 s45, s45, 3
    s_and_b32 s46, s47, 0xfc
    s_add_u32 s45, s45, s46
    s_mul_i32 s45, s45, 1280
    s_add_u32 s45, s45, 131072
    v_add_u32 v186, s45, v2
    v_add_u32 v189, s45, v62
    v_mov_b32 v106, 0x3e0293ee
    v_mov_b32 v107, v106
    v_mov_b32 v190, 0x2b800000
    v_mov_b32 v191, 0x53800000
    v_mov_b32 v108, 0x3f803f80
    v_mov_b32 v109, 0x3f803f80
    v_mov_b32 v110, 0x3f803f80
    v_mov_b32 v111, 0x3f803f80
    v_mov_b32 v104, 0
    v_mov_b32 v105, 0
    v_mov_b32 v112, 0
    v_mov_b32 v113, 0
    v_mov_b32 v114, 0
    v_mov_b32 v115, 0
    v_mov_b32 v116, 0
    v_mov_b32 v117, 0
    v_mov_b32 v118, 0
    v_mov_b32 v119, 0
    v_mov_b32 v120, 0
    v_mov_b32 v121, 0
    v_mov_b32 v122, 0
    v_mov_b32 v123, 0
    v_mov_b32 v124, 0
    v_mov_b32 v125, 0
    v_mov_b32 v126, 0
    v_mov_b32 v127, 0
    v_mov_b32 v128, 0
    v_mov_b32 v129, 0
    v_mov_b32 v130, 0
    v_mov_b32 v131, 0
    v_mov_b32 v132, 0
    v_mov_b32 v133, 0
    v_mov_b32 v134, 0
    v_mov_b32 v135, 0
    v_and_b32 v57, 15, v0
    v_mul_u32_u24 v57, 144, v57
    v_lshl_add_u32 v57, v11, 1, v57
    v_and_b32 v58, 0x1f0, v2
    v_or_b32 v59, 0x200, v58
    s_mov_b32 s45, 98566144
    s_mov_b32 s44, 0
CF_W5_G:
    buffer_load_dword v5, off, s[8:11], s45 sc1
    s_add_u32 s44, s44, 1
    s_cmp_gt_u32 s44, 60000
    s_cbranch_scc1 C_DONE
    s_waitcnt vmcnt(0)
    v_cmp_eq_u32 vcc, 128, v5
    s_cbranch_vccnz CF_W5_G_OK
    s_sleep 8
    s_branch CF_W5_G
CF_W5_G_OK:
    buffer_load_dwordx4 v[64:67], v56, s[8:11], s50 offen offset:0 sc1
    buffer_load_dwordx4 v[68:71], v56, s[8:11], s50 offen offset:64 sc1
    buffer_load_dwordx4 v[72:75], v56, s[8:11], s50 offen offset:2048 sc1
    buffer_load_dwordx4 v[76:79], v56, s[8:11], s50 offen offset:2112 sc1
    s_add_u32 s50, s50, 4096
    s_setprio 2
    s_barrier
    s_waitcnt vmcnt(0)
CF_W5_LOOP:
    s_barrier
    ds_read_b128 v[152:155], v57 offset:0
    ds_read_b128 v[156:159], v57 offset:16
    ds_read_b128 v[160:163], v57 offset:2304
    ds_read_b128 v[164:167], v57 offset:2320
    ds_read_b128 v[168:171], v57 offset:4608
    ds_read_b128 v[172:175], v57 offset:4624
    ds_read_b128 v[176:179], v57 offset:6912
    ds_read_b128 v[180:183], v57 offset:6928
    s_waitcnt lgkmcnt(4)
    v_pk_add_f32 v[152:153], v[152:153], v[160:161]
    v_pk_add_f32 v[154:155], v[154:155], v[162:163]
    v_pk_add_f32 v[156:157], v[156:157], v[164:165]
    v_pk_add_f32 v[158:159], v[158:159], v[166:167]
    s_waitcnt lgkmcnt(2)
    v_pk_add_f32 v[152:153], v[152:153], v[168:169]
    v_pk_add_f32 v[154:155], v[154:155], v[170:171]
    v_pk_add_f32 v[156:157], v[156:157], v[172:173]
    v_pk_add_f32 v[158:159], v[158:159], v[174:175]
    s_waitcnt lgkmcnt(0)
    v_pk_add_f32 v[152:153], v[152:153], v[176:177]
    v_pk_add_f32 v[154:155], v[154:155], v[178:179]
    v_pk_add_f32 v[156:157], v[156:157], v[180:181]
    v_pk_add_f32 v[158:159], v[158:159], v[182:183]
    v_cvt_pk_bf16_f32 v80, v152, v153
    v_cvt_pk_bf16_f32 v81, v154, v155
    v_cvt_pk_bf16_f32 v82, v156, v157
    v_cvt_pk_bf16_f32 v83, v158, v159
    s_nop 1
    v_mfma_f32_16x16x32_bf16 v[84:87], v[64:67], v[80:83], 0
    v_mfma_f32_16x16x32_bf16 v[92:95], v[68:71], v[80:83], 0
    v_mfma_f32_16x16x32_bf16 v[88:91], v[80:83], v[80:83], 0
    s_mov_b64 exec, s[40:41]
    s_nop 4
    buffer_store_dwordx4 v[84:87], v9, s[8:11], s36 offen
    buffer_store_dwordx4 v[92:95], v9, s[8:11], s36 offen offset:128
    s_mov_b64 exec, s[42:43]
    buffer_store_dwordx4 v[88:91], v63, s[8:11], s36 offen
    s_mov_b64 exec, -1
    v_mov_b32_dpp v84, v92 row_ror:8 row_mask:0xf bank_mask:0xc
    v_mov_b32_dpp v85, v93 row_ror:8 row_mask:0xf bank_mask:0xc
    v_mov_b32_dpp v86, v94 row_ror:8 row_mask:0xf bank_mask:0xc
    v_mov_b32_dpp v87, v95 row_ror:8 row_mask:0xf bank_mask:0xc
    v_cndmask_b32 v88, 0, v88, s[42:43]
    v_cndmask_b32 v89, 0, v89, s[42:43]
    v_cndmask_b32 v90, 0, v90, s[42:43]
    v_cndmask_b32 v91, 0, v91, s[42:43]
    s_sleep 1
    buffer_load_dwordx4 v[112:115], v184, s[8:11], s36 offen sc1
    buffer_load_dwordx4 v[120:123], v185, s[8:11], s36 offen sc1
    buffer_load_dwordx4 v[128:131], v186, s[8:11], s36 offen sc1
    s_mov_b64 exec, s[42:43]
    buffer_load_dwordx4 v[116:119], v187, s[8:11], s36 offen sc1
    buffer_load_dwordx4 v[124:127], v188, s[8:11], s36 offen sc1
    buffer_load_dwordx4 v[132:135], v189, s[8:11], s36 offen sc1
    s_mov_b64 exec, -1
    v_mul_f32 v84, v84, v106
    v_mul_f32 v85, v85, v106
    v_mul_f32 v86, v86, v106
    v_mul_f32 v87, v87, v106
    v_mul_f32 v88, v88, v106
    v_mul_f32 v89, v89, v106
    v_mul_f32 v90, v90, v106
    v_mul_f32 v91, v91, v106
    s_barrier
    ds_read_b128 v[152:155], v58 offset:9216
    ds_read_b128 v[156:159], v59 offset:9216
    ds_read_b128 v[160:163], v58 offset:10240
    ds_read_b128 v[164:167], v59 offset:10240
    ds_read_b128 v[168:171], v58 offset:11264
    ds_read_b128 v[172:175], v59 offset:11264
    ds_read_b128 v[176:179], v58 offset:12288
    ds_read_b128 v[180:183], v59 offset:12288
    s_waitcnt lgkmcnt(4)
    v_pk_add_f32 v[152:153], v[152:153], v[160:161]
    v_pk_add_f32 v[154:155], v[154:155], v[162:163]
    v_pk_add_f32 v[156:157], v[156:157], v[164:165]
    v_pk_add_f32 v[158:159], v[158:159], v[166:167]
    s_waitcnt lgkmcnt(2)
    v_pk_add_f32 v[152:153], v[152:153], v[168:169]
    v_pk_add_f32 v[154:155], v[154:155], v[170:171]
    v_pk_add_f32 v[156:157], v[156:157], v[172:173]
    v_pk_add_f32 v[158:159], v[158:159], v[174:175]
    s_waitcnt lgkmcnt(0)
    v_pk_add_f32 v[152:153], v[152:153], v[176:177]
    v_pk_add_f32 v[154:155], v[154:155], v[178:179]
    v_pk_add_f32 v[156:157], v[156:157], v[180:181]
    v_pk_add_f32 v[158:159], v[158:159], v[182:183]
    v_cvt_pk_bf16_f32 v96, v152, v153
    v_cvt_pk_bf16_f32 v97, v154, v155
    v_cvt_pk_bf16_f32 v98, v156, v157
    v_cvt_pk_bf16_f32 v99, v158, v159
    buffer_load_dwordx4 v[16:19], v184, s[8:11], s36 offen sc1
    buffer_load_dwordx4 v[24:27], v185, s[8:11], s36 offen sc1
    buffer_load_dwordx4 v[32:35], v186, s[8:11], s36 offen sc1
    s_mov_b64 exec, s[42:43]
    buffer_load_dwordx4 v[20:23], v187, s[8:11], s36 offen sc1
    buffer_load_dwordx4 v[28:31], v188, s[8:11], s36 offen sc1
    buffer_load_dwordx4 v[36:39], v189, s[8:11], s36 offen sc1
    s_mov_b64 exec, -1
    s_not_b64 exec, s[40:41]
    ds_write_b128 v60, v[80:83] offset:20480
    s_mov_b64 exec, s[54:55]
    ds_write_b64 v61, v[96:97] offset:20992
    ds_write_b64 v61, v[98:99] offset:21056
    s_mov_b64 exec, -1
    s_mov_b32 s44, 0
    s_add_u32 s46, s36, 65536
    s_cmp_eq_u32 s35, 63
    s_cbranch_scc1 CF_W5_END
CF_SP_W:
    s_waitcnt vmcnt(10)
    v_pk_fma_f32 v[160:161], v[112:113], v[106:107], v[84:85]
    v_pk_fma_f32 v[162:163], v[114:115], v[106:107], v[86:87]
    v_pk_fma_f32 v[160:161], v[120:121], v[106:107], v[160:161]
    v_pk_fma_f32 v[162:163], v[122:123], v[106:107], v[162:163]
    s_waitcnt vmcnt(8)
    v_pk_fma_f32 v[160:161], v[128:129], v[106:107], v[160:161]
    v_pk_fma_f32 v[162:163], v[130:131], v[106:107], v[162:163]
    v_pk_fma_f32 v[164:165], v[116:117], v[106:107], v[88:89]
    v_pk_fma_f32 v[166:167], v[118:119], v[106:107], v[90:91]
    s_waitcnt vmcnt(7)
    v_pk_fma_f32 v[164:165], v[124:125], v[106:107], v[164:165]
    v_pk_fma_f32 v[166:167], v[126:127], v[106:107], v[166:167]
    v_exp_f32 v152, v160
    v_exp_f32 v153, v161
    s_waitcnt vmcnt(6)
    v_pk_fma_f32 v[164:165], v[132:133], v[106:107], v[164:165]
    v_pk_fma_f32 v[166:167], v[134:135], v[106:107], v[166:167]
    v_cmp_u_f32 vcc, v160, v164
    v_exp_f32 v154, v162
    v_exp_f32 v155, v163
    s_cbranch_vccnz CF_SP_B
CF_SP_E:
    v_exp_f32 v156, v164
    v_exp_f32 v157, v165
    v_exp_f32 v158, v166
    v_exp_f32 v159, v167
    v_cvt_pk_bf16_f32 v100, v152, v153
    v_cvt_pk_bf16_f32 v101, v154, v155
    s_mov_b64 exec, s[42:43]
    v_cvt_pk_bf16_f32 v104, v156, v157
    v_cvt_pk_bf16_f32 v105, v158, v159
    s_mov_b64 exec, -1
    v_mov_b32_dpp v102, v100 row_ror:8 row_mask:0xf bank_mask:0xf
    v_mov_b32_dpp v103, v101 row_ror:8 row_mask:0xf bank_mask:0xf
    v_mfma_f32_16x16x16_bf16 v[144:147], v[108:109], v[104:105], 0
    v_mfma_f32_16x16x16_bf16 v[136:139], v[96:97], v[104:105], 0
    v_mfma_f32_16x16x16_bf16 v[140:143], v[98:99], v[104:105], 0
    v_mfma_f32_16x16x32_bf16 v[144:147], v[108:111], v[100:103], v[144:147]
    v_mfma_f32_16x16x32_bf16 v[136:139], v[72:75], v[100:103], v[136:139]
    v_mfma_f32_16x16x32_bf16 v[140:143], v[76:79], v[100:103], v[140:143]
    s_mov_b64 exec, s[40:41]
    s_nop 4
    v_rcp_f32 v148, v144
    v_med3_f32 v150, v144, v190, v191
    v_cmp_neq_f32 vcc, v150, v144
    s_cbranch_vccnz CF_SP_X
CF_SP_OK:
    v_pk_mul_f32 v[136:137], v[136:137], v[148:149] op_sel_hi:[1,0]
    v_pk_mul_f32 v[138:139], v[138:139], v[148:149] op_sel_hi:[1,0]
    v_pk_mul_f32 v[140:141], v[140:141], v[148:149] op_sel_hi:[1,0]
    v_pk_mul_f32 v[142:143], v[142:143], v[148:149] op_sel_hi:[1,0]
    v_cvt_pk_bf16_f32 v92, v136, v137
    v_cvt_pk_bf16_f32 v93, v138, v139
    v_cvt_pk_bf16_f32 v94, v140, v141
    v_cvt_pk_bf16_f32 v95, v142, v143
    v_min_u32 v92, -2, v92
    v_min_u32 v93, -2, v93
    v_min_u32 v94, -2, v94
    v_min_u32 v95, -2, v95
    buffer_store_dwordx4 v[92:95], v6, s[8:11], s46 offen
    s_mov_b64 exec, -1
    s_waitcnt lgkmcnt(0)
    s_barrier
    s_sleep 2
    s_mov_b32 s44, 0
CF_OP5_R0:
    buffer_load_dwordx4 v[16:19], v3, s[8:11], s36 offen offset:0 sc1
    buffer_load_dwordx4 v[20:23], v3, s[8:11], s36 offen offset:1024 sc1
    buffer_load_dwordx4 v[24:27], v3, s[8:11], s36 offen offset:2048 sc1
    buffer_load_dwordx4 v[28:31], v3, s[8:11], s36 offen offset:3072 sc1
    s_add_u32 s44, s44, 1
    s_cmp_gt_u32 s44, 60000
    s_cbranch_scc1 C_DONE
    s_waitcnt vmcnt(3)
    v_max3_u32 v5, v16, v17, v18
    v_max_u32 v5, v5, v19
    v_cmp_eq_u32 vcc, -1, v5
    s_cbranch_vccnz CF_OP5_R0
    v_mfma_f32_16x16x32_bf16 v[48:51], v[192:195], v[16:19], v[48:51]
    v_mov_b32_dpp v32, v16 row_ror:8 row_mask:0xf bank_mask:0xf
    v_mov_b32_dpp v33, v17 row_ror:8 row_mask:0xf bank_mask:0xf
    v_mov_b32_dpp v34, v18 row_ror:8 row_mask:0xf bank_mask:0xf
    v_mov_b32_dpp v35, v19 row_ror:8 row_mask:0xf bank_mask:0xf
    s_waitcnt vmcnt(2)
    v_mfma_f32_16x16x32_bf16 v[52:55], v[204:207], v[16:19], v[52:55]
    v_max3_u32 v5, v20, v21, v22
    v_mfma_f32_16x16x32_bf16 v[48:51], v[200:203], v[32:35], v[48:51]
    v_max_u32 v5, v5, v23
    v_cmp_eq_u32 vcc, -1, v5
    v_mfma_f32_16x16x32_bf16 v[52:55], v[196:199], v[32:35], v[52:55]
    s_cbranch_vccnz CF_OP5_R1
CF_OP5_B1:
    v_mfma_f32_16x16x32_bf16 v[48:51], v[208:211], v[20:23], v[48:51]
    v_mov_b32_dpp v32, v20 row_ror:8 row_mask:0xf bank_mask:0xf
    v_mov_b32_dpp v33, v21 row_ror:8 row_mask:0xf bank_mask:0xf
    v_mov_b32_dpp v34, v22 row_ror:8 row_mask:0xf bank_mask:0xf
    v_mov_b32_dpp v35, v23 row_ror:8 row_mask:0xf bank_mask:0xf
    s_waitcnt vmcnt(1)
    v_mfma_f32_16x16x32_bf16 v[52:55], v[220:223], v[20:23], v[52:55]
    v_max3_u32 v5, v24, v25, v26
    v_mfma_f32_16x16x32_bf16 v[48:51], v[216:219], v[32:35], v[48:51]
    v_max_u32 v5, v5, v27
    v_cmp_eq_u32 vcc, -1, v5
    v_mfma_f32_16x16x32_bf16 v[52:55], v[212:215], v[32:35], v[52:55]
    s_cbranch_vccnz CF_OP5_R2
CF_OP5_B2:
    v_mfma_f32_16x16x32_bf16 v[48:51], v[224:227], v[24:27], v[48:51]
    v_mov_b32_dpp v32, v24 row_ror:8 row_mask:0xf bank_mask:0xf
    v_mov_b32_dpp v33, v25 row_ror:8 row_mask:0xf bank_mask:0xf
    v_mov_b32_dpp v34, v26 row_ror:8 row_mask:0xf bank_mask:0xf
    v_mov_b32_dpp v35, v27 row_ror:8 row_mask:0xf bank_mask:0xf
    s_waitcnt vmcnt(0)
    v_mfma_f32_16x16x32_bf16 v[52:55], v[236:239], v[24:27], v[52:55]
    v_max3_u32 v5, v28, v29, v30
    v_mfma_f32_16x16x32_bf16 v[48:51], v[232:235], v[32:35], v[48:51]
    v_max_u32 v5, v5, v31
    v_cmp_eq_u32 vcc, -1, v5
    v_mfma_f32_16x16x32_bf16 v[52:55], v[228:231], v[32:35], v[52:55]
    s_cbranch_vccnz CF_OP5_R3
CF_OP5_B3:
    v_mfma_f32_16x16x32_bf16 v[48:51], v[240:243], v[28:31], v[48:51]
    v_mov_b32_dpp v32, v28 row_ror:8 row_mask:0xf bank_mask:0xf
    v_mov_b32_dpp v33, v29 row_ror:8 row_mask:0xf bank_mask:0xf
    v_mov_b32_dpp v34, v30 row_ror:8 row_mask:0xf bank_mask:0xf
    v_mov_b32_dpp v35, v31 row_ror:8 row_mask:0xf bank_mask:0xf
    v_mfma_f32_16x16x32_bf16 v[52:55], v[252:255], v[28:31], v[52:55]
    s_nop 0
    v_mfma_f32_16x16x32_bf16 v[48:51], v[248:251], v[32:35], v[48:51]
    v_mfma_f32_16x16x32_bf16 v[52:55], v[244:247], v[32:35], v[52:55]
    s_nop 7
    v_cndmask_b32 v48, v52, v48, s[40:41]
    v_cndmask_b32 v49, v53, v49, s[40:41]
    v_cndmask_b32 v50, v54, v50, s[40:41]
    v_cndmask_b32 v51, v55, v51, s[40:41]
    ds_write_b128 v4, v[48:51] offset:16384
    s_waitcnt lgkmcnt(0)
    s_barrier
    s_sleep 5
    buffer_load_dwordx4 v[64:67], v56, s[8:11], s50 offen offset:0 sc1
    buffer_load_dwordx4 v[68:71], v56, s[8:11], s50 offen offset:64 sc1
    buffer_load_dwordx4 v[72:75], v56, s[8:11], s50 offen offset:2048 sc1
    buffer_load_dwordx4 v[76:79], v56, s[8:11], s50 offen offset:2112 sc1
    s_add_u32 s50, s50, 4096
    v_mov_b32 v48, 0
    v_mov_b32 v49, 0
    v_mov_b32 v50, 0
    v_mov_b32 v51, 0
    v_mov_b32 v52, 0
    v_mov_b32 v53, 0
    v_mov_b32 v54, 0
    v_mov_b32 v55, 0
    s_mov_b32 s36, s37
    s_mov_b32 s37, s38
    s_add_u32 s38, s38, 524288
    s_cmp_eq_u32 s38, 94371840
    s_cselect_b32 s38, 92274688, s38
    s_add_u32 s35, s35, 1
    s_lshr_b32 s27, s35, 3
    s_lshl_b32 s27, s27, 22
    s_and_b32 s28, s35, 7
    s_lshl_b32 s28, s28, 18
    s_add_u32 s27, s27, s28
    s_barrier
    s_waitcnt vmcnt(0)
    s_branch CF_W5_LOOP
CF_W5_END:
    s_waitcnt lgkmcnt(0)
    ds_read_b128 v[152:155], v2 offset:20480
    s_add_u32 s52, s52, 64512
    s_waitcnt lgkmcnt(0)
    buffer_store_dwordx4 v[152:155], v2, s[8:11], s52 offen sc1
    s_waitcnt vmcnt(0)
    s_lshl_b32 s45, s32, 7
    s_add_u32 s45, s45, 98569728
    s_mov_b32 s21, 1
    s_atomic_add s21, s[84:85], s45
    s_branch C_FIN
CF_SP_X:
    s_mov_b64 exec, -1
    s_add_u32 s44, s44, 1
    s_cmp_gt_u32 s44, 60000
    s_cbranch_scc1 C_DONE
    v_max3_u32 v5, v112, v113, v114
    v_max3_u32 v5, v5, v115, v116
    v_max3_u32 v5, v5, v117, v118
    v_max3_u32 v5, v5, v119, v120
    v_max3_u32 v5, v5, v121, v122
    v_max3_u32 v5, v5, v123, v124
    v_max3_u32 v5, v5, v125, v126
    v_max3_u32 v5, v5, v127, v128
    v_max3_u32 v5, v5, v129, v130
    v_max3_u32 v5, v5, v131, v132
    v_max3_u32 v5, v5, v133, v134
    v_max_u32 v5, v5, v135
    v_cmp_eq_u32 vcc, -1, v5
    s_cbranch_vccnz CF_SP
    v_max3_f32 v148, v160, v161, v162
    v_max_f32 v148, v148, v163
    s_mov_b64 exec, s[42:43]
    v_max3_f32 v148, v148, v164, v165
    v_max3_f32 v148, v148, v166, v167
    s_mov_b64 exec, -1
    s_nop 0
    v_max_f32_dpp v148, v148, v148 row_ror:8 row_mask:0xf bank_mask:0xf
    v_mov_b32 v149, v148
    s_nop 1
    v_permlane16_swap_b32 v148, v149
    v_max_f32 v148, v148, v149
    v_mov_b32 v149, v148
    s_nop 1
    v_permlane32_swap_b32 v148, v149
    v_max_f32 v148, v148, v149
    v_sub_f32 v160, v160, v148
    v_sub_f32 v161, v161, v148
    v_sub_f32 v162, v162, v148
    v_sub_f32 v163, v163, v148
    v_sub_f32 v164, v164, v148
    v_sub_f32 v165, v165, v148
    v_sub_f32 v166, v166, v148
    v_sub_f32 v167, v167, v148
    v_exp_f32 v152, v160
    v_exp_f32 v153, v161
    v_exp_f32 v154, v162
    v_exp_f32 v155, v163
    v_exp_f32 v156, v164
    v_exp_f32 v157, v165
    v_exp_f32 v158, v166
    v_exp_f32 v159, v167
    v_cvt_pk_bf16_f32 v100, v152, v153
    v_cvt_pk_bf16_f32 v101, v154, v155
    s_mov_b64 exec, s[42:43]
    v_cvt_pk_bf16_f32 v104, v156, v157
    v_cvt_pk_bf16_f32 v105, v158, v159
    s_mov_b64 exec, -1
    v_mov_b32_dpp v102, v100 row_ror:8 row_mask:0xf bank_mask:0xf
    v_mov_b32_dpp v103, v101 row_ror:8 row_mask:0xf bank_mask:0xf
    v_mfma_f32_16x16x16_bf16 v[144:147], v[108:109], v[104:105], 0
    v_mfma_f32_16x16x16_bf16 v[136:139], v[96:97], v[104:105], 0
    v_mfma_f32_16x16x16_bf16 v[140:143], v[98:99], v[104:105], 0
    v_mfma_f32_16x16x32_bf16 v[144:147], v[108:111], v[100:103], v[144:147]
    v_mfma_f32_16x16x32_bf16 v[136:139], v[72:75], v[100:103], v[136:139]
    v_mfma_f32_16x16x32_bf16 v[140:143], v[76:79], v[100:103], v[140:143]
    s_mov_b64 exec, s[40:41]
    s_nop 4
    v_rcp_f32 v148, v144
    s_branch CF_SP_OK
CF_SP:
    buffer_load_dwordx4 v[112:115], v184, s[8:11], s36 offen sc1
    buffer_load_dwordx4 v[120:123], v185, s[8:11], s36 offen sc1
    buffer_load_dwordx4 v[128:131], v186, s[8:11], s36 offen sc1
    s_mov_b64 exec, s[42:43]
    buffer_load_dwordx4 v[116:119], v187, s[8:11], s36 offen sc1
    buffer_load_dwordx4 v[124:127], v188, s[8:11], s36 offen sc1
    buffer_load_dwordx4 v[132:135], v189, s[8:11], s36 offen sc1
    s_mov_b64 exec, -1
    s_waitcnt vmcnt(4)
    v_pk_fma_f32 v[160:161], v[112:113], v[106:107], v[84:85]
    v_pk_fma_f32 v[162:163], v[114:115], v[106:107], v[86:87]
    v_pk_fma_f32 v[160:161], v[120:121], v[106:107], v[160:161]
    v_pk_fma_f32 v[162:163], v[122:123], v[106:107], v[162:163]
    s_waitcnt vmcnt(2)
    v_pk_fma_f32 v[160:161], v[128:129], v[106:107], v[160:161]
    v_pk_fma_f32 v[162:163], v[130:131], v[106:107], v[162:163]
    v_pk_fma_f32 v[164:165], v[116:117], v[106:107], v[88:89]
    v_pk_fma_f32 v[166:167], v[118:119], v[106:107], v[90:91]
    s_waitcnt vmcnt(1)
    v_pk_fma_f32 v[164:165], v[124:125], v[106:107], v[164:165]
    v_pk_fma_f32 v[166:167], v[126:127], v[106:107], v[166:167]
    v_exp_f32 v152, v160
    v_exp_f32 v153, v161
    s_waitcnt vmcnt(0)
    v_pk_fma_f32 v[164:165], v[132:133], v[106:107], v[164:165]
    v_pk_fma_f32 v[166:167], v[134:135], v[106:107], v[166:167]
    v_exp_f32 v154, v162
    v_exp_f32 v155, v163
    s_branch CF_SP_E
CF_SP_B:
    s_waitcnt vmcnt(4)
    v_pk_fma_f32 v[160:161], v[16:17], v[106:107], v[84:85]
    v_pk_fma_f32 v[162:163], v[18:19], v[106:107], v[86:87]
    v_pk_fma_f32 v[160:161], v[24:25], v[106:107], v[160:161]
    v_pk_fma_f32 v[162:163], v[26:27], v[106:107], v[162:163]
    s_waitcnt vmcnt(2)
    v_pk_fma_f32 v[160:161], v[32:33], v[106:107], v[160:161]
    v_pk_fma_f32 v[162:163], v[34:35], v[106:107], v[162:163]
    v_pk_fma_f32 v[164:165], v[20:21], v[106:107], v[88:89]
    v_pk_fma_f32 v[166:167], v[22:23], v[106:107], v[90:91]
    s_waitcnt vmcnt(1)
    v_pk_fma_f32 v[164:165], v[28:29], v[106:107], v[164:165]
    v_pk_fma_f32 v[166:167], v[30:31], v[106:107], v[166:167]
    v_exp_f32 v152, v160
    v_exp_f32 v153, v161
    s_waitcnt vmcnt(0)
    v_pk_fma_f32 v[164:165], v[36:37], v[106:107], v[164:165]
    v_pk_fma_f32 v[166:167], v[38:39], v[106:107], v[166:167]
    v_exp_f32 v154, v162
    v_exp_f32 v155, v163
    s_branch CF_SP_E
CF_OP5_R1:
    buffer_load_dwordx4 v[20:23], v3, s[8:11], s36 offen offset:1024 sc1
    buffer_load_dwordx4 v[24:27], v3, s[8:11], s36 offen offset:2048 sc1
    buffer_load_dwordx4 v[28:31], v3, s[8:11], s36 offen offset:3072 sc1
    s_add_u32 s44, s44, 1
    s_cmp_gt_u32 s44, 60000
    s_cbranch_scc1 C_DONE
    s_waitcnt vmcnt(2)
    v_max3_u32 v5, v20, v21, v22
    v_max_u32 v5, v5, v23
    v_cmp_eq_u32 vcc, -1, v5
    s_cbranch_vccnz CF_OP5_R1
    s_branch CF_OP5_B1
CF_OP5_R2:
    buffer_load_dwordx4 v[24:27], v3, s[8:11], s36 offen offset:2048 sc1
    buffer_load_dwordx4 v[28:31], v3, s[8:11], s36 offen offset:3072 sc1
    s_add_u32 s44, s44, 1
    s_cmp_gt_u32 s44, 60000
    s_cbranch_scc1 C_DONE
    s_waitcnt vmcnt(1)
    v_max3_u32 v5, v24, v25, v26
    v_max_u32 v5, v5, v27
    v_cmp_eq_u32 vcc, -1, v5
    s_cbranch_vccnz CF_OP5_R2
    s_branch CF_OP5_B2
CF_OP5_R3:
    buffer_load_dwordx4 v[28:31], v3, s[8:11], s36 offen offset:3072 sc1
    s_add_u32 s44, s44, 1
    s_cmp_gt_u32 s44, 60000
    s_cbranch_scc1 C_DONE
    s_waitcnt vmcnt(0)
    v_max3_u32 v5, v28, v29, v30
    v_max_u32 v5, v5, v31
    v_cmp_eq_u32 vcc, -1, v5
    s_cbranch_vccnz CF_OP5_R3
    s_branch CF_OP5_B3
C_SLOW:
    v_lshrrev_b32 v1, 6, v0
    v_and_b32 v0, 63, v0
    v_readfirstlane_b32 s34, v1
    s_mov_b32 s42, 0
    s_mov_b32 s43, 0x00ff00ff
    s_mov_b32 s54, 0
    s_mov_b32 s55, -1
    s_mov_b32 s35, 0
    s_mov_b32 s36, 94371840
    s_mov_b32 s37, 94896128
    s_mov_b32 s38, 95420416
    s_lshr_b32 s27, s35, 3
    s_lshl_b32 s27, s27, 22
    s_and_b32 s28, s35, 7
    s_lshl_b32 s28, s28, 18
    s_add_u32 s27, s27, s28
    v_bfe_u32 v1, v0, 3, 1
    v_lshlrev_b32 v1, 9, v1
    v_lshrrev_b32 v2, 4, v0
    v_lshl_add_u32 v1, v2, 7, v1
    v_and_b32 v2, 7, v0
    v_lshl_add_u32 v1, v2, 4, v1
    v_lshlrev_b32 v2, 4, v0
    s_lshl_b32 s47, s32, 5
    s_add_u32 s47, s47, s33
    s_xor_b32 s47, s47, 8
    s_cmp_ge_u32 s34, 4
    s_cbranch_scc1 CS_WO
    s_lshl_b32 s48, s47, 6
    s_lshl_b32 s45, s34, 21
    s_add_u32 s48, s48, s45
    s_xor_b32 s50, s48, 128
    s_barrier
    s_mov_b32 s12, s66
    s_and_b32 s13, s67, 0xffff
    s_mov_b32 s14, 0x800000
    s_mov_b32 s15, 0x20000
    v_lshrrev_b32 v4, 2, v0
    s_mov_b32 s45, 8192
    v_mul_lo_u32 v4, v4, s45
    v_and_b32 v6, 3, v0
    v_lshl_add_u32 v4, v6, 4, v4
    s_mov_b32 s46, s48
    buffer_load_dwordx4 v[64:67], v4, s[12:15], s46 offen
    s_add_u32 s46, s46, 131072
    buffer_load_dwordx4 v[68:71], v4, s[12:15], s46 offen
    s_add_u32 s46, s46, 131072
    buffer_load_dwordx4 v[72:75], v4, s[12:15], s46 offen
    s_add_u32 s46, s46, 131072
    buffer_load_dwordx4 v[76:79], v4, s[12:15], s46 offen
    s_add_u32 s46, s46, 131072
    buffer_load_dwordx4 v[80:83], v4, s[12:15], s46 offen
    s_add_u32 s46, s46, 131072
    buffer_load_dwordx4 v[84:87], v4, s[12:15], s46 offen
    s_add_u32 s46, s46, 131072
    buffer_load_dwordx4 v[88:91], v4, s[12:15], s46 offen
    s_add_u32 s46, s46, 131072
    buffer_load_dwordx4 v[92:95], v4, s[12:15], s46 offen
    s_add_u32 s46, s46, 131072
    buffer_load_dwordx4 v[96:99], v4, s[12:15], s46 offen
    s_add_u32 s46, s46, 131072
    buffer_load_dwordx4 v[100:103], v4, s[12:15], s46 offen
    s_add_u32 s46, s46, 131072
    buffer_load_dwordx4 v[104:107], v4, s[12:15], s46 offen
    s_add_u32 s46, s46, 131072
    buffer_load_dwordx4 v[108:111], v4, s[12:15], s46 offen
    s_add_u32 s46, s46, 131072
    buffer_load_dwordx4 v[112:115], v4, s[12:15], s46 offen
    s_add_u32 s46, s46, 131072
    buffer_load_dwordx4 v[116:119], v4, s[12:15], s46 offen
    s_add_u32 s46, s46, 131072
    buffer_load_dwordx4 v[120:123], v4, s[12:15], s46 offen
    s_add_u32 s46, s46, 131072
    buffer_load_dwordx4 v[124:127], v4, s[12:15], s46 offen
    s_mov_b32 s12, s68
    s_and_b32 s13, s69, 0xffff
    s_mov_b32 s14, 0x800000
    s_mov_b32 s15, 0x20000
    v_lshrrev_b32 v4, 2, v0
    s_mov_b32 s45, 8192
    v_mul_lo_u32 v4, v4, s45
    v_and_b32 v6, 3, v0
    v_lshl_add_u32 v4, v6, 4, v4
    s_mov_b32 s46, s50
    buffer_load_dwordx4 v[128:131], v4, s[12:15], s46 offen
    s_add_u32 s46, s46, 131072
    buffer_load_dwordx4 v[132:135], v4, s[12:15], s46 offen
    s_add_u32 s46, s46, 131072
    buffer_load_dwordx4 v[136:139], v4, s[12:15], s46 offen
    s_add_u32 s46, s46, 131072
    buffer_load_dwordx4 v[140:143], v4, s[12:15], s46 offen
    s_add_u32 s46, s46, 131072
    buffer_load_dwordx4 v[144:147], v4, s[12:15], s46 offen
    s_add_u32 s46, s46, 131072
    buffer_load_dwordx4 v[148:151], v4, s[12:15], s46 offen
    s_add_u32 s46, s46, 131072
    buffer_load_dwordx4 v[152:155], v4, s[12:15], s46 offen
    s_add_u32 s46, s46, 131072
    buffer_load_dwordx4 v[156:159], v4, s[12:15], s46 offen
    s_add_u32 s46, s46, 131072
    buffer_load_dwordx4 v[160:163], v4, s[12:15], s46 offen
    s_add_u32 s46, s46, 131072
    buffer_load_dwordx4 v[164:167], v4, s[12:15], s46 offen
    s_add_u32 s46, s46, 131072
    buffer_load_dwordx4 v[168:171], v4, s[12:15], s46 offen
    s_add_u32 s46, s46, 131072
    buffer_load_dwordx4 v[172:175], v4, s[12:15], s46 offen
    s_add_u32 s46, s46, 131072
    buffer_load_dwordx4 v[176:179], v4, s[12:15], s46 offen
    s_add_u32 s46, s46, 131072
    buffer_load_dwordx4 v[180:183], v4, s[12:15], s46 offen
    s_add_u32 s46, s46, 131072
    buffer_load_dwordx4 v[184:187], v4, s[12:15], s46 offen
    s_add_u32 s46, s46, 131072
    buffer_load_dwordx4 v[188:191], v4, s[12:15], s46 offen
    s_mov_b32 s12, s64
    s_and_b32 s13, s65, 0xffff
    s_mov_b32 s14, 0x800000
    s_mov_b32 s15, 0x20000
    v_lshrrev_b32 v4, 2, v0
    s_mov_b32 s45, 8192
    v_mul_lo_u32 v4, v4, s45
    v_and_b32 v6, 3, v0
    v_lshl_add_u32 v4, v6, 4, v4
    s_mov_b32 s46, s48
    buffer_load_dwordx4 v[192:195], v4, s[12:15], s46 offen
    s_add_u32 s46, s46, 131072
    buffer_load_dwordx4 v[196:199], v4, s[12:15], s46 offen
    s_add_u32 s46, s46, 131072
    buffer_load_dwordx4 v[200:203], v4, s[12:15], s46 offen
    s_add_u32 s46, s46, 131072
    buffer_load_dwordx4 v[204:207], v4, s[12:15], s46 offen
    s_add_u32 s46, s46, 131072
    buffer_load_dwordx4 v[208:211], v4, s[12:15], s46 offen
    s_add_u32 s46, s46, 131072
    buffer_load_dwordx4 v[212:215], v4, s[12:15], s46 offen
    s_add_u32 s46, s46, 131072
    buffer_load_dwordx4 v[216:219], v4, s[12:15], s46 offen
    s_add_u32 s46, s46, 131072
    buffer_load_dwordx4 v[220:223], v4, s[12:15], s46 offen
    s_add_u32 s46, s46, 131072
    buffer_load_dwordx4 v[224:227], v4, s[12:15], s46 offen
    s_add_u32 s46, s46, 131072
    buffer_load_dwordx4 v[228:231], v4, s[12:15], s46 offen
    s_add_u32 s46, s46, 131072
    buffer_load_dwordx4 v[232:235], v4, s[12:15], s46 offen
    s_add_u32 s46, s46, 131072
    buffer_load_dwordx4 v[236:239], v4, s[12:15], s46 offen
    s_add_u32 s46, s46, 131072
    buffer_load_dwordx4 v[240:243], v4, s[12:15], s46 offen
    s_add_u32 s46, s46, 131072
    buffer_load_dwordx4 v[244:247], v4, s[12:15], s46 offen
    s_add_u32 s46, s46, 131072
    buffer_load_dwordx4 v[248:251], v4, s[12:15], s46 offen
    s_add_u32 s46, s46, 131072
    buffer_load_dwordx4 v[252:255], v4, s[12:15], s46 offen
    s_lshl_b32 s45, s34, 14
    v_lshlrev_b32 v5, 4, v0
    v_add_u32 v5, s45, v5
    v_lshrrev_b32 v4, 4, v0
    v_lshlrev_b32 v4, 9, v4
    v_bfe_u32 v6, v0, 2, 1
    v_lshl_add_u32 v4, v6, 6, v4
    v_bfe_u32 v6, v0, 3, 1
    v_lshl_add_u32 v4, v6, 8, v4
    v_and_b32 v6, 3, v0
    v_lshl_add_u32 v4, v6, 4, v4
    v_add_u32 v4, s45, v4
    s_waitcnt vmcnt(32)
    ds_write_b128 v5, v[64:67] offset:0
    ds_write_b128 v5, v[68:71] offset:1024
    ds_write_b128 v5, v[72:75] offset:2048
    ds_write_b128 v5, v[76:79] offset:3072
    ds_write_b128 v5, v[80:83] offset:4096
    ds_write_b128 v5, v[84:87] offset:5120
    ds_write_b128 v5, v[88:91] offset:6144
    ds_write_b128 v5, v[92:95] offset:7168
    ds_write_b128 v5, v[96:99] offset:8192
    ds_write_b128 v5, v[100:103] offset:9216
    ds_write_b128 v5, v[104:107] offset:10240
    ds_write_b128 v5, v[108:111] offset:11264
    ds_write_b128 v5, v[112:115] offset:12288
    ds_write_b128 v5, v[116:119] offset:13312
    ds_write_b128 v5, v[120:123] offset:14336
    ds_write_b128 v5, v[124:127] offset:15360
    s_waitcnt lgkmcnt(0)
    ds_read_b64_tr_b16 v[64:65], v4 offset:0
    ds_read_b64_tr_b16 v[66:67], v4 offset:128
    ds_read_b64_tr_b16 v[72:73], v4 offset:8
    ds_read_b64_tr_b16 v[74:75], v4 offset:136
    ds_read_b64_tr_b16 v[68:69], v4 offset:2048
    ds_read_b64_tr_b16 v[70:71], v4 offset:2176
    ds_read_b64_tr_b16 v[76:77], v4 offset:2056
    ds_read_b64_tr_b16 v[78:79], v4 offset:2184
    s_waitcnt lgkmcnt(0)
    ds_read_b64_tr_b16 v[80:81], v4 offset:4096
    ds_read_b64_tr_b16 v[82:83], v4 offset:4224
    ds_read_b64_tr_b16 v[88:89], v4 offset:4104
    ds_read_b64_tr_b16 v[90:91], v4 offset:4232
    ds_read_b64_tr_b16 v[84:85], v4 offset:6144
    ds_read_b64_tr_b16 v[86:87], v4 offset:6272
    ds_read_b64_tr_b16 v[92:93], v4 offset:6152
    ds_read_b64_tr_b16 v[94:95], v4 offset:6280
    s_waitcnt lgkmcnt(0)
    ds_read_b64_tr_b16 v[96:97], v4 offset:8192
    ds_read_b64_tr_b16 v[98:99], v4 offset:8320
    ds_read_b64_tr_b16 v[104:105], v4 offset:8200
    ds_read_b64_tr_b16 v[106:107], v4 offset:8328
    ds_read_b64_tr_b16 v[100:101], v4 offset:10240
    ds_read_b64_tr_b16 v[102:103], v4 offset:10368
    ds_read_b64_tr_b16 v[108:109], v4 offset:10248
    ds_read_b64_tr_b16 v[110:111], v4 offset:10376
    s_waitcnt lgkmcnt(0)
    ds_read_b64_tr_b16 v[112:113], v4 offset:12288
    ds_read_b64_tr_b16 v[114:115], v4 offset:12416
    ds_read_b64_tr_b16 v[120:121], v4 offset:12296
    ds_read_b64_tr_b16 v[122:123], v4 offset:12424
    ds_read_b64_tr_b16 v[116:117], v4 offset:14336
    ds_read_b64_tr_b16 v[118:119], v4 offset:14464
    ds_read_b64_tr_b16 v[124:125], v4 offset:14344
    ds_read_b64_tr_b16 v[126:127], v4 offset:14472
    s_waitcnt lgkmcnt(0)
    s_waitcnt vmcnt(16)
    ds_write_b128 v5, v[128:131] offset:0
    ds_write_b128 v5, v[132:135] offset:1024
    ds_write_b128 v5, v[136:139] offset:2048
    ds_write_b128 v5, v[140:143] offset:3072
    ds_write_b128 v5, v[144:147] offset:4096
    ds_write_b128 v5, v[148:151] offset:5120
    ds_write_b128 v5, v[152:155] offset:6144
    ds_write_b128 v5, v[156:159] offset:7168
    ds_write_b128 v5, v[160:163] offset:8192
    ds_write_b128 v5, v[164:167] offset:9216
    ds_write_b128 v5, v[168:171] offset:10240
    ds_write_b128 v5, v[172:175] offset:11264
    ds_write_b128 v5, v[176:179] offset:12288
    ds_write_b128 v5, v[180:183] offset:13312
    ds_write_b128 v5, v[184:187] offset:14336
    ds_write_b128 v5, v[188:191] offset:15360
    s_waitcnt lgkmcnt(0)
    ds_read_b64_tr_b16 v[128:129], v4 offset:0
    ds_read_b64_tr_b16 v[130:131], v4 offset:128
    ds_read_b64_tr_b16 v[136:137], v4 offset:8
    ds_read_b64_tr_b16 v[138:139], v4 offset:136
    ds_read_b64_tr_b16 v[132:133], v4 offset:2048
    ds_read_b64_tr_b16 v[134:135], v4 offset:2176
    ds_read_b64_tr_b16 v[140:141], v4 offset:2056
    ds_read_b64_tr_b16 v[142:143], v4 offset:2184
    s_waitcnt lgkmcnt(0)
    ds_read_b64_tr_b16 v[144:145], v4 offset:4096
    ds_read_b64_tr_b16 v[146:147], v4 offset:4224
    ds_read_b64_tr_b16 v[152:153], v4 offset:4104
    ds_read_b64_tr_b16 v[154:155], v4 offset:4232
    ds_read_b64_tr_b16 v[148:149], v4 offset:6144
    ds_read_b64_tr_b16 v[150:151], v4 offset:6272
    ds_read_b64_tr_b16 v[156:157], v4 offset:6152
    ds_read_b64_tr_b16 v[158:159], v4 offset:6280
    s_waitcnt lgkmcnt(0)
    ds_read_b64_tr_b16 v[160:161], v4 offset:8192
    ds_read_b64_tr_b16 v[162:163], v4 offset:8320
    ds_read_b64_tr_b16 v[168:169], v4 offset:8200
    ds_read_b64_tr_b16 v[170:171], v4 offset:8328
    ds_read_b64_tr_b16 v[164:165], v4 offset:10240
    ds_read_b64_tr_b16 v[166:167], v4 offset:10368
    ds_read_b64_tr_b16 v[172:173], v4 offset:10248
    ds_read_b64_tr_b16 v[174:175], v4 offset:10376
    s_waitcnt lgkmcnt(0)
    ds_read_b64_tr_b16 v[176:177], v4 offset:12288
    ds_read_b64_tr_b16 v[178:179], v4 offset:12416
    ds_read_b64_tr_b16 v[184:185], v4 offset:12296
    ds_read_b64_tr_b16 v[186:187], v4 offset:12424
    ds_read_b64_tr_b16 v[180:181], v4 offset:14336
    ds_read_b64_tr_b16 v[182:183], v4 offset:14464
    ds_read_b64_tr_b16 v[188:189], v4 offset:14344
    ds_read_b64_tr_b16 v[190:191], v4 offset:14472
    s_waitcnt lgkmcnt(0)
    s_waitcnt vmcnt(0)
    ds_write_b128 v5, v[192:195] offset:0
    ds_write_b128 v5, v[196:199] offset:1024
    ds_write_b128 v5, v[200:203] offset:2048
    ds_write_b128 v5, v[204:207] offset:3072
    ds_write_b128 v5, v[208:211] offset:4096
    ds_write_b128 v5, v[212:215] offset:5120
    ds_write_b128 v5, v[216:219] offset:6144
    ds_write_b128 v5, v[220:223] offset:7168
    ds_write_b128 v5, v[224:227] offset:8192
    ds_write_b128 v5, v[228:231] offset:9216
    ds_write_b128 v5, v[232:235] offset:10240
    ds_write_b128 v5, v[236:239] offset:11264
    ds_write_b128 v5, v[240:243] offset:12288
    ds_write_b128 v5, v[244:247] offset:13312
    ds_write_b128 v5, v[248:251] offset:14336
    ds_write_b128 v5, v[252:255] offset:15360
    s_waitcnt lgkmcnt(0)
    ds_read_b64_tr_b16 v[192:193], v4 offset:0
    ds_read_b64_tr_b16 v[194:195], v4 offset:128
    ds_read_b64_tr_b16 v[200:201], v4 offset:8
    ds_read_b64_tr_b16 v[202:203], v4 offset:136
    ds_read_b64_tr_b16 v[196:197], v4 offset:2048
    ds_read_b64_tr_b16 v[198:199], v4 offset:2176
    ds_read_b64_tr_b16 v[204:205], v4 offset:2056
    ds_read_b64_tr_b16 v[206:207], v4 offset:2184
    s_waitcnt lgkmcnt(0)
    ds_read_b64_tr_b16 v[208:209], v4 offset:4096
    ds_read_b64_tr_b16 v[210:211], v4 offset:4224
    ds_read_b64_tr_b16 v[216:217], v4 offset:4104
    ds_read_b64_tr_b16 v[218:219], v4 offset:4232
    ds_read_b64_tr_b16 v[212:213], v4 offset:6144
    ds_read_b64_tr_b16 v[214:215], v4 offset:6272
    ds_read_b64_tr_b16 v[220:221], v4 offset:6152
    ds_read_b64_tr_b16 v[222:223], v4 offset:6280
    s_waitcnt lgkmcnt(0)
    ds_read_b64_tr_b16 v[224:225], v4 offset:8192
    ds_read_b64_tr_b16 v[226:227], v4 offset:8320
    ds_read_b64_tr_b16 v[232:233], v4 offset:8200
    ds_read_b64_tr_b16 v[234:235], v4 offset:8328
    ds_read_b64_tr_b16 v[228:229], v4 offset:10240
    ds_read_b64_tr_b16 v[230:231], v4 offset:10368
    ds_read_b64_tr_b16 v[236:237], v4 offset:10248
    ds_read_b64_tr_b16 v[238:239], v4 offset:10376
    s_waitcnt lgkmcnt(0)
    ds_read_b64_tr_b16 v[240:241], v4 offset:12288
    ds_read_b64_tr_b16 v[242:243], v4 offset:12416
    ds_read_b64_tr_b16 v[248:249], v4 offset:12296
    ds_read_b64_tr_b16 v[250:251], v4 offset:12424
    ds_read_b64_tr_b16 v[244:245], v4 offset:14336
    ds_read_b64_tr_b16 v[246:247], v4 offset:14464
    ds_read_b64_tr_b16 v[252:253], v4 offset:14344
    ds_read_b64_tr_b16 v[254:255], v4 offset:14472
    s_waitcnt lgkmcnt(0)
    s_barrier
    s_bitcmp1_b32 s2, 31
    s_cbranch_scc1 VDCS_0_OK
    v_mov_b32 v4, 147456
    ds_read_b32 v5, v4
    s_bitset1_b32 s2, 31
    s_waitcnt lgkmcnt(0)
    v_readfirstlane_b32 s40, v5
    s_cmp_lg_u32 s40, 0
    s_cbranch_scc1 R_RESTART
VDCS_0_OK:
    s_mov_b32 s40, 0x00ff00ff
    s_mov_b32 s41, 0x00ff00ff
    s_lshl_b32 s45, s32, 14
    s_lshl_b32 s46, s34, 12
    s_add_u32 s45, s45, s46
    v_add_u32 v3, s45, v2
    s_lshl_b32 s45, s34, 10
    v_add_u32 v4, s45, v2
    v_lshrrev_b32 v6, 4, v0
    v_mul_u32_u24 v6, 576, v6
    v_bfe_u32 v7, v0, 2, 2
    v_lshl_add_u32 v6, v7, 5, v6
    v_and_b32 v7, 3, v0
    v_lshl_add_u32 v6, v7, 2, v6
    s_mul_i32 s45, s34, 2304
    v_add_u32 v6, s45, v6
    v_mov_b32 v7, 0xeeee
    v_mov_b32 v1, 0x4444
    v_cndmask_b32 v7, v7, v1, s[40:41]
    v_mov_b32 v40, 0
    v_mov_b32 v41, 0
    v_mov_b32 v42, 0
    v_mov_b32 v43, 0
    v_mov_b32 v44, 0
    v_mov_b32 v45, 0
    v_mov_b32 v46, 0
    v_mov_b32 v47, 0
    v_mov_b32 v48, 0
    v_mov_b32 v49, 0
    v_mov_b32 v50, 0
    v_mov_b32 v51, 0
    v_mov_b32 v52, 0
    v_mov_b32 v53, 0
    v_mov_b32 v54, 0
    v_mov_b32 v55, 0
    v_mov_b32 v56, 0
    v_mov_b32 v57, 0
    v_mov_b32 v58, 0
    v_mov_b32 v59, 0
    v_mov_b32 v60, 0
    v_mov_b32 v61, 0
    v_mov_b32 v62, 0
    v_mov_b32 v63, 0
CS_Q_LOOP:
    s_barrier
    s_sleep 2
    s_mov_b32 s44, 0
CS_QP_R0:
    buffer_load_dwordx4 v[8:11], v3, s[8:11], s36 offen offset:0 sc1
    buffer_load_dwordx4 v[12:15], v3, s[8:11], s36 offen offset:1024 sc1
    buffer_load_dwordx4 v[16:19], v3, s[8:11], s36 offen offset:2048 sc1
    buffer_load_dwordx4 v[20:23], v3, s[8:11], s36 offen offset:3072 sc1
    s_add_u32 s44, s44, 1
    s_cmp_gt_u32 s44, 60000
    s_cbranch_scc1 C_DONE
    s_waitcnt vmcnt(3)
    v_max3_u32 v5, v8, v9, v10
    v_max_u32 v5, v5, v11
    v_cmp_eq_u32 vcc, -1, v5
    s_cbranch_vccnz CS_QP_R0
    v_smfmac_f32_16x16x64_bf16 v[40:43], v[8:11], v[192:199], v7
    s_waitcnt vmcnt(2)
    v_smfmac_f32_16x16x64_bf16 v[48:51], v[8:11], v[64:71], v7
    v_max3_u32 v5, v12, v13, v14
    v_smfmac_f32_16x16x64_bf16 v[44:47], v[8:11], v[200:207], v7
    v_max_u32 v5, v5, v15
    v_cmp_eq_u32 vcc, -1, v5
    v_smfmac_f32_16x16x64_bf16 v[52:55], v[8:11], v[72:79], v7
    s_cbranch_vccnz CS_QP_R1
CS_QP_B1:
    v_smfmac_f32_16x16x64_bf16 v[40:43], v[12:15], v[208:215], v7
    s_waitcnt vmcnt(1)
    v_smfmac_f32_16x16x64_bf16 v[48:51], v[12:15], v[80:87], v7
    v_max3_u32 v5, v16, v17, v18
    v_smfmac_f32_16x16x64_bf16 v[44:47], v[12:15], v[216:223], v7
    v_max_u32 v5, v5, v19
    v_cmp_eq_u32 vcc, -1, v5
    v_smfmac_f32_16x16x64_bf16 v[52:55], v[12:15], v[88:95], v7
    s_cbranch_vccnz CS_QP_R2
CS_QP_B2:
    v_smfmac_f32_16x16x64_bf16 v[40:43], v[16:19], v[224:231], v7
    s_waitcnt vmcnt(0)
    v_smfmac_f32_16x16x64_bf16 v[48:51], v[16:19], v[96:103], v7
    v_max3_u32 v5, v20, v21, v22
    v_smfmac_f32_16x16x64_bf16 v[44:47], v[16:19], v[232:239], v7
    v_max_u32 v5, v5, v23
    v_cmp_eq_u32 vcc, -1, v5
    v_smfmac_f32_16x16x64_bf16 v[52:55], v[16:19], v[104:111], v7
    s_cbranch_vccnz CS_QP_R3
CS_QP_B3:
    v_smfmac_f32_16x16x64_bf16 v[40:43], v[20:23], v[240:247], v7
    v_smfmac_f32_16x16x64_bf16 v[48:51], v[20:23], v[112:119], v7
    v_smfmac_f32_16x16x64_bf16 v[44:47], v[20:23], v[248:255], v7
    v_smfmac_f32_16x16x64_bf16 v[52:55], v[20:23], v[120:127], v7
    s_nop 5
    v_permlane32_swap_b32 v40, v48
    v_permlane32_swap_b32 v41, v49
    v_permlane32_swap_b32 v42, v50
    v_permlane32_swap_b32 v43, v51
    v_permlane32_swap_b32 v44, v52
    v_permlane32_swap_b32 v45, v53
    v_permlane32_swap_b32 v46, v54
    v_permlane32_swap_b32 v47, v55
    v_add_f32 v40, v40, v48
    v_add_f32 v44, v44, v52
    ds_write2_b32 v6, v40, v44 offset0:0 offset1:4
    v_add_f32 v41, v41, v49
    v_add_f32 v45, v45, v53
    ds_write2_b32 v6, v41, v45 offset0:36 offset1:40
    v_add_f32 v42, v42, v50
    v_add_f32 v46, v46, v54
    ds_write2_b32 v6, v42, v46 offset0:72 offset1:76
    v_add_f32 v43, v43, v51
    v_add_f32 v47, v47, v55
    ds_write2_b32 v6, v43, v47 offset0:108 offset1:112
    v_smfmac_f32_16x16x64_bf16 v[56:59], v[8:11], v[128:135], v7
    v_smfmac_f32_16x16x64_bf16 v[60:63], v[8:11], v[136:143], v7
    s_waitcnt lgkmcnt(0)
    s_barrier
    v_smfmac_f32_16x16x64_bf16 v[56:59], v[12:15], v[144:151], v7
    v_smfmac_f32_16x16x64_bf16 v[60:63], v[12:15], v[152:159], v7
    v_smfmac_f32_16x16x64_bf16 v[56:59], v[16:19], v[160:167], v7
    v_smfmac_f32_16x16x64_bf16 v[60:63], v[16:19], v[168:175], v7
    v_smfmac_f32_16x16x64_bf16 v[56:59], v[20:23], v[176:183], v7
    v_smfmac_f32_16x16x64_bf16 v[60:63], v[20:23], v[184:191], v7
    s_nop 7
    v_permlane32_swap_b32 v56, v60
    v_permlane32_swap_b32 v57, v61
    v_permlane32_swap_b32 v58, v62
    v_permlane32_swap_b32 v59, v63
    v_add_f32 v56, v56, v60
    v_add_f32 v57, v57, v61
    v_add_f32 v58, v58, v62
    v_add_f32 v59, v59, v63
    ds_write_b128 v4, v[56:59] offset:9216
    s_waitcnt lgkmcnt(0)
    s_barrier
    s_cmp_eq_u32 s35, 63
    s_cbranch_scc1 C_FIN
    s_barrier
    s_barrier
    s_sleep 4
    v_mov_b32 v40, 0
    v_mov_b32 v41, 0
    v_mov_b32 v42, 0
    v_mov_b32 v43, 0
    v_mov_b32 v44, 0
    v_mov_b32 v45, 0
    v_mov_b32 v46, 0
    v_mov_b32 v47, 0
    v_mov_b32 v48, 0
    v_mov_b32 v49, 0
    v_mov_b32 v50, 0
    v_mov_b32 v51, 0
    v_mov_b32 v52, 0
    v_mov_b32 v53, 0
    v_mov_b32 v54, 0
    v_mov_b32 v55, 0
    v_mov_b32 v56, 0
    v_mov_b32 v57, 0
    v_mov_b32 v58, 0
    v_mov_b32 v59, 0
    v_mov_b32 v60, 0
    v_mov_b32 v61, 0
    v_mov_b32 v62, 0
    v_mov_b32 v63, 0
    s_mov_b32 s36, s37
    s_mov_b32 s37, s38
    s_add_u32 s38, s38, 524288
    s_cmp_eq_u32 s38, 96468992
    s_cselect_b32 s38, 94371840, s38
    s_add_u32 s35, s35, 1
    s_lshr_b32 s27, s35, 3
    s_lshl_b32 s27, s27, 22
    s_and_b32 s28, s35, 7
    s_lshl_b32 s28, s28, 18
    s_add_u32 s27, s27, s28
    s_branch CS_Q_LOOP
CS_QP_R1:
    buffer_load_dwordx4 v[12:15], v3, s[8:11], s36 offen offset:1024 sc1
    buffer_load_dwordx4 v[16:19], v3, s[8:11], s36 offen offset:2048 sc1
    buffer_load_dwordx4 v[20:23], v3, s[8:11], s36 offen offset:3072 sc1
    s_add_u32 s44, s44, 1
    s_cmp_gt_u32 s44, 60000
    s_cbranch_scc1 C_DONE
    s_waitcnt vmcnt(2)
    v_max3_u32 v5, v12, v13, v14
    v_max_u32 v5, v5, v15
    v_cmp_eq_u32 vcc, -1, v5
    s_cbranch_vccnz CS_QP_R1
    s_branch CS_QP_B1
CS_QP_R2:
    buffer_load_dwordx4 v[16:19], v3, s[8:11], s36 offen offset:2048 sc1
    buffer_load_dwordx4 v[20:23], v3, s[8:11], s36 offen offset:3072 sc1
    s_add_u32 s44, s44, 1
    s_cmp_gt_u32 s44, 60000
    s_cbranch_scc1 C_DONE
    s_waitcnt vmcnt(1)
    v_max3_u32 v5, v16, v17, v18
    v_max_u32 v5, v5, v19
    v_cmp_eq_u32 vcc, -1, v5
    s_cbranch_vccnz CS_QP_R2
    s_branch CS_QP_B2
CS_QP_R3:
    buffer_load_dwordx4 v[20:23], v3, s[8:11], s36 offen offset:3072 sc1
    s_add_u32 s44, s44, 1
    s_cmp_gt_u32 s44, 60000
    s_cbranch_scc1 C_DONE
    s_waitcnt vmcnt(0)
    v_max3_u32 v5, v20, v21, v22
    v_max_u32 v5, v5, v23
    v_cmp_eq_u32 vcc, -1, v5
    s_cbranch_vccnz CS_QP_R3
    s_branch CS_QP_B3
CS_WO:
    v_lshrrev_b32 v6, 4, v0
    v_lshlrev_b32 v6, 7, v6
    v_and_b32 v7, 7, v0
    v_lshl_add_u32 v6, v7, 4, v6
    v_lshrrev_b32 v7, 5, v0
    v_lshlrev_b32 v7, 8, v7
    v_and_b32 v8, 15, v0
    v_lshl_add_u32 v7, v8, 4, v7
    v_bfe_u32 v8, v0, 4, 1
    v_lshl_add_u32 v7, v8, 3, v7
    s_xor_b32 s45, s47, 2
    s_lshl_b32 s45, s45, 9
    v_add_u32 v6, s45, v6
    s_xor_b32 s45, s47, 8
    s_lshl_b32 s45, s45, 9
    v_add_u32 v7, s45, v7
    s_lshl_b32 s45, s32, 10
    s_lshr_b32 s46, s33, 1
    s_lshl_b32 s46, s46, 14
    s_add_u32 s45, s45, s46
    s_and_b32 s46, s33, 1
    s_lshl_b32 s46, s46, 12
    s_add_u32 s45, s45, s46
    s_add_u32 s45, s45, 134217728
    v_add_u32 v8, s45, v2
    s_mul_i32 s45, s47, 1280
    s_add_u32 s45, s45, 131072
    v_add_u32 v9, s45, v2
    v_mov_b32 v12, -1
    v_mov_b32 v13, -1
    v_mov_b32 v14, -1
    v_mov_b32 v15, -1
    s_cmp_lg_u32 s34, 4
    s_cbranch_scc1 CS_NI
    s_mov_b32 s46, 94371840
    buffer_store_dwordx4 v[12:15], v9, s[8:11], s46 offen sc1
    buffer_store_dwordx2 v[12:13], v7, s[8:11], s46 offen offset:0 sc1
    s_add_u32 s45, s46, 65536
    buffer_store_dwordx2 v[12:13], v7, s[8:11], s45 offen sc1
    s_mov_b64 exec, 0xffff
    buffer_store_dwordx4 v[12:15], v9, s[8:11], s46 offen offset:1024 sc1
    s_mov_b64 exec, -1
    s_mov_b32 s46, 94896128
    buffer_store_dwordx4 v[12:15], v9, s[8:11], s46 offen sc1
    buffer_store_dwordx2 v[12:13], v7, s[8:11], s46 offen offset:0 sc1
    s_add_u32 s45, s46, 65536
    buffer_store_dwordx2 v[12:13], v7, s[8:11], s45 offen sc1
    s_mov_b64 exec, 0xffff
    buffer_store_dwordx4 v[12:15], v9, s[8:11], s46 offen offset:1024 sc1
    s_mov_b64 exec, -1
    s_mov_b32 s46, 95420416
    buffer_store_dwordx4 v[12:15], v9, s[8:11], s46 offen sc1
    buffer_store_dwordx2 v[12:13], v7, s[8:11], s46 offen offset:0 sc1
    s_add_u32 s45, s46, 65536
    buffer_store_dwordx2 v[12:13], v7, s[8:11], s45 offen sc1
    s_mov_b64 exec, 0xffff
    buffer_store_dwordx4 v[12:15], v9, s[8:11], s46 offen offset:1024 sc1
    s_mov_b64 exec, -1
    s_mov_b32 s46, 95944704
    buffer_store_dwordx4 v[12:15], v9, s[8:11], s46 offen sc1
    buffer_store_dwordx2 v[12:13], v7, s[8:11], s46 offen offset:0 sc1
    s_add_u32 s45, s46, 65536
    buffer_store_dwordx2 v[12:13], v7, s[8:11], s45 offen sc1
    s_mov_b64 exec, 0xffff
    buffer_store_dwordx4 v[12:15], v9, s[8:11], s46 offen offset:1024 sc1
    s_mov_b64 exec, -1
    s_mov_b32 s12, s62
    s_and_b32 s13, s63, 0xffff
    s_mov_b32 s14, 0x4000
    s_mov_b32 s15, 0x20000
    v_and_b32 v10, 7, v0
    v_lshlrev_b32 v10, 11, v10
    v_lshrrev_b32 v11, 4, v0
    v_lshl_add_u32 v10, v11, 4, v10
    v_bfe_u32 v11, v0, 3, 1
    v_lshl_add_u32 v10, v11, 3, v10
    s_lshl_b32 s45, s33, 6
    buffer_load_dwordx2 v[16:17], v10, s[12:15], s45 offen
CS_NI:
    s_cmp_lg_u32 s34, 7
    s_cbranch_scc1 CS_NOPROBE0
    s_and_b32 s96, s47, 7
    s_lshl_b32 s96, s96, 9
    s_lshr_b32 s97, s47, 3
    s_lshl_b32 s97, s97, 14
    s_add_u32 s96, s96, s97
    s_add_u32 s96, s96, 167772160
    v_and_b32 v26, 3, v0
    v_lshlrev_b32 v26, 12, v26
    v_bfe_u32 v27, v0, 2, 2
    v_lshl_add_u32 v26, v27, 7, v26
    s_mov_b64 exec, 0xffff
    buffer_store_dword v26, v26, s[8:11], s96 offen sc1
    s_mov_b64 exec, -1
CS_NOPROBE0:
    s_barrier
    s_cmp_lg_u32 s34, 7
    s_cbranch_scc1 CS_NOPROBE1
    s_and_b32 s96, s47, 7
    s_lshl_b32 s96, s96, 9
    s_lshr_b32 s97, s47, 3
    s_lshl_b32 s97, s97, 14
    s_add_u32 s96, s96, s97
    s_add_u32 s96, s96, 167772160
    s_waitcnt vmcnt(0)
    s_add_u32 s96, s84, s96
    s_addc_u32 s97, s85, 0
    s_load_dword s92, s[96:97], 0x40
    s_load_dword s92, s[96:97], 0x1040
    s_load_dword s92, s[96:97], 0x2040
    s_load_dword s92, s[96:97], 0x3040
    s_mov_b32 s94, -1
    s_mov_b32 s95, -1
    s_waitcnt lgkmcnt(0)
    s_memtime s[90:91]
    s_waitcnt lgkmcnt(0)
    s_load_dword s92, s[96:97], 0x80
    s_waitcnt lgkmcnt(0)
    s_memtime s[92:93]
    s_waitcnt lgkmcnt(0)
    s_sub_u32 s92, s92, s90
    s_min_u32 s94, s94, s92
    s_memtime s[90:91]
    s_waitcnt lgkmcnt(0)
    s_load_dword s92, s[96:97], 0x2080
    s_waitcnt lgkmcnt(0)
    s_memtime s[92:93]
    s_waitcnt lgkmcnt(0)
    s_sub_u32 s92, s92, s90
    s_min_u32 s95, s95, s92
    s_memtime s[90:91]
    s_waitcnt lgkmcnt(0)
    s_load_dword s92, s[96:97], 0x3080
    s_waitcnt lgkmcnt(0)
    s_memtime s[92:93]
    s_waitcnt lgkmcnt(0)
    s_sub_u32 s92, s92, s90
    s_min_u32 s95, s95, s92
    s_memtime s[90:91]
    s_waitcnt lgkmcnt(0)
    s_load_dword s92, s[96:97], 0x1080
    s_waitcnt lgkmcnt(0)
    s_memtime s[92:93]
    s_waitcnt lgkmcnt(0)
    s_sub_u32 s92, s92, s90
    s_min_u32 s94, s94, s92
    s_memtime s[90:91]
    s_waitcnt lgkmcnt(0)
    s_load_dword s92, s[96:97], 0x100
    s_waitcnt lgkmcnt(0)
    s_memtime s[92:93]
    s_waitcnt lgkmcnt(0)
    s_sub_u32 s92, s92, s90
    s_min_u32 s94, s94, s92
    s_memtime s[90:91]
    s_waitcnt lgkmcnt(0)
    s_load_dword s92, s[96:97], 0x2100
    s_waitcnt lgkmcnt(0)
    s_memtime s[92:93]
    s_waitcnt lgkmcnt(0)
    s_sub_u32 s92, s92, s90
    s_min_u32 s95, s95, s92
    s_memtime s[90:91]
    s_waitcnt lgkmcnt(0)
    s_load_dword s92, s[96:97], 0x3100
    s_waitcnt lgkmcnt(0)
    s_memtime s[92:93]
    s_waitcnt lgkmcnt(0)
    s_sub_u32 s92, s92, s90
    s_min_u32 s95, s95, s92
    s_memtime s[90:91]
    s_waitcnt lgkmcnt(0)
    s_load_dword s92, s[96:97], 0x1100
    s_waitcnt lgkmcnt(0)
    s_memtime s[92:93]
    s_waitcnt lgkmcnt(0)
    s_sub_u32 s92, s92, s90
    s_min_u32 s94, s94, s92
    s_cmp_lt_u32 s95, s94
    s_cselect_b32 s29, 1, 0
    s_getreg_b32 s90, hwreg(HW_REG_XCC_ID)
    s_and_b32 s90, s90, 7
    s_lshl_b32 s91, s90, 2
    s_lshr_b32 s90, 0x73625140, s91
    s_and_b32 s90, s90, 7
    s_lshl_b32 s90, s90, 2
    s_add_u32 s90, s90, 64
    s_lshl_b32 s29, s29, 8
    s_add_u32 s29, s29, 1
    s_atomic_add s29, s[82:83], s90
CS_NOPROBE1:
    s_cmp_lg_u32 s34, 4
    s_cbranch_scc1 CLCS_
    s_bitcmp1_b32 s2, 30
    s_cbranch_scc1 CLCS_
    s_getreg_b32 s40, hwreg(HW_REG_XCC_ID)
    s_and_b32 s40, s40, 7
    s_lshl_b32 s41, s40, 2
    s_lshr_b32 s40, 0x73625140, s41
    s_and_b32 s40, s40, 7
    s_lshl_b32 s40, s40, 3
    s_bitset1_b32 s2, 30
    s_waitcnt vmcnt(0)
    s_atomic_add_x2 s[72:73], s[82:83], s40 glc
CLCS_:
    s_lshl_b32 s48, s32, 21
    s_sub_u32 s45, s34, 4
    s_lshl_b32 s45, s45, 19
    s_add_u32 s48, s48, s45
    s_lshl_b32 s45, s33, 6
    s_add_u32 s48, s48, s45
    s_mov_b32 s12, s70
    s_and_b32 s13, s71, 0xffff
    s_mov_b32 s14, 0x800000
    s_mov_b32 s15, 0x20000
    v_lshrrev_b32 v20, 2, v0
    s_mov_b32 s45, 2048
    v_mul_lo_u32 v20, v20, s45
    v_and_b32 v22, 3, v0
    v_lshl_add_u32 v20, v22, 4, v20
    s_mov_b32 s46, s48
    buffer_load_dwordx4 v[192:195], v20, s[12:15], s46 offen
    s_add_u32 s46, s46, 32768
    buffer_load_dwordx4 v[196:199], v20, s[12:15], s46 offen
    s_add_u32 s46, s46, 32768
    buffer_load_dwordx4 v[200:203], v20, s[12:15], s46 offen
    s_add_u32 s46, s46, 32768
    buffer_load_dwordx4 v[204:207], v20, s[12:15], s46 offen
    s_add_u32 s46, s46, 32768
    buffer_load_dwordx4 v[208:211], v20, s[12:15], s46 offen
    s_add_u32 s46, s46, 32768
    buffer_load_dwordx4 v[212:215], v20, s[12:15], s46 offen
    s_add_u32 s46, s46, 32768
    buffer_load_dwordx4 v[216:219], v20, s[12:15], s46 offen
    s_add_u32 s46, s46, 32768
    buffer_load_dwordx4 v[220:223], v20, s[12:15], s46 offen
    s_add_u32 s46, s46, 32768
    buffer_load_dwordx4 v[224:227], v20, s[12:15], s46 offen
    s_add_u32 s46, s46, 32768
    buffer_load_dwordx4 v[228:231], v20, s[12:15], s46 offen
    s_add_u32 s46, s46, 32768
    buffer_load_dwordx4 v[232:235], v20, s[12:15], s46 offen
    s_add_u32 s46, s46, 32768
    buffer_load_dwordx4 v[236:239], v20, s[12:15], s46 offen
    s_add_u32 s46, s46, 32768
    buffer_load_dwordx4 v[240:243], v20, s[12:15], s46 offen
    s_add_u32 s46, s46, 32768
    buffer_load_dwordx4 v[244:247], v20, s[12:15], s46 offen
    s_add_u32 s46, s46, 32768
    buffer_load_dwordx4 v[248:251], v20, s[12:15], s46 offen
    s_add_u32 s46, s46, 32768
    buffer_load_dwordx4 v[252:255], v20, s[12:15], s46 offen
    s_lshl_b32 s45, s34, 14
    v_lshlrev_b32 v21, 4, v0
    v_add_u32 v21, s45, v21
    v_lshrrev_b32 v20, 4, v0
    v_lshlrev_b32 v20, 9, v20
    v_bfe_u32 v22, v0, 2, 2
    v_lshl_add_u32 v20, v22, 6, v20
    v_and_b32 v22, 3, v0
    v_lshl_add_u32 v20, v22, 4, v20
    v_add_u32 v20, s45, v20
    s_waitcnt vmcnt(0)
    ds_write_b128 v21, v[192:195] offset:0
    ds_write_b128 v21, v[196:199] offset:1024
    ds_write_b128 v21, v[200:203] offset:2048
    ds_write_b128 v21, v[204:207] offset:3072
    ds_write_b128 v21, v[208:211] offset:4096
    ds_write_b128 v21, v[212:215] offset:5120
    ds_write_b128 v21, v[216:219] offset:6144
    ds_write_b128 v21, v[220:223] offset:7168
    ds_write_b128 v21, v[224:227] offset:8192
    ds_write_b128 v21, v[228:231] offset:9216
    ds_write_b128 v21, v[232:235] offset:10240
    ds_write_b128 v21, v[236:239] offset:11264
    ds_write_b128 v21, v[240:243] offset:12288
    ds_write_b128 v21, v[244:247] offset:13312
    ds_write_b128 v21, v[248:251] offset:14336
    ds_write_b128 v21, v[252:255] offset:15360
    s_waitcnt lgkmcnt(0)
    ds_read_b64_tr_b16 v[192:193], v20 offset:0
    ds_read_b64_tr_b16 v[194:195], v20 offset:256
    ds_read_b64_tr_b16 v[196:197], v20 offset:8
    ds_read_b64_tr_b16 v[198:199], v20 offset:264
    ds_read_b64_tr_b16 v[200:201], v20 offset:2048
    ds_read_b64_tr_b16 v[202:203], v20 offset:2304
    ds_read_b64_tr_b16 v[204:205], v20 offset:2056
    ds_read_b64_tr_b16 v[206:207], v20 offset:2312
    s_waitcnt lgkmcnt(0)
    ds_read_b64_tr_b16 v[208:209], v20 offset:4096
    ds_read_b64_tr_b16 v[210:211], v20 offset:4352
    ds_read_b64_tr_b16 v[212:213], v20 offset:4104
    ds_read_b64_tr_b16 v[214:215], v20 offset:4360
    ds_read_b64_tr_b16 v[216:217], v20 offset:6144
    ds_read_b64_tr_b16 v[218:219], v20 offset:6400
    ds_read_b64_tr_b16 v[220:221], v20 offset:6152
    ds_read_b64_tr_b16 v[222:223], v20 offset:6408
    s_waitcnt lgkmcnt(0)
    ds_read_b64_tr_b16 v[224:225], v20 offset:8192
    ds_read_b64_tr_b16 v[226:227], v20 offset:8448
    ds_read_b64_tr_b16 v[228:229], v20 offset:8200
    ds_read_b64_tr_b16 v[230:231], v20 offset:8456
    ds_read_b64_tr_b16 v[232:233], v20 offset:10240
    ds_read_b64_tr_b16 v[234:235], v20 offset:10496
    ds_read_b64_tr_b16 v[236:237], v20 offset:10248
    ds_read_b64_tr_b16 v[238:239], v20 offset:10504
    s_waitcnt lgkmcnt(0)
    ds_read_b64_tr_b16 v[240:241], v20 offset:12288
    ds_read_b64_tr_b16 v[242:243], v20 offset:12544
    ds_read_b64_tr_b16 v[244:245], v20 offset:12296
    ds_read_b64_tr_b16 v[246:247], v20 offset:12552
    ds_read_b64_tr_b16 v[248:249], v20 offset:14336
    ds_read_b64_tr_b16 v[250:251], v20 offset:14592
    ds_read_b64_tr_b16 v[252:253], v20 offset:14344
    ds_read_b64_tr_b16 v[254:255], v20 offset:14600
    s_waitcnt lgkmcnt(0)
    s_cmp_lg_u32 s34, 4
    s_cbranch_scc1 VCS__DONE
    s_bitcmp1_b32 s2, 31
    s_cbranch_scc1 VCS__DONE
    s_getreg_b32 s86, hwreg(HW_REG_XCC_ID)
    s_and_b32 s86, s86, 7
    s_lshl_b32 s92, s86, 2
    s_lshr_b32 s86, 0x73625140, s92
    s_and_b32 s86, s86, 7
    v_and_b32 v42, 15, v0
    v_lshlrev_b32 v42, 2, v42
    s_mov_b32 s93, 0
VCS__POLL:
    global_load_dword v43, v42, s[82:83] sc1
    s_add_u32 s93, s93, 1
    s_cmp_gt_u32 s93, 60000
    s_cbranch_scc1 C_DONE
    s_mov_b32 s88, 0
    s_mov_b32 s89, 0
    s_mov_b32 s90, 0
    s_mov_b32 s91, 0
    s_waitcnt vmcnt(0)
    v_readlane_b32 s92, v43, 1
    s_cmp_lg_u32 s92, 0x2000
    s_cselect_b32 s91, 1, s91
    s_lshr_b32 s92, s92, 8
    s_add_u32 s88, s88, s92
    s_cmp_lg_u32 s92, 32
    s_cselect_b32 s90, 1, s90
    s_cmp_gt_u32 s86, 0
    s_cselect_b32 s92, s92, 0
    s_add_u32 s89, s89, s92
    v_readlane_b32 s92, v43, 0
    s_cmp_lg_u32 s92, -1
    s_cselect_b32 s91, 1, s91
    v_readlane_b32 s92, v43, 3
    s_cmp_lg_u32 s92, 0x2000
    s_cselect_b32 s91, 1, s91
    s_lshr_b32 s92, s92, 8
    s_add_u32 s88, s88, s92
    s_cmp_lg_u32 s92, 32
    s_cselect_b32 s90, 1, s90
    s_cmp_gt_u32 s86, 1
    s_cselect_b32 s92, s92, 0
    s_add_u32 s89, s89, s92
    v_readlane_b32 s92, v43, 2
    s_cmp_lg_u32 s92, -1
    s_cselect_b32 s91, 1, s91
    v_readlane_b32 s92, v43, 5
    s_cmp_lg_u32 s92, 0x2000
    s_cselect_b32 s91, 1, s91
    s_lshr_b32 s92, s92, 8
    s_add_u32 s88, s88, s92
    s_cmp_lg_u32 s92, 32
    s_cselect_b32 s90, 1, s90
    s_cmp_gt_u32 s86, 2
    s_cselect_b32 s92, s92, 0
    s_add_u32 s89, s89, s92
    v_readlane_b32 s92, v43, 4
    s_cmp_lg_u32 s92, -1
    s_cselect_b32 s91, 1, s91
    v_readlane_b32 s92, v43, 7
    s_cmp_lg_u32 s92, 0x2000
    s_cselect_b32 s91, 1, s91
    s_lshr_b32 s92, s92, 8
    s_add_u32 s88, s88, s92
    s_cmp_lg_u32 s92, 32
    s_cselect_b32 s90, 1, s90
    s_cmp_gt_u32 s86, 3
    s_cselect_b32 s92, s92, 0
    s_add_u32 s89, s89, s92
    v_readlane_b32 s92, v43, 6
    s_cmp_lg_u32 s92, -1
    s_cselect_b32 s91, 1, s91
    v_readlane_b32 s92, v43, 9
    s_cmp_lg_u32 s92, 0x2000
    s_cselect_b32 s91, 1, s91
    s_lshr_b32 s92, s92, 8
    s_add_u32 s88, s88, s92
    s_cmp_lg_u32 s92, 32
    s_cselect_b32 s90, 1, s90
    s_cmp_gt_u32 s86, 4
    s_cselect_b32 s92, s92, 0
    s_add_u32 s89, s89, s92
    v_readlane_b32 s92, v43, 8
    s_cmp_lg_u32 s92, -1
    s_cselect_b32 s91, 1, s91
    v_readlane_b32 s92, v43, 11
    s_cmp_lg_u32 s92, 0x2000
    s_cselect_b32 s91, 1, s91
    s_lshr_b32 s92, s92, 8
    s_add_u32 s88, s88, s92
    s_cmp_lg_u32 s92, 32
    s_cselect_b32 s90, 1, s90
    s_cmp_gt_u32 s86, 5
    s_cselect_b32 s92, s92, 0
    s_add_u32 s89, s89, s92
    v_readlane_b32 s92, v43, 10
    s_cmp_lg_u32 s92, -1
    s_cselect_b32 s91, 1, s91
    v_readlane_b32 s92, v43, 13
    s_cmp_lg_u32 s92, 0x2000
    s_cselect_b32 s91, 1, s91
    s_lshr_b32 s92, s92, 8
    s_add_u32 s88, s88, s92
    s_cmp_lg_u32 s92, 32
    s_cselect_b32 s90, 1, s90
    s_cmp_gt_u32 s86, 6
    s_cselect_b32 s92, s92, 0
    s_add_u32 s89, s89, s92
    v_readlane_b32 s92, v43, 12
    s_cmp_lg_u32 s92, -1
    s_cselect_b32 s91, 1, s91
    v_readlane_b32 s92, v43, 15
    s_cmp_lg_u32 s92, 0x2000
    s_cselect_b32 s91, 1, s91
    s_lshr_b32 s92, s92, 8
    s_add_u32 s88, s88, s92
    s_cmp_lg_u32 s92, 32
    s_cselect_b32 s90, 1, s90
    s_cmp_gt_u32 s86, 7
    s_cselect_b32 s92, s92, 0
    s_add_u32 s89, s89, s92
    v_readlane_b32 s92, v43, 14
    s_cmp_lg_u32 s92, -1
    s_cselect_b32 s91, 1, s91
    s_cmp_lg_u32 s88, 256
    s_cbranch_scc1 VCS__POLL
    s_waitcnt lgkmcnt(0)
    s_lshr_b32 s87, s73, 8
    s_add_u32 s89, s89, s87
    s_lshl_b32 s92, s90, 8
    s_or_b32 s89, s89, s92
    s_or_b32 s89, s89, 0x8000
    s_or_b32 s91, s91, s90
    s_cselect_b32 s89, s89, 0
    v_mov_b32 v42, 147456
    v_mov_b32 v43, s89
    ds_write_b32 v42, v43
    s_waitcnt lgkmcnt(0)
VCS__DONE:
    s_barrier
    s_bitcmp1_b32 s2, 31
    s_cbranch_scc1 VDCS_4_OK
    v_mov_b32 v4, 147456
    ds_read_b32 v5, v4
    s_bitset1_b32 s2, 31
    s_waitcnt lgkmcnt(0)
    v_readfirstlane_b32 s40, v5
    s_cmp_lg_u32 s40, 0
    s_cbranch_scc1 R_RESTART
VDCS_4_OK:
    s_mov_b32 s40, 0x00ff00ff
    s_mov_b32 s41, 0x00ff00ff
    s_lshl_b32 s45, s32, 14
    s_sub_u32 s46, s34, 4
    s_lshl_b32 s46, s46, 12
    s_add_u32 s45, s45, s46
    s_add_u32 s45, s45, 65536
    v_add_u32 v3, s45, v1
    s_sub_u32 s45, s34, 4
    s_lshl_b32 s45, s45, 10
    v_add_u32 v4, s45, v2
    v_mov_b32 v48, 0
    v_mov_b32 v49, 0
    v_mov_b32 v50, 0
    v_mov_b32 v51, 0
    v_mov_b32 v52, 0
    v_mov_b32 v53, 0
    v_mov_b32 v54, 0
    v_mov_b32 v55, 0
    s_cmp_eq_u32 s34, 4
    s_cbranch_scc1 CS_W4
    s_cmp_eq_u32 s34, 5
    s_cbranch_scc1 CS_W5
    s_cmp_eq_u32 s34, 6
    s_cbranch_scc1 CS_W6
    s_lshl_b32 s45, s47, 18
    s_add_u32 s45, s45, 4096
    s_add_u32 s22, s84, s45
    s_addc_u32 s23, s85, 0
    s_setprio 2
    s_barrier
CS_W7_LOOP:
    s_add_u32 s45, s35, 2
    s_lshl_b32 s45, s45, 4
    s_and_b32 s45, s45, 0x380
    s_add_u32 s45, s45, 98566144
    s_load_dword s31, s[84:85], s45
    s_sleep 3
    s_cmp_ge_u32 s35, 63
    s_cbranch_scc1 CS_NWk0
    s_load_dword s20, s[22:23], 0x0
    s_load_dword s20, s[22:23], 0x40
    s_load_dword s20, s[22:23], 0x80
    s_load_dword s20, s[22:23], 0xc0
    s_load_dword s20, s[22:23], 0x100
    s_load_dword s20, s[22:23], 0x140
    s_load_dword s20, s[22:23], 0x180
    s_load_dword s20, s[22:23], 0x1c0
    s_load_dword s20, s[22:23], 0x200
    s_load_dword s20, s[22:23], 0x240
    s_load_dword s20, s[22:23], 0x280
CS_NWk0:
    s_barrier
    s_barrier
    buffer_store_dwordx4 v[12:15], v9, s[8:11], s38 offen sc1
    buffer_store_dwordx2 v[12:13], v7, s[8:11], s38 offen offset:0 sc1
    s_add_u32 s45, s38, 65536
    buffer_store_dwordx2 v[12:13], v7, s[8:11], s45 offen sc1
    s_mov_b64 exec, 0xffff
    buffer_store_dwordx4 v[12:15], v9, s[8:11], s38 offen offset:1024 sc1
    s_mov_b64 exec, -1
    s_cmp_eq_u32 s35, 63
    s_cbranch_scc1 C_FIN
    s_cmp_ge_u32 s35, 63
    s_cbranch_scc1 CS_NWk1
    s_load_dword s20, s[22:23], 0x2c0
    s_load_dword s20, s[22:23], 0x300
    s_load_dword s20, s[22:23], 0x340
    s_load_dword s20, s[22:23], 0x380
    s_load_dword s20, s[22:23], 0x3c0
    s_load_dword s20, s[22:23], 0x400
    s_load_dword s20, s[22:23], 0x440
    s_load_dword s20, s[22:23], 0x480
    s_load_dword s20, s[22:23], 0x4c0
    s_load_dword s20, s[22:23], 0x500
    s_load_dword s20, s[22:23], 0x540
    s_add_u32 s22, s22, 4096
    s_addc_u32 s23, s23, 0
CS_NWk1:
    s_barrier
    s_sleep 2
    s_mov_b32 s44, 0
CS_OP7_R0:
    buffer_load_dwordx4 v[16:19], v3, s[8:11], s36 offen offset:0 sc1
    buffer_load_dwordx4 v[20:23], v3, s[8:11], s36 offen offset:1024 sc1
    buffer_load_dwordx4 v[24:27], v3, s[8:11], s36 offen offset:2048 sc1
    buffer_load_dwordx4 v[28:31], v3, s[8:11], s36 offen offset:3072 sc1
    s_add_u32 s44, s44, 1
    s_cmp_gt_u32 s44, 60000
    s_cbranch_scc1 C_DONE
    s_waitcnt vmcnt(3)
    v_max3_u32 v5, v16, v17, v18
    v_max_u32 v5, v5, v19
    v_cmp_eq_u32 vcc, -1, v5
    s_cbranch_vccnz CS_OP7_R0
    v_mfma_f32_16x16x32_bf16 v[48:51], v[192:195], v[16:19], v[48:51]
    v_mov_b32_dpp v32, v16 row_ror:8 row_mask:0xf bank_mask:0xf
    v_mov_b32_dpp v33, v17 row_ror:8 row_mask:0xf bank_mask:0xf
    v_mov_b32_dpp v34, v18 row_ror:8 row_mask:0xf bank_mask:0xf
    v_mov_b32_dpp v35, v19 row_ror:8 row_mask:0xf bank_mask:0xf
    s_waitcnt vmcnt(2)
    v_mfma_f32_16x16x32_bf16 v[52:55], v[204:207], v[16:19], v[52:55]
    v_max3_u32 v5, v20, v21, v22
    v_mfma_f32_16x16x32_bf16 v[48:51], v[200:203], v[32:35], v[48:51]
    v_max_u32 v5, v5, v23
    v_cmp_eq_u32 vcc, -1, v5
    v_mfma_f32_16x16x32_bf16 v[52:55], v[196:199], v[32:35], v[52:55]
    s_cbranch_vccnz CS_OP7_R1
CS_OP7_B1:
    v_mfma_f32_16x16x32_bf16 v[48:51], v[208:211], v[20:23], v[48:51]
    v_mov_b32_dpp v32, v20 row_ror:8 row_mask:0xf bank_mask:0xf
    v_mov_b32_dpp v33, v21 row_ror:8 row_mask:0xf bank_mask:0xf
    v_mov_b32_dpp v34, v22 row_ror:8 row_mask:0xf bank_mask:0xf
    v_mov_b32_dpp v35, v23 row_ror:8 row_mask:0xf bank_mask:0xf
    s_waitcnt vmcnt(1)
    v_mfma_f32_16x16x32_bf16 v[52:55], v[220:223], v[20:23], v[52:55]
    v_max3_u32 v5, v24, v25, v26
    v_mfma_f32_16x16x32_bf16 v[48:51], v[216:219], v[32:35], v[48:51]
    v_max_u32 v5, v5, v27
    v_cmp_eq_u32 vcc, -1, v5
    v_mfma_f32_16x16x32_bf16 v[52:55], v[212:215], v[32:35], v[52:55]
    s_cbranch_vccnz CS_OP7_R2
CS_OP7_B2:
    v_mfma_f32_16x16x32_bf16 v[48:51], v[224:227], v[24:27], v[48:51]
    v_mov_b32_dpp v32, v24 row_ror:8 row_mask:0xf bank_mask:0xf
    v_mov_b32_dpp v33, v25 row_ror:8 row_mask:0xf bank_mask:0xf
    v_mov_b32_dpp v34, v26 row_ror:8 row_mask:0xf bank_mask:0xf
    v_mov_b32_dpp v35, v27 row_ror:8 row_mask:0xf bank_mask:0xf
    s_waitcnt vmcnt(0)
    v_mfma_f32_16x16x32_bf16 v[52:55], v[236:239], v[24:27], v[52:55]
    v_max3_u32 v5, v28, v29, v30
    v_mfma_f32_16x16x32_bf16 v[48:51], v[232:235], v[32:35], v[48:51]
    v_max_u32 v5, v5, v31
    v_cmp_eq_u32 vcc, -1, v5
    v_mfma_f32_16x16x32_bf16 v[52:55], v[228:231], v[32:35], v[52:55]
    s_cbranch_vccnz CS_OP7_R3
CS_OP7_B3:
    v_mfma_f32_16x16x32_bf16 v[48:51], v[240:243], v[28:31], v[48:51]
    v_mov_b32_dpp v32, v28 row_ror:8 row_mask:0xf bank_mask:0xf
    v_mov_b32_dpp v33, v29 row_ror:8 row_mask:0xf bank_mask:0xf
    v_mov_b32_dpp v34, v30 row_ror:8 row_mask:0xf bank_mask:0xf
    v_mov_b32_dpp v35, v31 row_ror:8 row_mask:0xf bank_mask:0xf
    v_mfma_f32_16x16x32_bf16 v[52:55], v[252:255], v[28:31], v[52:55]
    s_nop 0
    v_mfma_f32_16x16x32_bf16 v[48:51], v[248:251], v[32:35], v[48:51]
    v_mfma_f32_16x16x32_bf16 v[52:55], v[244:247], v[32:35], v[52:55]
    s_nop 7
    v_cndmask_b32 v48, v52, v48, s[40:41]
    v_cndmask_b32 v49, v53, v49, s[40:41]
    v_cndmask_b32 v50, v54, v50, s[40:41]
    v_cndmask_b32 v51, v55, v51, s[40:41]
    ds_write_b128 v4, v[48:51] offset:16384
    s_waitcnt lgkmcnt(0)
    s_barrier
    s_add_u32 s45, s35, 2
    s_and_b32 s46, s45, 0x47
    s_cbranch_scc1 CS_W7_NG
    s_cmp_eq_u32 s31, 64
    s_cbranch_scc1 CS_W7_NG
    s_lshl_b32 s45, s45, 4
    s_add_u32 s45, s45, 98566144
    s_mov_b32 s44, 0
CS_W7_G:
    buffer_load_dword v5, off, s[8:11], s45 sc1
    s_add_u32 s44, s44, 1
    s_cmp_gt_u32 s44, 60000
    s_cbranch_scc1 C_DONE
    s_waitcnt vmcnt(0)
    v_cmp_eq_u32 vcc, 64, v5
    s_cbranch_vccnz CS_W7_G_OK
    s_sleep 8
    s_branch CS_W7_G
CS_W7_G_OK:
CS_W7_NG:
    v_mov_b32 v48, 0
    v_mov_b32 v49, 0
    v_mov_b32 v50, 0
    v_mov_b32 v51, 0
    v_mov_b32 v52, 0
    v_mov_b32 v53, 0
    v_mov_b32 v54, 0
    v_mov_b32 v55, 0
    s_mov_b32 s36, s37
    s_mov_b32 s37, s38
    s_add_u32 s38, s38, 524288
    s_cmp_eq_u32 s38, 96468992
    s_cselect_b32 s38, 94371840, s38
    s_add_u32 s35, s35, 1
    s_lshr_b32 s27, s35, 3
    s_lshl_b32 s27, s27, 22
    s_and_b32 s28, s35, 7
    s_lshl_b32 s28, s28, 18
    s_add_u32 s27, s27, s28
    s_barrier
    s_branch CS_W7_LOOP
CS_OP7_R1:
    buffer_load_dwordx4 v[20:23], v3, s[8:11], s36 offen offset:1024 sc1
    buffer_load_dwordx4 v[24:27], v3, s[8:11], s36 offen offset:2048 sc1
    buffer_load_dwordx4 v[28:31], v3, s[8:11], s36 offen offset:3072 sc1
    s_add_u32 s44, s44, 1
    s_cmp_gt_u32 s44, 60000
    s_cbranch_scc1 C_DONE
    s_waitcnt vmcnt(2)
    v_max3_u32 v5, v20, v21, v22
    v_max_u32 v5, v5, v23
    v_cmp_eq_u32 vcc, -1, v5
    s_cbranch_vccnz CS_OP7_R1
    s_branch CS_OP7_B1
CS_OP7_R2:
    buffer_load_dwordx4 v[24:27], v3, s[8:11], s36 offen offset:2048 sc1
    buffer_load_dwordx4 v[28:31], v3, s[8:11], s36 offen offset:3072 sc1
    s_add_u32 s44, s44, 1
    s_cmp_gt_u32 s44, 60000
    s_cbranch_scc1 C_DONE
    s_waitcnt vmcnt(1)
    v_max3_u32 v5, v24, v25, v26
    v_max_u32 v5, v5, v27
    v_cmp_eq_u32 vcc, -1, v5
    s_cbranch_vccnz CS_OP7_R2
    s_branch CS_OP7_B2
CS_OP7_R3:
    buffer_load_dwordx4 v[28:31], v3, s[8:11], s36 offen offset:3072 sc1
    s_add_u32 s44, s44, 1
    s_cmp_gt_u32 s44, 60000
    s_cbranch_scc1 C_DONE
    s_waitcnt vmcnt(0)
    v_max3_u32 v5, v28, v29, v30
    v_max_u32 v5, v5, v31
    v_cmp_eq_u32 vcc, -1, v5
    s_cbranch_vccnz CS_OP7_R3
    s_branch CS_OP7_B3
CS_W6:
    s_add_u32 s45, s32, 1
    s_and_b32 s45, s45, 3
    s_lshl_b32 s45, s45, 10
    s_lshr_b32 s46, s33, 1
    s_lshl_b32 s46, s46, 14
    s_add_u32 s45, s45, s46
    s_and_b32 s46, s33, 1
    s_lshl_b32 s46, s46, 12
    s_add_u32 s45, s45, s46
    s_add_u32 s45, s45, 134217728
    v_add_u32 v60, s45, v2
    s_add_u32 s45, s32, 2
    s_and_b32 s45, s45, 3
    s_lshl_b32 s45, s45, 10
    s_lshr_b32 s46, s33, 1
    s_lshl_b32 s46, s46, 14
    s_add_u32 s45, s45, s46
    s_and_b32 s46, s33, 1
    s_lshl_b32 s46, s46, 12
    s_add_u32 s45, s45, s46
    s_add_u32 s45, s45, 134217728
    v_add_u32 v61, s45, v2
    s_add_u32 s45, s32, 3
    s_and_b32 s45, s45, 3
    s_lshl_b32 s45, s45, 10
    s_lshr_b32 s46, s33, 1
    s_lshl_b32 s46, s46, 14
    s_add_u32 s45, s45, s46
    s_and_b32 s46, s33, 1
    s_lshl_b32 s46, s46, 12
    s_add_u32 s45, s45, s46
    s_add_u32 s45, s45, 134217728
    v_add_u32 v62, s45, v2
    s_lshl_b32 s45, s47, 18
    s_add_u32 s45, s45, 6912
    s_add_u32 s22, s84, s45
    s_addc_u32 s23, s85, 0
    s_setprio 2
    s_barrier
    v_mov_b32 v24, 131072
    ds_read_b32 v25, v24
    s_waitcnt lgkmcnt(0)
    v_add_u32 v60, v60, v25
    v_add_u32 v61, v61, v25
    v_add_u32 v62, v62, v25
CS_W6_LOOP:
    s_sleep 3
    s_cmp_ge_u32 s35, 63
    s_cbranch_scc1 CS_NWv10
    s_load_dword s20, s[22:23], 0x0
    s_load_dword s20, s[22:23], 0x40
    s_load_dword s20, s[22:23], 0x80
    s_load_dword s20, s[22:23], 0xc0
    s_load_dword s20, s[22:23], 0x100
    s_load_dword s20, s[22:23], 0x140
    s_load_dword s20, s[22:23], 0x180
    s_load_dword s20, s[22:23], 0x1c0
    s_load_dword s20, s[22:23], 0x200
    s_load_dword s20, s[22:23], 0x240
CS_NWv10:
    s_barrier
    s_barrier
    s_cmp_eq_u32 s35, 63
    s_cbranch_scc1 C_FIN
    s_cmp_ge_u32 s35, 63
    s_cbranch_scc1 CS_NWv11
    s_load_dword s20, s[22:23], 0x280
    s_load_dword s20, s[22:23], 0x2c0
    s_load_dword s20, s[22:23], 0x300
    s_load_dword s20, s[22:23], 0x340
    s_load_dword s20, s[22:23], 0x380
    s_load_dword s20, s[22:23], 0x3c0
    s_load_dword s20, s[22:23], 0x400
    s_load_dword s20, s[22:23], 0x440
    s_load_dword s20, s[22:23], 0x480
    s_load_dword s20, s[22:23], 0x4c0
    s_add_u32 s22, s22, 4096
    s_addc_u32 s23, s23, 0
CS_NWv11:
    s_barrier
    s_sleep 2
    s_mov_b32 s44, 0
CS_OP6_R0:
    buffer_load_dwordx4 v[16:19], v3, s[8:11], s36 offen offset:0 sc1
    buffer_load_dwordx4 v[20:23], v3, s[8:11], s36 offen offset:1024 sc1
    buffer_load_dwordx4 v[24:27], v3, s[8:11], s36 offen offset:2048 sc1
    buffer_load_dwordx4 v[28:31], v3, s[8:11], s36 offen offset:3072 sc1
    s_add_u32 s44, s44, 1
    s_cmp_gt_u32 s44, 60000
    s_cbranch_scc1 C_DONE
    s_waitcnt vmcnt(3)
    v_max3_u32 v5, v16, v17, v18
    v_max_u32 v5, v5, v19
    v_cmp_eq_u32 vcc, -1, v5
    s_cbranch_vccnz CS_OP6_R0
    v_mfma_f32_16x16x32_bf16 v[48:51], v[192:195], v[16:19], v[48:51]
    v_mov_b32_dpp v32, v16 row_ror:8 row_mask:0xf bank_mask:0xf
    v_mov_b32_dpp v33, v17 row_ror:8 row_mask:0xf bank_mask:0xf
    v_mov_b32_dpp v34, v18 row_ror:8 row_mask:0xf bank_mask:0xf
    v_mov_b32_dpp v35, v19 row_ror:8 row_mask:0xf bank_mask:0xf
    s_waitcnt vmcnt(2)
    v_mfma_f32_16x16x32_bf16 v[52:55], v[204:207], v[16:19], v[52:55]
    v_max3_u32 v5, v20, v21, v22
    v_mfma_f32_16x16x32_bf16 v[48:51], v[200:203], v[32:35], v[48:51]
    v_max_u32 v5, v5, v23
    v_cmp_eq_u32 vcc, -1, v5
    v_mfma_f32_16x16x32_bf16 v[52:55], v[196:199], v[32:35], v[52:55]
    s_cbranch_vccnz CS_OP6_R1
CS_OP6_B1:
    v_mfma_f32_16x16x32_bf16 v[48:51], v[208:211], v[20:23], v[48:51]
    v_mov_b32_dpp v32, v20 row_ror:8 row_mask:0xf bank_mask:0xf
    v_mov_b32_dpp v33, v21 row_ror:8 row_mask:0xf bank_mask:0xf
    v_mov_b32_dpp v34, v22 row_ror:8 row_mask:0xf bank_mask:0xf
    v_mov_b32_dpp v35, v23 row_ror:8 row_mask:0xf bank_mask:0xf
    s_waitcnt vmcnt(1)
    v_mfma_f32_16x16x32_bf16 v[52:55], v[220:223], v[20:23], v[52:55]
    v_max3_u32 v5, v24, v25, v26
    v_mfma_f32_16x16x32_bf16 v[48:51], v[216:219], v[32:35], v[48:51]
    v_max_u32 v5, v5, v27
    v_cmp_eq_u32 vcc, -1, v5
    v_mfma_f32_16x16x32_bf16 v[52:55], v[212:215], v[32:35], v[52:55]
    s_cbranch_vccnz CS_OP6_R2
CS_OP6_B2:
    v_mfma_f32_16x16x32_bf16 v[48:51], v[224:227], v[24:27], v[48:51]
    v_mov_b32_dpp v32, v24 row_ror:8 row_mask:0xf bank_mask:0xf
    v_mov_b32_dpp v33, v25 row_ror:8 row_mask:0xf bank_mask:0xf
    v_mov_b32_dpp v34, v26 row_ror:8 row_mask:0xf bank_mask:0xf
    v_mov_b32_dpp v35, v27 row_ror:8 row_mask:0xf bank_mask:0xf
    s_waitcnt vmcnt(0)
    v_mfma_f32_16x16x32_bf16 v[52:55], v[236:239], v[24:27], v[52:55]
    v_max3_u32 v5, v28, v29, v30
    v_mfma_f32_16x16x32_bf16 v[48:51], v[232:235], v[32:35], v[48:51]
    v_max_u32 v5, v5, v31
    v_cmp_eq_u32 vcc, -1, v5
    v_mfma_f32_16x16x32_bf16 v[52:55], v[228:231], v[32:35], v[52:55]
    s_cbranch_vccnz CS_OP6_R3
CS_OP6_B3:
    v_mfma_f32_16x16x32_bf16 v[48:51], v[240:243], v[28:31], v[48:51]
    v_mov_b32_dpp v32, v28 row_ror:8 row_mask:0xf bank_mask:0xf
    v_mov_b32_dpp v33, v29 row_ror:8 row_mask:0xf bank_mask:0xf
    v_mov_b32_dpp v34, v30 row_ror:8 row_mask:0xf bank_mask:0xf
    v_mov_b32_dpp v35, v31 row_ror:8 row_mask:0xf bank_mask:0xf
    v_mfma_f32_16x16x32_bf16 v[52:55], v[252:255], v[28:31], v[52:55]
    s_nop 0
    v_mfma_f32_16x16x32_bf16 v[48:51], v[248:251], v[32:35], v[48:51]
    v_mfma_f32_16x16x32_bf16 v[52:55], v[244:247], v[32:35], v[52:55]
    s_nop 7
    v_cndmask_b32 v48, v52, v48, s[40:41]
    v_cndmask_b32 v49, v53, v49, s[40:41]
    v_cndmask_b32 v50, v54, v50, s[40:41]
    v_cndmask_b32 v51, v55, v51, s[40:41]
    ds_write_b128 v4, v[48:51] offset:16384
    s_waitcnt lgkmcnt(0)
    s_barrier
    ds_read_b128 v[32:35], v2 offset:16384
    ds_read_b128 v[36:39], v2 offset:17408
    ds_read_b128 v[40:43], v2 offset:19456
    s_waitcnt lgkmcnt(1)
    v_pk_add_f32 v[48:49], v[48:49], v[32:33]
    v_pk_add_f32 v[50:51], v[50:51], v[34:35]
    s_waitcnt lgkmcnt(0)
    v_pk_add_f32 v[36:37], v[36:37], v[40:41]
    v_pk_add_f32 v[38:39], v[38:39], v[42:43]
    v_pk_add_f32 v[48:49], v[48:49], v[36:37]
    v_pk_add_f32 v[50:51], v[50:51], v[38:39]
    s_sleep 12
    s_mov_b32 s44, 0
CS_PP:
    buffer_load_dwordx4 v[16:19], v60, s[8:11], s27 offen sc1
    buffer_load_dwordx4 v[20:23], v61, s[8:11], s27 offen sc1
    buffer_load_dwordx4 v[24:27], v62, s[8:11], s27 offen sc1
    s_waitcnt vmcnt(2)
    v_pk_add_f32 v[36:37], v[48:49], v[16:17]
    v_pk_add_f32 v[38:39], v[50:51], v[18:19]
    s_waitcnt vmcnt(1)
    v_pk_add_f32 v[36:37], v[36:37], v[20:21]
    v_pk_add_f32 v[38:39], v[38:39], v[22:23]
    s_waitcnt vmcnt(0)
    v_pk_add_f32 v[36:37], v[36:37], v[24:25]
    v_pk_add_f32 v[38:39], v[38:39], v[26:27]
    v_pk_add_f32 v[34:35], v[36:37], v[38:39]
    v_cvt_pk_bf16_f32 v32, v36, v37
    v_cmp_u_f32 vcc, v34, v35
    v_cvt_pk_bf16_f32 v33, v38, v39
    s_cbranch_vccnz CS_PP_X
CS_PP_OK:
    v_min_u32 v32, -2, v32
    v_min_u32 v33, -2, v33
    buffer_store_dwordx2 v[32:33], v7, s[8:11], s37 offen offset:0 sc1
    s_barrier
    v_mov_b32 v48, 0
    v_mov_b32 v49, 0
    v_mov_b32 v50, 0
    v_mov_b32 v51, 0
    v_mov_b32 v52, 0
    v_mov_b32 v53, 0
    v_mov_b32 v54, 0
    v_mov_b32 v55, 0
    s_mov_b32 s36, s37
    s_mov_b32 s37, s38
    s_add_u32 s38, s38, 524288
    s_cmp_eq_u32 s38, 96468992
    s_cselect_b32 s38, 94371840, s38
    s_add_u32 s35, s35, 1
    s_lshr_b32 s27, s35, 3
    s_lshl_b32 s27, s27, 22
    s_and_b32 s28, s35, 7
    s_lshl_b32 s28, s28, 18
    s_add_u32 s27, s27, s28
    s_branch CS_W6_LOOP
CS_OP6_R1:
    buffer_load_dwordx4 v[20:23], v3, s[8:11], s36 offen offset:1024 sc1
    buffer_load_dwordx4 v[24:27], v3, s[8:11], s36 offen offset:2048 sc1
    buffer_load_dwordx4 v[28:31], v3, s[8:11], s36 offen offset:3072 sc1
    s_add_u32 s44, s44, 1
    s_cmp_gt_u32 s44, 60000
    s_cbranch_scc1 C_DONE
    s_waitcnt vmcnt(2)
    v_max3_u32 v5, v20, v21, v22
    v_max_u32 v5, v5, v23
    v_cmp_eq_u32 vcc, -1, v5
    s_cbranch_vccnz CS_OP6_R1
    s_branch CS_OP6_B1
CS_OP6_R2:
    buffer_load_dwordx4 v[24:27], v3, s[8:11], s36 offen offset:2048 sc1
    buffer_load_dwordx4 v[28:31], v3, s[8:11], s36 offen offset:3072 sc1
    s_add_u32 s44, s44, 1
    s_cmp_gt_u32 s44, 60000
    s_cbranch_scc1 C_DONE
    s_waitcnt vmcnt(1)
    v_max3_u32 v5, v24, v25, v26
    v_max_u32 v5, v5, v27
    v_cmp_eq_u32 vcc, -1, v5
    s_cbranch_vccnz CS_OP6_R2
    s_branch CS_OP6_B2
CS_OP6_R3:
    buffer_load_dwordx4 v[28:31], v3, s[8:11], s36 offen offset:3072 sc1
    s_add_u32 s44, s44, 1
    s_cmp_gt_u32 s44, 60000
    s_cbranch_scc1 C_DONE
    s_waitcnt vmcnt(0)
    v_max3_u32 v5, v28, v29, v30
    v_max_u32 v5, v5, v31
    v_cmp_eq_u32 vcc, -1, v5
    s_cbranch_vccnz CS_OP6_R3
    s_branch CS_OP6_B3
CS_PP_X:
    s_add_u32 s44, s44, 1
    s_and_b32 s45, s44, 15
    s_cbranch_scc1 CS_PP
    s_cmp_gt_u32 s44, 60000
    s_cbranch_scc1 C_DONE
    v_max3_u32 v5, v16, v17, v18
    v_max3_u32 v5, v5, v19, v20
    v_max3_u32 v5, v5, v21, v22
    v_max3_u32 v5, v5, v23, v24
    v_max3_u32 v5, v5, v25, v26
    v_max_u32 v5, v5, v27
    v_cmp_eq_u32 vcc, -1, v5
    s_cbranch_vccnz CS_PP
    s_branch CS_PP_OK
CS_W4:
    s_bitcmp1_b32 s51, 15
    s_cbranch_scc0 CS_RDY_OK
    v_mov_b32 v24, 96
    v_mov_b32 v25, 1
    s_mov_b64 exec, 1
    global_atomic_add v24, v25, s[82:83]
    s_mov_b32 s44, 0
CS_RDY:
    s_add_u32 s44, s44, 1
    s_cmp_gt_u32 s44, 60000
    s_cbranch_scc1 C_DONE
    s_sleep 8
    global_load_dword v25, v24, s[82:83] sc1
    s_waitcnt vmcnt(0)
    v_cmp_ne_u32 vcc, 128, v25
    s_cbranch_vccnz CS_RDY
    s_mov_b64 exec, -1
CS_RDY_OK:
    s_getreg_b32 s29, hwreg(HW_REG_XCC_ID)
    s_and_b32 s29, s29, 7
    s_lshl_b32 s30, s29, 2
    s_lshr_b32 s29, 0x73625140, s30
    s_and_b32 s29, s29, 7
    s_lshl_b32 s29, s29, 2
    s_add_u32 s29, s29, 64
    s_load_dword s30, s[82:83], s29
    s_waitcnt lgkmcnt(0)
    s_lshr_b32 s29, s30, 7
    s_and_b32 s29, s29, 0x1fe
    s_and_b32 s30, s30, 0xff
    s_cmp_gt_u32 s29, s30
    s_cselect_b32 s29, 0x2000, 0
    v_mov_b32 v25, s29
    v_mov_b32 v24, 131072
    ds_write_b32 v24, v25
    v_xor_b32 v26, 0x2000, v25
    v_add_u32 v56, v8, v26
    v_add_u32 v8, v8, v25
    s_waitcnt lgkmcnt(0)
    v_min_u32 v16, -2, v16
    v_min_u32 v17, -2, v17
    buffer_store_dwordx2 v[16:17], v7, s[8:11], s36 offen offset:0 sc1
    v_bfe_u32 v10, v0, 2, 2
    v_lshlrev_b32 v10, 3, v10
    v_and_b32 v11, 3, v0
    v_add_u32 v10, v10, v11
    v_lshrrev_b32 v11, 4, v0
    v_lshlrev_b32 v11, 4, v11
    s_lshl_b32 s52, s47, 16
    s_add_u32 s52, s52, 67108864
    v_and_b32 v60, 7, v0
    v_lshlrev_b32 v60, 4, v60
    v_lshl_add_u32 v60, v11, 3, v60
    v_lshlrev_b32 v61, 4, v10
    v_bfe_u32 v62, v0, 4, 1
    v_lshl_add_u32 v61, v62, 3, v61
    s_setprio 2
    s_lshl_b32 s45, s47, 18
    s_add_u32 s45, s45, 5504
    s_add_u32 s22, s84, s45
    s_addc_u32 s23, s85, 0
    s_barrier
CS_W4_LOOP:
    s_cmp_eq_u32 s35, 0
    s_cbranch_scc1 CS_W4_NV
    s_waitcnt vmcnt(0)
    s_lshl_b32 s45, s32, 7
    s_add_u32 s45, s45, 98569216
    s_mov_b32 s21, 1
    s_atomic_add s21, s[84:85], s45
CS_W4_NV:
    s_sleep 3
    s_cmp_ge_u32 s35, 63
    s_cbranch_scc1 CS_NWv00
    s_load_dword s20, s[22:23], 0x0
    s_load_dword s20, s[22:23], 0x40
    s_load_dword s20, s[22:23], 0x80
    s_load_dword s20, s[22:23], 0xc0
    s_load_dword s20, s[22:23], 0x100
    s_load_dword s20, s[22:23], 0x140
    s_load_dword s20, s[22:23], 0x180
    s_load_dword s20, s[22:23], 0x1c0
    s_load_dword s20, s[22:23], 0x200
    s_load_dword s20, s[22:23], 0x240
    s_load_dword s20, s[22:23], 0x280
CS_NWv00:
    s_barrier
    s_barrier
    s_cmp_eq_u32 s35, 63
    s_cbranch_scc1 C_FIN
    s_cmp_ge_u32 s35, 63
    s_cbranch_scc1 CS_NWv01
    s_load_dword s20, s[22:23], 0x2c0
    s_load_dword s20, s[22:23], 0x300
    s_load_dword s20, s[22:23], 0x340
    s_load_dword s20, s[22:23], 0x380
    s_load_dword s20, s[22:23], 0x3c0
    s_load_dword s20, s[22:23], 0x400
    s_load_dword s20, s[22:23], 0x440
    s_load_dword s20, s[22:23], 0x480
    s_load_dword s20, s[22:23], 0x4c0
    s_load_dword s20, s[22:23], 0x500
    s_load_dword s20, s[22:23], 0x540
    s_add_u32 s22, s22, 4096
    s_addc_u32 s23, s23, 0
CS_NWv01:
    s_barrier
    ds_read_b128 v[64:67], v2 offset:20480
    s_sleep 2
    s_mov_b32 s44, 0
CS_OP4_R0:
    buffer_load_dwordx4 v[16:19], v3, s[8:11], s36 offen offset:0 sc1
    buffer_load_dwordx4 v[20:23], v3, s[8:11], s36 offen offset:1024 sc1
    buffer_load_dwordx4 v[24:27], v3, s[8:11], s36 offen offset:2048 sc1
    buffer_load_dwordx4 v[28:31], v3, s[8:11], s36 offen offset:3072 sc1
    s_add_u32 s44, s44, 1
    s_cmp_gt_u32 s44, 60000
    s_cbranch_scc1 C_DONE
    s_waitcnt vmcnt(3)
    v_max3_u32 v5, v16, v17, v18
    v_max_u32 v5, v5, v19
    v_cmp_eq_u32 vcc, -1, v5
    s_cbranch_vccnz CS_OP4_R0
    v_mfma_f32_16x16x32_bf16 v[48:51], v[192:195], v[16:19], v[48:51]
    v_mov_b32_dpp v32, v16 row_ror:8 row_mask:0xf bank_mask:0xf
    v_mov_b32_dpp v33, v17 row_ror:8 row_mask:0xf bank_mask:0xf
    v_mov_b32_dpp v34, v18 row_ror:8 row_mask:0xf bank_mask:0xf
    v_mov_b32_dpp v35, v19 row_ror:8 row_mask:0xf bank_mask:0xf
    s_waitcnt vmcnt(2)
    v_mfma_f32_16x16x32_bf16 v[52:55], v[204:207], v[16:19], v[52:55]
    v_max3_u32 v5, v20, v21, v22
    v_mfma_f32_16x16x32_bf16 v[48:51], v[200:203], v[32:35], v[48:51]
    v_max_u32 v5, v5, v23
    v_cmp_eq_u32 vcc, -1, v5
    v_mfma_f32_16x16x32_bf16 v[52:55], v[196:199], v[32:35], v[52:55]
    s_cbranch_vccnz CS_OP4_R1
CS_OP4_B1:
    v_mfma_f32_16x16x32_bf16 v[48:51], v[208:211], v[20:23], v[48:51]
    v_mov_b32_dpp v32, v20 row_ror:8 row_mask:0xf bank_mask:0xf
    v_mov_b32_dpp v33, v21 row_ror:8 row_mask:0xf bank_mask:0xf
    v_mov_b32_dpp v34, v22 row_ror:8 row_mask:0xf bank_mask:0xf
    v_mov_b32_dpp v35, v23 row_ror:8 row_mask:0xf bank_mask:0xf
    s_waitcnt vmcnt(1)
    v_mfma_f32_16x16x32_bf16 v[52:55], v[220:223], v[20:23], v[52:55]
    v_max3_u32 v5, v24, v25, v26
    v_mfma_f32_16x16x32_bf16 v[48:51], v[216:219], v[32:35], v[48:51]
    v_max_u32 v5, v5, v27
    v_cmp_eq_u32 vcc, -1, v5
    v_mfma_f32_16x16x32_bf16 v[52:55], v[212:215], v[32:35], v[52:55]
    s_cbranch_vccnz CS_OP4_R2
CS_OP4_B2:
    v_mfma_f32_16x16x32_bf16 v[48:51], v[224:227], v[24:27], v[48:51]
    v_mov_b32_dpp v32, v24 row_ror:8 row_mask:0xf bank_mask:0xf
    v_mov_b32_dpp v33, v25 row_ror:8 row_mask:0xf bank_mask:0xf
    v_mov_b32_dpp v34, v26 row_ror:8 row_mask:0xf bank_mask:0xf
    v_mov_b32_dpp v35, v27 row_ror:8 row_mask:0xf bank_mask:0xf
    s_waitcnt vmcnt(0)
    v_mfma_f32_16x16x32_bf16 v[52:55], v[236:239], v[24:27], v[52:55]
    v_max3_u32 v5, v28, v29, v30
    v_mfma_f32_16x16x32_bf16 v[48:51], v[232:235], v[32:35], v[48:51]
    v_max_u32 v5, v5, v31
    v_cmp_eq_u32 vcc, -1, v5
    v_mfma_f32_16x16x32_bf16 v[52:55], v[228:231], v[32:35], v[52:55]
    s_cbranch_vccnz CS_OP4_R3
CS_OP4_B3:
    v_mfma_f32_16x16x32_bf16 v[48:51], v[240:243], v[28:31], v[48:51]
    v_mov_b32_dpp v32, v28 row_ror:8 row_mask:0xf bank_mask:0xf
    v_mov_b32_dpp v33, v29 row_ror:8 row_mask:0xf bank_mask:0xf
    v_mov_b32_dpp v34, v30 row_ror:8 row_mask:0xf bank_mask:0xf
    v_mov_b32_dpp v35, v31 row_ror:8 row_mask:0xf bank_mask:0xf
    v_mfma_f32_16x16x32_bf16 v[52:55], v[252:255], v[28:31], v[52:55]
    s_nop 0
    v_mfma_f32_16x16x32_bf16 v[48:51], v[248:251], v[32:35], v[48:51]
    v_mfma_f32_16x16x32_bf16 v[52:55], v[244:247], v[32:35], v[52:55]
    s_nop 7
    v_cndmask_b32 v48, v52, v48, s[40:41]
    v_cndmask_b32 v49, v53, v49, s[40:41]
    v_cndmask_b32 v50, v54, v50, s[40:41]
    v_cndmask_b32 v51, v55, v51, s[40:41]
    ds_write_b128 v4, v[48:51] offset:16384
    s_waitcnt lgkmcnt(0)
    s_barrier
    ds_read_b128 v[32:35], v2 offset:17408
    ds_read_b128 v[36:39], v2 offset:18432
    ds_read_b128 v[40:43], v2 offset:19456
    s_waitcnt lgkmcnt(1)
    v_pk_add_f32 v[48:49], v[48:49], v[32:33]
    v_pk_add_f32 v[50:51], v[50:51], v[34:35]
    s_waitcnt lgkmcnt(0)
    v_pk_add_f32 v[36:37], v[36:37], v[40:41]
    v_pk_add_f32 v[38:39], v[38:39], v[42:43]
    v_pk_add_f32 v[48:49], v[48:49], v[36:37]
    v_pk_add_f32 v[50:51], v[50:51], v[38:39]
    buffer_store_dwordx4 v[48:51], v56, s[8:11], s27 offen sc1
    buffer_store_dwordx4 v[48:51], v8, s[8:11], s27 offen sc1
    buffer_store_dwordx4 v[64:67], v2, s[8:11], s52 offen sc1
    s_add_u32 s52, s52, 1024
    s_mov_b32 s36, s37
    s_mov_b32 s37, s38
    s_add_u32 s38, s38, 524288
    s_cmp_eq_u32 s38, 96468992
    s_cselect_b32 s38, 94371840, s38
    s_add_u32 s35, s35, 1
    s_lshr_b32 s27, s35, 3
    s_lshl_b32 s27, s27, 22
    s_and_b32 s28, s35, 7
    s_lshl_b32 s28, s28, 18
    s_add_u32 s27, s27, s28
    v_mov_b32 v48, 0
    v_mov_b32 v49, 0
    v_mov_b32 v50, 0
    v_mov_b32 v51, 0
    v_mov_b32 v52, 0
    v_mov_b32 v53, 0
    v_mov_b32 v54, 0
    v_mov_b32 v55, 0
    s_barrier
    s_branch CS_W4_LOOP
CS_OP4_R1:
    buffer_load_dwordx4 v[20:23], v3, s[8:11], s36 offen offset:1024 sc1
    buffer_load_dwordx4 v[24:27], v3, s[8:11], s36 offen offset:2048 sc1
    buffer_load_dwordx4 v[28:31], v3, s[8:11], s36 offen offset:3072 sc1
    s_add_u32 s44, s44, 1
    s_cmp_gt_u32 s44, 60000
    s_cbranch_scc1 C_DONE
    s_waitcnt vmcnt(2)
    v_max3_u32 v5, v20, v21, v22
    v_max_u32 v5, v5, v23
    v_cmp_eq_u32 vcc, -1, v5
    s_cbranch_vccnz CS_OP4_R1
    s_branch CS_OP4_B1
CS_OP4_R2:
    buffer_load_dwordx4 v[24:27], v3, s[8:11], s36 offen offset:2048 sc1
    buffer_load_dwordx4 v[28:31], v3, s[8:11], s36 offen offset:3072 sc1
    s_add_u32 s44, s44, 1
    s_cmp_gt_u32 s44, 60000
    s_cbranch_scc1 C_DONE
    s_waitcnt vmcnt(1)
    v_max3_u32 v5, v24, v25, v26
    v_max_u32 v5, v5, v27
    v_cmp_eq_u32 vcc, -1, v5
    s_cbranch_vccnz CS_OP4_R2
    s_branch CS_OP4_B2
CS_OP4_R3:
    buffer_load_dwordx4 v[28:31], v3, s[8:11], s36 offen offset:3072 sc1
    s_add_u32 s44, s44, 1
    s_cmp_gt_u32 s44, 60000
    s_cbranch_scc1 C_DONE
    s_waitcnt vmcnt(0)
    v_max3_u32 v5, v28, v29, v30
    v_max_u32 v5, v5, v31
    v_cmp_eq_u32 vcc, -1, v5
    s_cbranch_vccnz CS_OP4_R3
    s_branch CS_OP4_B3
CS_W5:
    v_bfe_u32 v10, v0, 2, 2
    v_lshlrev_b32 v10, 3, v10
    v_and_b32 v11, 3, v0
    v_add_u32 v10, v10, v11
    v_lshrrev_b32 v11, 4, v0
    v_lshlrev_b32 v11, 4, v11
    s_lshl_b32 s52, s47, 16
    s_add_u32 s52, s52, 67108864
    v_and_b32 v60, 7, v0
    v_lshlrev_b32 v60, 4, v60
    v_lshl_add_u32 v60, v11, 3, v60
    v_lshlrev_b32 v61, 4, v10
    v_bfe_u32 v62, v0, 4, 1
    v_lshl_add_u32 v61, v62, 3, v61
    v_lshlrev_b32 v56, 5, v11
    v_lshl_add_u32 v56, v10, 4, v56
    s_lshl_b32 s50, s47, 18
    s_add_u32 s50, s50, 0
    v_bfe_u32 v62, v0, 4, 1
    v_lshlrev_b32 v62, 7, v62
    v_and_b32 v63, 7, v0
    v_lshl_add_u32 v62, v63, 4, v62
    v_add_u32 v62, 0x400, v62
    s_mul_i32 s45, s47, 1280
    s_add_u32 s45, s45, 131072
    v_add_u32 v63, s45, v62
    s_add_u32 s45, s47, 1
    s_and_b32 s45, s45, 3
    s_and_b32 s46, s47, 0xfc
    s_add_u32 s45, s45, s46
    s_mul_i32 s45, s45, 1280
    s_add_u32 s45, s45, 131072
    v_add_u32 v184, s45, v2
    v_add_u32 v187, s45, v62
    s_add_u32 s45, s47, 2
    s_and_b32 s45, s45, 3
    s_and_b32 s46, s47, 0xfc
    s_add_u32 s45, s45, s46
    s_mul_i32 s45, s45, 1280
    s_add_u32 s45, s45, 131072
    v_add_u32 v185, s45, v2
    v_add_u32 v188, s45, v62
    s_add_u32 s45, s47, 3
    s_and_b32 s45, s45, 3
    s_and_b32 s46, s47, 0xfc
    s_add_u32 s45, s45, s46
    s_mul_i32 s45, s45, 1280
    s_add_u32 s45, s45, 131072
    v_add_u32 v186, s45, v2
    v_add_u32 v189, s45, v62
    v_mov_b32 v106, 0x3e0293ee
    v_mov_b32 v107, v106
    v_mov_b32 v190, 0x2b800000
    v_mov_b32 v191, 0x53800000
    v_mov_b32 v108, 0x3f803f80
    v_mov_b32 v109, 0x3f803f80
    v_mov_b32 v110, 0x3f803f80
    v_mov_b32 v111, 0x3f803f80
    v_mov_b32 v104, 0
    v_mov_b32 v105, 0
    v_mov_b32 v112, 0
    v_mov_b32 v113, 0
    v_mov_b32 v114, 0
    v_mov_b32 v115, 0
    v_mov_b32 v116, 0
    v_mov_b32 v117, 0
    v_mov_b32 v118, 0
    v_mov_b32 v119, 0
    v_mov_b32 v120, 0
    v_mov_b32 v121, 0
    v_mov_b32 v122, 0
    v_mov_b32 v123, 0
    v_mov_b32 v124, 0
    v_mov_b32 v125, 0
    v_mov_b32 v126, 0
    v_mov_b32 v127, 0
    v_mov_b32 v128, 0
    v_mov_b32 v129, 0
    v_mov_b32 v130, 0
    v_mov_b32 v131, 0
    v_mov_b32 v132, 0
    v_mov_b32 v133, 0
    v_mov_b32 v134, 0
    v_mov_b32 v135, 0
    v_and_b32 v57, 15, v0
    v_mul_u32_u24 v57, 144, v57
    v_lshl_add_u32 v57, v11, 1, v57
    v_and_b32 v58, 0x1f0, v2
    v_or_b32 v59, 0x200, v58
    s_mov_b32 s45, 98566144
    s_mov_b32 s44, 0
CS_W5_G:
    buffer_load_dword v5, off, s[8:11], s45 sc1
    s_add_u32 s44, s44, 1
    s_cmp_gt_u32 s44, 60000
    s_cbranch_scc1 C_DONE
    s_waitcnt vmcnt(0)
    v_cmp_eq_u32 vcc, 128, v5
    s_cbranch_vccnz CS_W5_G_OK
    s_sleep 8
    s_branch CS_W5_G
CS_W5_G_OK:
    buffer_load_dwordx4 v[64:67], v56, s[8:11], s50 offen offset:0 sc1
    buffer_load_dwordx4 v[68:71], v56, s[8:11], s50 offen offset:64 sc1
    buffer_load_dwordx4 v[72:75], v56, s[8:11], s50 offen offset:2048 sc1
    buffer_load_dwordx4 v[76:79], v56, s[8:11], s50 offen offset:2112 sc1
    s_add_u32 s50, s50, 4096
    s_setprio 2
    s_barrier
    s_waitcnt vmcnt(0)
CS_W5_LOOP:
    s_barrier
    ds_read_b128 v[152:155], v57 offset:0
    ds_read_b128 v[156:159], v57 offset:16
    ds_read_b128 v[160:163], v57 offset:2304
    ds_read_b128 v[164:167], v57 offset:2320
    ds_read_b128 v[168:171], v57 offset:4608
    ds_read_b128 v[172:175], v57 offset:4624
    ds_read_b128 v[176:179], v57 offset:6912
    ds_read_b128 v[180:183], v57 offset:6928
    s_waitcnt lgkmcnt(4)
    v_pk_add_f32 v[152:153], v[152:153], v[160:161]
    v_pk_add_f32 v[154:155], v[154:155], v[162:163]
    v_pk_add_f32 v[156:157], v[156:157], v[164:165]
    v_pk_add_f32 v[158:159], v[158:159], v[166:167]
    s_waitcnt lgkmcnt(2)
    v_pk_add_f32 v[152:153], v[152:153], v[168:169]
    v_pk_add_f32 v[154:155], v[154:155], v[170:171]
    v_pk_add_f32 v[156:157], v[156:157], v[172:173]
    v_pk_add_f32 v[158:159], v[158:159], v[174:175]
    s_waitcnt lgkmcnt(0)
    v_pk_add_f32 v[152:153], v[152:153], v[176:177]
    v_pk_add_f32 v[154:155], v[154:155], v[178:179]
    v_pk_add_f32 v[156:157], v[156:157], v[180:181]
    v_pk_add_f32 v[158:159], v[158:159], v[182:183]
    v_cvt_pk_bf16_f32 v80, v152, v153
    v_cvt_pk_bf16_f32 v81, v154, v155
    v_cvt_pk_bf16_f32 v82, v156, v157
    v_cvt_pk_bf16_f32 v83, v158, v159
    s_nop 1
    v_mfma_f32_16x16x32_bf16 v[84:87], v[64:67], v[80:83], 0
    v_mfma_f32_16x16x32_bf16 v[92:95], v[68:71], v[80:83], 0
    v_mfma_f32_16x16x32_bf16 v[88:91], v[80:83], v[80:83], 0
    s_mov_b64 exec, s[40:41]
    s_nop 4
    buffer_store_dwordx4 v[84:87], v9, s[8:11], s36 offen sc1
    buffer_store_dwordx4 v[92:95], v9, s[8:11], s36 offen offset:128 sc1
    s_mov_b64 exec, s[42:43]
    buffer_store_dwordx4 v[88:91], v63, s[8:11], s36 offen sc1
    s_mov_b64 exec, -1
    v_mov_b32_dpp v84, v92 row_ror:8 row_mask:0xf bank_mask:0xc
    v_mov_b32_dpp v85, v93 row_ror:8 row_mask:0xf bank_mask:0xc
    v_mov_b32_dpp v86, v94 row_ror:8 row_mask:0xf bank_mask:0xc
    v_mov_b32_dpp v87, v95 row_ror:8 row_mask:0xf bank_mask:0xc
    v_cndmask_b32 v88, 0, v88, s[42:43]
    v_cndmask_b32 v89, 0, v89, s[42:43]
    v_cndmask_b32 v90, 0, v90, s[42:43]
    v_cndmask_b32 v91, 0, v91, s[42:43]
    s_sleep 1
    buffer_load_dwordx4 v[112:115], v184, s[8:11], s36 offen sc1
    buffer_load_dwordx4 v[120:123], v185, s[8:11], s36 offen sc1
    buffer_load_dwordx4 v[128:131], v186, s[8:11], s36 offen sc1
    s_mov_b64 exec, s[42:43]
    buffer_load_dwordx4 v[116:119], v187, s[8:11], s36 offen sc1
    buffer_load_dwordx4 v[124:127], v188, s[8:11], s36 offen sc1
    buffer_load_dwordx4 v[132:135], v189, s[8:11], s36 offen sc1
    s_mov_b64 exec, -1
    v_mul_f32 v84, v84, v106
    v_mul_f32 v85, v85, v106
    v_mul_f32 v86, v86, v106
    v_mul_f32 v87, v87, v106
    v_mul_f32 v88, v88, v106
    v_mul_f32 v89, v89, v106
    v_mul_f32 v90, v90, v106
    v_mul_f32 v91, v91, v106
    s_barrier
    ds_read_b128 v[152:155], v58 offset:9216
    ds_read_b128 v[156:159], v59 offset:9216
    ds_read_b128 v[160:163], v58 offset:10240
    ds_read_b128 v[164:167], v59 offset:10240
    ds_read_b128 v[168:171], v58 offset:11264
    ds_read_b128 v[172:175], v59 offset:11264
    ds_read_b128 v[176:179], v58 offset:12288
    ds_read_b128 v[180:183], v59 offset:12288
    s_waitcnt lgkmcnt(4)
    v_pk_add_f32 v[152:153], v[152:153], v[160:161]
    v_pk_add_f32 v[154:155], v[154:155], v[162:163]
    v_pk_add_f32 v[156:157], v[156:157], v[164:165]
    v_pk_add_f32 v[158:159], v[158:159], v[166:167]
    s_waitcnt lgkmcnt(2)
    v_pk_add_f32 v[152:153], v[152:153], v[168:169]
    v_pk_add_f32 v[154:155], v[154:155], v[170:171]
    v_pk_add_f32 v[156:157], v[156:157], v[172:173]
    v_pk_add_f32 v[158:159], v[158:159], v[174:175]
    s_waitcnt lgkmcnt(0)
    v_pk_add_f32 v[152:153], v[152:153], v[176:177]
    v_pk_add_f32 v[154:155], v[154:155], v[178:179]
    v_pk_add_f32 v[156:157], v[156:157], v[180:181]
    v_pk_add_f32 v[158:159], v[158:159], v[182:183]
    v_cvt_pk_bf16_f32 v96, v152, v153
    v_cvt_pk_bf16_f32 v97, v154, v155
    v_cvt_pk_bf16_f32 v98, v156, v157
    v_cvt_pk_bf16_f32 v99, v158, v159
    buffer_load_dwordx4 v[16:19], v184, s[8:11], s36 offen sc1
    buffer_load_dwordx4 v[24:27], v185, s[8:11], s36 offen sc1
    buffer_load_dwordx4 v[32:35], v186, s[8:11], s36 offen sc1
    s_mov_b64 exec, s[42:43]
    buffer_load_dwordx4 v[20:23], v187, s[8:11], s36 offen sc1
    buffer_load_dwordx4 v[28:31], v188, s[8:11], s36 offen sc1
    buffer_load_dwordx4 v[36:39], v189, s[8:11], s36 offen sc1
    s_mov_b64 exec, -1
    s_not_b64 exec, s[40:41]
    ds_write_b128 v60, v[80:83] offset:20480
    s_mov_b64 exec, s[54:55]
    ds_write_b64 v61, v[96:97] offset:20992
    ds_write_b64 v61, v[98:99] offset:21056
    s_mov_b64 exec, -1
    s_mov_b32 s44, 0
    s_add_u32 s46, s36, 65536
    s_cmp_eq_u32 s35, 63
    s_cbranch_scc1 CS_W5_END
CS_SP_W:
    s_waitcnt vmcnt(10)
    v_pk_fma_f32 v[160:161], v[112:113], v[106:107], v[84:85]
    v_pk_fma_f32 v[162:163], v[114:115], v[106:107], v[86:87]
    v_pk_fma_f32 v[160:161], v[120:121], v[106:107], v[160:161]
    v_pk_fma_f32 v[162:163], v[122:123], v[106:107], v[162:163]
    s_waitcnt vmcnt(8)
    v_pk_fma_f32 v[160:161], v[128:129], v[106:107], v[160:161]
    v_pk_fma_f32 v[162:163], v[130:131], v[106:107], v[162:163]
    v_pk_fma_f32 v[164:165], v[116:117], v[106:107], v[88:89]
    v_pk_fma_f32 v[166:167], v[118:119], v[106:107], v[90:91]
    s_waitcnt vmcnt(7)
    v_pk_fma_f32 v[164:165], v[124:125], v[106:107], v[164:165]
    v_pk_fma_f32 v[166:167], v[126:127], v[106:107], v[166:167]
    v_exp_f32 v152, v160
    v_exp_f32 v153, v161
    s_waitcnt vmcnt(6)
    v_pk_fma_f32 v[164:165], v[132:133], v[106:107], v[164:165]
    v_pk_fma_f32 v[166:167], v[134:135], v[106:107], v[166:167]
    v_cmp_u_f32 vcc, v160, v164
    v_exp_f32 v154, v162
    v_exp_f32 v155, v163
    s_cbranch_vccnz CS_SP_B
CS_SP_E:
    v_exp_f32 v156, v164
    v_exp_f32 v157, v165
    v_exp_f32 v158, v166
    v_exp_f32 v159, v167
    v_cvt_pk_bf16_f32 v100, v152, v153
    v_cvt_pk_bf16_f32 v101, v154, v155
    s_mov_b64 exec, s[42:43]
    v_cvt_pk_bf16_f32 v104, v156, v157
    v_cvt_pk_bf16_f32 v105, v158, v159
    s_mov_b64 exec, -1
    v_mov_b32_dpp v102, v100 row_ror:8 row_mask:0xf bank_mask:0xf
    v_mov_b32_dpp v103, v101 row_ror:8 row_mask:0xf bank_mask:0xf
    v_mfma_f32_16x16x16_bf16 v[144:147], v[108:109], v[104:105], 0
    v_mfma_f32_16x16x16_bf16 v[136:139], v[96:97], v[104:105], 0
    v_mfma_f32_16x16x16_bf16 v[140:143], v[98:99], v[104:105], 0
    v_mfma_f32_16x16x32_bf16 v[144:147], v[108:111], v[100:103], v[144:147]
    v_mfma_f32_16x16x32_bf16 v[136:139], v[72:75], v[100:103], v[136:139]
    v_mfma_f32_16x16x32_bf16 v[140:143], v[76:79], v[100:103], v[140:143]
    s_mov_b64 exec, s[40:41]
    s_nop 4
    v_rcp_f32 v148, v144
    v_med3_f32 v150, v144, v190, v191
    v_cmp_neq_f32 vcc, v150, v144
    s_cbranch_vccnz CS_SP_X
CS_SP_OK:
    v_pk_mul_f32 v[136:137], v[136:137], v[148:149] op_sel_hi:[1,0]
    v_pk_mul_f32 v[138:139], v[138:139], v[148:149] op_sel_hi:[1,0]
    v_pk_mul_f32 v[140:141], v[140:141], v[148:149] op_sel_hi:[1,0]
    v_pk_mul_f32 v[142:143], v[142:143], v[148:149] op_sel_hi:[1,0]
    v_cvt_pk_bf16_f32 v92, v136, v137
    v_cvt_pk_bf16_f32 v93, v138, v139
    v_cvt_pk_bf16_f32 v94, v140, v141
    v_cvt_pk_bf16_f32 v95, v142, v143
    v_min_u32 v92, -2, v92
    v_min_u32 v93, -2, v93
    v_min_u32 v94, -2, v94
    v_min_u32 v95, -2, v95
    buffer_store_dwordx4 v[92:95], v6, s[8:11], s46 offen sc1
    s_mov_b64 exec, -1
    s_waitcnt lgkmcnt(0)
    s_barrier
    s_sleep 2
    s_mov_b32 s44, 0
CS_OP5_R0:
    buffer_load_dwordx4 v[16:19], v3, s[8:11], s36 offen offset:0 sc1
    buffer_load_dwordx4 v[20:23], v3, s[8:11], s36 offen offset:1024 sc1
    buffer_load_dwordx4 v[24:27], v3, s[8:11], s36 offen offset:2048 sc1
    buffer_load_dwordx4 v[28:31], v3, s[8:11], s36 offen offset:3072 sc1
    s_add_u32 s44, s44, 1
    s_cmp_gt_u32 s44, 60000
    s_cbranch_scc1 C_DONE
    s_waitcnt vmcnt(3)
    v_max3_u32 v5, v16, v17, v18
    v_max_u32 v5, v5, v19
    v_cmp_eq_u32 vcc, -1, v5
    s_cbranch_vccnz CS_OP5_R0
    v_mfma_f32_16x16x32_bf16 v[48:51], v[192:195], v[16:19], v[48:51]
    v_mov_b32_dpp v32, v16 row_ror:8 row_mask:0xf bank_mask:0xf
    v_mov_b32_dpp v33, v17 row_ror:8 row_mask:0xf bank_mask:0xf
    v_mov_b32_dpp v34, v18 row_ror:8 row_mask:0xf bank_mask:0xf
    v_mov_b32_dpp v35, v19 row_ror:8 row_mask:0xf bank_mask:0xf
    s_waitcnt vmcnt(2)
    v_mfma_f32_16x16x32_bf16 v[52:55], v[204:207], v[16:19], v[52:55]
    v_max3_u32 v5, v20, v21, v22
    v_mfma_f32_16x16x32_bf16 v[48:51], v[200:203], v[32:35], v[48:51]
    v_max_u32 v5, v5, v23
    v_cmp_eq_u32 vcc, -1, v5
    v_mfma_f32_16x16x32_bf16 v[52:55], v[196:199], v[32:35], v[52:55]
    s_cbranch_vccnz CS_OP5_R1
CS_OP5_B1:
    v_mfma_f32_16x16x32_bf16 v[48:51], v[208:211], v[20:23], v[48:51]
    v_mov_b32_dpp v32, v20 row_ror:8 row_mask:0xf bank_mask:0xf
    v_mov_b32_dpp v33, v21 row_ror:8 row_mask:0xf bank_mask:0xf
    v_mov_b32_dpp v34, v22 row_ror:8 row_mask:0xf bank_mask:0xf
    v_mov_b32_dpp v35, v23 row_ror:8 row_mask:0xf bank_mask:0xf
    s_waitcnt vmcnt(1)
    v_mfma_f32_16x16x32_bf16 v[52:55], v[220:223], v[20:23], v[52:55]
    v_max3_u32 v5, v24, v25, v26
    v_mfma_f32_16x16x32_bf16 v[48:51], v[216:219], v[32:35], v[48:51]
    v_max_u32 v5, v5, v27
    v_cmp_eq_u32 vcc, -1, v5
    v_mfma_f32_16x16x32_bf16 v[52:55], v[212:215], v[32:35], v[52:55]
    s_cbranch_vccnz CS_OP5_R2
CS_OP5_B2:
    v_mfma_f32_16x16x32_bf16 v[48:51], v[224:227], v[24:27], v[48:51]
    v_mov_b32_dpp v32, v24 row_ror:8 row_mask:0xf bank_mask:0xf
    v_mov_b32_dpp v33, v25 row_ror:8 row_mask:0xf bank_mask:0xf
    v_mov_b32_dpp v34, v26 row_ror:8 row_mask:0xf bank_mask:0xf
    v_mov_b32_dpp v35, v27 row_ror:8 row_mask:0xf bank_mask:0xf
    s_waitcnt vmcnt(0)
    v_mfma_f32_16x16x32_bf16 v[52:55], v[236:239], v[24:27], v[52:55]
    v_max3_u32 v5, v28, v29, v30
    v_mfma_f32_16x16x32_bf16 v[48:51], v[232:235], v[32:35], v[48:51]
    v_max_u32 v5, v5, v31
    v_cmp_eq_u32 vcc, -1, v5
    v_mfma_f32_16x16x32_bf16 v[52:55], v[228:231], v[32:35], v[52:55]
    s_cbranch_vccnz CS_OP5_R3
CS_OP5_B3:
    v_mfma_f32_16x16x32_bf16 v[48:51], v[240:243], v[28:31], v[48:51]
    v_mov_b32_dpp v32, v28 row_ror:8 row_mask:0xf bank_mask:0xf
    v_mov_b32_dpp v33, v29 row_ror:8 row_mask:0xf bank_mask:0xf
    v_mov_b32_dpp v34, v30 row_ror:8 row_mask:0xf bank_mask:0xf
    v_mov_b32_dpp v35, v31 row_ror:8 row_mask:0xf bank_mask:0xf
    v_mfma_f32_16x16x32_bf16 v[52:55], v[252:255], v[28:31], v[52:55]
    s_nop 0
    v_mfma_f32_16x16x32_bf16 v[48:51], v[248:251], v[32:35], v[48:51]
    v_mfma_f32_16x16x32_bf16 v[52:55], v[244:247], v[32:35], v[52:55]
    s_nop 7
    v_cndmask_b32 v48, v52, v48, s[40:41]
    v_cndmask_b32 v49, v53, v49, s[40:41]
    v_cndmask_b32 v50, v54, v50, s[40:41]
    v_cndmask_b32 v51, v55, v51, s[40:41]
    ds_write_b128 v4, v[48:51] offset:16384
    s_waitcnt lgkmcnt(0)
    s_barrier
    s_sleep 5
    buffer_load_dwordx4 v[64:67], v56, s[8:11], s50 offen offset:0 sc1
    buffer_load_dwordx4 v[68:71], v56, s[8:11], s50 offen offset:64 sc1
    buffer_load_dwordx4 v[72:75], v56, s[8:11], s50 offen offset:2048 sc1
    buffer_load_dwordx4 v[76:79], v56, s[8:11], s50 offen offset:2112 sc1
    s_add_u32 s50, s50, 4096
    v_mov_b32 v48, 0
    v_mov_b32 v49, 0
    v_mov_b32 v50, 0
    v_mov_b32 v51, 0
    v_mov_b32 v52, 0
    v_mov_b32 v53, 0
    v_mov_b32 v54, 0
    v_mov_b32 v55, 0
    s_mov_b32 s36, s37
    s_mov_b32 s37, s38
    s_add_u32 s38, s38, 524288
    s_cmp_eq_u32 s38, 96468992
    s_cselect_b32 s38, 94371840, s38
    s_add_u32 s35, s35, 1
    s_lshr_b32 s27, s35, 3
    s_lshl_b32 s27, s27, 22
    s_and_b32 s28, s35, 7
    s_lshl_b32 s28, s28, 18
    s_add_u32 s27, s27, s28
    s_barrier
    s_waitcnt vmcnt(0)
    s_branch CS_W5_LOOP
CS_W5_END:
    s_waitcnt lgkmcnt(0)
    ds_read_b128 v[152:155], v2 offset:20480
    s_add_u32 s52, s52, 64512
    s_waitcnt lgkmcnt(0)
    buffer_store_dwordx4 v[152:155], v2, s[8:11], s52 offen sc1
    s_waitcnt vmcnt(0)
    s_lshl_b32 s45, s32, 7
    s_add_u32 s45, s45, 98569728
    s_mov_b32 s21, 1
    s_atomic_add s21, s[84:85], s45
    s_branch C_FIN
CS_SP_X:
    s_mov_b64 exec, -1
    s_add_u32 s44, s44, 1
    s_cmp_gt_u32 s44, 60000
    s_cbranch_scc1 C_DONE
    v_max3_u32 v5, v112, v113, v114
    v_max3_u32 v5, v5, v115, v116
    v_max3_u32 v5, v5, v117, v118
    v_max3_u32 v5, v5, v119, v120
    v_max3_u32 v5, v5, v121, v122
    v_max3_u32 v5, v5, v123, v124
    v_max3_u32 v5, v5, v125, v126
    v_max3_u32 v5, v5, v127, v128
    v_max3_u32 v5, v5, v129, v130
    v_max3_u32 v5, v5, v131, v132
    v_max3_u32 v5, v5, v133, v134
    v_max_u32 v5, v5, v135
    v_cmp_eq_u32 vcc, -1, v5
    s_cbranch_vccnz CS_SP
    v_max3_f32 v148, v160, v161, v162
    v_max_f32 v148, v148, v163
    s_mov_b64 exec, s[42:43]
    v_max3_f32 v148, v148, v164, v165
    v_max3_f32 v148, v148, v166, v167
    s_mov_b64 exec, -1
    s_nop 0
    v_max_f32_dpp v148, v148, v148 row_ror:8 row_mask:0xf bank_mask:0xf
    v_mov_b32 v149, v148
    s_nop 1
    v_permlane16_swap_b32 v148, v149
    v_max_f32 v148, v148, v149
    v_mov_b32 v149, v148
    s_nop 1
    v_permlane32_swap_b32 v148, v149
    v_max_f32 v148, v148, v149
    v_sub_f32 v160, v160, v148
    v_sub_f32 v161, v161, v148
    v_sub_f32 v162, v162, v148
    v_sub_f32 v163, v163, v148
    v_sub_f32 v164, v164, v148
    v_sub_f32 v165, v165, v148
    v_sub_f32 v166, v166, v148
    v_sub_f32 v167, v167, v148
    v_exp_f32 v152, v160
    v_exp_f32 v153, v161
    v_exp_f32 v154, v162
    v_exp_f32 v155, v163
    v_exp_f32 v156, v164
    v_exp_f32 v157, v165
    v_exp_f32 v158, v166
    v_exp_f32 v159, v167
    v_cvt_pk_bf16_f32 v100, v152, v153
    v_cvt_pk_bf16_f32 v101, v154, v155
    s_mov_b64 exec, s[42:43]
    v_cvt_pk_bf16_f32 v104, v156, v157
    v_cvt_pk_bf16_f32 v105, v158, v159
    s_mov_b64 exec, -1
    v_mov_b32_dpp v102, v100 row_ror:8 row_mask:0xf bank_mask:0xf
    v_mov_b32_dpp v103, v101 row_ror:8 row_mask:0xf bank_mask:0xf
    v_mfma_f32_16x16x16_bf16 v[144:147], v[108:109], v[104:105], 0
    v_mfma_f32_16x16x16_bf16 v[136:139], v[96:97], v[104:105], 0
    v_mfma_f32_16x16x16_bf16 v[140:143], v[98:99], v[104:105], 0
    v_mfma_f32_16x16x32_bf16 v[144:147], v[108:111], v[100:103], v[144:147]
    v_mfma_f32_16x16x32_bf16 v[136:139], v[72:75], v[100:103], v[136:139]
    v_mfma_f32_16x16x32_bf16 v[140:143], v[76:79], v[100:103], v[140:143]
    s_mov_b64 exec, s[40:41]
    s_nop 4
    v_rcp_f32 v148, v144
    s_branch CS_SP_OK
CS_SP:
    buffer_load_dwordx4 v[112:115], v184, s[8:11], s36 offen sc1
    buffer_load_dwordx4 v[120:123], v185, s[8:11], s36 offen sc1
    buffer_load_dwordx4 v[128:131], v186, s[8:11], s36 offen sc1
    s_mov_b64 exec, s[42:43]
    buffer_load_dwordx4 v[116:119], v187, s[8:11], s36 offen sc1
    buffer_load_dwordx4 v[124:127], v188, s[8:11], s36 offen sc1
    buffer_load_dwordx4 v[132:135], v189, s[8:11], s36 offen sc1
    s_mov_b64 exec, -1
    s_waitcnt vmcnt(4)
    v_pk_fma_f32 v[160:161], v[112:113], v[106:107], v[84:85]
    v_pk_fma_f32 v[162:163], v[114:115], v[106:107], v[86:87]
    v_pk_fma_f32 v[160:161], v[120:121], v[106:107], v[160:161]
    v_pk_fma_f32 v[162:163], v[122:123], v[106:107], v[162:163]
    s_waitcnt vmcnt(2)
    v_pk_fma_f32 v[160:161], v[128:129], v[106:107], v[160:161]
    v_pk_fma_f32 v[162:163], v[130:131], v[106:107], v[162:163]
    v_pk_fma_f32 v[164:165], v[116:117], v[106:107], v[88:89]
    v_pk_fma_f32 v[166:167], v[118:119], v[106:107], v[90:91]
    s_waitcnt vmcnt(1)
    v_pk_fma_f32 v[164:165], v[124:125], v[106:107], v[164:165]
    v_pk_fma_f32 v[166:167], v[126:127], v[106:107], v[166:167]
    v_exp_f32 v152, v160
    v_exp_f32 v153, v161
    s_waitcnt vmcnt(0)
    v_pk_fma_f32 v[164:165], v[132:133], v[106:107], v[164:165]
    v_pk_fma_f32 v[166:167], v[134:135], v[106:107], v[166:167]
    v_exp_f32 v154, v162
    v_exp_f32 v155, v163
    s_branch CS_SP_E
CS_SP_B:
    s_waitcnt vmcnt(4)
    v_pk_fma_f32 v[160:161], v[16:17], v[106:107], v[84:85]
    v_pk_fma_f32 v[162:163], v[18:19], v[106:107], v[86:87]
    v_pk_fma_f32 v[160:161], v[24:25], v[106:107], v[160:161]
    v_pk_fma_f32 v[162:163], v[26:27], v[106:107], v[162:163]
    s_waitcnt vmcnt(2)
    v_pk_fma_f32 v[160:161], v[32:33], v[106:107], v[160:161]
    v_pk_fma_f32 v[162:163], v[34:35], v[106:107], v[162:163]
    v_pk_fma_f32 v[164:165], v[20:21], v[106:107], v[88:89]
    v_pk_fma_f32 v[166:167], v[22:23], v[106:107], v[90:91]
    s_waitcnt vmcnt(1)
    v_pk_fma_f32 v[164:165], v[28:29], v[106:107], v[164:165]
    v_pk_fma_f32 v[166:167], v[30:31], v[106:107], v[166:167]
    v_exp_f32 v152, v160
    v_exp_f32 v153, v161
    s_waitcnt vmcnt(0)
    v_pk_fma_f32 v[164:165], v[36:37], v[106:107], v[164:165]
    v_pk_fma_f32 v[166:167], v[38:39], v[106:107], v[166:167]
    v_exp_f32 v154, v162
    v_exp_f32 v155, v163
    s_branch CS_SP_E
CS_OP5_R1:
    buffer_load_dwordx4 v[20:23], v3, s[8:11], s36 offen offset:1024 sc1
    buffer_load_dwordx4 v[24:27], v3, s[8:11], s36 offen offset:2048 sc1
    buffer_load_dwordx4 v[28:31], v3, s[8:11], s36 offen offset:3072 sc1
    s_add_u32 s44, s44, 1
    s_cmp_gt_u32 s44, 60000
    s_cbranch_scc1 C_DONE
    s_waitcnt vmcnt(2)
    v_max3_u32 v5, v20, v21, v22
    v_max_u32 v5, v5, v23
    v_cmp_eq_u32 vcc, -1, v5
    s_cbranch_vccnz CS_OP5_R1
    s_branch CS_OP5_B1
CS_OP5_R2:
    buffer_load_dwordx4 v[24:27], v3, s[8:11], s36 offen offset:2048 sc1
    buffer_load_dwordx4 v[28:31], v3, s[8:11], s36 offen offset:3072 sc1
    s_add_u32 s44, s44, 1
    s_cmp_gt_u32 s44, 60000
    s_cbranch_scc1 C_DONE
    s_waitcnt vmcnt(1)
    v_max3_u32 v5, v24, v25, v26
    v_max_u32 v5, v5, v27
    v_cmp_eq_u32 vcc, -1, v5
    s_cbranch_vccnz CS_OP5_R2
    s_branch CS_OP5_B2
CS_OP5_R3:
    buffer_load_dwordx4 v[28:31], v3, s[8:11], s36 offen offset:3072 sc1
    s_add_u32 s44, s44, 1
    s_cmp_gt_u32 s44, 60000
    s_cbranch_scc1 C_DONE
    s_waitcnt vmcnt(0)
    v_max3_u32 v5, v28, v29, v30
    v_max_u32 v5, v5, v31
    v_cmp_eq_u32 vcc, -1, v5
    s_cbranch_vccnz CS_OP5_R3
    s_branch CS_OP5_B3
C_FIN:
    s_setprio 0
    s_waitcnt vmcnt(0) lgkmcnt(0)
    s_barrier
    v_and_b32 v1, 15, v0
    v_lshrrev_b32 v2, 4, v0
    v_lshlrev_b32 v4, 4, v0
    s_mov_b32 s40, 0
    s_cmp_lt_u32 s34, 4
    s_cbranch_scc1 CT_RED
    v_lshlrev_b32 v3, 9, v2
    v_lshl_add_u32 v3, v1, 4, v3
    s_sub_u32 s42, s34, 4
    s_lshl_b32 s43, s42, 12
    v_add_u32 v5, s43, v4
    s_lshl_b32 s42, s42, 14
    s_lshl_b32 s43, s32, 16
    s_add_u32 s51, s42, s43
    s_add_u32 s51, s51, 66060288
    v_min_u32 v8, 4, v0
    v_lshlrev_b32 v8, 7, v8
    v_add_u32 v8, 98582016, v8
CT_COLD:
    s_lshl_b32 s41, s40, 18
    s_add_u32 s41, s41, s51
    s_mov_b32 s44, 0
    s_add_u32 s43, s40, 0
CT_W0:
    buffer_load_dword v10, v8, s[8:11], 0 offen sc1
    s_add_u32 s44, s44, 1
    s_cmp_gt_u32 s44, 60000
    s_cbranch_scc1 C_DONE
    s_waitcnt vmcnt(0)
    v_cmp_eq_u32 s[52:53], 32, v10
    s_bitcmp1_b64 s[52:53], s43
    s_cbranch_scc1 CT_GO0
    s_sleep 3
    s_branch CT_W0
CT_GO0:
    buffer_load_dwordx4 v[32:35], v3, s[8:11], s41 offen offset:0 sc1
    buffer_load_dwordx4 v[36:39], v3, s[8:11], s41 offen offset:256 sc1
    buffer_load_dwordx4 v[40:43], v3, s[8:11], s41 offen offset:2048 sc1
    buffer_load_dwordx4 v[44:47], v3, s[8:11], s41 offen offset:2304 sc1
    s_add_u32 s41, s41, 4096
    buffer_load_dwordx4 v[48:51], v3, s[8:11], s41 offen offset:0 sc1
    buffer_load_dwordx4 v[52:55], v3, s[8:11], s41 offen offset:256 sc1
    buffer_load_dwordx4 v[56:59], v3, s[8:11], s41 offen offset:2048 sc1
    buffer_load_dwordx4 v[60:63], v3, s[8:11], s41 offen offset:2304 sc1
    s_add_u32 s41, s41, 4096
    buffer_load_dwordx4 v[64:67], v3, s[8:11], s41 offen offset:0 sc1
    buffer_load_dwordx4 v[68:71], v3, s[8:11], s41 offen offset:256 sc1
    buffer_load_dwordx4 v[72:75], v3, s[8:11], s41 offen offset:2048 sc1
    buffer_load_dwordx4 v[76:79], v3, s[8:11], s41 offen offset:2304 sc1
    s_add_u32 s41, s41, 4096
    buffer_load_dwordx4 v[80:83], v3, s[8:11], s41 offen offset:0 sc1
    buffer_load_dwordx4 v[84:87], v3, s[8:11], s41 offen offset:256 sc1
    buffer_load_dwordx4 v[88:91], v3, s[8:11], s41 offen offset:2048 sc1
    buffer_load_dwordx4 v[92:95], v3, s[8:11], s41 offen offset:2304 sc1
    s_add_u32 s41, s41, 249856
    s_mov_b32 s44, 0
    s_add_u32 s43, s40, 1
    s_bitcmp1_b64 s[52:53], s43
    s_cbranch_scc1 CT_GO1
CT_W1:
    buffer_load_dword v10, v8, s[8:11], 0 offen sc1
    s_add_u32 s44, s44, 1
    s_cmp_gt_u32 s44, 60000
    s_cbranch_scc1 C_DONE
    s_waitcnt vmcnt(0)
    v_cmp_eq_u32 s[52:53], 32, v10
    s_bitcmp1_b64 s[52:53], s43
    s_cbranch_scc1 CT_GO1
    s_sleep 3
    s_branch CT_W1
CT_GO1:
    buffer_load_dwordx4 v[96:99], v3, s[8:11], s41 offen offset:0 sc1
    buffer_load_dwordx4 v[100:103], v3, s[8:11], s41 offen offset:256 sc1
    buffer_load_dwordx4 v[104:107], v3, s[8:11], s41 offen offset:2048 sc1
    buffer_load_dwordx4 v[108:111], v3, s[8:11], s41 offen offset:2304 sc1
    s_add_u32 s41, s41, 4096
    buffer_load_dwordx4 v[112:115], v3, s[8:11], s41 offen offset:0 sc1
    buffer_load_dwordx4 v[116:119], v3, s[8:11], s41 offen offset:256 sc1
    buffer_load_dwordx4 v[120:123], v3, s[8:11], s41 offen offset:2048 sc1
    buffer_load_dwordx4 v[124:127], v3, s[8:11], s41 offen offset:2304 sc1
    s_add_u32 s41, s41, 4096
    buffer_load_dwordx4 v[128:131], v3, s[8:11], s41 offen offset:0 sc1
    buffer_load_dwordx4 v[132:135], v3, s[8:11], s41 offen offset:256 sc1
    buffer_load_dwordx4 v[136:139], v3, s[8:11], s41 offen offset:2048 sc1
    buffer_load_dwordx4 v[140:143], v3, s[8:11], s41 offen offset:2304 sc1
    s_add_u32 s41, s41, 4096
    buffer_load_dwordx4 v[144:147], v3, s[8:11], s41 offen offset:0 sc1
    buffer_load_dwordx4 v[148:151], v3, s[8:11], s41 offen offset:256 sc1
    buffer_load_dwordx4 v[152:155], v3, s[8:11], s41 offen offset:2048 sc1
    buffer_load_dwordx4 v[156:159], v3, s[8:11], s41 offen offset:2304 sc1
    s_add_u32 s41, s41, 4096
CT_ML:
    s_add_u32 s40, s40, 2
    s_lshr_b64 s[42:43], s[52:53], s40
    s_and_b32 s42, s42, 3
    s_cmp_eq_u32 s42, 3
    s_cselect_b32 s50, 1, 0
    s_cbranch_scc0 CT_DRAIN
    s_lshl_b32 s41, s40, 18
    s_add_u32 s41, s41, s51
    s_waitcnt vmcnt(30)
    v_mfma_f32_16x16x32_bf16 v[160:163], v[192:195], v[32:35], 0
    v_mfma_f32_16x16x32_bf16 v[164:167], v[196:199], v[32:35], 0
    v_mfma_f32_16x16x32_bf16 v[168:171], v[192:195], v[36:39], 0
    v_mfma_f32_16x16x32_bf16 v[172:175], v[196:199], v[36:39], 0
    buffer_load_dwordx4 v[32:35], v3, s[8:11], s41 offen offset:0 sc1
    buffer_load_dwordx4 v[36:39], v3, s[8:11], s41 offen offset:256 sc1
    s_waitcnt vmcnt(30)
    v_mfma_f32_16x16x32_bf16 v[160:163], v[200:203], v[40:43], v[160:163]
    v_mfma_f32_16x16x32_bf16 v[164:167], v[204:207], v[40:43], v[164:167]
    v_mfma_f32_16x16x32_bf16 v[168:171], v[200:203], v[44:47], v[168:171]
    v_mfma_f32_16x16x32_bf16 v[172:175], v[204:207], v[44:47], v[172:175]
    buffer_load_dwordx4 v[40:43], v3, s[8:11], s41 offen offset:2048 sc1
    buffer_load_dwordx4 v[44:47], v3, s[8:11], s41 offen offset:2304 sc1
    s_add_u32 s41, s41, 4096
    s_waitcnt vmcnt(30)
    v_mfma_f32_16x16x32_bf16 v[160:163], v[208:211], v[48:51], v[160:163]
    v_mfma_f32_16x16x32_bf16 v[164:167], v[212:215], v[48:51], v[164:167]
    v_mfma_f32_16x16x32_bf16 v[168:171], v[208:211], v[52:55], v[168:171]
    v_mfma_f32_16x16x32_bf16 v[172:175], v[212:215], v[52:55], v[172:175]
    buffer_load_dwordx4 v[48:51], v3, s[8:11], s41 offen offset:0 sc1
    buffer_load_dwordx4 v[52:55], v3, s[8:11], s41 offen offset:256 sc1
    s_waitcnt vmcnt(30)
    v_mfma_f32_16x16x32_bf16 v[160:163], v[216:219], v[56:59], v[160:163]
    v_mfma_f32_16x16x32_bf16 v[164:167], v[220:223], v[56:59], v[164:167]
    v_mfma_f32_16x16x32_bf16 v[168:171], v[216:219], v[60:63], v[168:171]
    v_mfma_f32_16x16x32_bf16 v[172:175], v[220:223], v[60:63], v[172:175]
    buffer_load_dwordx4 v[56:59], v3, s[8:11], s41 offen offset:2048 sc1
    buffer_load_dwordx4 v[60:63], v3, s[8:11], s41 offen offset:2304 sc1
    s_add_u32 s41, s41, 4096
    s_waitcnt vmcnt(30)
    v_mfma_f32_16x16x32_bf16 v[160:163], v[224:227], v[64:67], v[160:163]
    v_mfma_f32_16x16x32_bf16 v[164:167], v[228:231], v[64:67], v[164:167]
    v_mfma_f32_16x16x32_bf16 v[168:171], v[224:227], v[68:71], v[168:171]
    v_mfma_f32_16x16x32_bf16 v[172:175], v[228:231], v[68:71], v[172:175]
    buffer_load_dwordx4 v[64:67], v3, s[8:11], s41 offen offset:0 sc1
    buffer_load_dwordx4 v[68:71], v3, s[8:11], s41 offen offset:256 sc1
    s_waitcnt vmcnt(30)
    v_mfma_f32_16x16x32_bf16 v[160:163], v[232:235], v[72:75], v[160:163]
    v_mfma_f32_16x16x32_bf16 v[164:167], v[236:239], v[72:75], v[164:167]
    v_mfma_f32_16x16x32_bf16 v[168:171], v[232:235], v[76:79], v[168:171]
    v_mfma_f32_16x16x32_bf16 v[172:175], v[236:239], v[76:79], v[172:175]
    buffer_load_dwordx4 v[72:75], v3, s[8:11], s41 offen offset:2048 sc1
    buffer_load_dwordx4 v[76:79], v3, s[8:11], s41 offen offset:2304 sc1
    s_add_u32 s41, s41, 4096
    s_waitcnt vmcnt(30)
    v_mfma_f32_16x16x32_bf16 v[160:163], v[240:243], v[80:83], v[160:163]
    v_mfma_f32_16x16x32_bf16 v[164:167], v[244:247], v[80:83], v[164:167]
    v_mfma_f32_16x16x32_bf16 v[168:171], v[240:243], v[84:87], v[168:171]
    v_mfma_f32_16x16x32_bf16 v[172:175], v[244:247], v[84:87], v[172:175]
    buffer_load_dwordx4 v[80:83], v3, s[8:11], s41 offen offset:0 sc1
    buffer_load_dwordx4 v[84:87], v3, s[8:11], s41 offen offset:256 sc1
    s_waitcnt vmcnt(30)
    v_mfma_f32_16x16x32_bf16 v[160:163], v[248:251], v[88:91], v[160:163]
    v_mfma_f32_16x16x32_bf16 v[164:167], v[252:255], v[88:91], v[164:167]
    v_mfma_f32_16x16x32_bf16 v[168:171], v[248:251], v[92:95], v[168:171]
    v_mfma_f32_16x16x32_bf16 v[172:175], v[252:255], v[92:95], v[172:175]
    buffer_load_dwordx4 v[88:91], v3, s[8:11], s41 offen offset:2048 sc1
    buffer_load_dwordx4 v[92:95], v3, s[8:11], s41 offen offset:2304 sc1
    s_add_u32 s41, s41, 249856
    s_waitcnt vmcnt(30)
    v_mfma_f32_16x16x32_bf16 v[176:179], v[192:195], v[96:99], 0
    v_mfma_f32_16x16x32_bf16 v[180:183], v[196:199], v[96:99], 0
    v_mfma_f32_16x16x32_bf16 v[184:187], v[192:195], v[100:103], 0
    v_mfma_f32_16x16x32_bf16 v[188:191], v[196:199], v[100:103], 0
    buffer_load_dwordx4 v[96:99], v3, s[8:11], s41 offen offset:0 sc1
    buffer_load_dwordx4 v[100:103], v3, s[8:11], s41 offen offset:256 sc1
    s_waitcnt vmcnt(30)
    v_mfma_f32_16x16x32_bf16 v[176:179], v[200:203], v[104:107], v[176:179]
    v_mfma_f32_16x16x32_bf16 v[180:183], v[204:207], v[104:107], v[180:183]
    v_mfma_f32_16x16x32_bf16 v[184:187], v[200:203], v[108:111], v[184:187]
    v_mfma_f32_16x16x32_bf16 v[188:191], v[204:207], v[108:111], v[188:191]
    buffer_load_dwordx4 v[104:107], v3, s[8:11], s41 offen offset:2048 sc1
    buffer_load_dwordx4 v[108:111], v3, s[8:11], s41 offen offset:2304 sc1
    s_add_u32 s41, s41, 4096
    s_waitcnt vmcnt(30)
    v_mfma_f32_16x16x32_bf16 v[176:179], v[208:211], v[112:115], v[176:179]
    v_mfma_f32_16x16x32_bf16 v[180:183], v[212:215], v[112:115], v[180:183]
    v_mfma_f32_16x16x32_bf16 v[184:187], v[208:211], v[116:119], v[184:187]
    v_mfma_f32_16x16x32_bf16 v[188:191], v[212:215], v[116:119], v[188:191]
    buffer_load_dwordx4 v[112:115], v3, s[8:11], s41 offen offset:0 sc1
    buffer_load_dwordx4 v[116:119], v3, s[8:11], s41 offen offset:256 sc1
    s_waitcnt vmcnt(30)
    v_mfma_f32_16x16x32_bf16 v[176:179], v[216:219], v[120:123], v[176:179]
    v_mfma_f32_16x16x32_bf16 v[180:183], v[220:223], v[120:123], v[180:183]
    v_mfma_f32_16x16x32_bf16 v[184:187], v[216:219], v[124:127], v[184:187]
    v_mfma_f32_16x16x32_bf16 v[188:191], v[220:223], v[124:127], v[188:191]
    buffer_load_dwordx4 v[120:123], v3, s[8:11], s41 offen offset:2048 sc1
    buffer_load_dwordx4 v[124:127], v3, s[8:11], s41 offen offset:2304 sc1
    s_add_u32 s41, s41, 4096
    s_waitcnt vmcnt(30)
    v_mfma_f32_16x16x32_bf16 v[176:179], v[224:227], v[128:131], v[176:179]
    v_mfma_f32_16x16x32_bf16 v[180:183], v[228:231], v[128:131], v[180:183]
    v_mfma_f32_16x16x32_bf16 v[184:187], v[224:227], v[132:135], v[184:187]
    v_mfma_f32_16x16x32_bf16 v[188:191], v[228:231], v[132:135], v[188:191]
    buffer_load_dwordx4 v[128:131], v3, s[8:11], s41 offen offset:0 sc1
    buffer_load_dwordx4 v[132:135], v3, s[8:11], s41 offen offset:256 sc1
    s_waitcnt vmcnt(30)
    v_mfma_f32_16x16x32_bf16 v[176:179], v[232:235], v[136:139], v[176:179]
    v_mfma_f32_16x16x32_bf16 v[180:183], v[236:239], v[136:139], v[180:183]
    v_mfma_f32_16x16x32_bf16 v[184:187], v[232:235], v[140:143], v[184:187]
    v_mfma_f32_16x16x32_bf16 v[188:191], v[236:239], v[140:143], v[188:191]
    buffer_load_dwordx4 v[136:139], v3, s[8:11], s41 offen offset:2048 sc1
    buffer_load_dwordx4 v[140:143], v3, s[8:11], s41 offen offset:2304 sc1
    s_add_u32 s41, s41, 4096
    s_waitcnt vmcnt(30)
    v_mfma_f32_16x16x32_bf16 v[176:179], v[240:243], v[144:147], v[176:179]
    v_mfma_f32_16x16x32_bf16 v[180:183], v[244:247], v[144:147], v[180:183]
    v_mfma_f32_16x16x32_bf16 v[184:187], v[240:243], v[148:151], v[184:187]
    v_mfma_f32_16x16x32_bf16 v[188:191], v[244:247], v[148:151], v[188:191]
    buffer_load_dwordx4 v[144:147], v3, s[8:11], s41 offen offset:0 sc1
    buffer_load_dwordx4 v[148:151], v3, s[8:11], s41 offen offset:256 sc1
    s_waitcnt vmcnt(30)
    v_mfma_f32_16x16x32_bf16 v[176:179], v[248:251], v[152:155], v[176:179]
    v_mfma_f32_16x16x32_bf16 v[180:183], v[252:255], v[152:155], v[180:183]
    v_mfma_f32_16x16x32_bf16 v[184:187], v[248:251], v[156:159], v[184:187]
    v_mfma_f32_16x16x32_bf16 v[188:191], v[252:255], v[156:159], v[188:191]
    buffer_load_dwordx4 v[152:155], v3, s[8:11], s41 offen offset:2048 sc1
    buffer_load_dwordx4 v[156:159], v3, s[8:11], s41 offen offset:2304 sc1
    s_add_u32 s41, s41, 4096
    s_branch CT_PUT
CT_DRAIN:
    s_waitcnt vmcnt(30)
    v_mfma_f32_16x16x32_bf16 v[160:163], v[192:195], v[32:35], 0
    v_mfma_f32_16x16x32_bf16 v[164:167], v[196:199], v[32:35], 0
    v_mfma_f32_16x16x32_bf16 v[168:171], v[192:195], v[36:39], 0
    v_mfma_f32_16x16x32_bf16 v[172:175], v[196:199], v[36:39], 0
    s_waitcnt vmcnt(28)
    v_mfma_f32_16x16x32_bf16 v[160:163], v[200:203], v[40:43], v[160:163]
    v_mfma_f32_16x16x32_bf16 v[164:167], v[204:207], v[40:43], v[164:167]
    v_mfma_f32_16x16x32_bf16 v[168:171], v[200:203], v[44:47], v[168:171]
    v_mfma_f32_16x16x32_bf16 v[172:175], v[204:207], v[44:47], v[172:175]
    s_waitcnt vmcnt(26)
    v_mfma_f32_16x16x32_bf16 v[160:163], v[208:211], v[48:51], v[160:163]
    v_mfma_f32_16x16x32_bf16 v[164:167], v[212:215], v[48:51], v[164:167]
    v_mfma_f32_16x16x32_bf16 v[168:171], v[208:211], v[52:55], v[168:171]
    v_mfma_f32_16x16x32_bf16 v[172:175], v[212:215], v[52:55], v[172:175]
    s_waitcnt vmcnt(24)
    v_mfma_f32_16x16x32_bf16 v[160:163], v[216:219], v[56:59], v[160:163]
    v_mfma_f32_16x16x32_bf16 v[164:167], v[220:223], v[56:59], v[164:167]
    v_mfma_f32_16x16x32_bf16 v[168:171], v[216:219], v[60:63], v[168:171]
    v_mfma_f32_16x16x32_bf16 v[172:175], v[220:223], v[60:63], v[172:175]
    s_waitcnt vmcnt(22)
    v_mfma_f32_16x16x32_bf16 v[160:163], v[224:227], v[64:67], v[160:163]
    v_mfma_f32_16x16x32_bf16 v[164:167], v[228:231], v[64:67], v[164:167]
    v_mfma_f32_16x16x32_bf16 v[168:171], v[224:227], v[68:71], v[168:171]
    v_mfma_f32_16x16x32_bf16 v[172:175], v[228:231], v[68:71], v[172:175]
    s_waitcnt vmcnt(20)
    v_mfma_f32_16x16x32_bf16 v[160:163], v[232:235], v[72:75], v[160:163]
    v_mfma_f32_16x16x32_bf16 v[164:167], v[236:239], v[72:75], v[164:167]
    v_mfma_f32_16x16x32_bf16 v[168:171], v[232:235], v[76:79], v[168:171]
    v_mfma_f32_16x16x32_bf16 v[172:175], v[236:239], v[76:79], v[172:175]
    s_waitcnt vmcnt(18)
    v_mfma_f32_16x16x32_bf16 v[160:163], v[240:243], v[80:83], v[160:163]
    v_mfma_f32_16x16x32_bf16 v[164:167], v[244:247], v[80:83], v[164:167]
    v_mfma_f32_16x16x32_bf16 v[168:171], v[240:243], v[84:87], v[168:171]
    v_mfma_f32_16x16x32_bf16 v[172:175], v[244:247], v[84:87], v[172:175]
    s_waitcnt vmcnt(16)
    v_mfma_f32_16x16x32_bf16 v[160:163], v[248:251], v[88:91], v[160:163]
    v_mfma_f32_16x16x32_bf16 v[164:167], v[252:255], v[88:91], v[164:167]
    v_mfma_f32_16x16x32_bf16 v[168:171], v[248:251], v[92:95], v[168:171]
    v_mfma_f32_16x16x32_bf16 v[172:175], v[252:255], v[92:95], v[172:175]
    s_waitcnt vmcnt(14)
    v_mfma_f32_16x16x32_bf16 v[176:179], v[192:195], v[96:99], 0
    v_mfma_f32_16x16x32_bf16 v[180:183], v[196:199], v[96:99], 0
    v_mfma_f32_16x16x32_bf16 v[184:187], v[192:195], v[100:103], 0
    v_mfma_f32_16x16x32_bf16 v[188:191], v[196:199], v[100:103], 0
    s_waitcnt vmcnt(12)
    v_mfma_f32_16x16x32_bf16 v[176:179], v[200:203], v[104:107], v[176:179]
    v_mfma_f32_16x16x32_bf16 v[180:183], v[204:207], v[104:107], v[180:183]
    v_mfma_f32_16x16x32_bf16 v[184:187], v[200:203], v[108:111], v[184:187]
    v_mfma_f32_16x16x32_bf16 v[188:191], v[204:207], v[108:111], v[188:191]
    s_waitcnt vmcnt(10)
    v_mfma_f32_16x16x32_bf16 v[176:179], v[208:211], v[112:115], v[176:179]
    v_mfma_f32_16x16x32_bf16 v[180:183], v[212:215], v[112:115], v[180:183]
    v_mfma_f32_16x16x32_bf16 v[184:187], v[208:211], v[116:119], v[184:187]
    v_mfma_f32_16x16x32_bf16 v[188:191], v[212:215], v[116:119], v[188:191]
    s_waitcnt vmcnt(8)
    v_mfma_f32_16x16x32_bf16 v[176:179], v[216:219], v[120:123], v[176:179]
    v_mfma_f32_16x16x32_bf16 v[180:183], v[220:223], v[120:123], v[180:183]
    v_mfma_f32_16x16x32_bf16 v[184:187], v[216:219], v[124:127], v[184:187]
    v_mfma_f32_16x16x32_bf16 v[188:191], v[220:223], v[124:127], v[188:191]
    s_waitcnt vmcnt(6)
    v_mfma_f32_16x16x32_bf16 v[176:179], v[224:227], v[128:131], v[176:179]
    v_mfma_f32_16x16x32_bf16 v[180:183], v[228:231], v[128:131], v[180:183]
    v_mfma_f32_16x16x32_bf16 v[184:187], v[224:227], v[132:135], v[184:187]
    v_mfma_f32_16x16x32_bf16 v[188:191], v[228:231], v[132:135], v[188:191]
    s_waitcnt vmcnt(4)
    v_mfma_f32_16x16x32_bf16 v[176:179], v[232:235], v[136:139], v[176:179]
    v_mfma_f32_16x16x32_bf16 v[180:183], v[236:239], v[136:139], v[180:183]
    v_mfma_f32_16x16x32_bf16 v[184:187], v[232:235], v[140:143], v[184:187]
    v_mfma_f32_16x16x32_bf16 v[188:191], v[236:239], v[140:143], v[188:191]
    s_waitcnt vmcnt(2)
    v_mfma_f32_16x16x32_bf16 v[176:179], v[240:243], v[144:147], v[176:179]
    v_mfma_f32_16x16x32_bf16 v[180:183], v[244:247], v[144:147], v[180:183]
    v_mfma_f32_16x16x32_bf16 v[184:187], v[240:243], v[148:151], v[184:187]
    v_mfma_f32_16x16x32_bf16 v[188:191], v[244:247], v[148:151], v[188:191]
    s_waitcnt vmcnt(0)
    v_mfma_f32_16x16x32_bf16 v[176:179], v[248:251], v[152:155], v[176:179]
    v_mfma_f32_16x16x32_bf16 v[180:183], v[252:255], v[152:155], v[180:183]
    v_mfma_f32_16x16x32_bf16 v[184:187], v[248:251], v[156:159], v[184:187]
    v_mfma_f32_16x16x32_bf16 v[188:191], v[252:255], v[156:159], v[188:191]
CT_PUT:
    ds_write_b128 v5, v[160:163] offset:0
    ds_write_b128 v5, v[164:167] offset:1024
    ds_write_b128 v5, v[168:171] offset:2048
    ds_write_b128 v5, v[172:175] offset:3072
    s_nop 0
    ds_write_b128 v5, v[176:179] offset:16384
    ds_write_b128 v5, v[180:183] offset:17408
    ds_write_b128 v5, v[184:187] offset:18432
    ds_write_b128 v5, v[188:191] offset:19456
    v_xor_b32 v5, 0x8000, v5
    s_waitcnt lgkmcnt(0)
    s_barrier
    s_cmp_eq_u32 s50, 1
    s_cbranch_scc1 CT_ML
    s_cmp_lg_u32 s40, 4
    s_cbranch_scc1 CT_COLD
    s_branch CT_SYNC
CT_RED:
    s_lshl_b32 s42, s34, 10
    v_add_u32 v6, s42, v4
    s_lshl_b32 s42, s33, 14
    s_lshl_b32 s43, s34, 12
    s_add_u32 s51, s42, s43
    s_add_u32 s51, s51, 33554432
    s_lshl_b32 s42, s32, 10
    s_add_u32 s49, s51, s42
    s_sub_u32 s48, s32, s34
    s_and_b32 s48, s48, 3
    s_barrier
    ds_read_b128 v[32:35], v6 offset:0
    ds_read_b128 v[36:39], v6 offset:4096
    ds_read_b128 v[40:43], v6 offset:8192
    ds_read_b128 v[44:47], v6 offset:12288
    s_waitcnt lgkmcnt(2)
    v_add_f32 v48, v32, v36
    v_add_f32 v49, v33, v37
    v_add_f32 v50, v34, v38
    v_add_f32 v51, v35, v39
    s_waitcnt lgkmcnt(0)
    v_add_f32 v40, v40, v44
    v_add_f32 v41, v41, v45
    v_add_f32 v42, v42, v46
    v_add_f32 v43, v43, v47
    s_cmp_eq_u32 s48, 0
    s_cbranch_scc1 CT_O_1a
    v_add_f32 v52, v48, v40
    v_add_f32 v53, v49, v41
    v_add_f32 v54, v50, v42
    v_add_f32 v55, v51, v43
    buffer_store_dwordx4 v[52:55], v4, s[8:11], s49 offen sc1
    s_branch CT_O_1b
CT_O_1a:
    v_add_f32 v64, v48, v40
    v_add_f32 v65, v49, v41
    v_add_f32 v66, v50, v42
    v_add_f32 v67, v51, v43
CT_O_1b:
    s_add_u32 s49, s49, 0x80000
    ds_read_b128 v[32:35], v6 offset:16384
    ds_read_b128 v[36:39], v6 offset:20480
    ds_read_b128 v[40:43], v6 offset:24576
    ds_read_b128 v[44:47], v6 offset:28672
    s_waitcnt lgkmcnt(2)
    v_add_f32 v48, v32, v36
    v_add_f32 v49, v33, v37
    v_add_f32 v50, v34, v38
    v_add_f32 v51, v35, v39
    s_waitcnt lgkmcnt(0)
    v_add_f32 v40, v40, v44
    v_add_f32 v41, v41, v45
    v_add_f32 v42, v42, v46
    v_add_f32 v43, v43, v47
    s_cmp_eq_u32 s48, 1
    s_cbranch_scc1 CT_O_2a
    v_add_f32 v52, v48, v40
    v_add_f32 v53, v49, v41
    v_add_f32 v54, v50, v42
    v_add_f32 v55, v51, v43
    buffer_store_dwordx4 v[52:55], v4, s[8:11], s49 offen sc1
    s_branch CT_O_2b
CT_O_2a:
    v_add_f32 v64, v48, v40
    v_add_f32 v65, v49, v41
    v_add_f32 v66, v50, v42
    v_add_f32 v67, v51, v43
CT_O_2b:
    s_add_u32 s49, s49, 0x80000
    s_barrier
    ds_read_b128 v[32:35], v6 offset:32768
    ds_read_b128 v[36:39], v6 offset:36864
    ds_read_b128 v[40:43], v6 offset:40960
    ds_read_b128 v[44:47], v6 offset:45056
    s_waitcnt lgkmcnt(2)
    v_add_f32 v48, v32, v36
    v_add_f32 v49, v33, v37
    v_add_f32 v50, v34, v38
    v_add_f32 v51, v35, v39
    s_waitcnt lgkmcnt(0)
    v_add_f32 v40, v40, v44
    v_add_f32 v41, v41, v45
    v_add_f32 v42, v42, v46
    v_add_f32 v43, v43, v47
    s_cmp_eq_u32 s48, 2
    s_cbranch_scc1 CT_O_3a
    v_add_f32 v52, v48, v40
    v_add_f32 v53, v49, v41
    v_add_f32 v54, v50, v42
    v_add_f32 v55, v51, v43
    buffer_store_dwordx4 v[52:55], v4, s[8:11], s49 offen sc1
    s_branch CT_O_3b
CT_O_3a:
    v_add_f32 v64, v48, v40
    v_add_f32 v65, v49, v41
    v_add_f32 v66, v50, v42
    v_add_f32 v67, v51, v43
CT_O_3b:
    s_add_u32 s49, s49, 0x80000
    ds_read_b128 v[32:35], v6 offset:49152
    ds_read_b128 v[36:39], v6 offset:53248
    ds_read_b128 v[40:43], v6 offset:57344
    ds_read_b128 v[44:47], v6 offset:61440
    s_waitcnt lgkmcnt(2)
    v_add_f32 v48, v32, v36
    v_add_f32 v49, v33, v37
    v_add_f32 v50, v34, v38
    v_add_f32 v51, v35, v39
    s_waitcnt lgkmcnt(0)
    v_add_f32 v40, v40, v44
    v_add_f32 v41, v41, v45
    v_add_f32 v42, v42, v46
    v_add_f32 v43, v43, v47
    s_cmp_eq_u32 s48, 3
    s_cbranch_scc1 CT_O_4a
    v_add_f32 v52, v48, v40
    v_add_f32 v53, v49, v41
    v_add_f32 v54, v50, v42
    v_add_f32 v55, v51, v43
    buffer_store_dwordx4 v[52:55], v4, s[8:11], s49 offen sc1
    s_branch CT_O_4b
CT_O_4a:
    v_add_f32 v64, v48, v40
    v_add_f32 v65, v49, v41
    v_add_f32 v66, v50, v42
    v_add_f32 v67, v51, v43
CT_O_4b:
    s_add_u32 s49, s49, 0x80000
    s_waitcnt vmcnt(0)
CT_SYNC:
    s_barrier
    s_cmp_ge_u32 s34, 4
    s_cbranch_scc1 CT_END
    s_lshl_b32 s42, s33, 7
    s_add_u32 s42, s42, 98570240
    s_cmp_lg_u32 s34, 0
    s_cbranch_scc1 CT_NS
    s_mov_b32 s43, 1
    s_atomic_add s43, s[84:85], s42
CT_NS:
    s_mov_b32 s44, 0
CT_FW:
    buffer_load_dword v10, off, s[8:11], s42 sc1
    s_add_u32 s44, s44, 1
    s_cmp_gt_u32 s44, 60000
    s_cbranch_scc1 C_DONE
    s_waitcnt vmcnt(0)
    v_cmp_ne_u32 vcc, 4, v10
    s_cbranch_vccnz CT_FW
    s_mov_b32 s20, s80
    s_and_b32 s21, s81, 0xffff
    s_mov_b32 s22, 0x800000
    s_mov_b32 s23, 0x20000
    s_add_u32 s42, s32, 1
    s_and_b32 s42, s42, 3
    s_lshl_b32 s42, s42, 10
    v_add_u32 v11, s42, v4
    s_add_u32 s42, s32, 2
    s_and_b32 s42, s42, 3
    s_lshl_b32 s42, s42, 10
    v_add_u32 v12, s42, v4
    s_add_u32 s42, s32, 3
    s_and_b32 s42, s42, 3
    s_lshl_b32 s42, s42, 10
    v_add_u32 v13, s42, v4
    s_lshl_b32 s42, s48, 19
    s_add_u32 s51, s51, s42
    buffer_load_dwordx4 v[128:131], v11, s[8:11], s51 offen sc1
    buffer_load_dwordx4 v[132:135], v12, s[8:11], s51 offen sc1
    buffer_load_dwordx4 v[136:139], v13, s[8:11], s51 offen sc1
    s_add_u32 s51, s51, 0x200000
    s_lshr_b32 s42, s34, 1
    s_lshl_b32 s42, s42, 16
    s_and_b32 s43, s34, 1
    s_lshl_b32 s43, s43, 3
    s_add_u32 s42, s42, s43
    s_lshl_b32 s43, s33, 6
    s_add_u32 s42, s42, s43
    v_lshlrev_b32 v7, 12, v1
    v_lshl_add_u32 v7, v2, 4, v7
    v_add_u32 v7, s42, v7
    s_add_u32 s42, s48, 60
    s_lshl_b32 s42, s42, 17
    s_waitcnt vmcnt(0)
    v_add_f32 v64, v64, v128
    v_add_f32 v65, v65, v129
    v_add_f32 v66, v66, v130
    v_add_f32 v67, v67, v131
    v_add_f32 v64, v64, v132
    v_add_f32 v65, v65, v133
    v_add_f32 v66, v66, v134
    v_add_f32 v67, v67, v135
    v_add_f32 v64, v64, v136
    v_add_f32 v65, v65, v137
    v_add_f32 v66, v66, v138
    v_add_f32 v67, v67, v139
    v_cvt_pk_bf16_f32 v64, v64, v65
    v_cvt_pk_bf16_f32 v65, v66, v67
    buffer_store_dwordx2 v[64:65], v7, s[20:23], s42 offen
    s_add_u32 s42, s42, 0x80000
CT_END:
    s_branch A3_DONE
C_BULK:
    v_and_b32 v0, 63, v0
    v_lshlrev_b32 v21, 4, v0
    s_sub_u32 s59, s32, 4
    s_mov_b32 s35, -1
    s_mov_b32 s39, 0
    s_mov_b32 s36, 0
    s_mov_b32 s37, 0
    s_mov_b32 s38, 0
    s_mov_b32 s30, 2048
    s_getpc_b64 s[0:1]
B_PC:
    s_add_u32 s0, s0, JOBS-B_PC
    s_addc_u32 s1, s1, 0
    s_lshl_b32 s40, s59, 5
    s_add_u32 s40, s40, s33
    s_lshl_b32 s40, s40, 6
    s_add_u32 s0, s0, s40
    s_addc_u32 s1, s1, 0
    s_load_dword s6, s[0:1], 0
    s_mov_b32 s57, 0
    s_mov_b32 s58, 0
    s_mov_b32 s96, 0
    s_mov_b32 s97, 0
    s_mov_b32 s98, 0
    s_mov_b32 s93, 0
    s_mov_b32 s94, 0
    s_mov_b32 s12, s60
    s_and_b32 s13, s61, 0xffff
    s_mov_b32 s14, 0x400000
    s_mov_b32 s15, 0x20000
    s_mov_b32 s16, s66
    s_and_b32 s17, s67, 0xffff
    s_mov_b32 s18, 0x800000
    s_mov_b32 s19, 0x20000
    s_mov_b32 s20, s84
    s_and_b32 s21, s85, 0xffff
    s_mov_b32 s22, 0x10000000
    s_mov_b32 s23, 0x20000
    s_mov_b32 s35, 0
    s_lshl_b32 s40, s33, 2
    s_add_u32 s40, s40, s59
    s_lshl_b32 s40, s40, 3
    s_add_u32 s40, s40, s34
    s_lshl_b32 s40, s40, 12
    buffer_load_dwordx4 v[192:195], v21, s[12:15], s40 offen offset:0
    buffer_load_dwordx4 v[196:199], v21, s[12:15], s40 offen offset:1024
    buffer_load_dwordx4 v[200:203], v21, s[12:15], s40 offen offset:2048
    buffer_load_dwordx4 v[204:207], v21, s[12:15], s40 offen offset:3072
    s_and_b32 s41, s59, 1
    s_lshl_b32 s41, s41, 4
    s_and_b32 s42, s33, 15
    s_add_u32 s41, s41, s42
    s_lshr_b32 s40, s33, 4
    s_lshl_b32 s24, s40, 18
    s_lshl_b32 s25, s41, 8
    s_mov_b32 s31, 8192
    s_mov_b32 s27, 16
    s_lshl_b32 s26, s41, 20
    s_lshl_b32 s42, s40, 14
    s_add_u32 s26, s26, s42
    s_and_b32 s45, s34, 1
    s_lshl_b32 s45, s45, 2
    v_lshrrev_b32 v20, 4, v0
    v_or_b32 v21, s45, v20
    v_bfe_u32 v22, v0, 1, 3
    v_xor_b32 v22, v22, v21
    v_and_b32 v23, 1, v0
    v_lshl_or_b32 v22, v22, 1, v23
    v_lshlrev_b32 v25, 4, v22
    s_lshl_b32 s45, s34, 3
    v_add_u32 v24, s45, v20
    s_mul_i32 s53, s34, 2048
    s_lshl_b32 s54, s34, 11
    s_add_u32 s54, s54, 65536
    v_and_b32 v20, 15, v0
    v_lshrrev_b32 v21, 4, v0
    v_bfe_u32 v22, v0, 1, 3
    v_xor_b32 v22, v22, v21
    v_lshlrev_b32 v20, 7, v20
    v_lshl_add_u32 v8, v22, 4, v20
    s_lshr_b32 s45, s34, 1
    s_mul_i32 s45, s45, 4096
    v_add_u32 v8, s45, v8
    v_xor_b32 v9, 64, v8
    v_bfe_u32 v20, v0, 2, 2
    v_lshl_add_u32 v22, v21, 3, v20
    v_lshlrev_b32 v22, 8, v22
    v_and_b32 v23, 3, v0
    v_lshl_add_u32 v22, v23, 3, v22
    v_add_u32 v22, 65536, v22
    v_bfe_u32 v23, v0, 4, 1
    v_lshl_or_b32 v20, v23, 2, v20
    s_and_b32 s45, s34, 1
    s_lshl_b32 s45, s45, 2
    s_or_b32 s46, s45, 0
    v_xor_b32 v23, s46, v20
    v_lshl_add_u32 v10, v23, 5, v22
    s_or_b32 s46, s45, 1
    v_xor_b32 v23, s46, v20
    v_lshl_add_u32 v11, v23, 5, v22
    s_or_b32 s46, s45, 2
    v_xor_b32 v23, s46, v20
    v_lshl_add_u32 v12, v23, 5, v22
    s_or_b32 s46, s45, 3
    v_xor_b32 v23, s46, v20
    v_lshl_add_u32 v13, v23, 5, v22
    v_and_b32 v26, 15, v0
    v_bfe_u32 v27, v0, 4, 1
    v_lshrrev_b32 v20, 5, v0
    v_lshl_add_u32 v27, v27, 1, v20
    v_lshrrev_b32 v20, 3, v0
    s_mul_i32 s45, s34, 16
    v_add_u32 v20, s45, v20
    v_add_u32 v21, 0, v20
    v_bfe_u32 v22, v21, 1, 3
    v_and_b32 v23, 7, v0
    v_xor_b32 v22, v22, v23
    v_mul_lo_u32 v21, v21, s30
    v_lshl_add_u32 v2, v22, 4, v21
    v_add_u32 v21, 8, v20
    v_bfe_u32 v22, v21, 1, 3
    v_and_b32 v23, 7, v0
    v_xor_b32 v22, v22, v23
    v_mul_lo_u32 v21, v21, s30
    v_lshl_add_u32 v3, v22, 4, v21
    v_subrev_u32 v3, 1024, v3
    s_mov_b32 s30, 128
    v_mul_lo_u32 v6, v24, s31
    s_lshl_b32 s45, s31, 2
    s_sub_u32 s45, s45, 1024
    s_lshl_b32 s52, s31, 6
    v_add_u32 v6, v6, v25
    v_add_u32 v7, s45, v6
    s_cmp_ge_u32 s59, 2
    s_cbranch_scc1 F_V
    s_mov_b32 s28, 4096
    s_mov_b32 s29, 0x40000
    s_add_u32 s26, s26, 0
    s_mov_b32 s49, 0
    s_mov_b32 s50, 0
    s_mov_b32 s47, 0
    s_mov_b32 s48, 0
    s_add_u32 m0, s53, s49
    s_nop 0
    buffer_load_dwordx4 v2, s[12:15], s24 offen offset:0 sc1 lds
    buffer_load_dwordx4 v3, s[12:15], s24 offen offset:1024 sc1 lds
    s_add_u32 m0, s54, s50
    s_add_u32 s24, s24, s30
    s_add_u32 s49, s49, 16384
    buffer_load_dwordx4 v6, s[16:19], s25 offen offset:0 lds
    buffer_load_dwordx4 v7, s[16:19], s25 offen offset:1024 lds
    s_add_u32 s25, s25, s52
    s_add_u32 s50, s50, 16384
    s_cmp_eq_u32 s49, 65536
    s_cselect_b32 s49, 0, s49
    s_cselect_b32 s50, 0, s50
    s_add_u32 m0, s53, s49
    s_nop 0
    buffer_load_dwordx4 v2, s[12:15], s24 offen offset:0 sc1 lds
    buffer_load_dwordx4 v3, s[12:15], s24 offen offset:1024 sc1 lds
    s_add_u32 m0, s54, s50
    s_add_u32 s24, s24, s30
    s_add_u32 s49, s49, 16384
    buffer_load_dwordx4 v6, s[16:19], s25 offen offset:0 lds
    buffer_load_dwordx4 v7, s[16:19], s25 offen offset:1024 lds
    s_add_u32 s25, s25, s52
    s_add_u32 s50, s50, 16384
    s_cmp_eq_u32 s49, 65536
    s_cselect_b32 s49, 0, s49
    s_cselect_b32 s50, 0, s50
    s_add_u32 m0, s53, s49
    s_nop 0
    buffer_load_dwordx4 v2, s[12:15], s24 offen offset:0 sc1 lds
    buffer_load_dwordx4 v3, s[12:15], s24 offen offset:1024 sc1 lds
    s_add_u32 m0, s54, s50
    s_add_u32 s24, s24, s30
    s_add_u32 s49, s49, 16384
    buffer_load_dwordx4 v6, s[16:19], s25 offen offset:0 lds
    buffer_load_dwordx4 v7, s[16:19], s25 offen offset:1024 lds
    s_add_u32 s25, s25, s52
    s_add_u32 s50, s50, 16384
    s_cmp_eq_u32 s49, 65536
    s_cselect_b32 s49, 0, s49
    s_cselect_b32 s50, 0, s50
    s_add_u32 m0, s53, s49
    s_nop 0
    buffer_load_dwordx4 v2, s[12:15], s24 offen offset:0 sc1 lds
    buffer_load_dwordx4 v3, s[12:15], s24 offen offset:1024 sc1 lds
    s_add_u32 m0, s54, s50
    s_add_u32 s24, s24, s30
    s_add_u32 s49, s49, 16384
    buffer_load_dwordx4 v6, s[16:19], s25 offen offset:0 lds
    buffer_load_dwordx4 v7, s[16:19], s25 offen offset:1024 lds
    s_add_u32 s25, s25, s52
    s_add_u32 s50, s50, 16384
    s_cmp_eq_u32 s49, 65536
    s_cselect_b32 s49, 0, s49
    s_cselect_b32 s50, 0, s50
    s_cmp_lg_u32 s34, 4
    s_cbranch_scc1 CLFK
    s_bitcmp1_b32 s2, 30
    s_cbranch_scc1 CLFK
    s_getreg_b32 s40, hwreg(HW_REG_XCC_ID)
    s_and_b32 s40, s40, 7
    s_lshl_b32 s41, s40, 2
    s_lshr_b32 s40, 0x73625140, s41
    s_and_b32 s40, s40, 7
    s_lshl_b32 s40, s40, 3
    s_bitset1_b32 s2, 30
    s_waitcnt vmcnt(16)
    s_atomic_add_x2 s[72:73], s[82:83], s40 glc
CLFK:
    s_waitcnt vmcnt(12)
    s_barrier
    v_add_u32 v14, s47, v8
    v_add_u32 v15, s47, v9
    v_add_u32 v16, s48, v10
    v_add_u32 v17, s48, v11
    v_add_u32 v18, s48, v12
    v_add_u32 v19, s48, v13
    s_add_u32 s47, s47, 16384
    s_add_u32 s48, s48, 16384
    s_cmp_eq_u32 s47, 65536
    s_cselect_b32 s47, 0, s47
    s_cselect_b32 s48, 0, s48
    ds_read_b128 v[128:131], v14 offset:0
    ds_read_b64_tr_b16 v[144:145], v16 offset:0
    ds_read_b64_tr_b16 v[146:147], v16 offset:1024
    ds_read_b128 v[132:135], v14 offset:2048
    ds_read_b64_tr_b16 v[148:149], v17 offset:0
    ds_read_b64_tr_b16 v[150:151], v17 offset:1024
    ds_read_b64_tr_b16 v[152:153], v18 offset:0
    ds_read_b64_tr_b16 v[154:155], v18 offset:1024
    ds_read_b64_tr_b16 v[156:157], v19 offset:0
    ds_read_b64_tr_b16 v[158:159], v19 offset:1024
    s_waitcnt lgkmcnt(0)
    v_mfma_f32_16x16x32_bf16 v[64:67], v[144:147], v[128:131], 0
    ds_read_b128 v[160:163], v15 offset:0
    ds_read_b64_tr_b16 v[176:177], v16 offset:8192
    v_mfma_f32_16x16x32_bf16 v[68:71], v[148:151], v[128:131], 0
    ds_read_b64_tr_b16 v[178:179], v16 offset:9216
    ds_read_b128 v[164:167], v15 offset:2048
    v_mfma_f32_16x16x32_bf16 v[72:75], v[152:155], v[128:131], 0
    ds_read_b64_tr_b16 v[180:181], v17 offset:8192
    ds_read_b64_tr_b16 v[182:183], v17 offset:9216
    v_mfma_f32_16x16x32_bf16 v[76:79], v[156:159], v[128:131], 0
    ds_read_b64_tr_b16 v[184:185], v18 offset:8192
    ds_read_b64_tr_b16 v[186:187], v18 offset:9216
    v_mfma_f32_16x16x32_bf16 v[80:83], v[144:147], v[132:135], 0
    ds_read_b64_tr_b16 v[188:189], v19 offset:8192
    ds_read_b64_tr_b16 v[190:191], v19 offset:9216
    v_mfma_f32_16x16x32_bf16 v[84:87], v[148:151], v[132:135], 0
    v_add_u32 v14, s47, v8
    v_add_u32 v15, s47, v9
    v_add_u32 v16, s48, v10
    v_mfma_f32_16x16x32_bf16 v[88:91], v[152:155], v[132:135], 0
    v_add_u32 v17, s48, v11
    v_add_u32 v18, s48, v12
    v_add_u32 v19, s48, v13
    v_mfma_f32_16x16x32_bf16 v[92:95], v[156:159], v[132:135], 0
    s_add_u32 s47, s47, 16384
    s_add_u32 s48, s48, 16384
    s_cmp_eq_u32 s47, 65536
    s_cselect_b32 s47, 0, s47
    s_cselect_b32 s48, 0, s48
    s_add_u32 m0, s53, s49
    s_waitcnt vmcnt(8) lgkmcnt(0)
    s_barrier
    v_mfma_f32_16x16x32_bf16 v[64:67], v[176:179], v[160:163], v[64:67]
    ds_read_b128 v[128:131], v14 offset:0
    ds_read_b64_tr_b16 v[144:145], v16 offset:0
    v_mfma_f32_16x16x32_bf16 v[68:71], v[180:183], v[160:163], v[68:71]
    ds_read_b64_tr_b16 v[146:147], v16 offset:1024
    ds_read_b128 v[132:135], v14 offset:2048
    buffer_load_dwordx4 v2, s[12:15], s24 offen offset:0 sc1 lds
    v_mfma_f32_16x16x32_bf16 v[72:75], v[184:187], v[160:163], v[72:75]
    ds_read_b64_tr_b16 v[148:149], v17 offset:0
    ds_read_b64_tr_b16 v[150:151], v17 offset:1024
    v_mfma_f32_16x16x32_bf16 v[76:79], v[188:191], v[160:163], v[76:79]
    ds_read_b64_tr_b16 v[152:153], v18 offset:0
    ds_read_b64_tr_b16 v[154:155], v18 offset:1024
    buffer_load_dwordx4 v3, s[12:15], s24 offen offset:1024 sc1 lds
    s_add_u32 m0, s54, s50
    s_add_u32 s24, s24, s30
    s_add_u32 s49, s49, 16384
    v_mfma_f32_16x16x32_bf16 v[80:83], v[176:179], v[164:167], v[80:83]
    ds_read_b64_tr_b16 v[156:157], v19 offset:0
    ds_read_b64_tr_b16 v[158:159], v19 offset:1024
    v_mfma_f32_16x16x32_bf16 v[84:87], v[180:183], v[164:167], v[84:87]
    buffer_load_dwordx4 v6, s[16:19], s25 offen offset:0 lds
    v_mfma_f32_16x16x32_bf16 v[88:91], v[184:187], v[164:167], v[88:91]
    buffer_load_dwordx4 v7, s[16:19], s25 offen offset:1024 lds
    s_add_u32 s25, s25, s52
    s_add_u32 s50, s50, 16384
    v_mfma_f32_16x16x32_bf16 v[92:95], v[188:191], v[164:167], v[92:95]
    s_cmp_eq_u32 s49, 65536
    s_cselect_b32 s49, 0, s49
    s_cselect_b32 s50, 0, s50
    s_mov_b32 s51, 11
GFK_LOOP:
    s_waitcnt lgkmcnt(0)
    v_mfma_f32_16x16x32_bf16 v[64:67], v[144:147], v[128:131], v[64:67]
    ds_read_b128 v[160:163], v15 offset:0
    ds_read_b64_tr_b16 v[176:177], v16 offset:8192
    v_mfma_f32_16x16x32_bf16 v[68:71], v[148:151], v[128:131], v[68:71]
    ds_read_b64_tr_b16 v[178:179], v16 offset:9216
    ds_read_b128 v[164:167], v15 offset:2048
    v_mfma_f32_16x16x32_bf16 v[72:75], v[152:155], v[128:131], v[72:75]
    ds_read_b64_tr_b16 v[180:181], v17 offset:8192
    ds_read_b64_tr_b16 v[182:183], v17 offset:9216
    v_mfma_f32_16x16x32_bf16 v[76:79], v[156:159], v[128:131], v[76:79]
    ds_read_b64_tr_b16 v[184:185], v18 offset:8192
    ds_read_b64_tr_b16 v[186:187], v18 offset:9216
    v_mfma_f32_16x16x32_bf16 v[80:83], v[144:147], v[132:135], v[80:83]
    ds_read_b64_tr_b16 v[188:189], v19 offset:8192
    ds_read_b64_tr_b16 v[190:191], v19 offset:9216
    v_mfma_f32_16x16x32_bf16 v[84:87], v[148:151], v[132:135], v[84:87]
    v_add_u32 v14, s47, v8
    v_add_u32 v15, s47, v9
    v_add_u32 v16, s48, v10
    v_mfma_f32_16x16x32_bf16 v[88:91], v[152:155], v[132:135], v[88:91]
    v_add_u32 v17, s48, v11
    v_add_u32 v18, s48, v12
    v_add_u32 v19, s48, v13
    v_mfma_f32_16x16x32_bf16 v[92:95], v[156:159], v[132:135], v[92:95]
    s_add_u32 s47, s47, 16384
    s_add_u32 s48, s48, 16384
    s_cmp_eq_u32 s47, 65536
    s_cselect_b32 s47, 0, s47
    s_cselect_b32 s48, 0, s48
    s_add_u32 m0, s53, s49
    s_waitcnt vmcnt(8) lgkmcnt(0)
    s_barrier
    v_mfma_f32_16x16x32_bf16 v[64:67], v[176:179], v[160:163], v[64:67]
    ds_read_b128 v[128:131], v14 offset:0
    ds_read_b64_tr_b16 v[144:145], v16 offset:0
    v_mfma_f32_16x16x32_bf16 v[68:71], v[180:183], v[160:163], v[68:71]
    ds_read_b64_tr_b16 v[146:147], v16 offset:1024
    ds_read_b128 v[132:135], v14 offset:2048
    buffer_load_dwordx4 v2, s[12:15], s24 offen offset:0 sc1 lds
    v_mfma_f32_16x16x32_bf16 v[72:75], v[184:187], v[160:163], v[72:75]
    ds_read_b64_tr_b16 v[148:149], v17 offset:0
    ds_read_b64_tr_b16 v[150:151], v17 offset:1024
    v_mfma_f32_16x16x32_bf16 v[76:79], v[188:191], v[160:163], v[76:79]
    ds_read_b64_tr_b16 v[152:153], v18 offset:0
    ds_read_b64_tr_b16 v[154:155], v18 offset:1024
    buffer_load_dwordx4 v3, s[12:15], s24 offen offset:1024 sc1 lds
    s_add_u32 m0, s54, s50
    s_add_u32 s24, s24, s30
    s_add_u32 s49, s49, 16384
    v_mfma_f32_16x16x32_bf16 v[80:83], v[176:179], v[164:167], v[80:83]
    ds_read_b64_tr_b16 v[156:157], v19 offset:0
    ds_read_b64_tr_b16 v[158:159], v19 offset:1024
    v_mfma_f32_16x16x32_bf16 v[84:87], v[180:183], v[164:167], v[84:87]
    buffer_load_dwordx4 v6, s[16:19], s25 offen offset:0 lds
    v_mfma_f32_16x16x32_bf16 v[88:91], v[184:187], v[164:167], v[88:91]
    buffer_load_dwordx4 v7, s[16:19], s25 offen offset:1024 lds
    s_add_u32 s25, s25, s52
    s_add_u32 s50, s50, 16384
    v_mfma_f32_16x16x32_bf16 v[92:95], v[188:191], v[164:167], v[92:95]
    s_cmp_eq_u32 s49, 65536
    s_cselect_b32 s49, 0, s49
    s_cselect_b32 s50, 0, s50
    s_sub_u32 s51, s51, 1
    s_cmp_lg_u32 s51, 0
    s_cbranch_scc1 GFK_LOOP
    s_waitcnt lgkmcnt(0)
    v_mfma_f32_16x16x32_bf16 v[64:67], v[144:147], v[128:131], v[64:67]
    ds_read_b128 v[160:163], v15 offset:0
    ds_read_b64_tr_b16 v[176:177], v16 offset:8192
    v_mfma_f32_16x16x32_bf16 v[68:71], v[148:151], v[128:131], v[68:71]
    ds_read_b64_tr_b16 v[178:179], v16 offset:9216
    ds_read_b128 v[164:167], v15 offset:2048
    v_mfma_f32_16x16x32_bf16 v[72:75], v[152:155], v[128:131], v[72:75]
    ds_read_b64_tr_b16 v[180:181], v17 offset:8192
    ds_read_b64_tr_b16 v[182:183], v17 offset:9216
    v_mfma_f32_16x16x32_bf16 v[76:79], v[156:159], v[128:131], v[76:79]
    ds_read_b64_tr_b16 v[184:185], v18 offset:8192
    ds_read_b64_tr_b16 v[186:187], v18 offset:9216
    v_mfma_f32_16x16x32_bf16 v[80:83], v[144:147], v[132:135], v[80:83]
    ds_read_b64_tr_b16 v[188:189], v19 offset:8192
    ds_read_b64_tr_b16 v[190:191], v19 offset:9216
    v_mfma_f32_16x16x32_bf16 v[84:87], v[148:151], v[132:135], v[84:87]
    v_add_u32 v14, s47, v8
    v_add_u32 v15, s47, v9
    v_add_u32 v16, s48, v10
    v_mfma_f32_16x16x32_bf16 v[88:91], v[152:155], v[132:135], v[88:91]
    v_add_u32 v17, s48, v11
    v_add_u32 v18, s48, v12
    v_add_u32 v19, s48, v13
    v_mfma_f32_16x16x32_bf16 v[92:95], v[156:159], v[132:135], v[92:95]
    s_add_u32 s47, s47, 16384
    s_add_u32 s48, s48, 16384
    s_cmp_eq_u32 s47, 65536
    s_cselect_b32 s47, 0, s47
    s_cselect_b32 s48, 0, s48
    s_waitcnt vmcnt(8) lgkmcnt(0)
    s_barrier
    v_mfma_f32_16x16x32_bf16 v[64:67], v[176:179], v[160:163], v[64:67]
    ds_read_b128 v[128:131], v14 offset:0
    ds_read_b64_tr_b16 v[144:145], v16 offset:0
    v_mfma_f32_16x16x32_bf16 v[68:71], v[180:183], v[160:163], v[68:71]
    ds_read_b64_tr_b16 v[146:147], v16 offset:1024
    ds_read_b128 v[132:135], v14 offset:2048
    v_mfma_f32_16x16x32_bf16 v[72:75], v[184:187], v[160:163], v[72:75]
    ds_read_b64_tr_b16 v[148:149], v17 offset:0
    ds_read_b64_tr_b16 v[150:151], v17 offset:1024
    v_mfma_f32_16x16x32_bf16 v[76:79], v[188:191], v[160:163], v[76:79]
    ds_read_b64_tr_b16 v[152:153], v18 offset:0
    ds_read_b64_tr_b16 v[154:155], v18 offset:1024
    v_mfma_f32_16x16x32_bf16 v[80:83], v[176:179], v[164:167], v[80:83]
    ds_read_b64_tr_b16 v[156:157], v19 offset:0
    ds_read_b64_tr_b16 v[158:159], v19 offset:1024
    v_mfma_f32_16x16x32_bf16 v[84:87], v[180:183], v[164:167], v[84:87]
    v_mfma_f32_16x16x32_bf16 v[88:91], v[184:187], v[164:167], v[88:91]
    v_mfma_f32_16x16x32_bf16 v[92:95], v[188:191], v[164:167], v[92:95]
    s_waitcnt lgkmcnt(0)
    v_mfma_f32_16x16x32_bf16 v[64:67], v[144:147], v[128:131], v[64:67]
    ds_read_b128 v[160:163], v15 offset:0
    ds_read_b64_tr_b16 v[176:177], v16 offset:8192
    v_mfma_f32_16x16x32_bf16 v[68:71], v[148:151], v[128:131], v[68:71]
    ds_read_b64_tr_b16 v[178:179], v16 offset:9216
    ds_read_b128 v[164:167], v15 offset:2048
    v_mfma_f32_16x16x32_bf16 v[72:75], v[152:155], v[128:131], v[72:75]
    ds_read_b64_tr_b16 v[180:181], v17 offset:8192
    ds_read_b64_tr_b16 v[182:183], v17 offset:9216
    v_mfma_f32_16x16x32_bf16 v[76:79], v[156:159], v[128:131], v[76:79]
    ds_read_b64_tr_b16 v[184:185], v18 offset:8192
    ds_read_b64_tr_b16 v[186:187], v18 offset:9216
    v_mfma_f32_16x16x32_bf16 v[80:83], v[144:147], v[132:135], v[80:83]
    ds_read_b64_tr_b16 v[188:189], v19 offset:8192
    ds_read_b64_tr_b16 v[190:191], v19 offset:9216
    v_mfma_f32_16x16x32_bf16 v[84:87], v[148:151], v[132:135], v[84:87]
    v_add_u32 v14, s47, v8
    v_add_u32 v15, s47, v9
    v_add_u32 v16, s48, v10
    v_mfma_f32_16x16x32_bf16 v[88:91], v[152:155], v[132:135], v[88:91]
    v_add_u32 v17, s48, v11
    v_add_u32 v18, s48, v12
    v_add_u32 v19, s48, v13
    v_mfma_f32_16x16x32_bf16 v[92:95], v[156:159], v[132:135], v[92:95]
    s_add_u32 s47, s47, 16384
    s_add_u32 s48, s48, 16384
    s_cmp_eq_u32 s47, 65536
    s_cselect_b32 s47, 0, s47
    s_cselect_b32 s48, 0, s48
    s_waitcnt vmcnt(4) lgkmcnt(0)
    s_barrier
    v_mfma_f32_16x16x32_bf16 v[64:67], v[176:179], v[160:163], v[64:67]
    ds_read_b128 v[128:131], v14 offset:0
    ds_read_b64_tr_b16 v[144:145], v16 offset:0
    v_mfma_f32_16x16x32_bf16 v[68:71], v[180:183], v[160:163], v[68:71]
    ds_read_b64_tr_b16 v[146:147], v16 offset:1024
    ds_read_b128 v[132:135], v14 offset:2048
    v_mfma_f32_16x16x32_bf16 v[72:75], v[184:187], v[160:163], v[72:75]
    ds_read_b64_tr_b16 v[148:149], v17 offset:0
    ds_read_b64_tr_b16 v[150:151], v17 offset:1024
    v_mfma_f32_16x16x32_bf16 v[76:79], v[188:191], v[160:163], v[76:79]
    ds_read_b64_tr_b16 v[152:153], v18 offset:0
    ds_read_b64_tr_b16 v[154:155], v18 offset:1024
    v_mfma_f32_16x16x32_bf16 v[80:83], v[176:179], v[164:167], v[80:83]
    ds_read_b64_tr_b16 v[156:157], v19 offset:0
    ds_read_b64_tr_b16 v[158:159], v19 offset:1024
    v_mfma_f32_16x16x32_bf16 v[84:87], v[180:183], v[164:167], v[84:87]
    v_mfma_f32_16x16x32_bf16 v[88:91], v[184:187], v[164:167], v[88:91]
    v_mfma_f32_16x16x32_bf16 v[92:95], v[188:191], v[164:167], v[92:95]
    s_waitcnt lgkmcnt(0)
    v_mfma_f32_16x16x32_bf16 v[64:67], v[144:147], v[128:131], v[64:67]
    ds_read_b128 v[160:163], v15 offset:0
    ds_read_b64_tr_b16 v[176:177], v16 offset:8192
    v_mfma_f32_16x16x32_bf16 v[68:71], v[148:151], v[128:131], v[68:71]
    ds_read_b64_tr_b16 v[178:179], v16 offset:9216
    ds_read_b128 v[164:167], v15 offset:2048
    v_mfma_f32_16x16x32_bf16 v[72:75], v[152:155], v[128:131], v[72:75]
    ds_read_b64_tr_b16 v[180:181], v17 offset:8192
    ds_read_b64_tr_b16 v[182:183], v17 offset:9216
    v_mfma_f32_16x16x32_bf16 v[76:79], v[156:159], v[128:131], v[76:79]
    ds_read_b64_tr_b16 v[184:185], v18 offset:8192
    ds_read_b64_tr_b16 v[186:187], v18 offset:9216
    v_mfma_f32_16x16x32_bf16 v[80:83], v[144:147], v[132:135], v[80:83]
    ds_read_b64_tr_b16 v[188:189], v19 offset:8192
    ds_read_b64_tr_b16 v[190:191], v19 offset:9216
    v_mfma_f32_16x16x32_bf16 v[84:87], v[148:151], v[132:135], v[84:87]
    v_add_u32 v14, s47, v8
    v_add_u32 v15, s47, v9
    v_add_u32 v16, s48, v10
    v_mfma_f32_16x16x32_bf16 v[88:91], v[152:155], v[132:135], v[88:91]
    v_add_u32 v17, s48, v11
    v_add_u32 v18, s48, v12
    v_add_u32 v19, s48, v13
    v_mfma_f32_16x16x32_bf16 v[92:95], v[156:159], v[132:135], v[92:95]
    s_add_u32 s47, s47, 16384
    s_add_u32 s48, s48, 16384
    s_cmp_eq_u32 s47, 65536
    s_cselect_b32 s47, 0, s47
    s_cselect_b32 s48, 0, s48
    s_waitcnt vmcnt(0) lgkmcnt(0)
    s_barrier
    v_mfma_f32_16x16x32_bf16 v[64:67], v[176:179], v[160:163], v[64:67]
    ds_read_b128 v[128:131], v14 offset:0
    ds_read_b64_tr_b16 v[144:145], v16 offset:0
    v_mfma_f32_16x16x32_bf16 v[68:71], v[180:183], v[160:163], v[68:71]
    ds_read_b64_tr_b16 v[146:147], v16 offset:1024
    ds_read_b128 v[132:135], v14 offset:2048
    v_mfma_f32_16x16x32_bf16 v[72:75], v[184:187], v[160:163], v[72:75]
    ds_read_b64_tr_b16 v[148:149], v17 offset:0
    ds_read_b64_tr_b16 v[150:151], v17 offset:1024
    v_mfma_f32_16x16x32_bf16 v[76:79], v[188:191], v[160:163], v[76:79]
    ds_read_b64_tr_b16 v[152:153], v18 offset:0
    ds_read_b64_tr_b16 v[154:155], v18 offset:1024
    v_mfma_f32_16x16x32_bf16 v[80:83], v[176:179], v[164:167], v[80:83]
    ds_read_b64_tr_b16 v[156:157], v19 offset:0
    ds_read_b64_tr_b16 v[158:159], v19 offset:1024
    v_mfma_f32_16x16x32_bf16 v[84:87], v[180:183], v[164:167], v[84:87]
    v_mfma_f32_16x16x32_bf16 v[88:91], v[184:187], v[164:167], v[88:91]
    v_mfma_f32_16x16x32_bf16 v[92:95], v[188:191], v[164:167], v[92:95]
    s_waitcnt lgkmcnt(0)
    v_mfma_f32_16x16x32_bf16 v[64:67], v[144:147], v[128:131], v[64:67]
    ds_read_b128 v[160:163], v15 offset:0
    ds_read_b64_tr_b16 v[176:177], v16 offset:8192
    v_mfma_f32_16x16x32_bf16 v[68:71], v[148:151], v[128:131], v[68:71]
    ds_read_b64_tr_b16 v[178:179], v16 offset:9216
    ds_read_b128 v[164:167], v15 offset:2048
    v_mfma_f32_16x16x32_bf16 v[72:75], v[152:155], v[128:131], v[72:75]
    ds_read_b64_tr_b16 v[180:181], v17 offset:8192
    ds_read_b64_tr_b16 v[182:183], v17 offset:9216
    v_mfma_f32_16x16x32_bf16 v[76:79], v[156:159], v[128:131], v[76:79]
    ds_read_b64_tr_b16 v[184:185], v18 offset:8192
    ds_read_b64_tr_b16 v[186:187], v18 offset:9216
    v_mfma_f32_16x16x32_bf16 v[80:83], v[144:147], v[132:135], v[80:83]
    ds_read_b64_tr_b16 v[188:189], v19 offset:8192
    ds_read_b64_tr_b16 v[190:191], v19 offset:9216
    v_mfma_f32_16x16x32_bf16 v[84:87], v[148:151], v[132:135], v[84:87]
    v_mfma_f32_16x16x32_bf16 v[88:91], v[152:155], v[132:135], v[88:91]
    v_mfma_f32_16x16x32_bf16 v[92:95], v[156:159], v[132:135], v[92:95]
    s_waitcnt lgkmcnt(0)
    v_mfma_f32_16x16x32_bf16 v[64:67], v[176:179], v[160:163], v[64:67]
    v_mfma_f32_16x16x32_bf16 v[68:71], v[180:183], v[160:163], v[68:71]
    v_mfma_f32_16x16x32_bf16 v[72:75], v[184:187], v[160:163], v[72:75]
    v_mfma_f32_16x16x32_bf16 v[76:79], v[188:191], v[160:163], v[76:79]
    v_mfma_f32_16x16x32_bf16 v[80:83], v[176:179], v[164:167], v[80:83]
    v_mfma_f32_16x16x32_bf16 v[84:87], v[180:183], v[164:167], v[84:87]
    v_mfma_f32_16x16x32_bf16 v[88:91], v[184:187], v[164:167], v[88:91]
    v_mfma_f32_16x16x32_bf16 v[92:95], v[188:191], v[164:167], v[92:95]
    s_bitcmp1_b32 s2, 31
    s_cbranch_scc1 VDFK_OK
    s_cmp_lg_u32 s34, 4
    s_cbranch_scc1 VFK_DONE
    s_bitcmp1_b32 s2, 31
    s_cbranch_scc1 VFK_DONE
    s_getreg_b32 s40, hwreg(HW_REG_XCC_ID)
    s_and_b32 s40, s40, 7
    s_lshl_b32 s51, s40, 2
    s_lshr_b32 s40, 0x73625140, s51
    s_and_b32 s40, s40, 7
    v_and_b32 v42, 15, v0
    v_lshlrev_b32 v42, 2, v42
    s_mov_b32 s38, 0
VFK_POLL:
    global_load_dword v43, v42, s[82:83] sc1
    s_add_u32 s38, s38, 1
    s_cmp_gt_u32 s38, 60000
    s_cbranch_scc1 C_DONE
    s_mov_b32 s42, 0
    s_mov_b32 s43, 0
    s_mov_b32 s45, 0
    s_mov_b32 s46, 0
    s_waitcnt vmcnt(0)
    v_readlane_b32 s51, v43, 1
    s_cmp_lg_u32 s51, 0x2000
    s_cselect_b32 s46, 1, s46
    s_lshr_b32 s51, s51, 8
    s_add_u32 s42, s42, s51
    s_cmp_lg_u32 s51, 32
    s_cselect_b32 s45, 1, s45
    s_cmp_gt_u32 s40, 0
    s_cselect_b32 s51, s51, 0
    s_add_u32 s43, s43, s51
    v_readlane_b32 s51, v43, 0
    s_cmp_lg_u32 s51, -1
    s_cselect_b32 s46, 1, s46
    v_readlane_b32 s51, v43, 3
    s_cmp_lg_u32 s51, 0x2000
    s_cselect_b32 s46, 1, s46
    s_lshr_b32 s51, s51, 8
    s_add_u32 s42, s42, s51
    s_cmp_lg_u32 s51, 32
    s_cselect_b32 s45, 1, s45
    s_cmp_gt_u32 s40, 1
    s_cselect_b32 s51, s51, 0
    s_add_u32 s43, s43, s51
    v_readlane_b32 s51, v43, 2
    s_cmp_lg_u32 s51, -1
    s_cselect_b32 s46, 1, s46
    v_readlane_b32 s51, v43, 5
    s_cmp_lg_u32 s51, 0x2000
    s_cselect_b32 s46, 1, s46
    s_lshr_b32 s51, s51, 8
    s_add_u32 s42, s42, s51
    s_cmp_lg_u32 s51, 32
    s_cselect_b32 s45, 1, s45
    s_cmp_gt_u32 s40, 2
    s_cselect_b32 s51, s51, 0
    s_add_u32 s43, s43, s51
    v_readlane_b32 s51, v43, 4
    s_cmp_lg_u32 s51, -1
    s_cselect_b32 s46, 1, s46
    v_readlane_b32 s51, v43, 7
    s_cmp_lg_u32 s51, 0x2000
    s_cselect_b32 s46, 1, s46
    s_lshr_b32 s51, s51, 8
    s_add_u32 s42, s42, s51
    s_cmp_lg_u32 s51, 32
    s_cselect_b32 s45, 1, s45
    s_cmp_gt_u32 s40, 3
    s_cselect_b32 s51, s51, 0
    s_add_u32 s43, s43, s51
    v_readlane_b32 s51, v43, 6
    s_cmp_lg_u32 s51, -1
    s_cselect_b32 s46, 1, s46
    v_readlane_b32 s51, v43, 9
    s_cmp_lg_u32 s51, 0x2000
    s_cselect_b32 s46, 1, s46
    s_lshr_b32 s51, s51, 8
    s_add_u32 s42, s42, s51
    s_cmp_lg_u32 s51, 32
    s_cselect_b32 s45, 1, s45
    s_cmp_gt_u32 s40, 4
    s_cselect_b32 s51, s51, 0
    s_add_u32 s43, s43, s51
    v_readlane_b32 s51, v43, 8
    s_cmp_lg_u32 s51, -1
    s_cselect_b32 s46, 1, s46
    v_readlane_b32 s51, v43, 11
    s_cmp_lg_u32 s51, 0x2000
    s_cselect_b32 s46, 1, s46
    s_lshr_b32 s51, s51, 8
    s_add_u32 s42, s42, s51
    s_cmp_lg_u32 s51, 32
    s_cselect_b32 s45, 1, s45
    s_cmp_gt_u32 s40, 5
    s_cselect_b32 s51, s51, 0
    s_add_u32 s43, s43, s51
    v_readlane_b32 s51, v43, 10
    s_cmp_lg_u32 s51, -1
    s_cselect_b32 s46, 1, s46
    v_readlane_b32 s51, v43, 13
    s_cmp_lg_u32 s51, 0x2000
    s_cselect_b32 s46, 1, s46
    s_lshr_b32 s51, s51, 8
    s_add_u32 s42, s42, s51
    s_cmp_lg_u32 s51, 32
    s_cselect_b32 s45, 1, s45
    s_cmp_gt_u32 s40, 6
    s_cselect_b32 s51, s51, 0
    s_add_u32 s43, s43, s51
    v_readlane_b32 s51, v43, 12
    s_cmp_lg_u32 s51, -1
    s_cselect_b32 s46, 1, s46
    v_readlane_b32 s51, v43, 15
    s_cmp_lg_u32 s51, 0x2000
    s_cselect_b32 s46, 1, s46
    s_lshr_b32 s51, s51, 8
    s_add_u32 s42, s42, s51
    s_cmp_lg_u32 s51, 32
    s_cselect_b32 s45, 1, s45
    s_cmp_gt_u32 s40, 7
    s_cselect_b32 s51, s51, 0
    s_add_u32 s43, s43, s51
    v_readlane_b32 s51, v43, 14
    s_cmp_lg_u32 s51, -1
    s_cselect_b32 s46, 1, s46
    s_cmp_lg_u32 s42, 256
    s_cbranch_scc1 VFK_POLL
    s_waitcnt lgkmcnt(0)
    s_lshr_b32 s41, s73, 8
    s_add_u32 s43, s43, s41
    s_lshl_b32 s51, s45, 8
    s_or_b32 s43, s43, s51
    s_or_b32 s43, s43, 0x8000
    s_or_b32 s46, s46, s45
    s_cselect_b32 s43, s43, 0
    v_mov_b32 v42, 147456
    v_mov_b32 v43, s43
    ds_write_b32 v42, v43
    s_waitcnt lgkmcnt(0)
VFK_DONE:
    s_barrier
    s_bitcmp1_b32 s2, 31
    s_cbranch_scc1 VDFK_OK
    v_mov_b32 v42, 147456
    ds_read_b32 v43, v42
    s_bitset1_b32 s2, 31
    s_waitcnt lgkmcnt(0)
    v_readfirstlane_b32 s40, v43
    s_cmp_lg_u32 s40, 0
    s_cbranch_scc1 R_RESTART
VDFK_OK:
    v_mov_b32 v28, -1
    v_mov_b32 v29, -1
    v_mov_b32 v30, -1
    v_mov_b32 v31, -1
    v_lshlrev_b32 v1, 4, v0
    s_lshl_b32 s40, s59, 5
    s_add_u32 s40, s40, s33
    s_lshl_b32 s40, s40, 3
    s_add_u32 s40, s40, s34
    s_lshl_b32 s40, s40, 11
    s_add_u32 s40, s40, 134217728
    buffer_store_dwordx4 v[28:31], v1, s[8:11], s40 offen offset:0 sc1
    buffer_store_dwordx4 v[28:31], v1, s[8:11], s40 offen offset:1024 sc1
    s_lshr_b32 s45, s34, 1
    s_and_b32 s46, s34, 1
    s_lshl_b32 s46, s46, 1
    v_mul_lo_u32 v20, v26, s27
    s_mul_i32 s45, s45, 1
    s_mul_i32 s45, s45, s28
    s_mul_i32 s46, s46, s29
    s_add_u32 s26, s26, s45
    s_add_u32 s26, s26, s46
    s_cmp_eq_u32 s27, 16
    s_cselect_b32 s45, 9, 4
    v_lshl_add_u32 v20, v27, s45, v20
    s_lshl_b32 s45, s27, 4
    v_add_u32 v21, s45, v20
    v_cvt_pk_bf16_f32 v160, v64, v65
    v_cvt_pk_bf16_f32 v161, v66, v67
    v_cvt_pk_bf16_f32 v162, v68, v69
    v_cvt_pk_bf16_f32 v163, v70, v71
    v_cvt_pk_bf16_f32 v164, v72, v73
    v_cvt_pk_bf16_f32 v165, v74, v75
    v_cvt_pk_bf16_f32 v166, v76, v77
    v_cvt_pk_bf16_f32 v167, v78, v79
    v_cvt_pk_bf16_f32 v168, v80, v81
    v_cvt_pk_bf16_f32 v169, v82, v83
    v_cvt_pk_bf16_f32 v170, v84, v85
    v_cvt_pk_bf16_f32 v171, v86, v87
    v_cvt_pk_bf16_f32 v172, v88, v89
    v_cvt_pk_bf16_f32 v173, v90, v91
    v_cvt_pk_bf16_f32 v174, v92, v93
    v_cvt_pk_bf16_f32 v175, v94, v95
    s_add_u32 s46, s26, s29
    v_permlane16_swap_b32 v160, v162
    v_permlane16_swap_b32 v161, v163
    buffer_store_dwordx4 v[160:163], v20, s[20:23], s26 offen sc1
    v_permlane16_swap_b32 v164, v166
    v_permlane16_swap_b32 v165, v167
    buffer_store_dwordx4 v[164:167], v20, s[20:23], s46 offen sc1
    v_permlane16_swap_b32 v168, v170
    v_permlane16_swap_b32 v169, v171
    buffer_store_dwordx4 v[168:171], v21, s[20:23], s26 offen sc1
    v_permlane16_swap_b32 v172, v174
    v_permlane16_swap_b32 v173, v175
    buffer_store_dwordx4 v[172:175], v21, s[20:23], s46 offen sc1
    s_branch F_DONE
F_V:
    s_mov_b32 s16, s68
    s_and_b32 s17, s69, 0xffff
    s_mov_b32 s18, 0x800000
    s_mov_b32 s19, 0x20000
    s_mov_b32 s28, 0x40000
    s_mov_b32 s29, 4096
    s_add_u32 s26, s26, 2048
    s_mov_b32 s49, 0
    s_mov_b32 s50, 0
    s_mov_b32 s47, 0
    s_mov_b32 s48, 0
    s_add_u32 m0, s53, s49
    s_nop 0
    buffer_load_dwordx4 v2, s[12:15], s24 offen offset:0 sc1 lds
    buffer_load_dwordx4 v3, s[12:15], s24 offen offset:1024 sc1 lds
    s_add_u32 m0, s54, s50
    s_add_u32 s24, s24, s30
    s_add_u32 s49, s49, 16384
    buffer_load_dwordx4 v6, s[16:19], s25 offen offset:0 lds
    buffer_load_dwordx4 v7, s[16:19], s25 offen offset:1024 lds
    s_add_u32 s25, s25, s52
    s_add_u32 s50, s50, 16384
    s_cmp_eq_u32 s49, 65536
    s_cselect_b32 s49, 0, s49
    s_cselect_b32 s50, 0, s50
    s_add_u32 m0, s53, s49
    s_nop 0
    buffer_load_dwordx4 v2, s[12:15], s24 offen offset:0 sc1 lds
    buffer_load_dwordx4 v3, s[12:15], s24 offen offset:1024 sc1 lds
    s_add_u32 m0, s54, s50
    s_add_u32 s24, s24, s30
    s_add_u32 s49, s49, 16384
    buffer_load_dwordx4 v6, s[16:19], s25 offen offset:0 lds
    buffer_load_dwordx4 v7, s[16:19], s25 offen offset:1024 lds
    s_add_u32 s25, s25, s52
    s_add_u32 s50, s50, 16384
    s_cmp_eq_u32 s49, 65536
    s_cselect_b32 s49, 0, s49
    s_cselect_b32 s50, 0, s50
    s_add_u32 m0, s53, s49
    s_nop 0
    buffer_load_dwordx4 v2, s[12:15], s24 offen offset:0 sc1 lds
    buffer_load_dwordx4 v3, s[12:15], s24 offen offset:1024 sc1 lds
    s_add_u32 m0, s54, s50
    s_add_u32 s24, s24, s30
    s_add_u32 s49, s49, 16384
    buffer_load_dwordx4 v6, s[16:19], s25 offen offset:0 lds
    buffer_load_dwordx4 v7, s[16:19], s25 offen offset:1024 lds
    s_add_u32 s25, s25, s52
    s_add_u32 s50, s50, 16384
    s_cmp_eq_u32 s49, 65536
    s_cselect_b32 s49, 0, s49
    s_cselect_b32 s50, 0, s50
    s_add_u32 m0, s53, s49
    s_nop 0
    buffer_load_dwordx4 v2, s[12:15], s24 offen offset:0 sc1 lds
    buffer_load_dwordx4 v3, s[12:15], s24 offen offset:1024 sc1 lds
    s_add_u32 m0, s54, s50
    s_add_u32 s24, s24, s30
    s_add_u32 s49, s49, 16384
    buffer_load_dwordx4 v6, s[16:19], s25 offen offset:0 lds
    buffer_load_dwordx4 v7, s[16:19], s25 offen offset:1024 lds
    s_add_u32 s25, s25, s52
    s_add_u32 s50, s50, 16384
    s_cmp_eq_u32 s49, 65536
    s_cselect_b32 s49, 0, s49
    s_cselect_b32 s50, 0, s50
    s_cmp_lg_u32 s34, 4
    s_cbranch_scc1 CLFV
    s_bitcmp1_b32 s2, 30
    s_cbranch_scc1 CLFV
    s_getreg_b32 s40, hwreg(HW_REG_XCC_ID)
    s_and_b32 s40, s40, 7
    s_lshl_b32 s41, s40, 2
    s_lshr_b32 s40, 0x73625140, s41
    s_and_b32 s40, s40, 7
    s_lshl_b32 s40, s40, 3
    s_bitset1_b32 s2, 30
    s_waitcnt vmcnt(16)
    s_atomic_add_x2 s[72:73], s[82:83], s40 glc
CLFV:
    s_waitcnt vmcnt(12)
    s_barrier
    v_add_u32 v14, s47, v8
    v_add_u32 v15, s47, v9
    v_add_u32 v16, s48, v10
    v_add_u32 v17, s48, v11
    v_add_u32 v18, s48, v12
    v_add_u32 v19, s48, v13
    s_add_u32 s47, s47, 16384
    s_add_u32 s48, s48, 16384
    s_cmp_eq_u32 s47, 65536
    s_cselect_b32 s47, 0, s47
    s_cselect_b32 s48, 0, s48
    ds_read_b128 v[128:131], v14 offset:0
    ds_read_b64_tr_b16 v[144:145], v16 offset:0
    ds_read_b64_tr_b16 v[146:147], v16 offset:1024
    ds_read_b128 v[132:135], v14 offset:2048
    ds_read_b64_tr_b16 v[148:149], v17 offset:0
    ds_read_b64_tr_b16 v[150:151], v17 offset:1024
    ds_read_b64_tr_b16 v[152:153], v18 offset:0
    ds_read_b64_tr_b16 v[154:155], v18 offset:1024
    ds_read_b64_tr_b16 v[156:157], v19 offset:0
    ds_read_b64_tr_b16 v[158:159], v19 offset:1024
    s_waitcnt lgkmcnt(0)
    v_mfma_f32_16x16x32_bf16 v[64:67], v[128:131], v[144:147], 0
    ds_read_b128 v[160:163], v15 offset:0
    ds_read_b64_tr_b16 v[176:177], v16 offset:8192
    v_mfma_f32_16x16x32_bf16 v[68:71], v[128:131], v[148:151], 0
    ds_read_b64_tr_b16 v[178:179], v16 offset:9216
    ds_read_b128 v[164:167], v15 offset:2048
    v_mfma_f32_16x16x32_bf16 v[72:75], v[128:131], v[152:155], 0
    ds_read_b64_tr_b16 v[180:181], v17 offset:8192
    ds_read_b64_tr_b16 v[182:183], v17 offset:9216
    v_mfma_f32_16x16x32_bf16 v[76:79], v[128:131], v[156:159], 0
    ds_read_b64_tr_b16 v[184:185], v18 offset:8192
    ds_read_b64_tr_b16 v[186:187], v18 offset:9216
    v_mfma_f32_16x16x32_bf16 v[80:83], v[132:135], v[144:147], 0
    ds_read_b64_tr_b16 v[188:189], v19 offset:8192
    ds_read_b64_tr_b16 v[190:191], v19 offset:9216
    v_mfma_f32_16x16x32_bf16 v[84:87], v[132:135], v[148:151], 0
    v_add_u32 v14, s47, v8
    v_add_u32 v15, s47, v9
    v_add_u32 v16, s48, v10
    v_mfma_f32_16x16x32_bf16 v[88:91], v[132:135], v[152:155], 0
    v_add_u32 v17, s48, v11
    v_add_u32 v18, s48, v12
    v_add_u32 v19, s48, v13
    v_mfma_f32_16x16x32_bf16 v[92:95], v[132:135], v[156:159], 0
    s_add_u32 s47, s47, 16384
    s_add_u32 s48, s48, 16384
    s_cmp_eq_u32 s47, 65536
    s_cselect_b32 s47, 0, s47
    s_cselect_b32 s48, 0, s48
    s_add_u32 m0, s53, s49
    s_waitcnt vmcnt(8) lgkmcnt(0)
    s_barrier
    v_mfma_f32_16x16x32_bf16 v[64:67], v[160:163], v[176:179], v[64:67]
    ds_read_b128 v[128:131], v14 offset:0
    ds_read_b64_tr_b16 v[144:145], v16 offset:0
    v_mfma_f32_16x16x32_bf16 v[68:71], v[160:163], v[180:183], v[68:71]
    ds_read_b64_tr_b16 v[146:147], v16 offset:1024
    ds_read_b128 v[132:135], v14 offset:2048
    buffer_load_dwordx4 v2, s[12:15], s24 offen offset:0 sc1 lds
    v_mfma_f32_16x16x32_bf16 v[72:75], v[160:163], v[184:187], v[72:75]
    ds_read_b64_tr_b16 v[148:149], v17 offset:0
    ds_read_b64_tr_b16 v[150:151], v17 offset:1024
    v_mfma_f32_16x16x32_bf16 v[76:79], v[160:163], v[188:191], v[76:79]
    ds_read_b64_tr_b16 v[152:153], v18 offset:0
    ds_read_b64_tr_b16 v[154:155], v18 offset:1024
    buffer_load_dwordx4 v3, s[12:15], s24 offen offset:1024 sc1 lds
    s_add_u32 m0, s54, s50
    s_add_u32 s24, s24, s30
    s_add_u32 s49, s49, 16384
    v_mfma_f32_16x16x32_bf16 v[80:83], v[164:167], v[176:179], v[80:83]
    ds_read_b64_tr_b16 v[156:157], v19 offset:0
    ds_read_b64_tr_b16 v[158:159], v19 offset:1024
    v_mfma_f32_16x16x32_bf16 v[84:87], v[164:167], v[180:183], v[84:87]
    buffer_load_dwordx4 v6, s[16:19], s25 offen offset:0 lds
    v_mfma_f32_16x16x32_bf16 v[88:91], v[164:167], v[184:187], v[88:91]
    buffer_load_dwordx4 v7, s[16:19], s25 offen offset:1024 lds
    s_add_u32 s25, s25, s52
    s_add_u32 s50, s50, 16384
    v_mfma_f32_16x16x32_bf16 v[92:95], v[164:167], v[188:191], v[92:95]
    s_cmp_eq_u32 s49, 65536
    s_cselect_b32 s49, 0, s49
    s_cselect_b32 s50, 0, s50
    s_mov_b32 s51, 11
GFV_LOOP:
    s_waitcnt lgkmcnt(0)
    v_mfma_f32_16x16x32_bf16 v[64:67], v[128:131], v[144:147], v[64:67]
    ds_read_b128 v[160:163], v15 offset:0
    ds_read_b64_tr_b16 v[176:177], v16 offset:8192
    v_mfma_f32_16x16x32_bf16 v[68:71], v[128:131], v[148:151], v[68:71]
    ds_read_b64_tr_b16 v[178:179], v16 offset:9216
    ds_read_b128 v[164:167], v15 offset:2048
    v_mfma_f32_16x16x32_bf16 v[72:75], v[128:131], v[152:155], v[72:75]
    ds_read_b64_tr_b16 v[180:181], v17 offset:8192
    ds_read_b64_tr_b16 v[182:183], v17 offset:9216
    v_mfma_f32_16x16x32_bf16 v[76:79], v[128:131], v[156:159], v[76:79]
    ds_read_b64_tr_b16 v[184:185], v18 offset:8192
    ds_read_b64_tr_b16 v[186:187], v18 offset:9216
    v_mfma_f32_16x16x32_bf16 v[80:83], v[132:135], v[144:147], v[80:83]
    ds_read_b64_tr_b16 v[188:189], v19 offset:8192
    ds_read_b64_tr_b16 v[190:191], v19 offset:9216
    v_mfma_f32_16x16x32_bf16 v[84:87], v[132:135], v[148:151], v[84:87]
    v_add_u32 v14, s47, v8
    v_add_u32 v15, s47, v9
    v_add_u32 v16, s48, v10
    v_mfma_f32_16x16x32_bf16 v[88:91], v[132:135], v[152:155], v[88:91]
    v_add_u32 v17, s48, v11
    v_add_u32 v18, s48, v12
    v_add_u32 v19, s48, v13
    v_mfma_f32_16x16x32_bf16 v[92:95], v[132:135], v[156:159], v[92:95]
    s_add_u32 s47, s47, 16384
    s_add_u32 s48, s48, 16384
    s_cmp_eq_u32 s47, 65536
    s_cselect_b32 s47, 0, s47
    s_cselect_b32 s48, 0, s48
    s_add_u32 m0, s53, s49
    s_waitcnt vmcnt(8) lgkmcnt(0)
    s_barrier
    v_mfma_f32_16x16x32_bf16 v[64:67], v[160:163], v[176:179], v[64:67]
    ds_read_b128 v[128:131], v14 offset:0
    ds_read_b64_tr_b16 v[144:145], v16 offset:0
    v_mfma_f32_16x16x32_bf16 v[68:71], v[160:163], v[180:183], v[68:71]
    ds_read_b64_tr_b16 v[146:147], v16 offset:1024
    ds_read_b128 v[132:135], v14 offset:2048
    buffer_load_dwordx4 v2, s[12:15], s24 offen offset:0 sc1 lds
    v_mfma_f32_16x16x32_bf16 v[72:75], v[160:163], v[184:187], v[72:75]
    ds_read_b64_tr_b16 v[148:149], v17 offset:0
    ds_read_b64_tr_b16 v[150:151], v17 offset:1024
    v_mfma_f32_16x16x32_bf16 v[76:79], v[160:163], v[188:191], v[76:79]
    ds_read_b64_tr_b16 v[152:153], v18 offset:0
    ds_read_b64_tr_b16 v[154:155], v18 offset:1024
    buffer_load_dwordx4 v3, s[12:15], s24 offen offset:1024 sc1 lds
    s_add_u32 m0, s54, s50
    s_add_u32 s24, s24, s30
    s_add_u32 s49, s49, 16384
    v_mfma_f32_16x16x32_bf16 v[80:83], v[164:167], v[176:179], v[80:83]
    ds_read_b64_tr_b16 v[156:157], v19 offset:0
    ds_read_b64_tr_b16 v[158:159], v19 offset:1024
    v_mfma_f32_16x16x32_bf16 v[84:87], v[164:167], v[180:183], v[84:87]
    buffer_load_dwordx4 v6, s[16:19], s25 offen offset:0 lds
    v_mfma_f32_16x16x32_bf16 v[88:91], v[164:167], v[184:187], v[88:91]
    buffer_load_dwordx4 v7, s[16:19], s25 offen offset:1024 lds
    s_add_u32 s25, s25, s52
    s_add_u32 s50, s50, 16384
    v_mfma_f32_16x16x32_bf16 v[92:95], v[164:167], v[188:191], v[92:95]
    s_cmp_eq_u32 s49, 65536
    s_cselect_b32 s49, 0, s49
    s_cselect_b32 s50, 0, s50
    s_sub_u32 s51, s51, 1
    s_cmp_lg_u32 s51, 0
    s_cbranch_scc1 GFV_LOOP
    s_waitcnt lgkmcnt(0)
    v_mfma_f32_16x16x32_bf16 v[64:67], v[128:131], v[144:147], v[64:67]
    ds_read_b128 v[160:163], v15 offset:0
    ds_read_b64_tr_b16 v[176:177], v16 offset:8192
    v_mfma_f32_16x16x32_bf16 v[68:71], v[128:131], v[148:151], v[68:71]
    ds_read_b64_tr_b16 v[178:179], v16 offset:9216
    ds_read_b128 v[164:167], v15 offset:2048
    v_mfma_f32_16x16x32_bf16 v[72:75], v[128:131], v[152:155], v[72:75]
    ds_read_b64_tr_b16 v[180:181], v17 offset:8192
    ds_read_b64_tr_b16 v[182:183], v17 offset:9216
    v_mfma_f32_16x16x32_bf16 v[76:79], v[128:131], v[156:159], v[76:79]
    ds_read_b64_tr_b16 v[184:185], v18 offset:8192
    ds_read_b64_tr_b16 v[186:187], v18 offset:9216
    v_mfma_f32_16x16x32_bf16 v[80:83], v[132:135], v[144:147], v[80:83]
    ds_read_b64_tr_b16 v[188:189], v19 offset:8192
    ds_read_b64_tr_b16 v[190:191], v19 offset:9216
    v_mfma_f32_16x16x32_bf16 v[84:87], v[132:135], v[148:151], v[84:87]
    v_add_u32 v14, s47, v8
    v_add_u32 v15, s47, v9
    v_add_u32 v16, s48, v10
    v_mfma_f32_16x16x32_bf16 v[88:91], v[132:135], v[152:155], v[88:91]
    v_add_u32 v17, s48, v11
    v_add_u32 v18, s48, v12
    v_add_u32 v19, s48, v13
    v_mfma_f32_16x16x32_bf16 v[92:95], v[132:135], v[156:159], v[92:95]
    s_add_u32 s47, s47, 16384
    s_add_u32 s48, s48, 16384
    s_cmp_eq_u32 s47, 65536
    s_cselect_b32 s47, 0, s47
    s_cselect_b32 s48, 0, s48
    s_waitcnt vmcnt(8) lgkmcnt(0)
    s_barrier
    v_mfma_f32_16x16x32_bf16 v[64:67], v[160:163], v[176:179], v[64:67]
    ds_read_b128 v[128:131], v14 offset:0
    ds_read_b64_tr_b16 v[144:145], v16 offset:0
    v_mfma_f32_16x16x32_bf16 v[68:71], v[160:163], v[180:183], v[68:71]
    ds_read_b64_tr_b16 v[146:147], v16 offset:1024
    ds_read_b128 v[132:135], v14 offset:2048
    v_mfma_f32_16x16x32_bf16 v[72:75], v[160:163], v[184:187], v[72:75]
    ds_read_b64_tr_b16 v[148:149], v17 offset:0
    ds_read_b64_tr_b16 v[150:151], v17 offset:1024
    v_mfma_f32_16x16x32_bf16 v[76:79], v[160:163], v[188:191], v[76:79]
    ds_read_b64_tr_b16 v[152:153], v18 offset:0
    ds_read_b64_tr_b16 v[154:155], v18 offset:1024
    v_mfma_f32_16x16x32_bf16 v[80:83], v[164:167], v[176:179], v[80:83]
    ds_read_b64_tr_b16 v[156:157], v19 offset:0
    ds_read_b64_tr_b16 v[158:159], v19 offset:1024
    v_mfma_f32_16x16x32_bf16 v[84:87], v[164:167], v[180:183], v[84:87]
    v_mfma_f32_16x16x32_bf16 v[88:91], v[164:167], v[184:187], v[88:91]
    v_mfma_f32_16x16x32_bf16 v[92:95], v[164:167], v[188:191], v[92:95]
    s_waitcnt lgkmcnt(0)
    v_mfma_f32_16x16x32_bf16 v[64:67], v[128:131], v[144:147], v[64:67]
    ds_read_b128 v[160:163], v15 offset:0
    ds_read_b64_tr_b16 v[176:177], v16 offset:8192
    v_mfma_f32_16x16x32_bf16 v[68:71], v[128:131], v[148:151], v[68:71]
    ds_read_b64_tr_b16 v[178:179], v16 offset:9216
    ds_read_b128 v[164:167], v15 offset:2048
    v_mfma_f32_16x16x32_bf16 v[72:75], v[128:131], v[152:155], v[72:75]
    ds_read_b64_tr_b16 v[180:181], v17 offset:8192
    ds_read_b64_tr_b16 v[182:183], v17 offset:9216
    v_mfma_f32_16x16x32_bf16 v[76:79], v[128:131], v[156:159], v[76:79]
    ds_read_b64_tr_b16 v[184:185], v18 offset:8192
    ds_read_b64_tr_b16 v[186:187], v18 offset:9216
    v_mfma_f32_16x16x32_bf16 v[80:83], v[132:135], v[144:147], v[80:83]
    ds_read_b64_tr_b16 v[188:189], v19 offset:8192
    ds_read_b64_tr_b16 v[190:191], v19 offset:9216
    v_mfma_f32_16x16x32_bf16 v[84:87], v[132:135], v[148:151], v[84:87]
    v_add_u32 v14, s47, v8
    v_add_u32 v15, s47, v9
    v_add_u32 v16, s48, v10
    v_mfma_f32_16x16x32_bf16 v[88:91], v[132:135], v[152:155], v[88:91]
    v_add_u32 v17, s48, v11
    v_add_u32 v18, s48, v12
    v_add_u32 v19, s48, v13
    v_mfma_f32_16x16x32_bf16 v[92:95], v[132:135], v[156:159], v[92:95]
    s_add_u32 s47, s47, 16384
    s_add_u32 s48, s48, 16384
    s_cmp_eq_u32 s47, 65536
    s_cselect_b32 s47, 0, s47
    s_cselect_b32 s48, 0, s48
    s_waitcnt vmcnt(4) lgkmcnt(0)
    s_barrier
    v_mfma_f32_16x16x32_bf16 v[64:67], v[160:163], v[176:179], v[64:67]
    ds_read_b128 v[128:131], v14 offset:0
    ds_read_b64_tr_b16 v[144:145], v16 offset:0
    v_mfma_f32_16x16x32_bf16 v[68:71], v[160:163], v[180:183], v[68:71]
    ds_read_b64_tr_b16 v[146:147], v16 offset:1024
    ds_read_b128 v[132:135], v14 offset:2048
    v_mfma_f32_16x16x32_bf16 v[72:75], v[160:163], v[184:187], v[72:75]
    ds_read_b64_tr_b16 v[148:149], v17 offset:0
    ds_read_b64_tr_b16 v[150:151], v17 offset:1024
    v_mfma_f32_16x16x32_bf16 v[76:79], v[160:163], v[188:191], v[76:79]
    ds_read_b64_tr_b16 v[152:153], v18 offset:0
    ds_read_b64_tr_b16 v[154:155], v18 offset:1024
    v_mfma_f32_16x16x32_bf16 v[80:83], v[164:167], v[176:179], v[80:83]
    ds_read_b64_tr_b16 v[156:157], v19 offset:0
    ds_read_b64_tr_b16 v[158:159], v19 offset:1024
    v_mfma_f32_16x16x32_bf16 v[84:87], v[164:167], v[180:183], v[84:87]
    v_mfma_f32_16x16x32_bf16 v[88:91], v[164:167], v[184:187], v[88:91]
    v_mfma_f32_16x16x32_bf16 v[92:95], v[164:167], v[188:191], v[92:95]
    s_waitcnt lgkmcnt(0)
    v_mfma_f32_16x16x32_bf16 v[64:67], v[128:131], v[144:147], v[64:67]
    ds_read_b128 v[160:163], v15 offset:0
    ds_read_b64_tr_b16 v[176:177], v16 offset:8192
    v_mfma_f32_16x16x32_bf16 v[68:71], v[128:131], v[148:151], v[68:71]
    ds_read_b64_tr_b16 v[178:179], v16 offset:9216
    ds_read_b128 v[164:167], v15 offset:2048
    v_mfma_f32_16x16x32_bf16 v[72:75], v[128:131], v[152:155], v[72:75]
    ds_read_b64_tr_b16 v[180:181], v17 offset:8192
    ds_read_b64_tr_b16 v[182:183], v17 offset:9216
    v_mfma_f32_16x16x32_bf16 v[76:79], v[128:131], v[156:159], v[76:79]
    ds_read_b64_tr_b16 v[184:185], v18 offset:8192
    ds_read_b64_tr_b16 v[186:187], v18 offset:9216
    v_mfma_f32_16x16x32_bf16 v[80:83], v[132:135], v[144:147], v[80:83]
    ds_read_b64_tr_b16 v[188:189], v19 offset:8192
    ds_read_b64_tr_b16 v[190:191], v19 offset:9216
    v_mfma_f32_16x16x32_bf16 v[84:87], v[132:135], v[148:151], v[84:87]
    v_add_u32 v14, s47, v8
    v_add_u32 v15, s47, v9
    v_add_u32 v16, s48, v10
    v_mfma_f32_16x16x32_bf16 v[88:91], v[132:135], v[152:155], v[88:91]
    v_add_u32 v17, s48, v11
    v_add_u32 v18, s48, v12
    v_add_u32 v19, s48, v13
    v_mfma_f32_16x16x32_bf16 v[92:95], v[132:135], v[156:159], v[92:95]
    s_add_u32 s47, s47, 16384
    s_add_u32 s48, s48, 16384
    s_cmp_eq_u32 s47, 65536
    s_cselect_b32 s47, 0, s47
    s_cselect_b32 s48, 0, s48
    s_waitcnt vmcnt(0) lgkmcnt(0)
    s_barrier
    v_mfma_f32_16x16x32_bf16 v[64:67], v[160:163], v[176:179], v[64:67]
    ds_read_b128 v[128:131], v14 offset:0
    ds_read_b64_tr_b16 v[144:145], v16 offset:0
    v_mfma_f32_16x16x32_bf16 v[68:71], v[160:163], v[180:183], v[68:71]
    ds_read_b64_tr_b16 v[146:147], v16 offset:1024
    ds_read_b128 v[132:135], v14 offset:2048
    v_mfma_f32_16x16x32_bf16 v[72:75], v[160:163], v[184:187], v[72:75]
    ds_read_b64_tr_b16 v[148:149], v17 offset:0
    ds_read_b64_tr_b16 v[150:151], v17 offset:1024
    v_mfma_f32_16x16x32_bf16 v[76:79], v[160:163], v[188:191], v[76:79]
    ds_read_b64_tr_b16 v[152:153], v18 offset:0
    ds_read_b64_tr_b16 v[154:155], v18 offset:1024
    v_mfma_f32_16x16x32_bf16 v[80:83], v[164:167], v[176:179], v[80:83]
    ds_read_b64_tr_b16 v[156:157], v19 offset:0
    ds_read_b64_tr_b16 v[158:159], v19 offset:1024
    v_mfma_f32_16x16x32_bf16 v[84:87], v[164:167], v[180:183], v[84:87]
    v_mfma_f32_16x16x32_bf16 v[88:91], v[164:167], v[184:187], v[88:91]
    v_mfma_f32_16x16x32_bf16 v[92:95], v[164:167], v[188:191], v[92:95]
    s_waitcnt lgkmcnt(0)
    v_mfma_f32_16x16x32_bf16 v[64:67], v[128:131], v[144:147], v[64:67]
    ds_read_b128 v[160:163], v15 offset:0
    ds_read_b64_tr_b16 v[176:177], v16 offset:8192
    v_mfma_f32_16x16x32_bf16 v[68:71], v[128:131], v[148:151], v[68:71]
    ds_read_b64_tr_b16 v[178:179], v16 offset:9216
    ds_read_b128 v[164:167], v15 offset:2048
    v_mfma_f32_16x16x32_bf16 v[72:75], v[128:131], v[152:155], v[72:75]
    ds_read_b64_tr_b16 v[180:181], v17 offset:8192
    ds_read_b64_tr_b16 v[182:183], v17 offset:9216
    v_mfma_f32_16x16x32_bf16 v[76:79], v[128:131], v[156:159], v[76:79]
    ds_read_b64_tr_b16 v[184:185], v18 offset:8192
    ds_read_b64_tr_b16 v[186:187], v18 offset:9216
    v_mfma_f32_16x16x32_bf16 v[80:83], v[132:135], v[144:147], v[80:83]
    ds_read_b64_tr_b16 v[188:189], v19 offset:8192
    ds_read_b64_tr_b16 v[190:191], v19 offset:9216
    v_mfma_f32_16x16x32_bf16 v[84:87], v[132:135], v[148:151], v[84:87]
    v_mfma_f32_16x16x32_bf16 v[88:91], v[132:135], v[152:155], v[88:91]
    v_mfma_f32_16x16x32_bf16 v[92:95], v[132:135], v[156:159], v[92:95]
    s_waitcnt lgkmcnt(0)
    v_mfma_f32_16x16x32_bf16 v[64:67], v[160:163], v[176:179], v[64:67]
    v_mfma_f32_16x16x32_bf16 v[68:71], v[160:163], v[180:183], v[68:71]
    v_mfma_f32_16x16x32_bf16 v[72:75], v[160:163], v[184:187], v[72:75]
    v_mfma_f32_16x16x32_bf16 v[76:79], v[160:163], v[188:191], v[76:79]
    v_mfma_f32_16x16x32_bf16 v[80:83], v[164:167], v[176:179], v[80:83]
    v_mfma_f32_16x16x32_bf16 v[84:87], v[164:167], v[180:183], v[84:87]
    v_mfma_f32_16x16x32_bf16 v[88:91], v[164:167], v[184:187], v[88:91]
    v_mfma_f32_16x16x32_bf16 v[92:95], v[164:167], v[188:191], v[92:95]
    s_bitcmp1_b32 s2, 31
    s_cbranch_scc1 VDFV_OK
    s_cmp_lg_u32 s34, 4
    s_cbranch_scc1 VFV_DONE
    s_bitcmp1_b32 s2, 31
    s_cbranch_scc1 VFV_DONE
    s_getreg_b32 s40, hwreg(HW_REG_XCC_ID)
    s_and_b32 s40, s40, 7
    s_lshl_b32 s51, s40, 2
    s_lshr_b32 s40, 0x73625140, s51
    s_and_b32 s40, s40, 7
    v_and_b32 v42, 15, v0
    v_lshlrev_b32 v42, 2, v42
    s_mov_b32 s38, 0
VFV_POLL:
    global_load_dword v43, v42, s[82:83] sc1
    s_add_u32 s38, s38, 1
    s_cmp_gt_u32 s38, 60000
    s_cbranch_scc1 C_DONE
    s_mov_b32 s42, 0
    s_mov_b32 s43, 0
    s_mov_b32 s45, 0
    s_mov_b32 s46, 0
    s_waitcnt vmcnt(0)
    v_readlane_b32 s51, v43, 1
    s_cmp_lg_u32 s51, 0x2000
    s_cselect_b32 s46, 1, s46
    s_lshr_b32 s51, s51, 8
    s_add_u32 s42, s42, s51
    s_cmp_lg_u32 s51, 32
    s_cselect_b32 s45, 1, s45
    s_cmp_gt_u32 s40, 0
    s_cselect_b32 s51, s51, 0
    s_add_u32 s43, s43, s51
    v_readlane_b32 s51, v43, 0
    s_cmp_lg_u32 s51, -1
    s_cselect_b32 s46, 1, s46
    v_readlane_b32 s51, v43, 3
    s_cmp_lg_u32 s51, 0x2000
    s_cselect_b32 s46, 1, s46
    s_lshr_b32 s51, s51, 8
    s_add_u32 s42, s42, s51
    s_cmp_lg_u32 s51, 32
    s_cselect_b32 s45, 1, s45
    s_cmp_gt_u32 s40, 1
    s_cselect_b32 s51, s51, 0
    s_add_u32 s43, s43, s51
    v_readlane_b32 s51, v43, 2
    s_cmp_lg_u32 s51, -1
    s_cselect_b32 s46, 1, s46
    v_readlane_b32 s51, v43, 5
    s_cmp_lg_u32 s51, 0x2000
    s_cselect_b32 s46, 1, s46
    s_lshr_b32 s51, s51, 8
    s_add_u32 s42, s42, s51
    s_cmp_lg_u32 s51, 32
    s_cselect_b32 s45, 1, s45
    s_cmp_gt_u32 s40, 2
    s_cselect_b32 s51, s51, 0
    s_add_u32 s43, s43, s51
    v_readlane_b32 s51, v43, 4
    s_cmp_lg_u32 s51, -1
    s_cselect_b32 s46, 1, s46
    v_readlane_b32 s51, v43, 7
    s_cmp_lg_u32 s51, 0x2000
    s_cselect_b32 s46, 1, s46
    s_lshr_b32 s51, s51, 8
    s_add_u32 s42, s42, s51
    s_cmp_lg_u32 s51, 32
    s_cselect_b32 s45, 1, s45
    s_cmp_gt_u32 s40, 3
    s_cselect_b32 s51, s51, 0
    s_add_u32 s43, s43, s51
    v_readlane_b32 s51, v43, 6
    s_cmp_lg_u32 s51, -1
    s_cselect_b32 s46, 1, s46
    v_readlane_b32 s51, v43, 9
    s_cmp_lg_u32 s51, 0x2000
    s_cselect_b32 s46, 1, s46
    s_lshr_b32 s51, s51, 8
    s_add_u32 s42, s42, s51
    s_cmp_lg_u32 s51, 32
    s_cselect_b32 s45, 1, s45
    s_cmp_gt_u32 s40, 4
    s_cselect_b32 s51, s51, 0
    s_add_u32 s43, s43, s51
    v_readlane_b32 s51, v43, 8
    s_cmp_lg_u32 s51, -1
    s_cselect_b32 s46, 1, s46
    v_readlane_b32 s51, v43, 11
    s_cmp_lg_u32 s51, 0x2000
    s_cselect_b32 s46, 1, s46
    s_lshr_b32 s51, s51, 8
    s_add_u32 s42, s42, s51
    s_cmp_lg_u32 s51, 32
    s_cselect_b32 s45, 1, s45
    s_cmp_gt_u32 s40, 5
    s_cselect_b32 s51, s51, 0
    s_add_u32 s43, s43, s51
    v_readlane_b32 s51, v43, 10
    s_cmp_lg_u32 s51, -1
    s_cselect_b32 s46, 1, s46
    v_readlane_b32 s51, v43, 13
    s_cmp_lg_u32 s51, 0x2000
    s_cselect_b32 s46, 1, s46
    s_lshr_b32 s51, s51, 8
    s_add_u32 s42, s42, s51
    s_cmp_lg_u32 s51, 32
    s_cselect_b32 s45, 1, s45
    s_cmp_gt_u32 s40, 6
    s_cselect_b32 s51, s51, 0
    s_add_u32 s43, s43, s51
    v_readlane_b32 s51, v43, 12
    s_cmp_lg_u32 s51, -1
    s_cselect_b32 s46, 1, s46
    v_readlane_b32 s51, v43, 15
    s_cmp_lg_u32 s51, 0x2000
    s_cselect_b32 s46, 1, s46
    s_lshr_b32 s51, s51, 8
    s_add_u32 s42, s42, s51
    s_cmp_lg_u32 s51, 32
    s_cselect_b32 s45, 1, s45
    s_cmp_gt_u32 s40, 7
    s_cselect_b32 s51, s51, 0
    s_add_u32 s43, s43, s51
    v_readlane_b32 s51, v43, 14
    s_cmp_lg_u32 s51, -1
    s_cselect_b32 s46, 1, s46
    s_cmp_lg_u32 s42, 256
    s_cbranch_scc1 VFV_POLL
    s_waitcnt lgkmcnt(0)
    s_lshr_b32 s41, s73, 8
    s_add_u32 s43, s43, s41
    s_lshl_b32 s51, s45, 8
    s_or_b32 s43, s43, s51
    s_or_b32 s43, s43, 0x8000
    s_or_b32 s46, s46, s45
    s_cselect_b32 s43, s43, 0
    v_mov_b32 v42, 147456
    v_mov_b32 v43, s43
    ds_write_b32 v42, v43
    s_waitcnt lgkmcnt(0)
VFV_DONE:
    s_barrier
    s_bitcmp1_b32 s2, 31
    s_cbranch_scc1 VDFV_OK
    v_mov_b32 v42, 147456
    ds_read_b32 v43, v42
    s_bitset1_b32 s2, 31
    s_waitcnt lgkmcnt(0)
    v_readfirstlane_b32 s40, v43
    s_cmp_lg_u32 s40, 0
    s_cbranch_scc1 R_RESTART
VDFV_OK:
    v_mov_b32 v28, -1
    v_mov_b32 v29, -1
    v_mov_b32 v30, -1
    v_mov_b32 v31, -1
    v_lshlrev_b32 v1, 4, v0
    s_lshl_b32 s40, s59, 5
    s_add_u32 s40, s40, s33
    s_lshl_b32 s40, s40, 3
    s_add_u32 s40, s40, s34
    s_lshl_b32 s40, s40, 11
    s_add_u32 s40, s40, 134217728
    buffer_store_dwordx4 v[28:31], v1, s[8:11], s40 offen offset:0 sc1
    buffer_store_dwordx4 v[28:31], v1, s[8:11], s40 offen offset:1024 sc1
    s_lshr_b32 s45, s34, 1
    s_and_b32 s46, s34, 1
    s_lshl_b32 s46, s46, 1
    s_xor_b32 s46, s46, 2
    v_mul_lo_u32 v20, v26, s27
    s_mul_i32 s45, s45, 1
    s_mul_i32 s45, s45, s29
    s_mul_i32 s46, s46, s28
    s_add_u32 s26, s26, s45
    s_add_u32 s26, s26, s46
    s_cmp_eq_u32 s27, 16
    s_cselect_b32 s45, 9, 4
    v_lshl_add_u32 v20, v27, s45, v20
    s_lshl_b32 s45, s27, 4
    v_add_u32 v21, s45, v20
    v_cvt_pk_bf16_f32 v160, v64, v65
    v_cvt_pk_bf16_f32 v161, v66, v67
    v_cvt_pk_bf16_f32 v162, v80, v81
    v_cvt_pk_bf16_f32 v163, v82, v83
    v_cvt_pk_bf16_f32 v164, v68, v69
    v_cvt_pk_bf16_f32 v165, v70, v71
    v_cvt_pk_bf16_f32 v166, v84, v85
    v_cvt_pk_bf16_f32 v167, v86, v87
    v_cvt_pk_bf16_f32 v168, v72, v73
    v_cvt_pk_bf16_f32 v169, v74, v75
    v_cvt_pk_bf16_f32 v170, v88, v89
    v_cvt_pk_bf16_f32 v171, v90, v91
    v_cvt_pk_bf16_f32 v172, v76, v77
    v_cvt_pk_bf16_f32 v173, v78, v79
    v_cvt_pk_bf16_f32 v174, v92, v93
    v_cvt_pk_bf16_f32 v175, v94, v95
    v_permlane16_swap_b32 v160, v162
    v_permlane16_swap_b32 v161, v163
    buffer_store_dwordx4 v[160:163], v20, s[20:23], s26 offen sc1
    v_permlane16_swap_b32 v164, v166
    v_permlane16_swap_b32 v165, v167
    buffer_store_dwordx4 v[164:167], v21, s[20:23], s26 offen sc1
    s_add_u32 s26, s26, s28
    v_permlane16_swap_b32 v168, v170
    v_permlane16_swap_b32 v169, v171
    buffer_store_dwordx4 v[168:171], v20, s[20:23], s26 offen sc1
    v_permlane16_swap_b32 v172, v174
    v_permlane16_swap_b32 v173, v175
    buffer_store_dwordx4 v[172:175], v21, s[20:23], s26 offen sc1
F_DONE:
    s_mov_b32 s38, 0
    s_waitcnt vmcnt(0)
    s_barrier
    s_cmp_lg_u32 s34, 0
    s_cbranch_scc1 B_DECODE
    s_mov_b32 s40, 98566144
    v_mov_b32 v1, 1
    s_mov_b64 exec, 1
    buffer_atomic_add v1, off, s[8:11], s40
    s_mov_b64 exec, -1
B_DECODE:
    s_add_u32 s35, s35, 1
    s_mov_b32 s86, 0
    s_mov_b32 s100, 0
    s_mov_b32 s101, 0
    s_mov_b32 s56, 0
    s_mov_b32 s55, 0
    s_mov_b64 s[88:89], s[60:61]
    s_mov_b64 s[90:91], s[64:65]
    s_mov_b32 s4, 0
    s_mov_b32 s87, 0x400000
    s_mov_b32 s92, 0x800000
    s_mov_b32 s95, 8192
    s_mov_b32 s99, 64
    s_waitcnt lgkmcnt(0)
    s_bfe_u32 s41, s6, 0x30008
    s_and_b32 s40, s6, 0xff
    s_bfe_u32 s55, s6, 0x1000b
    s_add_u32 s0, s0, 4
    s_addc_u32 s1, s1, 0
    s_load_dword s6, s[0:1], 0
    s_cmp_eq_u32 s41, 0
    s_cbranch_scc1 D_KV
    s_cmp_eq_u32 s41, 1
    s_cbranch_scc1 D_B1
    s_cmp_eq_u32 s41, 2
    s_cbranch_scc1 D_B2
    s_cmp_eq_u32 s41, 3
    s_cbranch_scc1 D_Q
    s_cmp_eq_u32 s41, 4
    s_cbranch_scc1 D_B3
    s_cmp_eq_u32 s41, 5
    s_cbranch_scc1 D_A3
    s_cmp_eq_u32 s41, 6
    s_cbranch_scc1 D_A3S
    s_mov_b32 s86, 3
    s_lshr_b32 s58, s40, 5
    s_and_b32 s57, s40, 31
    s_branch B_DECODED
D_KV:
    s_and_b32 s41, s59, 1
    s_lshl_b32 s41, s41, 4
    s_and_b32 s42, s40, 15
    s_add_u32 s41, s41, s42
    s_lshr_b32 s40, s40, 4
    s_lshl_b32 s93, s40, 19
    s_lshl_b32 s94, s41, 8
    s_lshl_b32 s96, s41, 20
    s_lshl_b32 s42, s40, 15
    s_add_u32 s96, s96, s42
    s_lshl_b32 s100, s40, 7
    s_add_u32 s100, s100, 98566144
    s_mov_b32 s97, 16
    s_lshl_b32 s57, s40, 22
    s_lshr_b32 s42, s59, 1
    s_lshl_b32 s42, s42, 5
    s_add_u32 s42, s42, s41
    s_lshl_b32 s42, s42, 15
    s_add_u32 s57, s57, s42
    s_add_u32 s57, s57, 134217728
    s_mov_b32 s4, 4
    s_cmp_ge_u32 s59, 2
    s_cbranch_scc1 D_KV_V
    s_mov_b64 s[90:91], s[66:67]
    s_mov_b32 s98, 4096
    s_mov_b32 s99, 0x40000
    s_add_u32 s96, s96, 0
    s_branch B_DECODED
D_KV_V:
    s_mov_b64 s[90:91], s[68:69]
    s_mov_b32 s98, 0x40000
    s_mov_b32 s99, 4096
    s_add_u32 s96, s96, 2048
    s_mov_b32 s86, 1
    s_branch B_DECODED
D_B1:
    s_mov_b64 s[88:89], s[74:75]
    s_mov_b64 s[90:91], s[76:77]
    s_mov_b32 s92, 0x600000
    s_mov_b32 s95, 6144
    s_mov_b32 s97, 16
    s_mov_b32 s98, 2048
    s_mov_b32 s99, 0x20000
    s_and_b32 s41, s40, 7
    s_lshl_b32 s93, s41, 19
    s_bfe_u32 s42, s40, 0x10003
    s_lshl_b32 s43, s59, 1
    s_add_u32 s42, s42, s43
    s_lshl_b32 s100, s59, 7
    s_add_u32 s100, s100, 98567168
    s_lshr_b32 s40, s40, 4
    s_lshl_b32 s43, s40, 3
    s_add_u32 s43, s43, s42
    s_lshl_b32 s94, s43, 8
    s_lshl_b32 s96, s43, 19
    s_lshl_b32 s41, s41, 14
    s_add_u32 s96, s96, s41
    s_add_u32 s96, s96, 75497472
    s_cmp_eq_u32 s40, 0
    s_cselect_b32 s4, 1, 0
    s_cmp_lg_u32 s40, 2
    s_cbranch_scc1 B_DECODED
    s_mov_b32 s98, 0x20000
    s_mov_b32 s99, 2048
    s_mov_b32 s86, 1
    s_branch B_DECODED
D_Q:
    s_lshr_b32 s58, s40, 5
    s_and_b32 s57, s40, 31
    s_lshl_b32 s93, s58, 19
    s_lshl_b32 s94, s57, 8
    s_mov_b32 s4, 2
    s_branch B_DECODED
D_B3:
    s_mov_b64 s[88:89], s[84:85]
    s_mov_b64 s[90:91], s[78:79]
    s_mov_b32 s4, 6
    s_mov_b32 s87, 0x10000000
    s_mov_b32 s92, 0x200000
    s_mov_b32 s95, 2048
    s_mov_b32 s97, 4096
    s_mov_b32 s98, 0x20000
    s_mov_b32 s56, 1
    s_lshr_b32 s41, s40, 3
    s_and_b32 s42, s40, 7
    s_lshl_b32 s93, s41, 19
    s_add_u32 s93, s93, 88076288
    s_lshl_b32 s94, s42, 8
    s_lshl_b32 s96, s41, 20
    s_add_u32 s96, s96, s94
    s_add_u32 s96, s96, 2048
    s_lshl_b32 s101, s41, 7
    s_add_u32 s101, s101, 98568192
    s_mov_b32 s55, 32
    s_branch B_DECODED
D_A3:
    s_mov_b64 s[88:89], s[84:85]
    s_mov_b64 s[90:91], s[70:71]
    s_mov_b32 s87, 0x10000000
    s_mov_b32 s95, 2048
    s_mov_b32 s97, 4096
    s_mov_b32 s98, 0x20000
    s_mov_b32 s56, 1
    s_mov_b32 s4, 3
    s_lshr_b32 s41, s40, 3
    s_and_b32 s42, s40, 7
    s_lshl_b32 s93, s41, 21
    s_add_u32 s93, s93, 50327552
    s_lshl_b32 s94, s42, 8
    s_lshl_b32 s96, s41, 20
    s_add_u32 s96, s96, s94
    s_lshl_b32 s101, s41, 10
    s_add_u32 s101, s101, 98574336
    s_mov_b32 s55, 32
    s_branch B_DECODED
D_A3S:
    s_mov_b64 s[88:89], s[84:85]
    s_mov_b64 s[90:91], s[70:71]
    s_mov_b32 s87, 0x10000000
    s_mov_b32 s95, 2048
    s_mov_b32 s97, 4096
    s_mov_b32 s98, 0x20000
    s_mov_b32 s56, 1
    s_mov_b32 s4, 5
    s_lshr_b32 s41, s40, 3
    s_and_b32 s42, s40, 7
    s_lshl_b32 s93, s41, 20
    s_add_u32 s93, s93, 50327552
    s_lshl_b32 s94, s42, 8
    s_lshl_b32 s96, s41, 19
    s_add_u32 s96, s96, s94
    s_lshl_b32 s101, s41, 9
    s_add_u32 s101, s101, 98574336
    s_mov_b32 s55, 32
    s_branch B_DECODED
D_B2:
    s_cmp_lg_u32 s55, 1
    s_cbranch_scc1 D_B2X
    s_mov_b32 s55, 0
    s_mov_b32 s86, 2
    s_mov_b32 s4, 7
    s_mov_b32 s58, s40
    s_branch B_DECODED
D_B2X:
    s_lshl_b32 s57, s59, 3
    s_and_b32 s41, s40, 7
    s_add_u32 s57, s57, s41
    s_lshr_b32 s58, s40, 3
    s_lshr_b32 s101, s57, 3
    s_lshl_b32 s101, s101, 7
    s_add_u32 s101, s101, 98567168
    s_mov_b32 s55, 48
    s_lshl_b32 s100, s58, 7
    s_add_u32 s100, s100, 98568192
    s_mov_b32 s86, 2
B_DECODED:
    s_cmp_lg_u32 s55, 1
    s_cbranch_scc1 B_NBIG
    s_add_u32 s86, s86, 4
    s_min_u32 s40, s100, 1
    s_or_b32 s100, s100, s40
B_NBIG:
    s_load_dword s73, s[84:85], s101
    s_cmp_eq_u32 s39, 0
    s_cbranch_scc1 B_COLD
    s_cmp_eq_u32 s39, 2
    s_cbranch_scc1 B_B2
    s_cmp_eq_u32 s36, 4
    s_cbranch_scc1 H_BODY_row
    s_cmp_eq_u32 s36, 5
    s_cbranch_scc1 H_BODY_tr
    s_cmp_eq_u32 s36, 1
    s_cbranch_scc1 B_BODY_tr
    s_branch B_BODY_row
B_COLD:
    s_cmp_lg_u32 s4, 7
    s_cbranch_scc1 B_NWJ
    s_lshl_b32 s43, s58, 2
    s_add_u32 s43, s43, s59
    s_lshl_b32 s43, s43, 3
    s_add_u32 s43, s43, s34
    v_lshlrev_b32 v2, 4, v0
    s_add_u32 s40, s43, 0
    s_mov_b32 s41, s40
    s_mov_b64 s[12:13], s[74:75]
    s_mov_b32 s14, 0x400000
    s_sub_u32 s42, s40, 512
    s_cmp_ge_u32 s40, 512
    s_cselect_b32 s41, s42, s41
    s_cselect_b64 s[12:13], s[76:77], s[12:13]
    s_cselect_b32 s14, 0x600000, s14
    s_sub_u32 s42, s40, 1280
    s_cmp_ge_u32 s40, 1280
    s_cselect_b32 s41, s42, s41
    s_cselect_b64 s[12:13], s[78:79], s[12:13]
    s_cselect_b32 s14, 0x200000, s14
    s_and_b32 s13, s13, 0xffff
    s_lshl_b32 s41, s41, 13
    s_add_u32 s42, s41, 4096
    buffer_load_dwordx4 v[104:107], v2, s[12:15], s41 offen offset:0
    buffer_load_dwordx4 v[108:111], v2, s[12:15], s41 offen offset:1024
    buffer_load_dwordx4 v[112:115], v2, s[12:15], s41 offen offset:2048
    buffer_load_dwordx4 v[116:119], v2, s[12:15], s41 offen offset:3072
    buffer_load_dwordx4 v[120:123], v2, s[12:15], s42 offen offset:0
    buffer_load_dwordx4 v[124:127], v2, s[12:15], s42 offen offset:1024
    buffer_load_dwordx4 v[128:131], v2, s[12:15], s42 offen offset:2048
    buffer_load_dwordx4 v[132:135], v2, s[12:15], s42 offen offset:3072
    s_waitcnt vmcnt(8)
    s_barrier
    s_cmp_lg_u32 s34, 0
    s_cbranch_scc1 SG_wj
    s_cmp_eq_u32 s38, 0
    s_cbranch_scc1 SG_wj
    s_and_b32 s40, s38, 1
    s_add_u32 s40, s40, 1
    v_mov_b32 v1, s40
    s_and_b32 s40, s38, -2
    s_mov_b64 exec, 1
    buffer_atomic_add v1, off, s[8:11], s40
    s_mov_b64 exec, -1
SG_wj:
    s_add_u32 s40, s43, 512
    s_mov_b32 s41, s40
    s_mov_b64 s[12:13], s[74:75]
    s_mov_b32 s14, 0x400000
    s_sub_u32 s42, s40, 512
    s_cmp_ge_u32 s40, 512
    s_cselect_b32 s41, s42, s41
    s_cselect_b64 s[12:13], s[76:77], s[12:13]
    s_cselect_b32 s14, 0x600000, s14
    s_sub_u32 s42, s40, 1280
    s_cmp_ge_u32 s40, 1280
    s_cselect_b32 s41, s42, s41
    s_cselect_b64 s[12:13], s[78:79], s[12:13]
    s_cselect_b32 s14, 0x200000, s14
    s_and_b32 s13, s13, 0xffff
    s_lshl_b32 s41, s41, 13
    s_add_u32 s42, s41, 4096
    buffer_load_dwordx4 v[104:107], v2, s[12:15], s41 offen offset:0
    buffer_load_dwordx4 v[108:111], v2, s[12:15], s41 offen offset:1024
    buffer_load_dwordx4 v[112:115], v2, s[12:15], s41 offen offset:2048
    buffer_load_dwordx4 v[116:119], v2, s[12:15], s41 offen offset:3072
    buffer_load_dwordx4 v[120:123], v2, s[12:15], s42 offen offset:0
    buffer_load_dwordx4 v[124:127], v2, s[12:15], s42 offen offset:1024
    buffer_load_dwordx4 v[128:131], v2, s[12:15], s42 offen offset:2048
    buffer_load_dwordx4 v[132:135], v2, s[12:15], s42 offen offset:3072
    s_add_u32 s40, s43, 1024
    s_mov_b32 s41, s40
    s_mov_b64 s[12:13], s[74:75]
    s_mov_b32 s14, 0x400000
    s_sub_u32 s42, s40, 512
    s_cmp_ge_u32 s40, 512
    s_cselect_b32 s41, s42, s41
    s_cselect_b64 s[12:13], s[76:77], s[12:13]
    s_cselect_b32 s14, 0x600000, s14
    s_sub_u32 s42, s40, 1280
    s_cmp_ge_u32 s40, 1280
    s_cselect_b32 s41, s42, s41
    s_cselect_b64 s[12:13], s[78:79], s[12:13]
    s_cselect_b32 s14, 0x200000, s14
    s_and_b32 s13, s13, 0xffff
    s_lshl_b32 s41, s41, 13
    s_add_u32 s42, s41, 4096
    buffer_load_dwordx4 v[104:107], v2, s[12:15], s41 offen offset:0
    buffer_load_dwordx4 v[108:111], v2, s[12:15], s41 offen offset:1024
    buffer_load_dwordx4 v[112:115], v2, s[12:15], s41 offen offset:2048
    buffer_load_dwordx4 v[116:119], v2, s[12:15], s41 offen offset:3072
    buffer_load_dwordx4 v[120:123], v2, s[12:15], s42 offen offset:0
    buffer_load_dwordx4 v[124:127], v2, s[12:15], s42 offen offset:1024
    buffer_load_dwordx4 v[128:131], v2, s[12:15], s42 offen offset:2048
    buffer_load_dwordx4 v[132:135], v2, s[12:15], s42 offen offset:3072
    s_mov_b32 s38, 0
    s_mov_b32 s39, 0
    s_branch B_DECODE
B_NWJ:
    s_cmp_eq_u32 s38, 0
    s_cbranch_scc1 B_NOFL
    s_cmp_lg_u32 s86, 2
    s_cbranch_scc1 B_FL1
    s_sub_u32 s40, s38, 98567168
    s_cmp_ge_u32 s40, 1024
    s_cbranch_scc1 B_NOFL
    s_branch B_FLUSH
B_FL1:
    s_cmp_eq_u32 s86, 3
    s_cbranch_scc1 B_FLUSH
    s_cmp_eq_u32 s101, 0
    s_cbranch_scc1 B_NOFL
B_FLUSH:
    s_waitcnt vmcnt(0)
    s_barrier
    s_cmp_lg_u32 s34, 0
    s_cbranch_scc1 SG_fl
    s_cmp_eq_u32 s38, 0
    s_cbranch_scc1 SG_fl
    s_and_b32 s40, s38, 1
    s_add_u32 s40, s40, 1
    v_mov_b32 v1, s40
    s_and_b32 s40, s38, -2
    s_mov_b64 exec, 1
    buffer_atomic_add v1, off, s[8:11], s40
    s_mov_b64 exec, -1
SG_fl:
    s_mov_b32 s38, 0
B_NOFL:
    s_cmp_eq_u32 s86, 3
    s_cbranch_scc1 A3_ENTRY
    s_cmp_eq_u32 s101, 0
    s_cbranch_scc1 B_WOK
    s_cmp_lg_u32 s34, 0
    s_cbranch_scc1 B_WOK
    s_waitcnt lgkmcnt(0)
    s_bitcmp1_b32 s4, 0
    s_cselect_b32 s40, -1, s73
    s_cmp_eq_u32 s40, s55
    s_cbranch_scc1 B_WOK
    s_mov_b32 s44, 0
B_WPOLL:
    v_and_b32 v2, 7, v0
    v_lshlrev_b32 v2, 7, v2
    s_cmp_eq_u32 s4, 3
    s_cselect_b32 s40, -1, 0
    s_cmp_eq_u32 s4, 5
    s_cselect_b32 s40, 0x180, s40
    v_and_b32 v2, s40, v2
    buffer_load_dword v1, v2, s[8:11], s101 offen sc1
    s_add_u32 s44, s44, 1
    s_cmp_gt_u32 s44, 60000
    s_cbranch_scc1 C_DONE
    s_waitcnt vmcnt(0)
    v_cmp_ne_u32 vcc, s55, v1
    s_cbranch_vccz B_WOK
    s_sleep 8
    s_branch B_WPOLL
B_WOK:
    s_barrier
    s_cmp_lg_u32 s86, 2
    s_cbranch_scc1 B_CG
    s_mov_b32 s3, s57
    s_mov_b32 s7, s58
    s_mov_b32 s37, s100
    s_mov_b32 s44, 0
B2_START:
    v_lshlrev_b32 v2, 4, v0
    s_lshl_b32 s50, s3, 17
    s_lshl_b32 s49, s34, 11
    s_add_u32 s50, s50, s49
    s_add_u32 s51, s50, 83886080
    s_add_u32 s50, s50, 79691776
    s_mov_b32 s47, 0
    s_lshl_b32 s40, s7, 14
    s_add_u32 s40, s40, s49
    s_lshl_b32 s41, s3, 17
    s_add_u32 s40, s40, s41
    s_add_u32 s40, s40, 75497472
    s_cmp_eq_u32 s29, 1
    s_cbranch_scc1 B2_PRE
    buffer_load_dwordx4 v[196:199], v2, s[8:11], s40 offen sc1
    buffer_load_dwordx4 v[200:203], v2, s[8:11], s40 offen offset:1024 sc1
    s_add_u32 m0, s49, s47
    s_nop 0
    buffer_load_dwordx4 v2, s[8:11], s50 offen offset:0 sc1 lds
    buffer_load_dwordx4 v2, s[8:11], s50 offen offset:1024 sc1 lds
    s_add_u32 m0, m0, 0x4000
    s_nop 0
    buffer_load_dwordx4 v2, s[8:11], s51 offen offset:0 sc1 lds
    buffer_load_dwordx4 v2, s[8:11], s51 offen offset:1024 sc1 lds
    s_add_u32 s50, s50, 0x4000
    s_add_u32 s51, s51, 0x4000
    s_add_u32 s47, s47, 32768
    s_and_b32 s47, s47, 0x1ffff
    s_add_u32 m0, s49, s47
    s_nop 0
    buffer_load_dwordx4 v2, s[8:11], s50 offen offset:0 sc1 lds
    buffer_load_dwordx4 v2, s[8:11], s50 offen offset:1024 sc1 lds
    s_add_u32 m0, m0, 0x4000
    s_nop 0
    buffer_load_dwordx4 v2, s[8:11], s51 offen offset:0 sc1 lds
    buffer_load_dwordx4 v2, s[8:11], s51 offen offset:1024 sc1 lds
    s_add_u32 s50, s50, 0x4000
    s_add_u32 s51, s51, 0x4000
    s_add_u32 s47, s47, 32768
    s_and_b32 s47, s47, 0x1ffff
    s_add_u32 m0, s49, s47
    s_nop 0
    buffer_load_dwordx4 v2, s[8:11], s50 offen offset:0 sc1 lds
    buffer_load_dwordx4 v2, s[8:11], s50 offen offset:1024 sc1 lds
    s_add_u32 m0, m0, 0x4000
    s_nop 0
    buffer_load_dwordx4 v2, s[8:11], s51 offen offset:0 sc1 lds
    buffer_load_dwordx4 v2, s[8:11], s51 offen offset:1024 sc1 lds
    s_add_u32 s50, s50, 0x4000
    s_add_u32 s51, s51, 0x4000
    s_add_u32 s47, s47, 32768
    s_and_b32 s47, s47, 0x1ffff
    s_branch B2_REQ
B2_PRE:
    s_add_u32 s50, s50, 0xc000
    s_add_u32 s51, s51, 0xc000
    s_mov_b32 s47, 0x18000
B2_REQ:
    s_mov_b32 s29, 0
    s_cmp_eq_u32 s44, 1
    s_cbranch_scc1 B2_NOMID
    s_mov_b32 s39, 2
    s_branch B_DECODE
B_B2:
B2_NOMID:
    v_and_b32 v94, 31, v0
    v_lshrrev_b32 v95, 5, v0
    v_lshlrev_b32 v13, 11, v94
    v_lshl_add_u32 v13, v95, 4, v13
    v_and_b32 v14, 0x13, v94
    v_bfe_u32 v15, v94, 2, 1
    v_lshl_or_b32 v14, v15, 3, v14
    v_bfe_u32 v15, v94, 3, 1
    v_lshl_or_b32 v14, v15, 2, v14
    v_lshlrev_b32 v14, 4, v14
    v_lshl_add_u32 v4, v95, 9, v14
    v_mov_b32 v24, 0
    v_mov_b32 v25, 0
    v_mov_b32 v26, 0
    v_mov_b32 v27, 0
    v_mov_b32 v28, 0
    v_mov_b32 v29, 0
    v_mov_b32 v30, 0
    v_mov_b32 v31, 0
    v_mov_b32 v32, 0
    v_mov_b32 v33, 0
    v_mov_b32 v34, 0
    v_mov_b32 v35, 0
    v_mov_b32 v36, 0
    v_mov_b32 v37, 0
    v_mov_b32 v38, 0
    v_mov_b32 v39, 0
    v_mov_b32 v176, 0
    v_mov_b32 v177, 0
    v_mov_b32 v178, 0
    v_mov_b32 v179, 0
    v_lshrrev_b32 v14, 2, v0
    v_lshrrev_b32 v15, 4, v0
    v_xor_b32 v14, v14, v15
    v_and_b32 v14, 1, v14
    v_cmp_eq_u32 vcc, 0, v14
    v_mov_b32 v15, 0x3f803f80
    s_nop 0
    v_cndmask_b32 v192, 0, v15, vcc
    v_cndmask_b32 v193, 0, v15, vcc
    v_cndmask_b32 v194, 0, v15, vcc
    v_cndmask_b32 v195, 0, v15, vcc
    v_mov_b32 v88, 0xff800000
    s_mov_b32 s48, 0
    s_mov_b32 s46, 0
    v_mov_b32 v8, v4
    v_mov_b32 v10, v2
    s_waitcnt vmcnt(8)
    s_barrier
    ds_read_b128 v[40:43], v8 offset:0
    ds_read_b128 v[44:47], v8 offset:1024
    ds_read_b128 v[48:51], v8 offset:2048
    ds_read_b128 v[52:55], v8 offset:3072
    v_mov_b32 v16, v196
    v_mov_b32 v17, v197
    v_mov_b32 v18, v198
    v_mov_b32 v19, v199
    v_mov_b32 v20, v200
    v_mov_b32 v21, v201
    v_mov_b32 v22, v202
    v_mov_b32 v23, v203
    s_waitcnt lgkmcnt(0)
    s_cmp_eq_u32 s44, 1
    s_cbranch_scc1 B2_XL
    v_mfma_f32_32x32x16_bf16 v[96:111], v[40:43], v[16:19], 0
    v_mfma_f32_32x32x16_bf16 v[112:127], v[48:51], v[16:19], 0
    v_mfma_f32_32x32x16_bf16 v[96:111], v[44:47], v[20:23], v[96:111]
    v_mfma_f32_32x32x16_bf16 v[112:127], v[52:55], v[20:23], v[112:127]
    s_nop 10
    v_max3_f32 v92, v96, v96, v97
    v_max3_f32 v92, v92, v98, v99
    v_max3_f32 v92, v92, v100, v101
    v_max3_f32 v92, v92, v102, v103
    v_max3_f32 v92, v92, v104, v105
    v_max3_f32 v92, v92, v106, v107
    v_max3_f32 v92, v92, v108, v109
    v_max3_f32 v92, v92, v110, v111
    v_max3_f32 v92, v92, v112, v113
    v_max3_f32 v92, v92, v114, v115
    v_max3_f32 v92, v92, v116, v117
    v_max3_f32 v92, v92, v118, v119
    v_max3_f32 v92, v92, v120, v121
    v_max3_f32 v92, v92, v122, v123
    v_max3_f32 v92, v92, v124, v125
    v_max3_f32 v92, v92, v126, v127
    v_mov_b32 v94, v92
    s_nop 1
    v_permlane32_swap_b32 v92, v94
    v_max_f32 v92, v92, v94
    v_sub_f32 v160, 0, v92
    v_sub_f32 v161, 0, v92
    v_sub_f32 v162, 0, v92
    v_sub_f32 v163, 0, v92
    v_sub_f32 v164, 0, v92
    v_sub_f32 v165, 0, v92
    v_sub_f32 v166, 0, v92
    v_sub_f32 v167, 0, v92
    v_sub_f32 v168, 0, v92
    v_sub_f32 v169, 0, v92
    v_sub_f32 v170, 0, v92
    v_sub_f32 v171, 0, v92
    v_sub_f32 v172, 0, v92
    v_sub_f32 v173, 0, v92
    v_sub_f32 v174, 0, v92
    v_sub_f32 v175, 0, v92
    v_mov_b32 v84, 0
    v_mov_b32 v85, 0
    v_mov_b32 v86, 0
    v_mov_b32 v87, 0
    ds_read_b128 v[68:71], v10 offset:19456
    v_mfma_f32_32x32x16_bf16 v[96:111], v[40:43], v[16:19], v[160:175]
    v_mfma_f32_32x32x16_bf16 v[112:127], v[48:51], v[16:19], v[160:175]
    v_mfma_f32_32x32x16_bf16 v[96:111], v[44:47], v[20:23], v[96:111]
    v_mfma_f32_32x32x16_bf16 v[112:127], v[52:55], v[20:23], v[112:127]
    s_waitcnt lgkmcnt(0)
B2_CH:
    s_nop 9
    v_exp_f32 v96, v96
    ds_read_b128 v[40:43], v8 offset:4096
    ds_read_b128 v[44:47], v8 offset:5120
    v_exp_f32 v97, v97
    v_mfma_f32_32x32x16_bf16 v[24:39], v[68:71], v[84:87], v[24:39]
    v_exp_f32 v98, v98
    ds_read_b128 v[48:51], v8 offset:6144
    ds_read_b128 v[52:55], v8 offset:7168
    v_exp_f32 v99, v99
    ds_read_b128 v[56:59], v10 offset:16384
    ds_read_b128 v[60:63], v10 offset:17408
    v_exp_f32 v100, v100
    v_mfma_f32_16x16x32_bf16 v[176:179], v[192:195], v[84:87], v[176:179]
    v_exp_f32 v101, v101
    ds_read_b128 v[64:67], v10 offset:18432
    ds_read_b128 v[68:71], v10 offset:19456
    v_exp_f32 v102, v102
    v_exp_f32 v103, v103
    s_waitcnt lgkmcnt(4)
    v_mfma_f32_32x32x16_bf16 v[128:143], v[40:43], v[16:19], v[160:175]
    v_cvt_pk_bf16_f32 v72, v96, v97
    v_cvt_pk_bf16_f32 v73, v98, v99
    v_cvt_pk_bf16_f32 v74, v100, v101
    v_cvt_pk_bf16_f32 v75, v102, v103
    v_exp_f32 v104, v104
    v_exp_f32 v105, v105
    s_waitcnt lgkmcnt(0)
    v_mfma_f32_32x32x16_bf16 v[24:39], v[56:59], v[72:75], v[24:39]
    v_exp_f32 v106, v106
    v_exp_f32 v107, v107
    v_exp_f32 v108, v108
    v_mfma_f32_16x16x32_bf16 v[176:179], v[192:195], v[72:75], v[176:179]
    v_exp_f32 v109, v109
    v_exp_f32 v110, v110
    v_exp_f32 v111, v111
    v_mfma_f32_32x32x16_bf16 v[144:159], v[48:51], v[16:19], v[160:175]
    v_cvt_pk_bf16_f32 v76, v104, v105
    v_cvt_pk_bf16_f32 v77, v106, v107
    v_cvt_pk_bf16_f32 v78, v108, v109
    v_cvt_pk_bf16_f32 v79, v110, v111
    v_exp_f32 v112, v112
    v_exp_f32 v113, v113
    v_mfma_f32_32x32x16_bf16 v[24:39], v[60:63], v[76:79], v[24:39]
    v_exp_f32 v114, v114
    v_exp_f32 v115, v115
    v_exp_f32 v116, v116
    v_mfma_f32_16x16x32_bf16 v[176:179], v[192:195], v[76:79], v[176:179]
    v_exp_f32 v117, v117
    v_exp_f32 v118, v118
    v_exp_f32 v119, v119
    v_mfma_f32_32x32x16_bf16 v[128:143], v[44:47], v[20:23], v[128:143]
    v_cvt_pk_bf16_f32 v80, v112, v113
    v_cvt_pk_bf16_f32 v81, v114, v115
    v_cvt_pk_bf16_f32 v82, v116, v117
    v_cvt_pk_bf16_f32 v83, v118, v119
    v_exp_f32 v120, v120
    v_exp_f32 v121, v121
    v_mfma_f32_32x32x16_bf16 v[24:39], v[64:67], v[80:83], v[24:39]
    v_exp_f32 v122, v122
    v_exp_f32 v123, v123
    v_exp_f32 v124, v124
    v_mfma_f32_16x16x32_bf16 v[176:179], v[192:195], v[80:83], v[176:179]
    v_exp_f32 v125, v125
    v_exp_f32 v126, v126
    v_exp_f32 v127, v127
    v_mfma_f32_32x32x16_bf16 v[144:159], v[52:55], v[20:23], v[144:159]
    v_cvt_pk_bf16_f32 v84, v120, v121
    v_cvt_pk_bf16_f32 v85, v122, v123
    v_cvt_pk_bf16_f32 v86, v124, v125
    v_cvt_pk_bf16_f32 v87, v126, v127
    v_exp_f32 v128, v128
    ds_read_b128 v[40:43], v8 offset:8192
    ds_read_b128 v[44:47], v8 offset:9216
    v_exp_f32 v129, v129
    v_mfma_f32_32x32x16_bf16 v[24:39], v[68:71], v[84:87], v[24:39]
    v_exp_f32 v130, v130
    ds_read_b128 v[48:51], v8 offset:10240
    ds_read_b128 v[52:55], v8 offset:11264
    v_exp_f32 v131, v131
    ds_read_b128 v[56:59], v10 offset:20480
    ds_read_b128 v[60:63], v10 offset:21504
    v_exp_f32 v132, v132
    v_mfma_f32_16x16x32_bf16 v[176:179], v[192:195], v[84:87], v[176:179]
    v_exp_f32 v133, v133
    ds_read_b128 v[64:67], v10 offset:22528
    ds_read_b128 v[68:71], v10 offset:23552
    v_exp_f32 v134, v134
    v_exp_f32 v135, v135
    s_waitcnt lgkmcnt(4)
    v_mfma_f32_32x32x16_bf16 v[96:111], v[40:43], v[16:19], v[160:175]
    v_cvt_pk_bf16_f32 v72, v128, v129
    v_cvt_pk_bf16_f32 v73, v130, v131
    v_cvt_pk_bf16_f32 v74, v132, v133
    v_cvt_pk_bf16_f32 v75, v134, v135
    v_exp_f32 v136, v136
    v_exp_f32 v137, v137
    s_waitcnt lgkmcnt(0)
    v_mfma_f32_32x32x16_bf16 v[24:39], v[56:59], v[72:75], v[24:39]
    v_exp_f32 v138, v138
    v_exp_f32 v139, v139
    v_exp_f32 v140, v140
    v_mfma_f32_16x16x32_bf16 v[176:179], v[192:195], v[72:75], v[176:179]
    v_exp_f32 v141, v141
    v_exp_f32 v142, v142
    v_exp_f32 v143, v143
    v_mfma_f32_32x32x16_bf16 v[112:127], v[48:51], v[16:19], v[160:175]
    v_cvt_pk_bf16_f32 v76, v136, v137
    v_cvt_pk_bf16_f32 v77, v138, v139
    v_cvt_pk_bf16_f32 v78, v140, v141
    v_cvt_pk_bf16_f32 v79, v142, v143
    v_exp_f32 v144, v144
    v_exp_f32 v145, v145
    v_mfma_f32_32x32x16_bf16 v[24:39], v[60:63], v[76:79], v[24:39]
    v_exp_f32 v146, v146
    v_exp_f32 v147, v147
    v_exp_f32 v148, v148
    v_mfma_f32_16x16x32_bf16 v[176:179], v[192:195], v[76:79], v[176:179]
    v_exp_f32 v149, v149
    v_exp_f32 v150, v150
    v_exp_f32 v151, v151
    v_mfma_f32_32x32x16_bf16 v[96:111], v[44:47], v[20:23], v[96:111]
    v_cvt_pk_bf16_f32 v80, v144, v145
    v_cvt_pk_bf16_f32 v81, v146, v147
    v_cvt_pk_bf16_f32 v82, v148, v149
    v_cvt_pk_bf16_f32 v83, v150, v151
    v_exp_f32 v152, v152
    v_exp_f32 v153, v153
    v_mfma_f32_32x32x16_bf16 v[24:39], v[64:67], v[80:83], v[24:39]
    v_exp_f32 v154, v154
    v_exp_f32 v155, v155
    v_exp_f32 v156, v156
    v_mfma_f32_16x16x32_bf16 v[176:179], v[192:195], v[80:83], v[176:179]
    v_exp_f32 v157, v157
    v_exp_f32 v158, v158
    v_exp_f32 v159, v159
    v_mfma_f32_32x32x16_bf16 v[112:127], v[52:55], v[20:23], v[112:127]
    v_cvt_pk_bf16_f32 v84, v152, v153
    v_cvt_pk_bf16_f32 v85, v154, v155
    v_cvt_pk_bf16_f32 v86, v156, v157
    v_cvt_pk_bf16_f32 v87, v158, v159
    v_exp_f32 v96, v96
    ds_read_b128 v[40:43], v8 offset:12288
    ds_read_b128 v[44:47], v8 offset:13312
    v_exp_f32 v97, v97
    v_mfma_f32_32x32x16_bf16 v[24:39], v[68:71], v[84:87], v[24:39]
    v_exp_f32 v98, v98
    ds_read_b128 v[48:51], v8 offset:14336
    ds_read_b128 v[52:55], v8 offset:15360
    v_exp_f32 v99, v99
    ds_read_b128 v[56:59], v10 offset:24576
    ds_read_b128 v[60:63], v10 offset:25600
    v_exp_f32 v100, v100
    v_mfma_f32_16x16x32_bf16 v[176:179], v[192:195], v[84:87], v[176:179]
    v_exp_f32 v101, v101
    ds_read_b128 v[64:67], v10 offset:26624
    ds_read_b128 v[68:71], v10 offset:27648
    v_exp_f32 v102, v102
    v_exp_f32 v103, v103
    s_waitcnt lgkmcnt(4)
    v_mfma_f32_32x32x16_bf16 v[128:143], v[40:43], v[16:19], v[160:175]
    v_cvt_pk_bf16_f32 v72, v96, v97
    v_cvt_pk_bf16_f32 v73, v98, v99
    v_cvt_pk_bf16_f32 v74, v100, v101
    v_cvt_pk_bf16_f32 v75, v102, v103
    v_exp_f32 v104, v104
    v_exp_f32 v105, v105
    s_waitcnt lgkmcnt(0)
    v_mfma_f32_32x32x16_bf16 v[24:39], v[56:59], v[72:75], v[24:39]
    v_exp_f32 v106, v106
    v_exp_f32 v107, v107
    v_exp_f32 v108, v108
    v_mfma_f32_16x16x32_bf16 v[176:179], v[192:195], v[72:75], v[176:179]
    v_exp_f32 v109, v109
    v_exp_f32 v110, v110
    v_exp_f32 v111, v111
    v_mfma_f32_32x32x16_bf16 v[144:159], v[48:51], v[16:19], v[160:175]
    v_cvt_pk_bf16_f32 v76, v104, v105
    v_cvt_pk_bf16_f32 v77, v106, v107
    v_cvt_pk_bf16_f32 v78, v108, v109
    v_cvt_pk_bf16_f32 v79, v110, v111
    v_exp_f32 v112, v112
    v_exp_f32 v113, v113
    v_mfma_f32_32x32x16_bf16 v[24:39], v[60:63], v[76:79], v[24:39]
    v_exp_f32 v114, v114
    v_exp_f32 v115, v115
    v_exp_f32 v116, v116
    v_mfma_f32_16x16x32_bf16 v[176:179], v[192:195], v[76:79], v[176:179]
    v_exp_f32 v117, v117
    v_exp_f32 v118, v118
    v_exp_f32 v119, v119
    v_mfma_f32_32x32x16_bf16 v[128:143], v[44:47], v[20:23], v[128:143]
    v_cvt_pk_bf16_f32 v80, v112, v113
    v_cvt_pk_bf16_f32 v81, v114, v115
    v_cvt_pk_bf16_f32 v82, v116, v117
    v_cvt_pk_bf16_f32 v83, v118, v119
    v_exp_f32 v120, v120
    v_exp_f32 v121, v121
    v_mfma_f32_32x32x16_bf16 v[24:39], v[64:67], v[80:83], v[24:39]
    v_exp_f32 v122, v122
    v_exp_f32 v123, v123
    v_exp_f32 v124, v124
    v_mfma_f32_16x16x32_bf16 v[176:179], v[192:195], v[80:83], v[176:179]
    v_exp_f32 v125, v125
    v_exp_f32 v126, v126
    v_exp_f32 v127, v127
    v_mfma_f32_32x32x16_bf16 v[144:159], v[52:55], v[20:23], v[144:159]
    v_cvt_pk_bf16_f32 v84, v120, v121
    v_cvt_pk_bf16_f32 v85, v122, v123
    v_cvt_pk_bf16_f32 v86, v124, v125
    v_cvt_pk_bf16_f32 v87, v126, v127
    s_cmp_lt_u32 s46, 6
    s_cbranch_scc1 B2_Wf
    s_cmp_eq_u32 s29, 1
    s_cbranch_scc1 B2_Wf
    s_waitcnt vmcnt(0)
B2_Wf:
    s_waitcnt vmcnt(4)
    s_barrier
    s_cmp_lg_u32 s46, 1
    s_cbranch_scc1 B2_NSG
    s_cmp_lg_u32 s34, 0
    s_cbranch_scc1 SG_b2f
    s_cmp_eq_u32 s38, 0
    s_cbranch_scc1 SG_b2f
    s_and_b32 s40, s38, 1
    s_add_u32 s40, s40, 1
    v_mov_b32 v1, s40
    s_and_b32 s40, s38, -2
    s_mov_b64 exec, 1
    buffer_atomic_add v1, off, s[8:11], s40
    s_mov_b64 exec, -1
SG_b2f:
    s_mov_b32 s38, 0
B2_NSG:
    s_add_u32 s48, s48, 32768
    s_and_b32 s48, s48, 0x1ffff
    v_add_u32 v8, s48, v4
    s_cmp_lt_u32 s46, 5
    s_cbranch_scc1 B2_Df
    s_cmp_lg_u32 s46, 5
    s_cbranch_scc1 B2_Pf
    s_cmp_eq_u32 s55, 48
    s_cselect_b32 s29, 1, 0
    s_cmp_lg_u32 s29, 1
    s_cbranch_scc1 B2_Nf
    s_lshl_b32 s50, s57, 17
    s_add_u32 s50, s50, s49
    s_lshl_b32 s40, s58, 14
    s_add_u32 s40, s40, s50
    s_add_u32 s40, s40, 75497472
    s_add_u32 s51, s50, 83886080
    s_add_u32 s50, s50, 79691776
    buffer_load_dwordx4 v[196:199], v2, s[8:11], s40 offen sc1
    buffer_load_dwordx4 v[200:203], v2, s[8:11], s40 offen offset:1024 sc1
B2_Pf:
    s_cmp_lg_u32 s29, 1
    s_cbranch_scc1 B2_Nf
B2_Df:
    s_add_u32 m0, s49, s47
    s_nop 0
    buffer_load_dwordx4 v2, s[8:11], s50 offen offset:0 sc1 lds
    buffer_load_dwordx4 v2, s[8:11], s50 offen offset:1024 sc1 lds
    s_add_u32 m0, m0, 0x4000
    s_nop 0
    buffer_load_dwordx4 v2, s[8:11], s51 offen offset:0 sc1 lds
    buffer_load_dwordx4 v2, s[8:11], s51 offen offset:1024 sc1 lds
    s_add_u32 s50, s50, 0x4000
    s_add_u32 s51, s51, 0x4000
    s_add_u32 s47, s47, 32768
    s_and_b32 s47, s47, 0x1ffff
B2_Nf:
    v_exp_f32 v128, v128
    ds_read_b128 v[40:43], v8 offset:0
    ds_read_b128 v[44:47], v8 offset:1024
    v_exp_f32 v129, v129
    v_mfma_f32_32x32x16_bf16 v[24:39], v[68:71], v[84:87], v[24:39]
    v_exp_f32 v130, v130
    ds_read_b128 v[48:51], v8 offset:2048
    ds_read_b128 v[52:55], v8 offset:3072
    v_exp_f32 v131, v131
    ds_read_b128 v[56:59], v10 offset:28672
    ds_read_b128 v[60:63], v10 offset:29696
    v_exp_f32 v132, v132
    v_mfma_f32_16x16x32_bf16 v[176:179], v[192:195], v[84:87], v[176:179]
    v_exp_f32 v133, v133
    ds_read_b128 v[64:67], v10 offset:30720
    ds_read_b128 v[68:71], v10 offset:31744
    v_exp_f32 v134, v134
    v_exp_f32 v135, v135
    s_waitcnt lgkmcnt(4)
    v_mfma_f32_32x32x16_bf16 v[96:111], v[40:43], v[16:19], v[160:175]
    v_cvt_pk_bf16_f32 v72, v128, v129
    v_cvt_pk_bf16_f32 v73, v130, v131
    v_cvt_pk_bf16_f32 v74, v132, v133
    v_cvt_pk_bf16_f32 v75, v134, v135
    v_exp_f32 v136, v136
    v_exp_f32 v137, v137
    s_waitcnt lgkmcnt(0)
    v_mfma_f32_32x32x16_bf16 v[24:39], v[56:59], v[72:75], v[24:39]
    v_exp_f32 v138, v138
    v_exp_f32 v139, v139
    v_exp_f32 v140, v140
    v_mfma_f32_16x16x32_bf16 v[176:179], v[192:195], v[72:75], v[176:179]
    v_exp_f32 v141, v141
    v_exp_f32 v142, v142
    v_exp_f32 v143, v143
    v_mfma_f32_32x32x16_bf16 v[112:127], v[48:51], v[16:19], v[160:175]
    v_cvt_pk_bf16_f32 v76, v136, v137
    v_cvt_pk_bf16_f32 v77, v138, v139
    v_cvt_pk_bf16_f32 v78, v140, v141
    v_cvt_pk_bf16_f32 v79, v142, v143
    v_exp_f32 v144, v144
    v_exp_f32 v145, v145
    v_mfma_f32_32x32x16_bf16 v[24:39], v[60:63], v[76:79], v[24:39]
    v_exp_f32 v146, v146
    v_exp_f32 v147, v147
    v_exp_f32 v148, v148
    v_mfma_f32_16x16x32_bf16 v[176:179], v[192:195], v[76:79], v[176:179]
    v_exp_f32 v149, v149
    v_exp_f32 v150, v150
    v_exp_f32 v151, v151
    v_mfma_f32_32x32x16_bf16 v[96:111], v[44:47], v[20:23], v[96:111]
    v_cvt_pk_bf16_f32 v80, v144, v145
    v_cvt_pk_bf16_f32 v81, v146, v147
    v_cvt_pk_bf16_f32 v82, v148, v149
    v_cvt_pk_bf16_f32 v83, v150, v151
    v_exp_f32 v152, v152
    v_exp_f32 v153, v153
    v_mfma_f32_32x32x16_bf16 v[24:39], v[64:67], v[80:83], v[24:39]
    v_exp_f32 v154, v154
    v_exp_f32 v155, v155
    v_exp_f32 v156, v156
    v_mfma_f32_16x16x32_bf16 v[176:179], v[192:195], v[80:83], v[176:179]
    v_exp_f32 v157, v157
    v_exp_f32 v158, v158
    v_exp_f32 v159, v159
    v_mfma_f32_32x32x16_bf16 v[112:127], v[52:55], v[20:23], v[112:127]
    v_cvt_pk_bf16_f32 v84, v152, v153
    v_cvt_pk_bf16_f32 v85, v154, v155
    v_cvt_pk_bf16_f32 v86, v156, v157
    v_cvt_pk_bf16_f32 v87, v158, v159
    v_add_u32 v10, s48, v2
    s_add_u32 s46, s46, 1
    s_cmp_lt_u32 s46, 8
    s_cbranch_scc1 B2_CH
    v_mfma_f32_32x32x16_bf16 v[24:39], v[68:71], v[84:87], v[24:39]
    v_mfma_f32_16x16x32_bf16 v[176:179], v[192:195], v[84:87], v[176:179]
    v_mov_b32 v94, 0x4e800000
    s_nop 6
    v_cmp_nlt_f32 vcc, v176, v94
    s_cmp_lg_u64 vcc, 0
    s_cselect_b32 s40, 1, 0
    s_lshl_b32 s41, s34, 2
    s_add_u32 s41, s41, 147488
    v_mov_b32 v94, s41
    v_mov_b32 v95, s40
    ds_write_b32 v94, v95
    s_waitcnt lgkmcnt(0)
    s_barrier
    v_and_b32 v94, 7, v0
    v_lshlrev_b32 v94, 2, v94
    v_add_u32 v94, 147488, v94
    ds_read_b32 v95, v94
    s_waitcnt lgkmcnt(0)
    v_cmp_ne_u32 vcc, 0, v95
    s_cbranch_vccz B2_FIN
    s_waitcnt vmcnt(0)
    s_barrier
    s_mov_b32 s29, 0
    s_mov_b32 s44, 1
    s_branch B2_START
B2_XL:
    v_mfma_f32_32x32x16_bf16 v[96:111], v[40:43], v[16:19], 0
    v_mfma_f32_32x32x16_bf16 v[112:127], v[48:51], v[16:19], 0
    v_mfma_f32_32x32x16_bf16 v[96:111], v[44:47], v[20:23], v[96:111]
    v_mfma_f32_32x32x16_bf16 v[112:127], v[52:55], v[20:23], v[112:127]
    ds_read_b128 v[56:59], v10 offset:16384
    ds_read_b128 v[60:63], v10 offset:17408
    ds_read_b128 v[64:67], v10 offset:18432
    ds_read_b128 v[68:71], v10 offset:19456
    s_nop 6
    v_max3_f32 v92, v88, v96, v97
    v_max3_f32 v92, v92, v98, v99
    v_max3_f32 v92, v92, v100, v101
    v_max3_f32 v92, v92, v102, v103
    v_max3_f32 v92, v92, v104, v105
    v_max3_f32 v92, v92, v106, v107
    v_max3_f32 v92, v92, v108, v109
    v_max3_f32 v92, v92, v110, v111
    v_max3_f32 v92, v92, v112, v113
    v_max3_f32 v92, v92, v114, v115
    v_max3_f32 v92, v92, v116, v117
    v_max3_f32 v92, v92, v118, v119
    v_max3_f32 v92, v92, v120, v121
    v_max3_f32 v92, v92, v122, v123
    v_max3_f32 v92, v92, v124, v125
    v_max3_f32 v92, v92, v126, v127
    v_mov_b32 v94, v92
    s_nop 1
    v_permlane32_swap_b32 v92, v94
    v_max_f32 v92, v92, v94
    v_sub_f32 v94, v88, v92
    v_exp_f32 v94, v94
    v_mov_b32 v88, v92
    v_mul_f32 v24, v24, v94
    v_mul_f32 v25, v25, v94
    v_mul_f32 v26, v26, v94
    v_mul_f32 v27, v27, v94
    v_mul_f32 v28, v28, v94
    v_mul_f32 v29, v29, v94
    v_mul_f32 v30, v30, v94
    v_mul_f32 v31, v31, v94
    v_mul_f32 v32, v32, v94
    v_mul_f32 v33, v33, v94
    v_mul_f32 v34, v34, v94
    v_mul_f32 v35, v35, v94
    v_mul_f32 v36, v36, v94
    v_mul_f32 v37, v37, v94
    v_mul_f32 v38, v38, v94
    v_mul_f32 v39, v39, v94
    v_mul_f32 v176, v176, v94
    v_sub_f32 v96, v96, v88
    v_sub_f32 v97, v97, v88
    v_sub_f32 v98, v98, v88
    v_sub_f32 v99, v99, v88
    v_sub_f32 v100, v100, v88
    v_sub_f32 v101, v101, v88
    v_sub_f32 v102, v102, v88
    v_sub_f32 v103, v103, v88
    v_sub_f32 v104, v104, v88
    v_sub_f32 v105, v105, v88
    v_sub_f32 v106, v106, v88
    v_sub_f32 v107, v107, v88
    v_sub_f32 v108, v108, v88
    v_sub_f32 v109, v109, v88
    v_sub_f32 v110, v110, v88
    v_sub_f32 v111, v111, v88
    v_sub_f32 v112, v112, v88
    v_sub_f32 v113, v113, v88
    v_sub_f32 v114, v114, v88
    v_sub_f32 v115, v115, v88
    v_sub_f32 v116, v116, v88
    v_sub_f32 v117, v117, v88
    v_sub_f32 v118, v118, v88
    v_sub_f32 v119, v119, v88
    v_sub_f32 v120, v120, v88
    v_sub_f32 v121, v121, v88
    v_sub_f32 v122, v122, v88
    v_sub_f32 v123, v123, v88
    v_sub_f32 v124, v124, v88
    v_sub_f32 v125, v125, v88
    v_sub_f32 v126, v126, v88
    v_sub_f32 v127, v127, v88
    v_exp_f32 v96, v96
    v_exp_f32 v97, v97
    v_exp_f32 v98, v98
    v_exp_f32 v99, v99
    v_exp_f32 v100, v100
    v_exp_f32 v101, v101
    v_exp_f32 v102, v102
    v_exp_f32 v103, v103
    v_exp_f32 v104, v104
    v_exp_f32 v105, v105
    v_exp_f32 v106, v106
    v_exp_f32 v107, v107
    v_exp_f32 v108, v108
    v_exp_f32 v109, v109
    v_exp_f32 v110, v110
    v_exp_f32 v111, v111
    v_exp_f32 v112, v112
    v_exp_f32 v113, v113
    v_exp_f32 v114, v114
    v_exp_f32 v115, v115
    v_exp_f32 v116, v116
    v_exp_f32 v117, v117
    v_exp_f32 v118, v118
    v_exp_f32 v119, v119
    v_exp_f32 v120, v120
    v_exp_f32 v121, v121
    v_exp_f32 v122, v122
    v_exp_f32 v123, v123
    v_exp_f32 v124, v124
    v_exp_f32 v125, v125
    v_exp_f32 v126, v126
    v_exp_f32 v127, v127
    v_cvt_pk_bf16_f32 v72, v96, v97
    v_cvt_pk_bf16_f32 v73, v98, v99
    v_cvt_pk_bf16_f32 v74, v100, v101
    v_cvt_pk_bf16_f32 v75, v102, v103
    v_cvt_pk_bf16_f32 v76, v104, v105
    v_cvt_pk_bf16_f32 v77, v106, v107
    v_cvt_pk_bf16_f32 v78, v108, v109
    v_cvt_pk_bf16_f32 v79, v110, v111
    v_cvt_pk_bf16_f32 v80, v112, v113
    v_cvt_pk_bf16_f32 v81, v114, v115
    v_cvt_pk_bf16_f32 v82, v116, v117
    v_cvt_pk_bf16_f32 v83, v118, v119
    v_cvt_pk_bf16_f32 v84, v120, v121
    v_cvt_pk_bf16_f32 v85, v122, v123
    v_cvt_pk_bf16_f32 v86, v124, v125
    v_cvt_pk_bf16_f32 v87, v126, v127
    s_waitcnt lgkmcnt(0)
    v_mfma_f32_32x32x16_bf16 v[24:39], v[56:59], v[72:75], v[24:39]
    v_mfma_f32_16x16x32_bf16 v[176:179], v[192:195], v[72:75], v[176:179]
    v_mfma_f32_32x32x16_bf16 v[24:39], v[60:63], v[76:79], v[24:39]
    v_mfma_f32_16x16x32_bf16 v[176:179], v[192:195], v[76:79], v[176:179]
    v_mfma_f32_32x32x16_bf16 v[24:39], v[64:67], v[80:83], v[24:39]
    v_mfma_f32_16x16x32_bf16 v[176:179], v[192:195], v[80:83], v[176:179]
    v_mfma_f32_32x32x16_bf16 v[24:39], v[68:71], v[84:87], v[24:39]
    v_mfma_f32_16x16x32_bf16 v[176:179], v[192:195], v[84:87], v[176:179]
    ds_read_b128 v[40:43], v8 offset:4096
    ds_read_b128 v[44:47], v8 offset:5120
    ds_read_b128 v[48:51], v8 offset:6144
    ds_read_b128 v[52:55], v8 offset:7168
    s_waitcnt lgkmcnt(0)
    v_mfma_f32_32x32x16_bf16 v[96:111], v[40:43], v[16:19], 0
    v_mfma_f32_32x32x16_bf16 v[112:127], v[48:51], v[16:19], 0
    v_mfma_f32_32x32x16_bf16 v[96:111], v[44:47], v[20:23], v[96:111]
    v_mfma_f32_32x32x16_bf16 v[112:127], v[52:55], v[20:23], v[112:127]
    ds_read_b128 v[56:59], v10 offset:20480
    ds_read_b128 v[60:63], v10 offset:21504
    ds_read_b128 v[64:67], v10 offset:22528
    ds_read_b128 v[68:71], v10 offset:23552
    s_nop 6
    v_max3_f32 v92, v88, v96, v97
    v_max3_f32 v92, v92, v98, v99
    v_max3_f32 v92, v92, v100, v101
    v_max3_f32 v92, v92, v102, v103
    v_max3_f32 v92, v92, v104, v105
    v_max3_f32 v92, v92, v106, v107
    v_max3_f32 v92, v92, v108, v109
    v_max3_f32 v92, v92, v110, v111
    v_max3_f32 v92, v92, v112, v113
    v_max3_f32 v92, v92, v114, v115
    v_max3_f32 v92, v92, v116, v117
    v_max3_f32 v92, v92, v118, v119
    v_max3_f32 v92, v92, v120, v121
    v_max3_f32 v92, v92, v122, v123
    v_max3_f32 v92, v92, v124, v125
    v_max3_f32 v92, v92, v126, v127
    v_mov_b32 v94, v92
    s_nop 1
    v_permlane32_swap_b32 v92, v94
    v_max_f32 v92, v92, v94
    v_sub_f32 v94, v88, v92
    v_exp_f32 v94, v94
    v_mov_b32 v88, v92
    v_mul_f32 v24, v24, v94
    v_mul_f32 v25, v25, v94
    v_mul_f32 v26, v26, v94
    v_mul_f32 v27, v27, v94
    v_mul_f32 v28, v28, v94
    v_mul_f32 v29, v29, v94
    v_mul_f32 v30, v30, v94
    v_mul_f32 v31, v31, v94
    v_mul_f32 v32, v32, v94
    v_mul_f32 v33, v33, v94
    v_mul_f32 v34, v34, v94
    v_mul_f32 v35, v35, v94
    v_mul_f32 v36, v36, v94
    v_mul_f32 v37, v37, v94
    v_mul_f32 v38, v38, v94
    v_mul_f32 v39, v39, v94
    v_mul_f32 v176, v176, v94
    v_sub_f32 v96, v96, v88
    v_sub_f32 v97, v97, v88
    v_sub_f32 v98, v98, v88
    v_sub_f32 v99, v99, v88
    v_sub_f32 v100, v100, v88
    v_sub_f32 v101, v101, v88
    v_sub_f32 v102, v102, v88
    v_sub_f32 v103, v103, v88
    v_sub_f32 v104, v104, v88
    v_sub_f32 v105, v105, v88
    v_sub_f32 v106, v106, v88
    v_sub_f32 v107, v107, v88
    v_sub_f32 v108, v108, v88
    v_sub_f32 v109, v109, v88
    v_sub_f32 v110, v110, v88
    v_sub_f32 v111, v111, v88
    v_sub_f32 v112, v112, v88
    v_sub_f32 v113, v113, v88
    v_sub_f32 v114, v114, v88
    v_sub_f32 v115, v115, v88
    v_sub_f32 v116, v116, v88
    v_sub_f32 v117, v117, v88
    v_sub_f32 v118, v118, v88
    v_sub_f32 v119, v119, v88
    v_sub_f32 v120, v120, v88
    v_sub_f32 v121, v121, v88
    v_sub_f32 v122, v122, v88
    v_sub_f32 v123, v123, v88
    v_sub_f32 v124, v124, v88
    v_sub_f32 v125, v125, v88
    v_sub_f32 v126, v126, v88
    v_sub_f32 v127, v127, v88
    v_exp_f32 v96, v96
    v_exp_f32 v97, v97
    v_exp_f32 v98, v98
    v_exp_f32 v99, v99
    v_exp_f32 v100, v100
    v_exp_f32 v101, v101
    v_exp_f32 v102, v102
    v_exp_f32 v103, v103
    v_exp_f32 v104, v104
    v_exp_f32 v105, v105
    v_exp_f32 v106, v106
    v_exp_f32 v107, v107
    v_exp_f32 v108, v108
    v_exp_f32 v109, v109
    v_exp_f32 v110, v110
    v_exp_f32 v111, v111
    v_exp_f32 v112, v112
    v_exp_f32 v113, v113
    v_exp_f32 v114, v114
    v_exp_f32 v115, v115
    v_exp_f32 v116, v116
    v_exp_f32 v117, v117
    v_exp_f32 v118, v118
    v_exp_f32 v119, v119
    v_exp_f32 v120, v120
    v_exp_f32 v121, v121
    v_exp_f32 v122, v122
    v_exp_f32 v123, v123
    v_exp_f32 v124, v124
    v_exp_f32 v125, v125
    v_exp_f32 v126, v126
    v_exp_f32 v127, v127
    v_cvt_pk_bf16_f32 v72, v96, v97
    v_cvt_pk_bf16_f32 v73, v98, v99
    v_cvt_pk_bf16_f32 v74, v100, v101
    v_cvt_pk_bf16_f32 v75, v102, v103
    v_cvt_pk_bf16_f32 v76, v104, v105
    v_cvt_pk_bf16_f32 v77, v106, v107
    v_cvt_pk_bf16_f32 v78, v108, v109
    v_cvt_pk_bf16_f32 v79, v110, v111
    v_cvt_pk_bf16_f32 v80, v112, v113
    v_cvt_pk_bf16_f32 v81, v114, v115
    v_cvt_pk_bf16_f32 v82, v116, v117
    v_cvt_pk_bf16_f32 v83, v118, v119
    v_cvt_pk_bf16_f32 v84, v120, v121
    v_cvt_pk_bf16_f32 v85, v122, v123
    v_cvt_pk_bf16_f32 v86, v124, v125
    v_cvt_pk_bf16_f32 v87, v126, v127
    s_waitcnt lgkmcnt(0)
    v_mfma_f32_32x32x16_bf16 v[24:39], v[56:59], v[72:75], v[24:39]
    v_mfma_f32_16x16x32_bf16 v[176:179], v[192:195], v[72:75], v[176:179]
    v_mfma_f32_32x32x16_bf16 v[24:39], v[60:63], v[76:79], v[24:39]
    v_mfma_f32_16x16x32_bf16 v[176:179], v[192:195], v[76:79], v[176:179]
    v_mfma_f32_32x32x16_bf16 v[24:39], v[64:67], v[80:83], v[24:39]
    v_mfma_f32_16x16x32_bf16 v[176:179], v[192:195], v[80:83], v[176:179]
    v_mfma_f32_32x32x16_bf16 v[24:39], v[68:71], v[84:87], v[24:39]
    v_mfma_f32_16x16x32_bf16 v[176:179], v[192:195], v[84:87], v[176:179]
    ds_read_b128 v[40:43], v8 offset:8192
    ds_read_b128 v[44:47], v8 offset:9216
    ds_read_b128 v[48:51], v8 offset:10240
    ds_read_b128 v[52:55], v8 offset:11264
    s_waitcnt lgkmcnt(0)
    v_mfma_f32_32x32x16_bf16 v[96:111], v[40:43], v[16:19], 0
    v_mfma_f32_32x32x16_bf16 v[112:127], v[48:51], v[16:19], 0
    v_mfma_f32_32x32x16_bf16 v[96:111], v[44:47], v[20:23], v[96:111]
    v_mfma_f32_32x32x16_bf16 v[112:127], v[52:55], v[20:23], v[112:127]
    ds_read_b128 v[56:59], v10 offset:24576
    ds_read_b128 v[60:63], v10 offset:25600
    ds_read_b128 v[64:67], v10 offset:26624
    ds_read_b128 v[68:71], v10 offset:27648
    s_nop 6
    v_max3_f32 v92, v88, v96, v97
    v_max3_f32 v92, v92, v98, v99
    v_max3_f32 v92, v92, v100, v101
    v_max3_f32 v92, v92, v102, v103
    v_max3_f32 v92, v92, v104, v105
    v_max3_f32 v92, v92, v106, v107
    v_max3_f32 v92, v92, v108, v109
    v_max3_f32 v92, v92, v110, v111
    v_max3_f32 v92, v92, v112, v113
    v_max3_f32 v92, v92, v114, v115
    v_max3_f32 v92, v92, v116, v117
    v_max3_f32 v92, v92, v118, v119
    v_max3_f32 v92, v92, v120, v121
    v_max3_f32 v92, v92, v122, v123
    v_max3_f32 v92, v92, v124, v125
    v_max3_f32 v92, v92, v126, v127
    v_mov_b32 v94, v92
    s_nop 1
    v_permlane32_swap_b32 v92, v94
    v_max_f32 v92, v92, v94
    v_sub_f32 v94, v88, v92
    v_exp_f32 v94, v94
    v_mov_b32 v88, v92
    v_mul_f32 v24, v24, v94
    v_mul_f32 v25, v25, v94
    v_mul_f32 v26, v26, v94
    v_mul_f32 v27, v27, v94
    v_mul_f32 v28, v28, v94
    v_mul_f32 v29, v29, v94
    v_mul_f32 v30, v30, v94
    v_mul_f32 v31, v31, v94
    v_mul_f32 v32, v32, v94
    v_mul_f32 v33, v33, v94
    v_mul_f32 v34, v34, v94
    v_mul_f32 v35, v35, v94
    v_mul_f32 v36, v36, v94
    v_mul_f32 v37, v37, v94
    v_mul_f32 v38, v38, v94
    v_mul_f32 v39, v39, v94
    v_mul_f32 v176, v176, v94
    v_sub_f32 v96, v96, v88
    v_sub_f32 v97, v97, v88
    v_sub_f32 v98, v98, v88
    v_sub_f32 v99, v99, v88
    v_sub_f32 v100, v100, v88
    v_sub_f32 v101, v101, v88
    v_sub_f32 v102, v102, v88
    v_sub_f32 v103, v103, v88
    v_sub_f32 v104, v104, v88
    v_sub_f32 v105, v105, v88
    v_sub_f32 v106, v106, v88
    v_sub_f32 v107, v107, v88
    v_sub_f32 v108, v108, v88
    v_sub_f32 v109, v109, v88
    v_sub_f32 v110, v110, v88
    v_sub_f32 v111, v111, v88
    v_sub_f32 v112, v112, v88
    v_sub_f32 v113, v113, v88
    v_sub_f32 v114, v114, v88
    v_sub_f32 v115, v115, v88
    v_sub_f32 v116, v116, v88
    v_sub_f32 v117, v117, v88
    v_sub_f32 v118, v118, v88
    v_sub_f32 v119, v119, v88
    v_sub_f32 v120, v120, v88
    v_sub_f32 v121, v121, v88
    v_sub_f32 v122, v122, v88
    v_sub_f32 v123, v123, v88
    v_sub_f32 v124, v124, v88
    v_sub_f32 v125, v125, v88
    v_sub_f32 v126, v126, v88
    v_sub_f32 v127, v127, v88
    v_exp_f32 v96, v96
    v_exp_f32 v97, v97
    v_exp_f32 v98, v98
    v_exp_f32 v99, v99
    v_exp_f32 v100, v100
    v_exp_f32 v101, v101
    v_exp_f32 v102, v102
    v_exp_f32 v103, v103
    v_exp_f32 v104, v104
    v_exp_f32 v105, v105
    v_exp_f32 v106, v106
    v_exp_f32 v107, v107
    v_exp_f32 v108, v108
    v_exp_f32 v109, v109
    v_exp_f32 v110, v110
    v_exp_f32 v111, v111
    v_exp_f32 v112, v112
    v_exp_f32 v113, v113
    v_exp_f32 v114, v114
    v_exp_f32 v115, v115
    v_exp_f32 v116, v116
    v_exp_f32 v117, v117
    v_exp_f32 v118, v118
    v_exp_f32 v119, v119
    v_exp_f32 v120, v120
    v_exp_f32 v121, v121
    v_exp_f32 v122, v122
    v_exp_f32 v123, v123
    v_exp_f32 v124, v124
    v_exp_f32 v125, v125
    v_exp_f32 v126, v126
    v_exp_f32 v127, v127
    v_cvt_pk_bf16_f32 v72, v96, v97
    v_cvt_pk_bf16_f32 v73, v98, v99
    v_cvt_pk_bf16_f32 v74, v100, v101
    v_cvt_pk_bf16_f32 v75, v102, v103
    v_cvt_pk_bf16_f32 v76, v104, v105
    v_cvt_pk_bf16_f32 v77, v106, v107
    v_cvt_pk_bf16_f32 v78, v108, v109
    v_cvt_pk_bf16_f32 v79, v110, v111
    v_cvt_pk_bf16_f32 v80, v112, v113
    v_cvt_pk_bf16_f32 v81, v114, v115
    v_cvt_pk_bf16_f32 v82, v116, v117
    v_cvt_pk_bf16_f32 v83, v118, v119
    v_cvt_pk_bf16_f32 v84, v120, v121
    v_cvt_pk_bf16_f32 v85, v122, v123
    v_cvt_pk_bf16_f32 v86, v124, v125
    v_cvt_pk_bf16_f32 v87, v126, v127
    s_waitcnt lgkmcnt(0)
    v_mfma_f32_32x32x16_bf16 v[24:39], v[56:59], v[72:75], v[24:39]
    v_mfma_f32_16x16x32_bf16 v[176:179], v[192:195], v[72:75], v[176:179]
    v_mfma_f32_32x32x16_bf16 v[24:39], v[60:63], v[76:79], v[24:39]
    v_mfma_f32_16x16x32_bf16 v[176:179], v[192:195], v[76:79], v[176:179]
    v_mfma_f32_32x32x16_bf16 v[24:39], v[64:67], v[80:83], v[24:39]
    v_mfma_f32_16x16x32_bf16 v[176:179], v[192:195], v[80:83], v[176:179]
    v_mfma_f32_32x32x16_bf16 v[24:39], v[68:71], v[84:87], v[24:39]
    v_mfma_f32_16x16x32_bf16 v[176:179], v[192:195], v[84:87], v[176:179]
    ds_read_b128 v[40:43], v8 offset:12288
    ds_read_b128 v[44:47], v8 offset:13312
    ds_read_b128 v[48:51], v8 offset:14336
    ds_read_b128 v[52:55], v8 offset:15360
    s_waitcnt lgkmcnt(0)
    v_mfma_f32_32x32x16_bf16 v[96:111], v[40:43], v[16:19], 0
    v_mfma_f32_32x32x16_bf16 v[112:127], v[48:51], v[16:19], 0
    v_mfma_f32_32x32x16_bf16 v[96:111], v[44:47], v[20:23], v[96:111]
    v_mfma_f32_32x32x16_bf16 v[112:127], v[52:55], v[20:23], v[112:127]
    ds_read_b128 v[56:59], v10 offset:28672
    ds_read_b128 v[60:63], v10 offset:29696
    ds_read_b128 v[64:67], v10 offset:30720
    ds_read_b128 v[68:71], v10 offset:31744
    s_nop 6
    v_max3_f32 v92, v88, v96, v97
    v_max3_f32 v92, v92, v98, v99
    v_max3_f32 v92, v92, v100, v101
    v_max3_f32 v92, v92, v102, v103
    v_max3_f32 v92, v92, v104, v105
    v_max3_f32 v92, v92, v106, v107
    v_max3_f32 v92, v92, v108, v109
    v_max3_f32 v92, v92, v110, v111
    v_max3_f32 v92, v92, v112, v113
    v_max3_f32 v92, v92, v114, v115
    v_max3_f32 v92, v92, v116, v117
    v_max3_f32 v92, v92, v118, v119
    v_max3_f32 v92, v92, v120, v121
    v_max3_f32 v92, v92, v122, v123
    v_max3_f32 v92, v92, v124, v125
    v_max3_f32 v92, v92, v126, v127
    v_mov_b32 v94, v92
    s_nop 1
    v_permlane32_swap_b32 v92, v94
    v_max_f32 v92, v92, v94
    v_sub_f32 v94, v88, v92
    v_exp_f32 v94, v94
    v_mov_b32 v88, v92
    v_mul_f32 v24, v24, v94
    v_mul_f32 v25, v25, v94
    v_mul_f32 v26, v26, v94
    v_mul_f32 v27, v27, v94
    v_mul_f32 v28, v28, v94
    v_mul_f32 v29, v29, v94
    v_mul_f32 v30, v30, v94
    v_mul_f32 v31, v31, v94
    v_mul_f32 v32, v32, v94
    v_mul_f32 v33, v33, v94
    v_mul_f32 v34, v34, v94
    v_mul_f32 v35, v35, v94
    v_mul_f32 v36, v36, v94
    v_mul_f32 v37, v37, v94
    v_mul_f32 v38, v38, v94
    v_mul_f32 v39, v39, v94
    v_mul_f32 v176, v176, v94
    v_sub_f32 v96, v96, v88
    v_sub_f32 v97, v97, v88
    v_sub_f32 v98, v98, v88
    v_sub_f32 v99, v99, v88
    v_sub_f32 v100, v100, v88
    v_sub_f32 v101, v101, v88
    v_sub_f32 v102, v102, v88
    v_sub_f32 v103, v103, v88
    v_sub_f32 v104, v104, v88
    v_sub_f32 v105, v105, v88
    v_sub_f32 v106, v106, v88
    v_sub_f32 v107, v107, v88
    v_sub_f32 v108, v108, v88
    v_sub_f32 v109, v109, v88
    v_sub_f32 v110, v110, v88
    v_sub_f32 v111, v111, v88
    v_sub_f32 v112, v112, v88
    v_sub_f32 v113, v113, v88
    v_sub_f32 v114, v114, v88
    v_sub_f32 v115, v115, v88
    v_sub_f32 v116, v116, v88
    v_sub_f32 v117, v117, v88
    v_sub_f32 v118, v118, v88
    v_sub_f32 v119, v119, v88
    v_sub_f32 v120, v120, v88
    v_sub_f32 v121, v121, v88
    v_sub_f32 v122, v122, v88
    v_sub_f32 v123, v123, v88
    v_sub_f32 v124, v124, v88
    v_sub_f32 v125, v125, v88
    v_sub_f32 v126, v126, v88
    v_sub_f32 v127, v127, v88
    v_exp_f32 v96, v96
    v_exp_f32 v97, v97
    v_exp_f32 v98, v98
    v_exp_f32 v99, v99
    v_exp_f32 v100, v100
    v_exp_f32 v101, v101
    v_exp_f32 v102, v102
    v_exp_f32 v103, v103
    v_exp_f32 v104, v104
    v_exp_f32 v105, v105
    v_exp_f32 v106, v106
    v_exp_f32 v107, v107
    v_exp_f32 v108, v108
    v_exp_f32 v109, v109
    v_exp_f32 v110, v110
    v_exp_f32 v111, v111
    v_exp_f32 v112, v112
    v_exp_f32 v113, v113
    v_exp_f32 v114, v114
    v_exp_f32 v115, v115
    v_exp_f32 v116, v116
    v_exp_f32 v117, v117
    v_exp_f32 v118, v118
    v_exp_f32 v119, v119
    v_exp_f32 v120, v120
    v_exp_f32 v121, v121
    v_exp_f32 v122, v122
    v_exp_f32 v123, v123
    v_exp_f32 v124, v124
    v_exp_f32 v125, v125
    v_exp_f32 v126, v126
    v_exp_f32 v127, v127
    v_cvt_pk_bf16_f32 v72, v96, v97
    v_cvt_pk_bf16_f32 v73, v98, v99
    v_cvt_pk_bf16_f32 v74, v100, v101
    v_cvt_pk_bf16_f32 v75, v102, v103
    v_cvt_pk_bf16_f32 v76, v104, v105
    v_cvt_pk_bf16_f32 v77, v106, v107
    v_cvt_pk_bf16_f32 v78, v108, v109
    v_cvt_pk_bf16_f32 v79, v110, v111
    v_cvt_pk_bf16_f32 v80, v112, v113
    v_cvt_pk_bf16_f32 v81, v114, v115
    v_cvt_pk_bf16_f32 v82, v116, v117
    v_cvt_pk_bf16_f32 v83, v118, v119
    v_cvt_pk_bf16_f32 v84, v120, v121
    v_cvt_pk_bf16_f32 v85, v122, v123
    v_cvt_pk_bf16_f32 v86, v124, v125
    v_cvt_pk_bf16_f32 v87, v126, v127
    s_waitcnt lgkmcnt(0)
    v_mfma_f32_32x32x16_bf16 v[24:39], v[56:59], v[72:75], v[24:39]
    v_mfma_f32_16x16x32_bf16 v[176:179], v[192:195], v[72:75], v[176:179]
    v_mfma_f32_32x32x16_bf16 v[24:39], v[60:63], v[76:79], v[24:39]
    v_mfma_f32_16x16x32_bf16 v[176:179], v[192:195], v[76:79], v[176:179]
    v_mfma_f32_32x32x16_bf16 v[24:39], v[64:67], v[80:83], v[24:39]
    v_mfma_f32_16x16x32_bf16 v[176:179], v[192:195], v[80:83], v[176:179]
    v_mfma_f32_32x32x16_bf16 v[24:39], v[68:71], v[84:87], v[24:39]
    v_mfma_f32_16x16x32_bf16 v[176:179], v[192:195], v[84:87], v[176:179]
    s_cmp_lt_u32 s46, 6
    s_cbranch_scc1 B2_Wx
    s_cmp_eq_u32 s29, 1
    s_cbranch_scc1 B2_Wx
    s_waitcnt vmcnt(0)
B2_Wx:
    s_waitcnt vmcnt(4)
    s_barrier
    s_add_u32 s48, s48, 32768
    s_and_b32 s48, s48, 0x1ffff
    v_add_u32 v8, s48, v4
    s_cmp_lt_u32 s46, 5
    s_cbranch_scc1 B2_Dx
    s_cmp_lg_u32 s29, 1
    s_cbranch_scc1 B2_Nx
B2_Dx:
    s_add_u32 m0, s49, s47
    s_nop 0
    buffer_load_dwordx4 v2, s[8:11], s50 offen offset:0 sc1 lds
    buffer_load_dwordx4 v2, s[8:11], s50 offen offset:1024 sc1 lds
    s_add_u32 m0, m0, 0x4000
    s_nop 0
    buffer_load_dwordx4 v2, s[8:11], s51 offen offset:0 sc1 lds
    buffer_load_dwordx4 v2, s[8:11], s51 offen offset:1024 sc1 lds
    s_add_u32 s50, s50, 0x4000
    s_add_u32 s51, s51, 0x4000
    s_add_u32 s47, s47, 32768
    s_and_b32 s47, s47, 0x1ffff
B2_Nx:
    v_add_u32 v10, s48, v2
    ds_read_b128 v[40:43], v8 offset:0
    ds_read_b128 v[44:47], v8 offset:1024
    ds_read_b128 v[48:51], v8 offset:2048
    ds_read_b128 v[52:55], v8 offset:3072
    s_waitcnt lgkmcnt(0)
    s_add_u32 s46, s46, 1
    s_cmp_lt_u32 s46, 8
    s_cbranch_scc1 B2_XL
B2_FIN:
    s_setprio 0
    v_rcp_f32 v88, v176
    s_nop 0
    v_mul_f32 v24, v24, v88
    v_mul_f32 v25, v25, v88
    v_mul_f32 v26, v26, v88
    v_mul_f32 v27, v27, v88
    v_mul_f32 v28, v28, v88
    v_mul_f32 v29, v29, v88
    v_mul_f32 v30, v30, v88
    v_mul_f32 v31, v31, v88
    v_mul_f32 v32, v32, v88
    v_mul_f32 v33, v33, v88
    v_mul_f32 v34, v34, v88
    v_mul_f32 v35, v35, v88
    v_mul_f32 v36, v36, v88
    v_mul_f32 v37, v37, v88
    v_mul_f32 v38, v38, v88
    v_mul_f32 v39, v39, v88
    v_cvt_pk_bf16_f32 v72, v24, v25
    v_cvt_pk_bf16_f32 v73, v26, v27
    v_cvt_pk_bf16_f32 v74, v28, v29
    v_cvt_pk_bf16_f32 v75, v30, v31
    v_cvt_pk_bf16_f32 v76, v32, v33
    v_cvt_pk_bf16_f32 v77, v34, v35
    v_cvt_pk_bf16_f32 v78, v36, v37
    v_cvt_pk_bf16_f32 v79, v38, v39
    s_lshl_b32 s40, s7, 19
    s_lshl_b32 s41, s34, 16
    s_add_u32 s40, s40, s41
    s_lshl_b32 s41, s3, 11
    s_add_u32 s40, s40, s41
    s_add_u32 s40, s40, 88080384
    v_permlane32_swap_b32 v72, v74
    v_permlane32_swap_b32 v73, v75
    buffer_store_dwordx4 v[72:75], v2, s[8:11], s40 offen offset:0 sc1
    v_permlane32_swap_b32 v76, v78
    v_permlane32_swap_b32 v77, v79
    buffer_store_dwordx4 v[76:79], v2, s[8:11], s40 offen offset:1024 sc1
    s_mov_b32 s38, s37
    s_branch B_COLD
B_CG:
    s_cmp_lt_u32 s86, 4
    s_cbranch_scc1 B_CGN
    v_lshrrev_b32 v14, 3, v0
    s_lshl_b32 s45, s34, 5
    v_add_u32 v14, s45, v14
    v_add_u32 v15, 0, v14
    v_bfe_u32 v16, v15, 1, 3
    v_and_b32 v17, 7, v0
    v_xor_b32 v16, v16, v17
    v_lshlrev_b32 v15, 11, v15
    v_lshl_add_u32 v2, v16, 4, v15
    v_add_u32 v15, 8, v14
    v_bfe_u32 v16, v15, 1, 3
    v_and_b32 v17, 7, v0
    v_xor_b32 v16, v16, v17
    v_lshlrev_b32 v15, 11, v15
    v_lshl_add_u32 v3, v16, 4, v15
    v_subrev_u32 v3, 1024, v3
    v_add_u32 v15, 16, v14
    v_bfe_u32 v16, v15, 1, 3
    v_and_b32 v17, 7, v0
    v_xor_b32 v16, v16, v17
    v_lshlrev_b32 v15, 11, v15
    v_lshl_add_u32 v4, v16, 4, v15
    v_subrev_u32 v4, 2048, v4
    v_add_u32 v15, 24, v14
    v_bfe_u32 v16, v15, 1, 3
    v_and_b32 v17, 7, v0
    v_xor_b32 v16, v16, v17
    v_lshlrev_b32 v15, 11, v15
    v_lshl_add_u32 v5, v16, 4, v15
    v_subrev_u32 v5, 3072, v5
    s_and_b32 s45, s34, 1
    s_lshl_b32 s45, s45, 2
    v_lshrrev_b32 v14, 4, v0
    v_or_b32 v15, s45, v14
    v_bfe_u32 v16, v0, 1, 3
    v_xor_b32 v16, v16, v15
    v_and_b32 v17, 1, v0
    v_lshl_or_b32 v16, v16, 1, v17
    v_lshlrev_b32 v19, 4, v16
    s_lshl_b32 s45, s34, 3
    v_add_u32 v18, s45, v14
    s_lshl_b32 s53, s34, 12
    s_lshl_b32 s54, s34, 11
    s_add_u32 s54, s54, 0x8000
    v_and_b32 v14, 15, v0
    v_lshrrev_b32 v15, 4, v0
    v_bfe_u32 v16, v0, 1, 3
    v_xor_b32 v16, v16, v15
    v_lshlrev_b32 v14, 7, v14
    v_lshl_add_u32 v8, v16, 4, v14
    s_lshr_b32 s45, s34, 2
    s_lshl_b32 s45, s45, 14
    v_add_u32 v8, s45, v8
    v_xor_b32 v9, 64, v8
    v_bfe_u32 v14, v0, 2, 2
    v_lshl_add_u32 v16, v15, 3, v14
    v_lshlrev_b32 v16, 8, v16
    v_and_b32 v17, 3, v0
    v_lshl_add_u32 v16, v17, 3, v16
    s_and_b32 s45, s34, 2
    s_lshl_b32 s45, s45, 13
    s_add_u32 s45, s45, 0x8000
    v_add_u32 v16, s45, v16
    v_bfe_u32 v17, v0, 4, 1
    v_lshl_or_b32 v14, v17, 2, v14
    s_and_b32 s45, s34, 1
    s_lshl_b32 s45, s45, 2
    s_or_b32 s46, s45, 0
    v_xor_b32 v17, s46, v14
    v_lshl_add_u32 v10, v17, 5, v16
    s_or_b32 s46, s45, 1
    v_xor_b32 v17, s46, v14
    v_lshl_add_u32 v11, v17, 5, v16
    s_or_b32 s46, s45, 2
    v_xor_b32 v17, s46, v14
    v_lshl_add_u32 v12, v17, 5, v16
    s_or_b32 s46, s45, 3
    v_xor_b32 v17, s46, v14
    v_lshl_add_u32 v13, v17, 5, v16
    v_bfe_u32 v14, v0, 4, 1
    v_lshrrev_b32 v15, 5, v0
    v_lshl_add_u32 v14, v14, 1, v15
    v_lshlrev_b32 v14, 9, v14
    v_and_b32 v15, 15, v0
    v_lshl_add_u32 v20, v15, 4, v14
    s_mov_b32 s12, s88
    s_and_b32 s13, s89, 0xffff
    s_mov_b32 s14, s87
    s_mov_b32 s16, s90
    s_and_b32 s17, s91, 0xffff
    s_mov_b32 s18, s92
    s_mov_b32 s24, s93
    s_mov_b32 s25, s94
    s_mov_b32 s31, s95
    v_mul_lo_u32 v6, v18, s31
    s_lshl_b32 s45, s31, 2
    s_sub_u32 s45, s45, 1024
    s_lshl_b32 s52, s31, 6
    v_add_u32 v6, v6, v19
    v_add_u32 v7, s45, v6
    s_mov_b32 s49, 0
    s_add_u32 m0, s53, s49
    s_add_u32 s48, s25, 256
    buffer_load_dwordx4 v2, s[12:15], s24 offen offset:0 sc1 lds
    buffer_load_dwordx4 v3, s[12:15], s24 offen offset:1024 sc1 lds
    buffer_load_dwordx4 v4, s[12:15], s24 offen offset:2048 sc1 lds
    buffer_load_dwordx4 v5, s[12:15], s24 offen offset:3072 sc1 lds
    s_add_u32 m0, s54, s49
    s_add_u32 s24, s24, 128
    buffer_load_dwordx4 v6, s[16:19], s25 offen offset:0 lds
    buffer_load_dwordx4 v7, s[16:19], s25 offen offset:1024 lds
    s_add_u32 m0, m0, 0x4000
    s_add_u32 s25, s25, s52
    buffer_load_dwordx4 v6, s[16:19], s48 offen offset:0 lds
    buffer_load_dwordx4 v7, s[16:19], s48 offen offset:1024 lds
    s_xor_b32 s49, s49, 0x10000
    s_add_u32 m0, s53, s49
    s_add_u32 s48, s25, 256
    buffer_load_dwordx4 v2, s[12:15], s24 offen offset:0 sc1 lds
    buffer_load_dwordx4 v3, s[12:15], s24 offen offset:1024 sc1 lds
    buffer_load_dwordx4 v4, s[12:15], s24 offen offset:2048 sc1 lds
    buffer_load_dwordx4 v5, s[12:15], s24 offen offset:3072 sc1 lds
    s_add_u32 m0, s54, s49
    s_add_u32 s24, s24, 128
    buffer_load_dwordx4 v6, s[16:19], s25 offen offset:0 lds
    buffer_load_dwordx4 v7, s[16:19], s25 offen offset:1024 lds
    s_add_u32 m0, m0, 0x4000
    s_add_u32 s25, s25, s52
    buffer_load_dwordx4 v6, s[16:19], s48 offen offset:0 lds
    buffer_load_dwordx4 v7, s[16:19], s48 offen offset:1024 lds
    s_xor_b32 s49, s49, 0x10000
    s_waitcnt vmcnt(8)
    s_barrier
    ds_read_b64_tr_b16 v[184:185], v10 offset:0
    ds_read_b64_tr_b16 v[186:187], v10 offset:1024
    ds_read_b128 v[152:155], v8 offset:0
    ds_read_b128 v[156:159], v8 offset:2048
    ds_read_b64_tr_b16 v[188:189], v11 offset:0
    ds_read_b64_tr_b16 v[190:191], v11 offset:1024
    ds_read_b128 v[160:163], v8 offset:4096
    ds_read_b128 v[164:167], v8 offset:6144
    ds_read_b64_tr_b16 v[192:193], v12 offset:0
    ds_read_b64_tr_b16 v[194:195], v12 offset:1024
    ds_read_b128 v[168:171], v8 offset:8192
    ds_read_b128 v[172:175], v8 offset:10240
    ds_read_b64_tr_b16 v[196:197], v13 offset:0
    ds_read_b64_tr_b16 v[198:199], v13 offset:1024
    ds_read_b128 v[176:179], v8 offset:12288
    ds_read_b128 v[180:183], v8 offset:14336
    v_mov_b32 v248, -1
    v_mov_b32 v249, -1
    v_mov_b32 v250, -1
    v_mov_b32 v251, -1
    v_lshlrev_b32 v21, 4, v0
    s_mov_b32 s44, 0
    s_branch B_WARM
B_CGN:
    s_cmp_lg_u32 s4, 5
    s_cbranch_scc1 B_CG4
    s_and_b32 s45, s34, 1
    s_lshl_b32 s45, s45, 2
    v_lshrrev_b32 v20, 4, v0
    v_or_b32 v21, s45, v20
    v_bfe_u32 v22, v0, 1, 3
    v_xor_b32 v22, v22, v21
    v_and_b32 v23, 1, v0
    v_lshl_or_b32 v22, v22, 1, v23
    v_lshlrev_b32 v25, 4, v22
    s_lshl_b32 s45, s34, 3
    v_add_u32 v24, s45, v20
    s_mul_i32 s53, s34, 2048
    s_lshl_b32 s54, s34, 11
    s_add_u32 s54, s54, 65536
    v_and_b32 v20, 15, v0
    v_lshrrev_b32 v21, 4, v0
    v_bfe_u32 v22, v0, 1, 3
    v_xor_b32 v22, v22, v21
    v_lshlrev_b32 v20, 7, v20
    v_lshl_add_u32 v8, v22, 4, v20
    s_lshr_b32 s45, s34, 1
    s_mul_i32 s45, s45, 4096
    v_add_u32 v8, s45, v8
    v_xor_b32 v9, 64, v8
    v_bfe_u32 v20, v0, 2, 2
    v_lshl_add_u32 v22, v21, 3, v20
    v_lshlrev_b32 v22, 8, v22
    v_and_b32 v23, 3, v0
    v_lshl_add_u32 v22, v23, 3, v22
    v_add_u32 v22, 65536, v22
    v_bfe_u32 v23, v0, 4, 1
    v_lshl_or_b32 v20, v23, 2, v20
    s_and_b32 s45, s34, 1
    s_lshl_b32 s45, s45, 2
    s_or_b32 s46, s45, 0
    v_xor_b32 v23, s46, v20
    v_lshl_add_u32 v10, v23, 5, v22
    s_or_b32 s46, s45, 1
    v_xor_b32 v23, s46, v20
    v_lshl_add_u32 v11, v23, 5, v22
    s_or_b32 s46, s45, 2
    v_xor_b32 v23, s46, v20
    v_lshl_add_u32 v12, v23, 5, v22
    s_or_b32 s46, s45, 3
    v_xor_b32 v23, s46, v20
    v_lshl_add_u32 v13, v23, 5, v22
    v_and_b32 v26, 15, v0
    v_bfe_u32 v27, v0, 4, 1
    v_lshrrev_b32 v20, 5, v0
    v_lshl_add_u32 v27, v27, 1, v20
    v_and_b32 v20, 15, v0
    v_lshrrev_b32 v21, 4, v0
    v_lshlrev_b32 v21, 9, v21
    v_lshl_add_u32 v20, v20, 4, v21
    s_lshr_b32 s45, s34, 1
    s_lshl_b32 s45, s45, 18
    s_and_b32 s46, s34, 1
    s_lshl_b32 s46, s46, 8
    s_add_u32 s45, s45, s46
    v_add_u32 v20, s45, v20
    v_add_u32 v2, 4096, v20
    v_add_u32 v3, 5120, v20
    s_lshr_b32 s45, s34, 1
    s_mul_i32 s45, s45, 4096
    v_lshlrev_b32 v8, 4, v0
    v_add_u32 v8, s45, v8
    v_add_u32 v9, 0x400, v8
    s_mov_b32 s30, 4096
    s_mov_b32 s12, s88
    s_and_b32 s13, s89, 0xffff
    s_mov_b32 s14, s87
    s_mov_b32 s16, s90
    s_and_b32 s17, s91, 0xffff
    s_mov_b32 s18, s92
    s_mov_b32 s24, s93
    s_mov_b32 s25, s94
    s_mov_b32 s31, s95
    v_mul_lo_u32 v6, v24, s31
    s_lshl_b32 s45, s31, 2
    s_sub_u32 s45, s45, 1024
    s_lshl_b32 s52, s31, 6
    v_add_u32 v6, v6, v25
    v_add_u32 v7, s45, v6
    s_mov_b32 s26, s96
    s_mov_b32 s27, s97
    s_mov_b32 s28, s98
    s_mov_b32 s29, s99
    s_mov_b32 s37, s100
    s_mov_b32 s36, s86
    s_cmp_eq_u32 s56, 1
    s_cselect_b32 s20, s80, s84
    s_cselect_b32 s21, s81, s85
    s_and_b32 s21, s21, 0xffff
    s_mov_b32 s22, 0x10000000
    s_cmp_eq_u32 s56, 1
    s_cselect_b32 s22, 0x800000, s22
    s_mov_b32 s49, 0
    s_mov_b32 s50, 0
    s_mov_b32 s47, 0
    s_mov_b32 s48, 0
    s_add_u32 m0, s53, s49
    s_nop 0
    buffer_load_dwordx4 v2, s[12:15], s24 offen offset:0 sc1 lds
    buffer_load_dwordx4 v3, s[12:15], s24 offen offset:1024 sc1 lds
    s_add_u32 m0, s54, s50
    s_add_u32 s24, s24, s30
    s_add_u32 s49, s49, 16384
    buffer_load_dwordx4 v6, s[16:19], s25 offen offset:0 lds
    buffer_load_dwordx4 v7, s[16:19], s25 offen offset:1024 lds
    s_add_u32 s25, s25, s52
    s_add_u32 s50, s50, 16384
    s_cmp_eq_u32 s49, 65536
    s_cselect_b32 s49, 0, s49
    s_cselect_b32 s50, 0, s50
    s_add_u32 m0, s53, s49
    s_nop 0
    buffer_load_dwordx4 v2, s[12:15], s24 offen offset:0 sc1 lds
    buffer_load_dwordx4 v3, s[12:15], s24 offen offset:1024 sc1 lds
    s_add_u32 m0, s54, s50
    s_add_u32 s24, s24, s30
    s_add_u32 s49, s49, 16384
    buffer_load_dwordx4 v6, s[16:19], s25 offen offset:0 lds
    buffer_load_dwordx4 v7, s[16:19], s25 offen offset:1024 lds
    s_add_u32 s25, s25, s52
    s_add_u32 s50, s50, 16384
    s_cmp_eq_u32 s49, 65536
    s_cselect_b32 s49, 0, s49
    s_cselect_b32 s50, 0, s50
    s_add_u32 m0, s53, s49
    s_nop 0
    buffer_load_dwordx4 v2, s[12:15], s24 offen offset:0 sc1 lds
    buffer_load_dwordx4 v3, s[12:15], s24 offen offset:1024 sc1 lds
    s_add_u32 m0, s54, s50
    s_add_u32 s24, s24, s30
    s_add_u32 s49, s49, 16384
    buffer_load_dwordx4 v6, s[16:19], s25 offen offset:0 lds
    buffer_load_dwordx4 v7, s[16:19], s25 offen offset:1024 lds
    s_add_u32 s25, s25, s52
    s_add_u32 s50, s50, 16384
    s_cmp_eq_u32 s49, 65536
    s_cselect_b32 s49, 0, s49
    s_cselect_b32 s50, 0, s50
    s_add_u32 m0, s53, s49
    s_nop 0
    buffer_load_dwordx4 v2, s[12:15], s24 offen offset:0 sc1 lds
    buffer_load_dwordx4 v3, s[12:15], s24 offen offset:1024 sc1 lds
    s_add_u32 m0, s54, s50
    s_add_u32 s24, s24, s30
    s_add_u32 s49, s49, 16384
    buffer_load_dwordx4 v6, s[16:19], s25 offen offset:0 lds
    buffer_load_dwordx4 v7, s[16:19], s25 offen offset:1024 lds
    s_add_u32 s25, s25, s52
    s_add_u32 s50, s50, 16384
    s_cmp_eq_u32 s49, 65536
    s_cselect_b32 s49, 0, s49
    s_cselect_b32 s50, 0, s50
    s_waitcnt vmcnt(12)
    s_barrier
    v_add_u32 v14, s47, v8
    v_add_u32 v15, s47, v9
    v_add_u32 v16, s48, v10
    v_add_u32 v17, s48, v11
    v_add_u32 v18, s48, v12
    v_add_u32 v19, s48, v13
    s_add_u32 s47, s47, 16384
    s_add_u32 s48, s48, 16384
    s_cmp_eq_u32 s47, 65536
    s_cselect_b32 s47, 0, s47
    s_cselect_b32 s48, 0, s48
    ds_read_b128 v[128:131], v14 offset:0
    ds_read_b64_tr_b16 v[144:145], v16 offset:0
    ds_read_b64_tr_b16 v[146:147], v16 offset:1024
    ds_read_b128 v[132:135], v14 offset:2048
    ds_read_b64_tr_b16 v[148:149], v17 offset:0
    ds_read_b64_tr_b16 v[150:151], v17 offset:1024
    ds_read_b64_tr_b16 v[152:153], v18 offset:0
    ds_read_b64_tr_b16 v[154:155], v18 offset:1024
    ds_read_b64_tr_b16 v[156:157], v19 offset:0
    ds_read_b64_tr_b16 v[158:159], v19 offset:1024
    s_waitcnt lgkmcnt(0)
    v_mfma_f32_16x16x32_bf16 v[64:67], v[144:147], v[128:131], 0
    ds_read_b128 v[160:163], v15 offset:0
    ds_read_b64_tr_b16 v[176:177], v16 offset:8192
    v_mfma_f32_16x16x32_bf16 v[68:71], v[148:151], v[128:131], 0
    ds_read_b64_tr_b16 v[178:179], v16 offset:9216
    ds_read_b128 v[164:167], v15 offset:2048
    v_mfma_f32_16x16x32_bf16 v[72:75], v[152:155], v[128:131], 0
    ds_read_b64_tr_b16 v[180:181], v17 offset:8192
    ds_read_b64_tr_b16 v[182:183], v17 offset:9216
    v_mfma_f32_16x16x32_bf16 v[76:79], v[156:159], v[128:131], 0
    ds_read_b64_tr_b16 v[184:185], v18 offset:8192
    ds_read_b64_tr_b16 v[186:187], v18 offset:9216
    v_mfma_f32_16x16x32_bf16 v[80:83], v[144:147], v[132:135], 0
    ds_read_b64_tr_b16 v[188:189], v19 offset:8192
    ds_read_b64_tr_b16 v[190:191], v19 offset:9216
    v_mfma_f32_16x16x32_bf16 v[84:87], v[148:151], v[132:135], 0
    v_add_u32 v14, s47, v8
    v_add_u32 v15, s47, v9
    v_add_u32 v16, s48, v10
    v_mfma_f32_16x16x32_bf16 v[88:91], v[152:155], v[132:135], 0
    v_add_u32 v17, s48, v11
    v_add_u32 v18, s48, v12
    v_add_u32 v19, s48, v13
    v_mfma_f32_16x16x32_bf16 v[92:95], v[156:159], v[132:135], 0
    s_add_u32 s47, s47, 16384
    s_add_u32 s48, s48, 16384
    s_cmp_eq_u32 s47, 65536
    s_cselect_b32 s47, 0, s47
    s_cselect_b32 s48, 0, s48
    s_add_u32 m0, s53, s49
    s_waitcnt vmcnt(8) lgkmcnt(0)
    s_barrier
    v_mfma_f32_16x16x32_bf16 v[64:67], v[176:179], v[160:163], v[64:67]
    ds_read_b128 v[128:131], v14 offset:0
    ds_read_b64_tr_b16 v[144:145], v16 offset:0
    v_mfma_f32_16x16x32_bf16 v[68:71], v[180:183], v[160:163], v[68:71]
    ds_read_b64_tr_b16 v[146:147], v16 offset:1024
    ds_read_b128 v[132:135], v14 offset:2048
    buffer_load_dwordx4 v2, s[12:15], s24 offen offset:0 sc1 lds
    v_mfma_f32_16x16x32_bf16 v[72:75], v[184:187], v[160:163], v[72:75]
    ds_read_b64_tr_b16 v[148:149], v17 offset:0
    ds_read_b64_tr_b16 v[150:151], v17 offset:1024
    v_mfma_f32_16x16x32_bf16 v[76:79], v[188:191], v[160:163], v[76:79]
    ds_read_b64_tr_b16 v[152:153], v18 offset:0
    ds_read_b64_tr_b16 v[154:155], v18 offset:1024
    buffer_load_dwordx4 v3, s[12:15], s24 offen offset:1024 sc1 lds
    s_add_u32 m0, s54, s50
    s_add_u32 s24, s24, s30
    s_add_u32 s49, s49, 16384
    v_mfma_f32_16x16x32_bf16 v[80:83], v[176:179], v[164:167], v[80:83]
    ds_read_b64_tr_b16 v[156:157], v19 offset:0
    ds_read_b64_tr_b16 v[158:159], v19 offset:1024
    v_mfma_f32_16x16x32_bf16 v[84:87], v[180:183], v[164:167], v[84:87]
    buffer_load_dwordx4 v6, s[16:19], s25 offen offset:0 lds
    v_mfma_f32_16x16x32_bf16 v[88:91], v[184:187], v[164:167], v[88:91]
    buffer_load_dwordx4 v7, s[16:19], s25 offen offset:1024 lds
    s_add_u32 s25, s25, s52
    s_add_u32 s50, s50, 16384
    v_mfma_f32_16x16x32_bf16 v[92:95], v[188:191], v[164:167], v[92:95]
    s_cmp_eq_u32 s49, 65536
    s_cselect_b32 s49, 0, s49
    s_cselect_b32 s50, 0, s50
    s_mov_b32 s51, 59
GS_LOOP:
    s_waitcnt lgkmcnt(0)
    v_mfma_f32_16x16x32_bf16 v[64:67], v[144:147], v[128:131], v[64:67]
    ds_read_b128 v[160:163], v15 offset:0
    ds_read_b64_tr_b16 v[176:177], v16 offset:8192
    v_mfma_f32_16x16x32_bf16 v[68:71], v[148:151], v[128:131], v[68:71]
    ds_read_b64_tr_b16 v[178:179], v16 offset:9216
    ds_read_b128 v[164:167], v15 offset:2048
    v_mfma_f32_16x16x32_bf16 v[72:75], v[152:155], v[128:131], v[72:75]
    ds_read_b64_tr_b16 v[180:181], v17 offset:8192
    ds_read_b64_tr_b16 v[182:183], v17 offset:9216
    v_mfma_f32_16x16x32_bf16 v[76:79], v[156:159], v[128:131], v[76:79]
    ds_read_b64_tr_b16 v[184:185], v18 offset:8192
    ds_read_b64_tr_b16 v[186:187], v18 offset:9216
    v_mfma_f32_16x16x32_bf16 v[80:83], v[144:147], v[132:135], v[80:83]
    ds_read_b64_tr_b16 v[188:189], v19 offset:8192
    ds_read_b64_tr_b16 v[190:191], v19 offset:9216
    v_mfma_f32_16x16x32_bf16 v[84:87], v[148:151], v[132:135], v[84:87]
    v_add_u32 v14, s47, v8
    v_add_u32 v15, s47, v9
    v_add_u32 v16, s48, v10
    v_mfma_f32_16x16x32_bf16 v[88:91], v[152:155], v[132:135], v[88:91]
    v_add_u32 v17, s48, v11
    v_add_u32 v18, s48, v12
    v_add_u32 v19, s48, v13
    v_mfma_f32_16x16x32_bf16 v[92:95], v[156:159], v[132:135], v[92:95]
    s_add_u32 s47, s47, 16384
    s_add_u32 s48, s48, 16384
    s_cmp_eq_u32 s47, 65536
    s_cselect_b32 s47, 0, s47
    s_cselect_b32 s48, 0, s48
    s_add_u32 m0, s53, s49
    s_waitcnt vmcnt(8) lgkmcnt(0)
    s_barrier
    v_mfma_f32_16x16x32_bf16 v[64:67], v[176:179], v[160:163], v[64:67]
    ds_read_b128 v[128:131], v14 offset:0
    ds_read_b64_tr_b16 v[144:145], v16 offset:0
    v_mfma_f32_16x16x32_bf16 v[68:71], v[180:183], v[160:163], v[68:71]
    ds_read_b64_tr_b16 v[146:147], v16 offset:1024
    ds_read_b128 v[132:135], v14 offset:2048
    buffer_load_dwordx4 v2, s[12:15], s24 offen offset:0 sc1 lds
    v_mfma_f32_16x16x32_bf16 v[72:75], v[184:187], v[160:163], v[72:75]
    ds_read_b64_tr_b16 v[148:149], v17 offset:0
    ds_read_b64_tr_b16 v[150:151], v17 offset:1024
    v_mfma_f32_16x16x32_bf16 v[76:79], v[188:191], v[160:163], v[76:79]
    ds_read_b64_tr_b16 v[152:153], v18 offset:0
    ds_read_b64_tr_b16 v[154:155], v18 offset:1024
    buffer_load_dwordx4 v3, s[12:15], s24 offen offset:1024 sc1 lds
    s_add_u32 m0, s54, s50
    s_add_u32 s24, s24, s30
    s_add_u32 s49, s49, 16384
    v_mfma_f32_16x16x32_bf16 v[80:83], v[176:179], v[164:167], v[80:83]
    ds_read_b64_tr_b16 v[156:157], v19 offset:0
    ds_read_b64_tr_b16 v[158:159], v19 offset:1024
    v_mfma_f32_16x16x32_bf16 v[84:87], v[180:183], v[164:167], v[84:87]
    buffer_load_dwordx4 v6, s[16:19], s25 offen offset:0 lds
    v_mfma_f32_16x16x32_bf16 v[88:91], v[184:187], v[164:167], v[88:91]
    buffer_load_dwordx4 v7, s[16:19], s25 offen offset:1024 lds
    s_add_u32 s25, s25, s52
    s_add_u32 s50, s50, 16384
    v_mfma_f32_16x16x32_bf16 v[92:95], v[188:191], v[164:167], v[92:95]
    s_cmp_eq_u32 s49, 65536
    s_cselect_b32 s49, 0, s49
    s_cselect_b32 s50, 0, s50
    s_sub_u32 s51, s51, 1
    s_cmp_lg_u32 s51, 0
    s_cbranch_scc1 GS_LOOP
    s_waitcnt lgkmcnt(0)
    v_mfma_f32_16x16x32_bf16 v[64:67], v[144:147], v[128:131], v[64:67]
    ds_read_b128 v[160:163], v15 offset:0
    ds_read_b64_tr_b16 v[176:177], v16 offset:8192
    v_mfma_f32_16x16x32_bf16 v[68:71], v[148:151], v[128:131], v[68:71]
    ds_read_b64_tr_b16 v[178:179], v16 offset:9216
    ds_read_b128 v[164:167], v15 offset:2048
    v_mfma_f32_16x16x32_bf16 v[72:75], v[152:155], v[128:131], v[72:75]
    ds_read_b64_tr_b16 v[180:181], v17 offset:8192
    ds_read_b64_tr_b16 v[182:183], v17 offset:9216
    v_mfma_f32_16x16x32_bf16 v[76:79], v[156:159], v[128:131], v[76:79]
    ds_read_b64_tr_b16 v[184:185], v18 offset:8192
    ds_read_b64_tr_b16 v[186:187], v18 offset:9216
    v_mfma_f32_16x16x32_bf16 v[80:83], v[144:147], v[132:135], v[80:83]
    ds_read_b64_tr_b16 v[188:189], v19 offset:8192
    ds_read_b64_tr_b16 v[190:191], v19 offset:9216
    v_mfma_f32_16x16x32_bf16 v[84:87], v[148:151], v[132:135], v[84:87]
    v_add_u32 v14, s47, v8
    v_add_u32 v15, s47, v9
    v_add_u32 v16, s48, v10
    v_mfma_f32_16x16x32_bf16 v[88:91], v[152:155], v[132:135], v[88:91]
    v_add_u32 v17, s48, v11
    v_add_u32 v18, s48, v12
    v_add_u32 v19, s48, v13
    v_mfma_f32_16x16x32_bf16 v[92:95], v[156:159], v[132:135], v[92:95]
    s_add_u32 s47, s47, 16384
    s_add_u32 s48, s48, 16384
    s_cmp_eq_u32 s47, 65536
    s_cselect_b32 s47, 0, s47
    s_cselect_b32 s48, 0, s48
    s_waitcnt vmcnt(8) lgkmcnt(0)
    s_barrier
    v_mfma_f32_16x16x32_bf16 v[64:67], v[176:179], v[160:163], v[64:67]
    ds_read_b128 v[128:131], v14 offset:0
    ds_read_b64_tr_b16 v[144:145], v16 offset:0
    v_mfma_f32_16x16x32_bf16 v[68:71], v[180:183], v[160:163], v[68:71]
    ds_read_b64_tr_b16 v[146:147], v16 offset:1024
    ds_read_b128 v[132:135], v14 offset:2048
    v_mfma_f32_16x16x32_bf16 v[72:75], v[184:187], v[160:163], v[72:75]
    ds_read_b64_tr_b16 v[148:149], v17 offset:0
    ds_read_b64_tr_b16 v[150:151], v17 offset:1024
    v_mfma_f32_16x16x32_bf16 v[76:79], v[188:191], v[160:163], v[76:79]
    ds_read_b64_tr_b16 v[152:153], v18 offset:0
    ds_read_b64_tr_b16 v[154:155], v18 offset:1024
    v_mfma_f32_16x16x32_bf16 v[80:83], v[176:179], v[164:167], v[80:83]
    ds_read_b64_tr_b16 v[156:157], v19 offset:0
    ds_read_b64_tr_b16 v[158:159], v19 offset:1024
    v_mfma_f32_16x16x32_bf16 v[84:87], v[180:183], v[164:167], v[84:87]
    v_mfma_f32_16x16x32_bf16 v[88:91], v[184:187], v[164:167], v[88:91]
    v_mfma_f32_16x16x32_bf16 v[92:95], v[188:191], v[164:167], v[92:95]
    s_waitcnt lgkmcnt(0)
    v_mfma_f32_16x16x32_bf16 v[64:67], v[144:147], v[128:131], v[64:67]
    ds_read_b128 v[160:163], v15 offset:0
    ds_read_b64_tr_b16 v[176:177], v16 offset:8192
    v_mfma_f32_16x16x32_bf16 v[68:71], v[148:151], v[128:131], v[68:71]
    ds_read_b64_tr_b16 v[178:179], v16 offset:9216
    ds_read_b128 v[164:167], v15 offset:2048
    v_mfma_f32_16x16x32_bf16 v[72:75], v[152:155], v[128:131], v[72:75]
    ds_read_b64_tr_b16 v[180:181], v17 offset:8192
    ds_read_b64_tr_b16 v[182:183], v17 offset:9216
    v_mfma_f32_16x16x32_bf16 v[76:79], v[156:159], v[128:131], v[76:79]
    ds_read_b64_tr_b16 v[184:185], v18 offset:8192
    ds_read_b64_tr_b16 v[186:187], v18 offset:9216
    v_mfma_f32_16x16x32_bf16 v[80:83], v[144:147], v[132:135], v[80:83]
    ds_read_b64_tr_b16 v[188:189], v19 offset:8192
    ds_read_b64_tr_b16 v[190:191], v19 offset:9216
    v_mfma_f32_16x16x32_bf16 v[84:87], v[148:151], v[132:135], v[84:87]
    v_add_u32 v14, s47, v8
    v_add_u32 v15, s47, v9
    v_add_u32 v16, s48, v10
    v_mfma_f32_16x16x32_bf16 v[88:91], v[152:155], v[132:135], v[88:91]
    v_add_u32 v17, s48, v11
    v_add_u32 v18, s48, v12
    v_add_u32 v19, s48, v13
    v_mfma_f32_16x16x32_bf16 v[92:95], v[156:159], v[132:135], v[92:95]
    s_add_u32 s47, s47, 16384
    s_add_u32 s48, s48, 16384
    s_cmp_eq_u32 s47, 65536
    s_cselect_b32 s47, 0, s47
    s_cselect_b32 s48, 0, s48
    s_waitcnt vmcnt(4) lgkmcnt(0)
    s_barrier
    v_mfma_f32_16x16x32_bf16 v[64:67], v[176:179], v[160:163], v[64:67]
    ds_read_b128 v[128:131], v14 offset:0
    ds_read_b64_tr_b16 v[144:145], v16 offset:0
    v_mfma_f32_16x16x32_bf16 v[68:71], v[180:183], v[160:163], v[68:71]
    ds_read_b64_tr_b16 v[146:147], v16 offset:1024
    ds_read_b128 v[132:135], v14 offset:2048
    v_mfma_f32_16x16x32_bf16 v[72:75], v[184:187], v[160:163], v[72:75]
    ds_read_b64_tr_b16 v[148:149], v17 offset:0
    ds_read_b64_tr_b16 v[150:151], v17 offset:1024
    v_mfma_f32_16x16x32_bf16 v[76:79], v[188:191], v[160:163], v[76:79]
    ds_read_b64_tr_b16 v[152:153], v18 offset:0
    ds_read_b64_tr_b16 v[154:155], v18 offset:1024
    v_mfma_f32_16x16x32_bf16 v[80:83], v[176:179], v[164:167], v[80:83]
    ds_read_b64_tr_b16 v[156:157], v19 offset:0
    ds_read_b64_tr_b16 v[158:159], v19 offset:1024
    v_mfma_f32_16x16x32_bf16 v[84:87], v[180:183], v[164:167], v[84:87]
    v_mfma_f32_16x16x32_bf16 v[88:91], v[184:187], v[164:167], v[88:91]
    v_mfma_f32_16x16x32_bf16 v[92:95], v[188:191], v[164:167], v[92:95]
    s_waitcnt lgkmcnt(0)
    v_mfma_f32_16x16x32_bf16 v[64:67], v[144:147], v[128:131], v[64:67]
    ds_read_b128 v[160:163], v15 offset:0
    ds_read_b64_tr_b16 v[176:177], v16 offset:8192
    v_mfma_f32_16x16x32_bf16 v[68:71], v[148:151], v[128:131], v[68:71]
    ds_read_b64_tr_b16 v[178:179], v16 offset:9216
    ds_read_b128 v[164:167], v15 offset:2048
    v_mfma_f32_16x16x32_bf16 v[72:75], v[152:155], v[128:131], v[72:75]
    ds_read_b64_tr_b16 v[180:181], v17 offset:8192
    ds_read_b64_tr_b16 v[182:183], v17 offset:9216
    v_mfma_f32_16x16x32_bf16 v[76:79], v[156:159], v[128:131], v[76:79]
    ds_read_b64_tr_b16 v[184:185], v18 offset:8192
    ds_read_b64_tr_b16 v[186:187], v18 offset:9216
    v_mfma_f32_16x16x32_bf16 v[80:83], v[144:147], v[132:135], v[80:83]
    ds_read_b64_tr_b16 v[188:189], v19 offset:8192
    ds_read_b64_tr_b16 v[190:191], v19 offset:9216
    v_mfma_f32_16x16x32_bf16 v[84:87], v[148:151], v[132:135], v[84:87]
    v_add_u32 v14, s47, v8
    v_add_u32 v15, s47, v9
    v_add_u32 v16, s48, v10
    v_mfma_f32_16x16x32_bf16 v[88:91], v[152:155], v[132:135], v[88:91]
    v_add_u32 v17, s48, v11
    v_add_u32 v18, s48, v12
    v_add_u32 v19, s48, v13
    v_mfma_f32_16x16x32_bf16 v[92:95], v[156:159], v[132:135], v[92:95]
    s_add_u32 s47, s47, 16384
    s_add_u32 s48, s48, 16384
    s_cmp_eq_u32 s47, 65536
    s_cselect_b32 s47, 0, s47
    s_cselect_b32 s48, 0, s48
    s_waitcnt vmcnt(0) lgkmcnt(0)
    s_barrier
    v_mfma_f32_16x16x32_bf16 v[64:67], v[176:179], v[160:163], v[64:67]
    ds_read_b128 v[128:131], v14 offset:0
    ds_read_b64_tr_b16 v[144:145], v16 offset:0
    v_mfma_f32_16x16x32_bf16 v[68:71], v[180:183], v[160:163], v[68:71]
    ds_read_b64_tr_b16 v[146:147], v16 offset:1024
    ds_read_b128 v[132:135], v14 offset:2048
    v_mfma_f32_16x16x32_bf16 v[72:75], v[184:187], v[160:163], v[72:75]
    ds_read_b64_tr_b16 v[148:149], v17 offset:0
    ds_read_b64_tr_b16 v[150:151], v17 offset:1024
    v_mfma_f32_16x16x32_bf16 v[76:79], v[188:191], v[160:163], v[76:79]
    ds_read_b64_tr_b16 v[152:153], v18 offset:0
    ds_read_b64_tr_b16 v[154:155], v18 offset:1024
    v_mfma_f32_16x16x32_bf16 v[80:83], v[176:179], v[164:167], v[80:83]
    ds_read_b64_tr_b16 v[156:157], v19 offset:0
    ds_read_b64_tr_b16 v[158:159], v19 offset:1024
    v_mfma_f32_16x16x32_bf16 v[84:87], v[180:183], v[164:167], v[84:87]
    v_mfma_f32_16x16x32_bf16 v[88:91], v[184:187], v[164:167], v[88:91]
    v_mfma_f32_16x16x32_bf16 v[92:95], v[188:191], v[164:167], v[92:95]
    s_waitcnt lgkmcnt(0)
    v_mfma_f32_16x16x32_bf16 v[64:67], v[144:147], v[128:131], v[64:67]
    ds_read_b128 v[160:163], v15 offset:0
    ds_read_b64_tr_b16 v[176:177], v16 offset:8192
    v_mfma_f32_16x16x32_bf16 v[68:71], v[148:151], v[128:131], v[68:71]
    ds_read_b64_tr_b16 v[178:179], v16 offset:9216
    ds_read_b128 v[164:167], v15 offset:2048
    v_mfma_f32_16x16x32_bf16 v[72:75], v[152:155], v[128:131], v[72:75]
    ds_read_b64_tr_b16 v[180:181], v17 offset:8192
    ds_read_b64_tr_b16 v[182:183], v17 offset:9216
    v_mfma_f32_16x16x32_bf16 v[76:79], v[156:159], v[128:131], v[76:79]
    ds_read_b64_tr_b16 v[184:185], v18 offset:8192
    ds_read_b64_tr_b16 v[186:187], v18 offset:9216
    v_mfma_f32_16x16x32_bf16 v[80:83], v[144:147], v[132:135], v[80:83]
    ds_read_b64_tr_b16 v[188:189], v19 offset:8192
    ds_read_b64_tr_b16 v[190:191], v19 offset:9216
    v_mfma_f32_16x16x32_bf16 v[84:87], v[148:151], v[132:135], v[84:87]
    v_mfma_f32_16x16x32_bf16 v[88:91], v[152:155], v[132:135], v[88:91]
    v_mfma_f32_16x16x32_bf16 v[92:95], v[156:159], v[132:135], v[92:95]
    s_waitcnt lgkmcnt(0)
    v_mfma_f32_16x16x32_bf16 v[64:67], v[176:179], v[160:163], v[64:67]
    v_mfma_f32_16x16x32_bf16 v[68:71], v[180:183], v[160:163], v[68:71]
    v_mfma_f32_16x16x32_bf16 v[72:75], v[184:187], v[160:163], v[72:75]
    v_mfma_f32_16x16x32_bf16 v[76:79], v[188:191], v[160:163], v[76:79]
    v_mfma_f32_16x16x32_bf16 v[80:83], v[176:179], v[164:167], v[80:83]
    v_mfma_f32_16x16x32_bf16 v[84:87], v[180:183], v[164:167], v[84:87]
    v_mfma_f32_16x16x32_bf16 v[88:91], v[184:187], v[164:167], v[88:91]
    v_mfma_f32_16x16x32_bf16 v[92:95], v[188:191], v[164:167], v[92:95]
    s_lshr_b32 s45, s34, 1
    s_and_b32 s46, s34, 1
    s_lshl_b32 s46, s46, 1
    v_mul_lo_u32 v20, v26, s27
    s_mul_i32 s45, s45, 1
    s_mul_i32 s45, s45, s28
    s_mul_i32 s46, s46, s29
    s_add_u32 s26, s26, s45
    s_add_u32 s26, s26, s46
    s_cmp_eq_u32 s27, 16
    s_cselect_b32 s45, 9, 4
    v_lshl_add_u32 v20, v27, s45, v20
    s_lshl_b32 s45, s27, 4
    v_add_u32 v21, s45, v20
    v_cvt_pk_bf16_f32 v160, v64, v65
    v_cvt_pk_bf16_f32 v161, v66, v67
    v_cvt_pk_bf16_f32 v162, v68, v69
    v_cvt_pk_bf16_f32 v163, v70, v71
    v_cvt_pk_bf16_f32 v164, v72, v73
    v_cvt_pk_bf16_f32 v165, v74, v75
    v_cvt_pk_bf16_f32 v166, v76, v77
    v_cvt_pk_bf16_f32 v167, v78, v79
    v_cvt_pk_bf16_f32 v168, v80, v81
    v_cvt_pk_bf16_f32 v169, v82, v83
    v_cvt_pk_bf16_f32 v170, v84, v85
    v_cvt_pk_bf16_f32 v171, v86, v87
    v_cvt_pk_bf16_f32 v172, v88, v89
    v_cvt_pk_bf16_f32 v173, v90, v91
    v_cvt_pk_bf16_f32 v174, v92, v93
    v_cvt_pk_bf16_f32 v175, v94, v95
    s_add_u32 s46, s26, s29
    v_permlane16_swap_b32 v160, v162
    v_permlane16_swap_b32 v161, v163
    buffer_store_dwordx4 v[160:163], v20, s[20:23], s26 offen sc1
    v_permlane16_swap_b32 v164, v166
    v_permlane16_swap_b32 v165, v167
    buffer_store_dwordx4 v[164:167], v20, s[20:23], s46 offen sc1
    v_permlane16_swap_b32 v168, v170
    v_permlane16_swap_b32 v169, v171
    buffer_store_dwordx4 v[168:171], v21, s[20:23], s26 offen sc1
    v_permlane16_swap_b32 v172, v174
    v_permlane16_swap_b32 v173, v175
    buffer_store_dwordx4 v[172:175], v21, s[20:23], s46 offen sc1
    s_mov_b32 s39, 0
    s_branch B_DECODE
B_CG4:
    s_and_b32 s45, s34, 1
    s_lshl_b32 s45, s45, 2
    v_lshrrev_b32 v20, 4, v0
    v_or_b32 v21, s45, v20
    v_bfe_u32 v22, v0, 1, 3
    v_xor_b32 v22, v22, v21
    v_and_b32 v23, 1, v0
    v_lshl_or_b32 v22, v22, 1, v23
    v_lshlrev_b32 v25, 4, v22
    s_lshl_b32 s45, s34, 3
    v_add_u32 v24, s45, v20
    s_mul_i32 s53, s34, 4096
    s_lshl_b32 s54, s34, 11
    s_add_u32 s54, s54, 98304
    v_and_b32 v20, 15, v0
    v_lshrrev_b32 v21, 4, v0
    v_bfe_u32 v22, v0, 1, 3
    v_xor_b32 v22, v22, v21
    v_lshlrev_b32 v20, 7, v20
    v_lshl_add_u32 v8, v22, 4, v20
    s_lshr_b32 s45, s34, 1
    s_mul_i32 s45, s45, 8192
    v_add_u32 v8, s45, v8
    v_xor_b32 v9, 64, v8
    v_bfe_u32 v20, v0, 2, 2
    v_lshl_add_u32 v22, v21, 3, v20
    v_lshlrev_b32 v22, 8, v22
    v_and_b32 v23, 3, v0
    v_lshl_add_u32 v22, v23, 3, v22
    v_add_u32 v22, 98304, v22
    v_bfe_u32 v23, v0, 4, 1
    v_lshl_or_b32 v20, v23, 2, v20
    s_and_b32 s45, s34, 1
    s_lshl_b32 s45, s45, 2
    s_or_b32 s46, s45, 0
    v_xor_b32 v23, s46, v20
    v_lshl_add_u32 v10, v23, 5, v22
    s_or_b32 s46, s45, 1
    v_xor_b32 v23, s46, v20
    v_lshl_add_u32 v11, v23, 5, v22
    s_or_b32 s46, s45, 2
    v_xor_b32 v23, s46, v20
    v_lshl_add_u32 v12, v23, 5, v22
    s_or_b32 s46, s45, 3
    v_xor_b32 v23, s46, v20
    v_lshl_add_u32 v13, v23, 5, v22
    v_and_b32 v26, 15, v0
    v_bfe_u32 v27, v0, 4, 1
    v_lshrrev_b32 v20, 5, v0
    v_lshl_add_u32 v27, v27, 1, v20
    s_cmp_eq_u32 s4, 6
    s_cselect_b32 s40, 16, 18
    s_cbranch_scc1 B_CT
    s_cmp_eq_u32 s4, 3
    s_cbranch_scc1 B_CT
    s_mov_b32 s30, 2048
    v_lshrrev_b32 v20, 3, v0
    s_mul_i32 s45, s34, 32
    v_add_u32 v20, s45, v20
    v_add_u32 v21, 0, v20
    v_bfe_u32 v22, v21, 1, 3
    v_and_b32 v23, 7, v0
    v_xor_b32 v22, v22, v23
    v_mul_lo_u32 v21, v21, s30
    v_lshl_add_u32 v2, v22, 4, v21
    v_add_u32 v21, 8, v20
    v_bfe_u32 v22, v21, 1, 3
    v_and_b32 v23, 7, v0
    v_xor_b32 v22, v22, v23
    v_mul_lo_u32 v21, v21, s30
    v_lshl_add_u32 v3, v22, 4, v21
    v_subrev_u32 v3, 1024, v3
    v_add_u32 v21, 16, v20
    v_bfe_u32 v22, v21, 1, 3
    v_and_b32 v23, 7, v0
    v_xor_b32 v22, v22, v23
    v_mul_lo_u32 v21, v21, s30
    v_lshl_add_u32 v4, v22, 4, v21
    v_subrev_u32 v4, 2048, v4
    v_add_u32 v21, 24, v20
    v_bfe_u32 v22, v21, 1, 3
    v_and_b32 v23, 7, v0
    v_xor_b32 v22, v22, v23
    v_mul_lo_u32 v21, v21, s30
    v_lshl_add_u32 v5, v22, 4, v21
    v_subrev_u32 v5, 3072, v5
    s_mov_b32 s30, 128
    s_branch B_CS
B_CT:
    v_and_b32 v20, 15, v0
    v_lshrrev_b32 v21, 4, v0
    v_lshlrev_b32 v21, 9, v21
    v_lshl_add_u32 v20, v20, 4, v21
    s_lshl_b32 s45, s34, s40
    v_add_u32 v20, s45, v20
    v_add_u32 v2, 4096, v20
    v_add_u32 v3, 5120, v20
    v_add_u32 v4, 2304, v20
    v_add_u32 v5, 3328, v20
    s_lshr_b32 s45, s34, 1
    s_mul_i32 s45, s45, 8192
    v_lshlrev_b32 v8, 4, v0
    v_add_u32 v8, s45, v8
    v_add_u32 v9, 0x400, v8
    s_mov_b32 s30, 4096
B_CS:
    s_mov_b32 s12, s88
    s_and_b32 s13, s89, 0xffff
    s_mov_b32 s14, s87
    s_mov_b32 s16, s90
    s_and_b32 s17, s91, 0xffff
    s_mov_b32 s18, s92
    s_mov_b32 s24, s93
    s_mov_b32 s25, s94
    s_mov_b32 s31, s95
    v_mul_lo_u32 v6, v24, s31
    s_lshl_b32 s45, s31, 2
    s_sub_u32 s45, s45, 1024
    s_lshl_b32 s52, s31, 6
    v_add_u32 v6, v6, v25
    v_add_u32 v7, s45, v6
    s_mov_b32 s49, 0
    s_mov_b32 s50, 0
    s_mov_b32 s47, 0
    s_mov_b32 s48, 0
    s_add_u32 m0, s53, s49
    s_nop 0
    buffer_load_dwordx4 v2, s[12:15], s24 offen offset:0 sc1 lds
    buffer_load_dwordx4 v3, s[12:15], s24 offen offset:1024 sc1 lds
    buffer_load_dwordx4 v4, s[12:15], s24 offen offset:2048 sc1 lds
    buffer_load_dwordx4 v5, s[12:15], s24 offen offset:3072 sc1 lds
    s_add_u32 m0, s54, s50
    s_add_u32 s24, s24, s30
    s_add_u32 s49, s49, 32768
    buffer_load_dwordx4 v6, s[16:19], s25 offen offset:0 lds
    buffer_load_dwordx4 v7, s[16:19], s25 offen offset:1024 lds
    s_add_u32 s25, s25, s52
    s_add_u32 s50, s50, 16384
    s_cmp_eq_u32 s49, 98304
    s_cselect_b32 s49, 0, s49
    s_cselect_b32 s50, 0, s50
    s_add_u32 m0, s53, s49
    s_nop 0
    buffer_load_dwordx4 v2, s[12:15], s24 offen offset:0 sc1 lds
    buffer_load_dwordx4 v3, s[12:15], s24 offen offset:1024 sc1 lds
    buffer_load_dwordx4 v4, s[12:15], s24 offen offset:2048 sc1 lds
    buffer_load_dwordx4 v5, s[12:15], s24 offen offset:3072 sc1 lds
    s_add_u32 m0, s54, s50
    s_add_u32 s24, s24, s30
    s_add_u32 s49, s49, 32768
    buffer_load_dwordx4 v6, s[16:19], s25 offen offset:0 lds
    buffer_load_dwordx4 v7, s[16:19], s25 offen offset:1024 lds
    s_add_u32 s25, s25, s52
    s_add_u32 s50, s50, 16384
    s_cmp_eq_u32 s49, 98304
    s_cselect_b32 s49, 0, s49
    s_cselect_b32 s50, 0, s50
    s_add_u32 m0, s53, s49
    s_nop 0
    buffer_load_dwordx4 v2, s[12:15], s24 offen offset:0 sc1 lds
    buffer_load_dwordx4 v3, s[12:15], s24 offen offset:1024 sc1 lds
    buffer_load_dwordx4 v4, s[12:15], s24 offen offset:2048 sc1 lds
    buffer_load_dwordx4 v5, s[12:15], s24 offen offset:3072 sc1 lds
    s_add_u32 m0, s54, s50
    s_add_u32 s24, s24, s30
    s_add_u32 s49, s49, 32768
    buffer_load_dwordx4 v6, s[16:19], s25 offen offset:0 lds
    buffer_load_dwordx4 v7, s[16:19], s25 offen offset:1024 lds
    s_add_u32 s25, s25, s52
    s_add_u32 s50, s50, 16384
    s_cmp_eq_u32 s49, 98304
    s_cselect_b32 s49, 0, s49
    s_cselect_b32 s50, 0, s50
    s_waitcnt vmcnt(12)
    s_barrier
    v_add_u32 v14, s47, v8
    v_add_u32 v15, s47, v9
    v_add_u32 v16, s48, v10
    v_add_u32 v17, s48, v11
    v_add_u32 v18, s48, v12
    v_add_u32 v19, s48, v13
    s_add_u32 s47, s47, 32768
    s_add_u32 s48, s48, 16384
    s_cmp_eq_u32 s47, 98304
    s_cselect_b32 s47, 0, s47
    s_cselect_b32 s48, 0, s48
    ds_read_b128 v[128:131], v14 offset:0
    ds_read_b64_tr_b16 v[144:145], v16 offset:0
    ds_read_b64_tr_b16 v[146:147], v16 offset:1024
    ds_read_b128 v[132:135], v14 offset:2048
    ds_read_b64_tr_b16 v[148:149], v17 offset:0
    ds_read_b64_tr_b16 v[150:151], v17 offset:1024
    ds_read_b128 v[136:139], v14 offset:4096
    ds_read_b64_tr_b16 v[152:153], v18 offset:0
    ds_read_b64_tr_b16 v[154:155], v18 offset:1024
    ds_read_b128 v[140:143], v14 offset:6144
    ds_read_b64_tr_b16 v[156:157], v19 offset:0
    ds_read_b64_tr_b16 v[158:159], v19 offset:1024
    s_mov_b32 s44, 0
B_WARM:
    s_mov_b32 s5, s4
    s_mov_b32 s3, s57
    s_lshl_b32 s7, s58, 3
    s_add_u32 s7, s7, s34
    s_mov_b32 s26, s96
    s_mov_b32 s27, s97
    s_mov_b32 s28, s98
    s_mov_b32 s29, s99
    s_mov_b32 s37, s100
    s_mov_b32 s36, s86
    s_cmp_eq_u32 s56, 1
    s_cselect_b32 s20, s80, s84
    s_cselect_b32 s21, s81, s85
    s_and_b32 s21, s21, 0xffff
    s_mov_b32 s22, 0x10000000
    s_cmp_eq_u32 s56, 1
    s_cselect_b32 s22, 0x800000, s22
    s_lshl_b32 s40, s58, 7
    s_add_u32 s40, s40, 98566144
    s_cmp_eq_u32 s4, 2
    s_cselect_b32 s40, s40, 0
    s_load_dword s72, s[84:85], s40
    s_mov_b32 s39, 1
    s_branch B_DECODE
B_BODY_row:
    s_waitcnt lgkmcnt(0)
    v_mfma_f32_16x16x32_bf16 v[64:67], v[144:147], v[128:131], 0
    ds_read_b128 v[160:163], v15 offset:0
    v_mfma_f32_16x16x32_bf16 v[68:71], v[148:151], v[128:131], 0
    ds_read_b64_tr_b16 v[176:177], v16 offset:8192
    v_mfma_f32_16x16x32_bf16 v[72:75], v[152:155], v[128:131], 0
    ds_read_b64_tr_b16 v[178:179], v16 offset:9216
    v_mfma_f32_16x16x32_bf16 v[76:79], v[156:159], v[128:131], 0
    ds_read_b128 v[164:167], v15 offset:2048
    v_mfma_f32_16x16x32_bf16 v[80:83], v[144:147], v[132:135], 0
    ds_read_b64_tr_b16 v[180:181], v17 offset:8192
    v_mfma_f32_16x16x32_bf16 v[84:87], v[148:151], v[132:135], 0
    ds_read_b64_tr_b16 v[182:183], v17 offset:9216
    v_mfma_f32_16x16x32_bf16 v[88:91], v[152:155], v[132:135], 0
    ds_read_b128 v[168:171], v15 offset:4096
    v_mfma_f32_16x16x32_bf16 v[92:95], v[156:159], v[132:135], 0
    ds_read_b64_tr_b16 v[184:185], v18 offset:8192
    v_mfma_f32_16x16x32_bf16 v[96:99], v[144:147], v[136:139], 0
    ds_read_b64_tr_b16 v[186:187], v18 offset:9216
    v_mfma_f32_16x16x32_bf16 v[100:103], v[148:151], v[136:139], 0
    ds_read_b128 v[172:175], v15 offset:6144
    v_mfma_f32_16x16x32_bf16 v[104:107], v[152:155], v[136:139], 0
    ds_read_b64_tr_b16 v[188:189], v19 offset:8192
    v_mfma_f32_16x16x32_bf16 v[108:111], v[156:159], v[136:139], 0
    ds_read_b64_tr_b16 v[190:191], v19 offset:9216
    v_mfma_f32_16x16x32_bf16 v[112:115], v[144:147], v[140:143], 0
    v_add_u32 v14, s47, v8
    v_add_u32 v15, s47, v9
    v_mfma_f32_16x16x32_bf16 v[116:119], v[148:151], v[140:143], 0
    v_add_u32 v16, s48, v10
    v_add_u32 v17, s48, v11
    v_mfma_f32_16x16x32_bf16 v[120:123], v[152:155], v[140:143], 0
    v_add_u32 v18, s48, v12
    v_add_u32 v19, s48, v13
    v_mfma_f32_16x16x32_bf16 v[124:127], v[156:159], v[140:143], 0
    s_add_u32 s47, s47, 32768
    s_add_u32 s48, s48, 16384
    s_cmp_eq_u32 s47, 98304
    s_cselect_b32 s47, 0, s47
    s_cselect_b32 s48, 0, s48
    s_add_u32 m0, s53, s49
    s_cmp_eq_u32 s44, 1
    s_cbranch_scc1 B_CW0row
    s_waitcnt vmcnt(6)
B_CW0row:
    s_waitcnt vmcnt(14) lgkmcnt(0)
    s_barrier
    v_mfma_f32_16x16x32_bf16 v[64:67], v[176:179], v[160:163], v[64:67]
    ds_read_b128 v[128:131], v14 offset:0
    v_mfma_f32_16x16x32_bf16 v[68:71], v[180:183], v[160:163], v[68:71]
    ds_read_b64_tr_b16 v[144:145], v16 offset:0
    buffer_load_dwordx4 v2, s[12:15], s24 offen offset:0 sc1 lds
    v_mfma_f32_16x16x32_bf16 v[72:75], v[184:187], v[160:163], v[72:75]
    ds_read_b64_tr_b16 v[146:147], v16 offset:1024
    v_mfma_f32_16x16x32_bf16 v[76:79], v[188:191], v[160:163], v[76:79]
    ds_read_b128 v[132:135], v14 offset:2048
    v_mfma_f32_16x16x32_bf16 v[80:83], v[176:179], v[164:167], v[80:83]
    ds_read_b64_tr_b16 v[148:149], v17 offset:0
    buffer_load_dwordx4 v3, s[12:15], s24 offen offset:1024 sc1 lds
    v_mfma_f32_16x16x32_bf16 v[84:87], v[180:183], v[164:167], v[84:87]
    ds_read_b64_tr_b16 v[150:151], v17 offset:1024
    v_mfma_f32_16x16x32_bf16 v[88:91], v[184:187], v[164:167], v[88:91]
    ds_read_b128 v[136:139], v14 offset:4096
    v_mfma_f32_16x16x32_bf16 v[92:95], v[188:191], v[164:167], v[92:95]
    ds_read_b64_tr_b16 v[152:153], v18 offset:0
    buffer_load_dwordx4 v4, s[12:15], s24 offen offset:2048 sc1 lds
    v_mfma_f32_16x16x32_bf16 v[96:99], v[176:179], v[168:171], v[96:99]
    ds_read_b64_tr_b16 v[154:155], v18 offset:1024
    v_mfma_f32_16x16x32_bf16 v[100:103], v[180:183], v[168:171], v[100:103]
    ds_read_b128 v[140:143], v14 offset:6144
    v_mfma_f32_16x16x32_bf16 v[104:107], v[184:187], v[168:171], v[104:107]
    ds_read_b64_tr_b16 v[156:157], v19 offset:0
    buffer_load_dwordx4 v5, s[12:15], s24 offen offset:3072 sc1 lds
    s_add_u32 m0, s54, s50
    s_add_u32 s24, s24, s30
    s_add_u32 s49, s49, 32768
    v_mfma_f32_16x16x32_bf16 v[108:111], v[188:191], v[168:171], v[108:111]
    ds_read_b64_tr_b16 v[158:159], v19 offset:1024
    v_mfma_f32_16x16x32_bf16 v[112:115], v[176:179], v[172:175], v[112:115]
    buffer_load_dwordx4 v6, s[16:19], s25 offen offset:0 lds
    v_mfma_f32_16x16x32_bf16 v[116:119], v[180:183], v[172:175], v[116:119]
    v_mfma_f32_16x16x32_bf16 v[120:123], v[184:187], v[172:175], v[120:123]
    buffer_load_dwordx4 v7, s[16:19], s25 offen offset:1024 lds
    s_add_u32 s25, s25, s52
    s_add_u32 s50, s50, 16384
    v_mfma_f32_16x16x32_bf16 v[124:127], v[188:191], v[172:175], v[124:127]
    s_cmp_eq_u32 s49, 98304
    s_cselect_b32 s49, 0, s49
    s_cselect_b32 s50, 0, s50
    s_waitcnt lgkmcnt(0)
    v_mfma_f32_16x16x32_bf16 v[64:67], v[144:147], v[128:131], v[64:67]
    ds_read_b128 v[160:163], v15 offset:0
    v_mfma_f32_16x16x32_bf16 v[68:71], v[148:151], v[128:131], v[68:71]
    ds_read_b64_tr_b16 v[176:177], v16 offset:8192
    v_mfma_f32_16x16x32_bf16 v[72:75], v[152:155], v[128:131], v[72:75]
    ds_read_b64_tr_b16 v[178:179], v16 offset:9216
    v_mfma_f32_16x16x32_bf16 v[76:79], v[156:159], v[128:131], v[76:79]
    ds_read_b128 v[164:167], v15 offset:2048
    v_mfma_f32_16x16x32_bf16 v[80:83], v[144:147], v[132:135], v[80:83]
    ds_read_b64_tr_b16 v[180:181], v17 offset:8192
    v_mfma_f32_16x16x32_bf16 v[84:87], v[148:151], v[132:135], v[84:87]
    ds_read_b64_tr_b16 v[182:183], v17 offset:9216
    v_mfma_f32_16x16x32_bf16 v[88:91], v[152:155], v[132:135], v[88:91]
    ds_read_b128 v[168:171], v15 offset:4096
    v_mfma_f32_16x16x32_bf16 v[92:95], v[156:159], v[132:135], v[92:95]
    ds_read_b64_tr_b16 v[184:185], v18 offset:8192
    v_mfma_f32_16x16x32_bf16 v[96:99], v[144:147], v[136:139], v[96:99]
    ds_read_b64_tr_b16 v[186:187], v18 offset:9216
    v_mfma_f32_16x16x32_bf16 v[100:103], v[148:151], v[136:139], v[100:103]
    ds_read_b128 v[172:175], v15 offset:6144
    v_mfma_f32_16x16x32_bf16 v[104:107], v[152:155], v[136:139], v[104:107]
    ds_read_b64_tr_b16 v[188:189], v19 offset:8192
    v_mfma_f32_16x16x32_bf16 v[108:111], v[156:159], v[136:139], v[108:111]
    ds_read_b64_tr_b16 v[190:191], v19 offset:9216
    v_mfma_f32_16x16x32_bf16 v[112:115], v[144:147], v[140:143], v[112:115]
    v_add_u32 v14, s47, v8
    v_add_u32 v15, s47, v9
    v_mfma_f32_16x16x32_bf16 v[116:119], v[148:151], v[140:143], v[116:119]
    v_add_u32 v16, s48, v10
    v_add_u32 v17, s48, v11
    v_mfma_f32_16x16x32_bf16 v[120:123], v[152:155], v[140:143], v[120:123]
    v_add_u32 v18, s48, v12
    v_add_u32 v19, s48, v13
    v_mfma_f32_16x16x32_bf16 v[124:127], v[156:159], v[140:143], v[124:127]
    s_add_u32 s47, s47, 32768
    s_add_u32 s48, s48, 16384
    s_cmp_eq_u32 s47, 98304
    s_cselect_b32 s47, 0, s47
    s_cselect_b32 s48, 0, s48
    s_add_u32 m0, s53, s49
    s_cmp_eq_u32 s44, 1
    s_cbranch_scc1 B_CW1row
    s_waitcnt vmcnt(6)
B_CW1row:
    s_waitcnt vmcnt(14) lgkmcnt(0)
    s_barrier
    v_mfma_f32_16x16x32_bf16 v[64:67], v[176:179], v[160:163], v[64:67]
    ds_read_b128 v[128:131], v14 offset:0
    v_mfma_f32_16x16x32_bf16 v[68:71], v[180:183], v[160:163], v[68:71]
    ds_read_b64_tr_b16 v[144:145], v16 offset:0
    buffer_load_dwordx4 v2, s[12:15], s24 offen offset:0 sc1 lds
    v_mfma_f32_16x16x32_bf16 v[72:75], v[184:187], v[160:163], v[72:75]
    ds_read_b64_tr_b16 v[146:147], v16 offset:1024
    v_mfma_f32_16x16x32_bf16 v[76:79], v[188:191], v[160:163], v[76:79]
    ds_read_b128 v[132:135], v14 offset:2048
    v_mfma_f32_16x16x32_bf16 v[80:83], v[176:179], v[164:167], v[80:83]
    ds_read_b64_tr_b16 v[148:149], v17 offset:0
    buffer_load_dwordx4 v3, s[12:15], s24 offen offset:1024 sc1 lds
    v_mfma_f32_16x16x32_bf16 v[84:87], v[180:183], v[164:167], v[84:87]
    ds_read_b64_tr_b16 v[150:151], v17 offset:1024
    v_mfma_f32_16x16x32_bf16 v[88:91], v[184:187], v[164:167], v[88:91]
    ds_read_b128 v[136:139], v14 offset:4096
    v_mfma_f32_16x16x32_bf16 v[92:95], v[188:191], v[164:167], v[92:95]
    ds_read_b64_tr_b16 v[152:153], v18 offset:0
    buffer_load_dwordx4 v4, s[12:15], s24 offen offset:2048 sc1 lds
    v_mfma_f32_16x16x32_bf16 v[96:99], v[176:179], v[168:171], v[96:99]
    ds_read_b64_tr_b16 v[154:155], v18 offset:1024
    v_mfma_f32_16x16x32_bf16 v[100:103], v[180:183], v[168:171], v[100:103]
    ds_read_b128 v[140:143], v14 offset:6144
    v_mfma_f32_16x16x32_bf16 v[104:107], v[184:187], v[168:171], v[104:107]
    ds_read_b64_tr_b16 v[156:157], v19 offset:0
    buffer_load_dwordx4 v5, s[12:15], s24 offen offset:3072 sc1 lds
    s_add_u32 m0, s54, s50
    s_add_u32 s24, s24, s30
    s_add_u32 s49, s49, 32768
    v_mfma_f32_16x16x32_bf16 v[108:111], v[188:191], v[168:171], v[108:111]
    ds_read_b64_tr_b16 v[158:159], v19 offset:1024
    v_mfma_f32_16x16x32_bf16 v[112:115], v[176:179], v[172:175], v[112:115]
    buffer_load_dwordx4 v6, s[16:19], s25 offen offset:0 lds
    v_mfma_f32_16x16x32_bf16 v[116:119], v[180:183], v[172:175], v[116:119]
    v_mfma_f32_16x16x32_bf16 v[120:123], v[184:187], v[172:175], v[120:123]
    buffer_load_dwordx4 v7, s[16:19], s25 offen offset:1024 lds
    s_add_u32 s25, s25, s52
    s_add_u32 s50, s50, 16384
    v_mfma_f32_16x16x32_bf16 v[124:127], v[188:191], v[172:175], v[124:127]
    s_cmp_eq_u32 s49, 98304
    s_cselect_b32 s49, 0, s49
    s_cselect_b32 s50, 0, s50
    s_waitcnt lgkmcnt(0)
    v_mfma_f32_16x16x32_bf16 v[64:67], v[144:147], v[128:131], v[64:67]
    ds_read_b128 v[160:163], v15 offset:0
    v_mfma_f32_16x16x32_bf16 v[68:71], v[148:151], v[128:131], v[68:71]
    ds_read_b64_tr_b16 v[176:177], v16 offset:8192
    v_mfma_f32_16x16x32_bf16 v[72:75], v[152:155], v[128:131], v[72:75]
    ds_read_b64_tr_b16 v[178:179], v16 offset:9216
    v_mfma_f32_16x16x32_bf16 v[76:79], v[156:159], v[128:131], v[76:79]
    ds_read_b128 v[164:167], v15 offset:2048
    v_mfma_f32_16x16x32_bf16 v[80:83], v[144:147], v[132:135], v[80:83]
    ds_read_b64_tr_b16 v[180:181], v17 offset:8192
    v_mfma_f32_16x16x32_bf16 v[84:87], v[148:151], v[132:135], v[84:87]
    ds_read_b64_tr_b16 v[182:183], v17 offset:9216
    v_mfma_f32_16x16x32_bf16 v[88:91], v[152:155], v[132:135], v[88:91]
    ds_read_b128 v[168:171], v15 offset:4096
    v_mfma_f32_16x16x32_bf16 v[92:95], v[156:159], v[132:135], v[92:95]
    ds_read_b64_tr_b16 v[184:185], v18 offset:8192
    v_mfma_f32_16x16x32_bf16 v[96:99], v[144:147], v[136:139], v[96:99]
    ds_read_b64_tr_b16 v[186:187], v18 offset:9216
    v_mfma_f32_16x16x32_bf16 v[100:103], v[148:151], v[136:139], v[100:103]
    ds_read_b128 v[172:175], v15 offset:6144
    v_mfma_f32_16x16x32_bf16 v[104:107], v[152:155], v[136:139], v[104:107]
    ds_read_b64_tr_b16 v[188:189], v19 offset:8192
    v_mfma_f32_16x16x32_bf16 v[108:111], v[156:159], v[136:139], v[108:111]
    ds_read_b64_tr_b16 v[190:191], v19 offset:9216
    v_mfma_f32_16x16x32_bf16 v[112:115], v[144:147], v[140:143], v[112:115]
    v_add_u32 v14, s47, v8
    v_add_u32 v15, s47, v9
    v_mfma_f32_16x16x32_bf16 v[116:119], v[148:151], v[140:143], v[116:119]
    v_add_u32 v16, s48, v10
    v_add_u32 v17, s48, v11
    v_mfma_f32_16x16x32_bf16 v[120:123], v[152:155], v[140:143], v[120:123]
    v_add_u32 v18, s48, v12
    v_add_u32 v19, s48, v13
    v_mfma_f32_16x16x32_bf16 v[124:127], v[156:159], v[140:143], v[124:127]
    s_add_u32 s47, s47, 32768
    s_add_u32 s48, s48, 16384
    s_cmp_eq_u32 s47, 98304
    s_cselect_b32 s47, 0, s47
    s_cselect_b32 s48, 0, s48
    s_add_u32 m0, s53, s49
    s_waitcnt vmcnt(6) lgkmcnt(0)
    s_barrier
    s_cmp_lg_u32 s34, 0
    s_cbranch_scc1 SG_prow
    s_cmp_eq_u32 s38, 0
    s_cbranch_scc1 SG_prow
    s_and_b32 s40, s38, 1
    s_add_u32 s40, s40, 1
    v_mov_b32 v1, s40
    s_and_b32 s40, s38, -2
    s_mov_b64 exec, 1
    buffer_atomic_add v1, off, s[8:11], s40
    s_mov_b64 exec, -1
SG_prow:
    v_mfma_f32_16x16x32_bf16 v[64:67], v[176:179], v[160:163], v[64:67]
    ds_read_b128 v[128:131], v14 offset:0
    v_mfma_f32_16x16x32_bf16 v[68:71], v[180:183], v[160:163], v[68:71]
    ds_read_b64_tr_b16 v[144:145], v16 offset:0
    buffer_load_dwordx4 v2, s[12:15], s24 offen offset:0 sc1 lds
    v_mfma_f32_16x16x32_bf16 v[72:75], v[184:187], v[160:163], v[72:75]
    ds_read_b64_tr_b16 v[146:147], v16 offset:1024
    v_mfma_f32_16x16x32_bf16 v[76:79], v[188:191], v[160:163], v[76:79]
    ds_read_b128 v[132:135], v14 offset:2048
    v_mfma_f32_16x16x32_bf16 v[80:83], v[176:179], v[164:167], v[80:83]
    ds_read_b64_tr_b16 v[148:149], v17 offset:0
    buffer_load_dwordx4 v3, s[12:15], s24 offen offset:1024 sc1 lds
    v_mfma_f32_16x16x32_bf16 v[84:87], v[180:183], v[164:167], v[84:87]
    ds_read_b64_tr_b16 v[150:151], v17 offset:1024
    v_mfma_f32_16x16x32_bf16 v[88:91], v[184:187], v[164:167], v[88:91]
    ds_read_b128 v[136:139], v14 offset:4096
    v_mfma_f32_16x16x32_bf16 v[92:95], v[188:191], v[164:167], v[92:95]
    ds_read_b64_tr_b16 v[152:153], v18 offset:0
    buffer_load_dwordx4 v4, s[12:15], s24 offen offset:2048 sc1 lds
    v_mfma_f32_16x16x32_bf16 v[96:99], v[176:179], v[168:171], v[96:99]
    ds_read_b64_tr_b16 v[154:155], v18 offset:1024
    v_mfma_f32_16x16x32_bf16 v[100:103], v[180:183], v[168:171], v[100:103]
    ds_read_b128 v[140:143], v14 offset:6144
    v_mfma_f32_16x16x32_bf16 v[104:107], v[184:187], v[168:171], v[104:107]
    ds_read_b64_tr_b16 v[156:157], v19 offset:0
    buffer_load_dwordx4 v5, s[12:15], s24 offen offset:3072 sc1 lds
    s_add_u32 m0, s54, s50
    s_add_u32 s24, s24, s30
    s_add_u32 s49, s49, 32768
    v_mfma_f32_16x16x32_bf16 v[108:111], v[188:191], v[168:171], v[108:111]
    ds_read_b64_tr_b16 v[158:159], v19 offset:1024
    v_mfma_f32_16x16x32_bf16 v[112:115], v[176:179], v[172:175], v[112:115]
    buffer_load_dwordx4 v6, s[16:19], s25 offen offset:0 lds
    v_mfma_f32_16x16x32_bf16 v[116:119], v[180:183], v[172:175], v[116:119]
    v_mfma_f32_16x16x32_bf16 v[120:123], v[184:187], v[172:175], v[120:123]
    buffer_load_dwordx4 v7, s[16:19], s25 offen offset:1024 lds
    s_add_u32 s25, s25, s52
    s_add_u32 s50, s50, 16384
    v_mfma_f32_16x16x32_bf16 v[124:127], v[188:191], v[172:175], v[124:127]
    s_cmp_eq_u32 s49, 98304
    s_cselect_b32 s49, 0, s49
    s_cselect_b32 s50, 0, s50
    s_cmp_eq_u32 s5, 3
    s_cselect_b32 s51, 58, 10
    s_mov_b32 s44, 0
B_LOOP_row:
    s_waitcnt lgkmcnt(0)
    v_mfma_f32_16x16x32_bf16 v[64:67], v[144:147], v[128:131], v[64:67]
    ds_read_b128 v[160:163], v15 offset:0
    v_mfma_f32_16x16x32_bf16 v[68:71], v[148:151], v[128:131], v[68:71]
    ds_read_b64_tr_b16 v[176:177], v16 offset:8192
    v_mfma_f32_16x16x32_bf16 v[72:75], v[152:155], v[128:131], v[72:75]
    ds_read_b64_tr_b16 v[178:179], v16 offset:9216
    v_mfma_f32_16x16x32_bf16 v[76:79], v[156:159], v[128:131], v[76:79]
    ds_read_b128 v[164:167], v15 offset:2048
    v_mfma_f32_16x16x32_bf16 v[80:83], v[144:147], v[132:135], v[80:83]
    ds_read_b64_tr_b16 v[180:181], v17 offset:8192
    v_mfma_f32_16x16x32_bf16 v[84:87], v[148:151], v[132:135], v[84:87]
    ds_read_b64_tr_b16 v[182:183], v17 offset:9216
    v_mfma_f32_16x16x32_bf16 v[88:91], v[152:155], v[132:135], v[88:91]
    ds_read_b128 v[168:171], v15 offset:4096
    v_mfma_f32_16x16x32_bf16 v[92:95], v[156:159], v[132:135], v[92:95]
    ds_read_b64_tr_b16 v[184:185], v18 offset:8192
    v_mfma_f32_16x16x32_bf16 v[96:99], v[144:147], v[136:139], v[96:99]
    ds_read_b64_tr_b16 v[186:187], v18 offset:9216
    v_mfma_f32_16x16x32_bf16 v[100:103], v[148:151], v[136:139], v[100:103]
    ds_read_b128 v[172:175], v15 offset:6144
    v_mfma_f32_16x16x32_bf16 v[104:107], v[152:155], v[136:139], v[104:107]
    ds_read_b64_tr_b16 v[188:189], v19 offset:8192
    v_mfma_f32_16x16x32_bf16 v[108:111], v[156:159], v[136:139], v[108:111]
    ds_read_b64_tr_b16 v[190:191], v19 offset:9216
    v_mfma_f32_16x16x32_bf16 v[112:115], v[144:147], v[140:143], v[112:115]
    v_add_u32 v14, s47, v8
    v_add_u32 v15, s47, v9
    v_mfma_f32_16x16x32_bf16 v[116:119], v[148:151], v[140:143], v[116:119]
    v_add_u32 v16, s48, v10
    v_add_u32 v17, s48, v11
    v_mfma_f32_16x16x32_bf16 v[120:123], v[152:155], v[140:143], v[120:123]
    v_add_u32 v18, s48, v12
    v_add_u32 v19, s48, v13
    v_mfma_f32_16x16x32_bf16 v[124:127], v[156:159], v[140:143], v[124:127]
    s_add_u32 s47, s47, 32768
    s_add_u32 s48, s48, 16384
    s_cmp_eq_u32 s47, 98304
    s_cselect_b32 s47, 0, s47
    s_cselect_b32 s48, 0, s48
    s_add_u32 m0, s53, s49
    s_waitcnt vmcnt(6) lgkmcnt(0)
    s_barrier
    v_mfma_f32_16x16x32_bf16 v[64:67], v[176:179], v[160:163], v[64:67]
    ds_read_b128 v[128:131], v14 offset:0
    v_mfma_f32_16x16x32_bf16 v[68:71], v[180:183], v[160:163], v[68:71]
    ds_read_b64_tr_b16 v[144:145], v16 offset:0
    buffer_load_dwordx4 v2, s[12:15], s24 offen offset:0 sc1 lds
    v_mfma_f32_16x16x32_bf16 v[72:75], v[184:187], v[160:163], v[72:75]
    ds_read_b64_tr_b16 v[146:147], v16 offset:1024
    v_mfma_f32_16x16x32_bf16 v[76:79], v[188:191], v[160:163], v[76:79]
    ds_read_b128 v[132:135], v14 offset:2048
    v_mfma_f32_16x16x32_bf16 v[80:83], v[176:179], v[164:167], v[80:83]
    ds_read_b64_tr_b16 v[148:149], v17 offset:0
    buffer_load_dwordx4 v3, s[12:15], s24 offen offset:1024 sc1 lds
    v_mfma_f32_16x16x32_bf16 v[84:87], v[180:183], v[164:167], v[84:87]
    ds_read_b64_tr_b16 v[150:151], v17 offset:1024
    v_mfma_f32_16x16x32_bf16 v[88:91], v[184:187], v[164:167], v[88:91]
    ds_read_b128 v[136:139], v14 offset:4096
    v_mfma_f32_16x16x32_bf16 v[92:95], v[188:191], v[164:167], v[92:95]
    ds_read_b64_tr_b16 v[152:153], v18 offset:0
    buffer_load_dwordx4 v4, s[12:15], s24 offen offset:2048 sc1 lds
    v_mfma_f32_16x16x32_bf16 v[96:99], v[176:179], v[168:171], v[96:99]
    ds_read_b64_tr_b16 v[154:155], v18 offset:1024
    v_mfma_f32_16x16x32_bf16 v[100:103], v[180:183], v[168:171], v[100:103]
    ds_read_b128 v[140:143], v14 offset:6144
    v_mfma_f32_16x16x32_bf16 v[104:107], v[184:187], v[168:171], v[104:107]
    ds_read_b64_tr_b16 v[156:157], v19 offset:0
    buffer_load_dwordx4 v5, s[12:15], s24 offen offset:3072 sc1 lds
    s_add_u32 m0, s54, s50
    s_add_u32 s24, s24, s30
    s_add_u32 s49, s49, 32768
    v_mfma_f32_16x16x32_bf16 v[108:111], v[188:191], v[168:171], v[108:111]
    ds_read_b64_tr_b16 v[158:159], v19 offset:1024
    v_mfma_f32_16x16x32_bf16 v[112:115], v[176:179], v[172:175], v[112:115]
    buffer_load_dwordx4 v6, s[16:19], s25 offen offset:0 lds
    v_mfma_f32_16x16x32_bf16 v[116:119], v[180:183], v[172:175], v[116:119]
    v_mfma_f32_16x16x32_bf16 v[120:123], v[184:187], v[172:175], v[120:123]
    buffer_load_dwordx4 v7, s[16:19], s25 offen offset:1024 lds
    s_add_u32 s25, s25, s52
    s_add_u32 s50, s50, 16384
    v_mfma_f32_16x16x32_bf16 v[124:127], v[188:191], v[172:175], v[124:127]
    s_cmp_eq_u32 s49, 98304
    s_cselect_b32 s49, 0, s49
    s_cselect_b32 s50, 0, s50
    s_sub_u32 s51, s51, 1
    s_cmp_lg_u32 s51, 0
    s_cbranch_scc1 B_LOOP_row
    s_cmp_eq_u32 s44, 1
    s_cbranch_scc1 B_EPW_row
    s_cmp_eq_u32 s5, 2
    s_cbranch_scc1 B_QA
    s_cmp_eq_u32 s5, 3
    s_cbranch_scc1 B_TAIL_row
    s_cmp_eq_u32 s5, 6
    s_cbranch_scc1 B_TAIL_row
    s_cmp_ge_u32 s86, 2
    s_cbranch_scc1 B_TAIL_row
    s_cmp_lg_u32 s101, 0
    s_cbranch_scc1 B_TAIL_row
    s_mov_b32 s12, s88
    s_and_b32 s13, s89, 0xffff
    s_mov_b32 s14, s87
    s_mov_b32 s16, s90
    s_and_b32 s17, s91, 0xffff
    s_mov_b32 s18, s92
    s_mov_b32 s24, s93
    s_mov_b32 s25, s94
    s_mov_b32 s31, s95
    v_mul_lo_u32 v6, v24, s31
    s_lshl_b32 s45, s31, 2
    s_sub_u32 s45, s45, 1024
    s_lshl_b32 s52, s31, 6
    v_add_u32 v6, v6, v25
    v_add_u32 v7, s45, v6
    s_mov_b32 s51, 3
    s_mov_b32 s44, 1
    s_branch B_LOOP_row
B_TAIL_row:
    s_waitcnt lgkmcnt(0)
    v_mfma_f32_16x16x32_bf16 v[64:67], v[144:147], v[128:131], v[64:67]
    ds_read_b128 v[160:163], v15 offset:0
    v_mfma_f32_16x16x32_bf16 v[68:71], v[148:151], v[128:131], v[68:71]
    ds_read_b64_tr_b16 v[176:177], v16 offset:8192
    v_mfma_f32_16x16x32_bf16 v[72:75], v[152:155], v[128:131], v[72:75]
    ds_read_b64_tr_b16 v[178:179], v16 offset:9216
    v_mfma_f32_16x16x32_bf16 v[76:79], v[156:159], v[128:131], v[76:79]
    ds_read_b128 v[164:167], v15 offset:2048
    v_mfma_f32_16x16x32_bf16 v[80:83], v[144:147], v[132:135], v[80:83]
    ds_read_b64_tr_b16 v[180:181], v17 offset:8192
    v_mfma_f32_16x16x32_bf16 v[84:87], v[148:151], v[132:135], v[84:87]
    ds_read_b64_tr_b16 v[182:183], v17 offset:9216
    v_mfma_f32_16x16x32_bf16 v[88:91], v[152:155], v[132:135], v[88:91]
    ds_read_b128 v[168:171], v15 offset:4096
    v_mfma_f32_16x16x32_bf16 v[92:95], v[156:159], v[132:135], v[92:95]
    ds_read_b64_tr_b16 v[184:185], v18 offset:8192
    v_mfma_f32_16x16x32_bf16 v[96:99], v[144:147], v[136:139], v[96:99]
    ds_read_b64_tr_b16 v[186:187], v18 offset:9216
    v_mfma_f32_16x16x32_bf16 v[100:103], v[148:151], v[136:139], v[100:103]
    ds_read_b128 v[172:175], v15 offset:6144
    v_mfma_f32_16x16x32_bf16 v[104:107], v[152:155], v[136:139], v[104:107]
    ds_read_b64_tr_b16 v[188:189], v19 offset:8192
    v_mfma_f32_16x16x32_bf16 v[108:111], v[156:159], v[136:139], v[108:111]
    ds_read_b64_tr_b16 v[190:191], v19 offset:9216
    v_mfma_f32_16x16x32_bf16 v[112:115], v[144:147], v[140:143], v[112:115]
    v_add_u32 v14, s47, v8
    v_add_u32 v15, s47, v9
    v_mfma_f32_16x16x32_bf16 v[116:119], v[148:151], v[140:143], v[116:119]
    v_add_u32 v16, s48, v10
    v_add_u32 v17, s48, v11
    v_mfma_f32_16x16x32_bf16 v[120:123], v[152:155], v[140:143], v[120:123]
    v_add_u32 v18, s48, v12
    v_add_u32 v19, s48, v13
    v_mfma_f32_16x16x32_bf16 v[124:127], v[156:159], v[140:143], v[124:127]
    s_add_u32 s47, s47, 32768
    s_add_u32 s48, s48, 16384
    s_cmp_eq_u32 s47, 98304
    s_cselect_b32 s47, 0, s47
    s_cselect_b32 s48, 0, s48
    s_waitcnt vmcnt(6) lgkmcnt(0)
    s_barrier
    v_mfma_f32_16x16x32_bf16 v[64:67], v[176:179], v[160:163], v[64:67]
    ds_read_b128 v[128:131], v14 offset:0
    v_mfma_f32_16x16x32_bf16 v[68:71], v[180:183], v[160:163], v[68:71]
    ds_read_b64_tr_b16 v[144:145], v16 offset:0
    v_mfma_f32_16x16x32_bf16 v[72:75], v[184:187], v[160:163], v[72:75]
    ds_read_b64_tr_b16 v[146:147], v16 offset:1024
    v_mfma_f32_16x16x32_bf16 v[76:79], v[188:191], v[160:163], v[76:79]
    ds_read_b128 v[132:135], v14 offset:2048
    v_mfma_f32_16x16x32_bf16 v[80:83], v[176:179], v[164:167], v[80:83]
    ds_read_b64_tr_b16 v[148:149], v17 offset:0
    v_mfma_f32_16x16x32_bf16 v[84:87], v[180:183], v[164:167], v[84:87]
    ds_read_b64_tr_b16 v[150:151], v17 offset:1024
    v_mfma_f32_16x16x32_bf16 v[88:91], v[184:187], v[164:167], v[88:91]
    ds_read_b128 v[136:139], v14 offset:4096
    v_mfma_f32_16x16x32_bf16 v[92:95], v[188:191], v[164:167], v[92:95]
    ds_read_b64_tr_b16 v[152:153], v18 offset:0
    v_mfma_f32_16x16x32_bf16 v[96:99], v[176:179], v[168:171], v[96:99]
    ds_read_b64_tr_b16 v[154:155], v18 offset:1024
    v_mfma_f32_16x16x32_bf16 v[100:103], v[180:183], v[168:171], v[100:103]
    ds_read_b128 v[140:143], v14 offset:6144
    v_mfma_f32_16x16x32_bf16 v[104:107], v[184:187], v[168:171], v[104:107]
    ds_read_b64_tr_b16 v[156:157], v19 offset:0
    v_mfma_f32_16x16x32_bf16 v[108:111], v[188:191], v[168:171], v[108:111]
    ds_read_b64_tr_b16 v[158:159], v19 offset:1024
    v_mfma_f32_16x16x32_bf16 v[112:115], v[176:179], v[172:175], v[112:115]
    v_mfma_f32_16x16x32_bf16 v[116:119], v[180:183], v[172:175], v[116:119]
    v_mfma_f32_16x16x32_bf16 v[120:123], v[184:187], v[172:175], v[120:123]
    v_mfma_f32_16x16x32_bf16 v[124:127], v[188:191], v[172:175], v[124:127]
    s_waitcnt lgkmcnt(0)
    v_mfma_f32_16x16x32_bf16 v[64:67], v[144:147], v[128:131], v[64:67]
    ds_read_b128 v[160:163], v15 offset:0
    v_mfma_f32_16x16x32_bf16 v[68:71], v[148:151], v[128:131], v[68:71]
    ds_read_b64_tr_b16 v[176:177], v16 offset:8192
    v_mfma_f32_16x16x32_bf16 v[72:75], v[152:155], v[128:131], v[72:75]
    ds_read_b64_tr_b16 v[178:179], v16 offset:9216
    v_mfma_f32_16x16x32_bf16 v[76:79], v[156:159], v[128:131], v[76:79]
    ds_read_b128 v[164:167], v15 offset:2048
    v_mfma_f32_16x16x32_bf16 v[80:83], v[144:147], v[132:135], v[80:83]
    ds_read_b64_tr_b16 v[180:181], v17 offset:8192
    v_mfma_f32_16x16x32_bf16 v[84:87], v[148:151], v[132:135], v[84:87]
    ds_read_b64_tr_b16 v[182:183], v17 offset:9216
    v_mfma_f32_16x16x32_bf16 v[88:91], v[152:155], v[132:135], v[88:91]
    ds_read_b128 v[168:171], v15 offset:4096
    v_mfma_f32_16x16x32_bf16 v[92:95], v[156:159], v[132:135], v[92:95]
    ds_read_b64_tr_b16 v[184:185], v18 offset:8192
    v_mfma_f32_16x16x32_bf16 v[96:99], v[144:147], v[136:139], v[96:99]
    ds_read_b64_tr_b16 v[186:187], v18 offset:9216
    v_mfma_f32_16x16x32_bf16 v[100:103], v[148:151], v[136:139], v[100:103]
    ds_read_b128 v[172:175], v15 offset:6144
    v_mfma_f32_16x16x32_bf16 v[104:107], v[152:155], v[136:139], v[104:107]
    ds_read_b64_tr_b16 v[188:189], v19 offset:8192
    v_mfma_f32_16x16x32_bf16 v[108:111], v[156:159], v[136:139], v[108:111]
    ds_read_b64_tr_b16 v[190:191], v19 offset:9216
    v_mfma_f32_16x16x32_bf16 v[112:115], v[144:147], v[140:143], v[112:115]
    v_add_u32 v14, s47, v8
    v_add_u32 v15, s47, v9
    v_mfma_f32_16x16x32_bf16 v[116:119], v[148:151], v[140:143], v[116:119]
    v_add_u32 v16, s48, v10
    v_add_u32 v17, s48, v11
    v_mfma_f32_16x16x32_bf16 v[120:123], v[152:155], v[140:143], v[120:123]
    v_add_u32 v18, s48, v12
    v_add_u32 v19, s48, v13
    v_mfma_f32_16x16x32_bf16 v[124:127], v[156:159], v[140:143], v[124:127]
    s_add_u32 s47, s47, 32768
    s_add_u32 s48, s48, 16384
    s_cmp_eq_u32 s47, 98304
    s_cselect_b32 s47, 0, s47
    s_cselect_b32 s48, 0, s48
    s_waitcnt vmcnt(0) lgkmcnt(0)
    s_barrier
    v_mfma_f32_16x16x32_bf16 v[64:67], v[176:179], v[160:163], v[64:67]
    ds_read_b128 v[128:131], v14 offset:0
    v_mfma_f32_16x16x32_bf16 v[68:71], v[180:183], v[160:163], v[68:71]
    ds_read_b64_tr_b16 v[144:145], v16 offset:0
    v_mfma_f32_16x16x32_bf16 v[72:75], v[184:187], v[160:163], v[72:75]
    ds_read_b64_tr_b16 v[146:147], v16 offset:1024
    v_mfma_f32_16x16x32_bf16 v[76:79], v[188:191], v[160:163], v[76:79]
    ds_read_b128 v[132:135], v14 offset:2048
    v_mfma_f32_16x16x32_bf16 v[80:83], v[176:179], v[164:167], v[80:83]
    ds_read_b64_tr_b16 v[148:149], v17 offset:0
    v_mfma_f32_16x16x32_bf16 v[84:87], v[180:183], v[164:167], v[84:87]
    ds_read_b64_tr_b16 v[150:151], v17 offset:1024
    v_mfma_f32_16x16x32_bf16 v[88:91], v[184:187], v[164:167], v[88:91]
    ds_read_b128 v[136:139], v14 offset:4096
    v_mfma_f32_16x16x32_bf16 v[92:95], v[188:191], v[164:167], v[92:95]
    ds_read_b64_tr_b16 v[152:153], v18 offset:0
    v_mfma_f32_16x16x32_bf16 v[96:99], v[176:179], v[168:171], v[96:99]
    ds_read_b64_tr_b16 v[154:155], v18 offset:1024
    v_mfma_f32_16x16x32_bf16 v[100:103], v[180:183], v[168:171], v[100:103]
    ds_read_b128 v[140:143], v14 offset:6144
    v_mfma_f32_16x16x32_bf16 v[104:107], v[184:187], v[168:171], v[104:107]
    ds_read_b64_tr_b16 v[156:157], v19 offset:0
    v_mfma_f32_16x16x32_bf16 v[108:111], v[188:191], v[168:171], v[108:111]
    ds_read_b64_tr_b16 v[158:159], v19 offset:1024
    v_mfma_f32_16x16x32_bf16 v[112:115], v[176:179], v[172:175], v[112:115]
    v_mfma_f32_16x16x32_bf16 v[116:119], v[180:183], v[172:175], v[116:119]
    v_mfma_f32_16x16x32_bf16 v[120:123], v[184:187], v[172:175], v[120:123]
    v_mfma_f32_16x16x32_bf16 v[124:127], v[188:191], v[172:175], v[124:127]
    s_waitcnt lgkmcnt(0)
    v_mfma_f32_16x16x32_bf16 v[64:67], v[144:147], v[128:131], v[64:67]
    ds_read_b128 v[160:163], v15 offset:0
    v_mfma_f32_16x16x32_bf16 v[68:71], v[148:151], v[128:131], v[68:71]
    ds_read_b64_tr_b16 v[176:177], v16 offset:8192
    v_mfma_f32_16x16x32_bf16 v[72:75], v[152:155], v[128:131], v[72:75]
    ds_read_b64_tr_b16 v[178:179], v16 offset:9216
    v_mfma_f32_16x16x32_bf16 v[76:79], v[156:159], v[128:131], v[76:79]
    ds_read_b128 v[164:167], v15 offset:2048
    v_mfma_f32_16x16x32_bf16 v[80:83], v[144:147], v[132:135], v[80:83]
    ds_read_b64_tr_b16 v[180:181], v17 offset:8192
    v_mfma_f32_16x16x32_bf16 v[84:87], v[148:151], v[132:135], v[84:87]
    ds_read_b64_tr_b16 v[182:183], v17 offset:9216
    v_mfma_f32_16x16x32_bf16 v[88:91], v[152:155], v[132:135], v[88:91]
    ds_read_b128 v[168:171], v15 offset:4096
    v_mfma_f32_16x16x32_bf16 v[92:95], v[156:159], v[132:135], v[92:95]
    ds_read_b64_tr_b16 v[184:185], v18 offset:8192
    v_mfma_f32_16x16x32_bf16 v[96:99], v[144:147], v[136:139], v[96:99]
    ds_read_b64_tr_b16 v[186:187], v18 offset:9216
    v_mfma_f32_16x16x32_bf16 v[100:103], v[148:151], v[136:139], v[100:103]
    ds_read_b128 v[172:175], v15 offset:6144
    v_mfma_f32_16x16x32_bf16 v[104:107], v[152:155], v[136:139], v[104:107]
    ds_read_b64_tr_b16 v[188:189], v19 offset:8192
    v_mfma_f32_16x16x32_bf16 v[108:111], v[156:159], v[136:139], v[108:111]
    ds_read_b64_tr_b16 v[190:191], v19 offset:9216
    v_mfma_f32_16x16x32_bf16 v[112:115], v[144:147], v[140:143], v[112:115]
    v_mfma_f32_16x16x32_bf16 v[116:119], v[148:151], v[140:143], v[116:119]
    v_mfma_f32_16x16x32_bf16 v[120:123], v[152:155], v[140:143], v[120:123]
    v_mfma_f32_16x16x32_bf16 v[124:127], v[156:159], v[140:143], v[124:127]
    s_waitcnt lgkmcnt(0)
    v_mfma_f32_16x16x32_bf16 v[64:67], v[176:179], v[160:163], v[64:67]
    v_mfma_f32_16x16x32_bf16 v[68:71], v[180:183], v[160:163], v[68:71]
    v_mfma_f32_16x16x32_bf16 v[72:75], v[184:187], v[160:163], v[72:75]
    v_mfma_f32_16x16x32_bf16 v[76:79], v[188:191], v[160:163], v[76:79]
    v_mfma_f32_16x16x32_bf16 v[80:83], v[176:179], v[164:167], v[80:83]
    v_mfma_f32_16x16x32_bf16 v[84:87], v[180:183], v[164:167], v[84:87]
    v_mfma_f32_16x16x32_bf16 v[88:91], v[184:187], v[164:167], v[88:91]
    v_mfma_f32_16x16x32_bf16 v[92:95], v[188:191], v[164:167], v[92:95]
    v_mfma_f32_16x16x32_bf16 v[96:99], v[176:179], v[168:171], v[96:99]
    v_mfma_f32_16x16x32_bf16 v[100:103], v[180:183], v[168:171], v[100:103]
    v_mfma_f32_16x16x32_bf16 v[104:107], v[184:187], v[168:171], v[104:107]
    v_mfma_f32_16x16x32_bf16 v[108:111], v[188:191], v[168:171], v[108:111]
    v_mfma_f32_16x16x32_bf16 v[112:115], v[176:179], v[172:175], v[112:115]
    v_mfma_f32_16x16x32_bf16 v[116:119], v[180:183], v[172:175], v[116:119]
    v_mfma_f32_16x16x32_bf16 v[120:123], v[184:187], v[172:175], v[120:123]
    v_mfma_f32_16x16x32_bf16 v[124:127], v[188:191], v[172:175], v[124:127]
B_EPW_row:
    s_cmp_lg_u32 s5, 4
    s_cbranch_scc1 B_NArow
    v_mov_b32 v28, -1
    v_mov_b32 v29, -1
    v_mov_b32 v30, -1
    v_mov_b32 v31, -1
    v_lshlrev_b32 v1, 4, v0
    s_lshl_b32 s40, s34, 12
    s_add_u32 s40, s40, s3
    buffer_store_dwordx4 v[28:31], v1, s[8:11], s40 offen offset:0 sc1
    buffer_store_dwordx4 v[28:31], v1, s[8:11], s40 offen offset:1024 sc1
    buffer_store_dwordx4 v[28:31], v1, s[8:11], s40 offen offset:2048 sc1
    buffer_store_dwordx4 v[28:31], v1, s[8:11], s40 offen offset:3072 sc1
B_NArow:
    s_cmp_lg_u32 s5, 1
    s_cbranch_scc1 B_NOSC
    v_mov_b32 v1, 0x3e8293ee
    v_mul_f32 v64, v64, v1
    v_mul_f32 v65, v65, v1
    v_mul_f32 v66, v66, v1
    v_mul_f32 v67, v67, v1
    v_mul_f32 v68, v68, v1
    v_mul_f32 v69, v69, v1
    v_mul_f32 v70, v70, v1
    v_mul_f32 v71, v71, v1
    v_mul_f32 v72, v72, v1
    v_mul_f32 v73, v73, v1
    v_mul_f32 v74, v74, v1
    v_mul_f32 v75, v75, v1
    v_mul_f32 v76, v76, v1
    v_mul_f32 v77, v77, v1
    v_mul_f32 v78, v78, v1
    v_mul_f32 v79, v79, v1
    v_mul_f32 v80, v80, v1
    v_mul_f32 v81, v81, v1
    v_mul_f32 v82, v82, v1
    v_mul_f32 v83, v83, v1
    v_mul_f32 v84, v84, v1
    v_mul_f32 v85, v85, v1
    v_mul_f32 v86, v86, v1
    v_mul_f32 v87, v87, v1
    v_mul_f32 v88, v88, v1
    v_mul_f32 v89, v89, v1
    v_mul_f32 v90, v90, v1
    v_mul_f32 v91, v91, v1
    v_mul_f32 v92, v92, v1
    v_mul_f32 v93, v93, v1
    v_mul_f32 v94, v94, v1
    v_mul_f32 v95, v95, v1
    v_mul_f32 v96, v96, v1
    v_mul_f32 v97, v97, v1
    v_mul_f32 v98, v98, v1
    v_mul_f32 v99, v99, v1
    v_mul_f32 v100, v100, v1
    v_mul_f32 v101, v101, v1
    v_mul_f32 v102, v102, v1
    v_mul_f32 v103, v103, v1
    v_mul_f32 v104, v104, v1
    v_mul_f32 v105, v105, v1
    v_mul_f32 v106, v106, v1
    v_mul_f32 v107, v107, v1
    v_mul_f32 v108, v108, v1
    v_mul_f32 v109, v109, v1
    v_mul_f32 v110, v110, v1
    v_mul_f32 v111, v111, v1
    v_mul_f32 v112, v112, v1
    v_mul_f32 v113, v113, v1
    v_mul_f32 v114, v114, v1
    v_mul_f32 v115, v115, v1
    v_mul_f32 v116, v116, v1
    v_mul_f32 v117, v117, v1
    v_mul_f32 v118, v118, v1
    v_mul_f32 v119, v119, v1
    v_mul_f32 v120, v120, v1
    v_mul_f32 v121, v121, v1
    v_mul_f32 v122, v122, v1
    v_mul_f32 v123, v123, v1
    v_mul_f32 v124, v124, v1
    v_mul_f32 v125, v125, v1
    v_mul_f32 v126, v126, v1
    v_mul_f32 v127, v127, v1
B_NOSC:
    s_lshr_b32 s45, s34, 1
    s_and_b32 s46, s34, 1
    s_lshl_b32 s46, s46, 1
    v_mul_lo_u32 v20, v26, s27
    s_mul_i32 s45, s45, 2
    s_mul_i32 s45, s45, s28
    s_mul_i32 s46, s46, s29
    s_add_u32 s26, s26, s45
    s_add_u32 s26, s26, s46
    s_cmp_eq_u32 s27, 16
    s_cselect_b32 s45, 9, 4
    v_lshl_add_u32 v20, v27, s45, v20
    s_lshl_b32 s45, s27, 4
    v_add_u32 v21, s45, v20
    v_cvt_pk_bf16_f32 v160, v64, v65
    v_cvt_pk_bf16_f32 v161, v66, v67
    v_cvt_pk_bf16_f32 v162, v68, v69
    v_cvt_pk_bf16_f32 v163, v70, v71
    v_cvt_pk_bf16_f32 v164, v72, v73
    v_cvt_pk_bf16_f32 v165, v74, v75
    v_cvt_pk_bf16_f32 v166, v76, v77
    v_cvt_pk_bf16_f32 v167, v78, v79
    v_cvt_pk_bf16_f32 v168, v80, v81
    v_cvt_pk_bf16_f32 v169, v82, v83
    v_cvt_pk_bf16_f32 v170, v84, v85
    v_cvt_pk_bf16_f32 v171, v86, v87
    v_cvt_pk_bf16_f32 v172, v88, v89
    v_cvt_pk_bf16_f32 v173, v90, v91
    v_cvt_pk_bf16_f32 v174, v92, v93
    v_cvt_pk_bf16_f32 v175, v94, v95
    v_cvt_pk_bf16_f32 v176, v96, v97
    v_cvt_pk_bf16_f32 v177, v98, v99
    v_cvt_pk_bf16_f32 v178, v100, v101
    v_cvt_pk_bf16_f32 v179, v102, v103
    v_cvt_pk_bf16_f32 v180, v104, v105
    v_cvt_pk_bf16_f32 v181, v106, v107
    v_cvt_pk_bf16_f32 v182, v108, v109
    v_cvt_pk_bf16_f32 v183, v110, v111
    v_cvt_pk_bf16_f32 v184, v112, v113
    v_cvt_pk_bf16_f32 v185, v114, v115
    v_cvt_pk_bf16_f32 v186, v116, v117
    v_cvt_pk_bf16_f32 v187, v118, v119
    v_cvt_pk_bf16_f32 v188, v120, v121
    v_cvt_pk_bf16_f32 v189, v122, v123
    v_cvt_pk_bf16_f32 v190, v124, v125
    v_cvt_pk_bf16_f32 v191, v126, v127
    s_add_u32 s46, s26, s29
    v_permlane16_swap_b32 v160, v162
    v_permlane16_swap_b32 v161, v163
    buffer_store_dwordx4 v[160:163], v20, s[20:23], s26 offen sc1
    v_permlane16_swap_b32 v164, v166
    v_permlane16_swap_b32 v165, v167
    buffer_store_dwordx4 v[164:167], v20, s[20:23], s46 offen sc1
    v_permlane16_swap_b32 v168, v170
    v_permlane16_swap_b32 v169, v171
    buffer_store_dwordx4 v[168:171], v21, s[20:23], s26 offen sc1
    v_permlane16_swap_b32 v172, v174
    v_permlane16_swap_b32 v173, v175
    buffer_store_dwordx4 v[172:175], v21, s[20:23], s46 offen sc1
    s_add_u32 s26, s26, s28
    s_add_u32 s46, s26, s29
    v_permlane16_swap_b32 v176, v178
    v_permlane16_swap_b32 v177, v179
    buffer_store_dwordx4 v[176:179], v20, s[20:23], s26 offen sc1
    v_permlane16_swap_b32 v180, v182
    v_permlane16_swap_b32 v181, v183
    buffer_store_dwordx4 v[180:183], v20, s[20:23], s46 offen sc1
    v_permlane16_swap_b32 v184, v186
    v_permlane16_swap_b32 v185, v187
    buffer_store_dwordx4 v[184:187], v21, s[20:23], s26 offen sc1
    v_permlane16_swap_b32 v188, v190
    v_permlane16_swap_b32 v189, v191
    buffer_store_dwordx4 v[188:191], v21, s[20:23], s46 offen sc1
    s_mov_b32 s38, s37
    s_cmp_eq_u32 s44, 1
    s_cbranch_scc1 B_WARM
    s_branch B_COLD
B_BODY_tr:
    s_waitcnt lgkmcnt(0)
    v_mfma_f32_16x16x32_bf16 v[64:67], v[128:131], v[144:147], 0
    ds_read_b128 v[160:163], v15 offset:0
    v_mfma_f32_16x16x32_bf16 v[68:71], v[128:131], v[148:151], 0
    ds_read_b64_tr_b16 v[176:177], v16 offset:8192
    v_mfma_f32_16x16x32_bf16 v[72:75], v[128:131], v[152:155], 0
    ds_read_b64_tr_b16 v[178:179], v16 offset:9216
    v_mfma_f32_16x16x32_bf16 v[76:79], v[128:131], v[156:159], 0
    ds_read_b128 v[164:167], v15 offset:2048
    v_mfma_f32_16x16x32_bf16 v[80:83], v[132:135], v[144:147], 0
    ds_read_b64_tr_b16 v[180:181], v17 offset:8192
    v_mfma_f32_16x16x32_bf16 v[84:87], v[132:135], v[148:151], 0
    ds_read_b64_tr_b16 v[182:183], v17 offset:9216
    v_mfma_f32_16x16x32_bf16 v[88:91], v[132:135], v[152:155], 0
    ds_read_b128 v[168:171], v15 offset:4096
    v_mfma_f32_16x16x32_bf16 v[92:95], v[132:135], v[156:159], 0
    ds_read_b64_tr_b16 v[184:185], v18 offset:8192
    v_mfma_f32_16x16x32_bf16 v[96:99], v[136:139], v[144:147], 0
    ds_read_b64_tr_b16 v[186:187], v18 offset:9216
    v_mfma_f32_16x16x32_bf16 v[100:103], v[136:139], v[148:151], 0
    ds_read_b128 v[172:175], v15 offset:6144
    v_mfma_f32_16x16x32_bf16 v[104:107], v[136:139], v[152:155], 0
    ds_read_b64_tr_b16 v[188:189], v19 offset:8192
    v_mfma_f32_16x16x32_bf16 v[108:111], v[136:139], v[156:159], 0
    ds_read_b64_tr_b16 v[190:191], v19 offset:9216
    v_mfma_f32_16x16x32_bf16 v[112:115], v[140:143], v[144:147], 0
    v_add_u32 v14, s47, v8
    v_add_u32 v15, s47, v9
    v_mfma_f32_16x16x32_bf16 v[116:119], v[140:143], v[148:151], 0
    v_add_u32 v16, s48, v10
    v_add_u32 v17, s48, v11
    v_mfma_f32_16x16x32_bf16 v[120:123], v[140:143], v[152:155], 0
    v_add_u32 v18, s48, v12
    v_add_u32 v19, s48, v13
    v_mfma_f32_16x16x32_bf16 v[124:127], v[140:143], v[156:159], 0
    s_add_u32 s47, s47, 32768
    s_add_u32 s48, s48, 16384
    s_cmp_eq_u32 s47, 98304
    s_cselect_b32 s47, 0, s47
    s_cselect_b32 s48, 0, s48
    s_add_u32 m0, s53, s49
    s_cmp_eq_u32 s44, 1
    s_cbranch_scc1 B_CW0tr
    s_waitcnt vmcnt(6)
B_CW0tr:
    s_waitcnt vmcnt(14) lgkmcnt(0)
    s_barrier
    v_mfma_f32_16x16x32_bf16 v[64:67], v[160:163], v[176:179], v[64:67]
    ds_read_b128 v[128:131], v14 offset:0
    v_mfma_f32_16x16x32_bf16 v[68:71], v[160:163], v[180:183], v[68:71]
    ds_read_b64_tr_b16 v[144:145], v16 offset:0
    buffer_load_dwordx4 v2, s[12:15], s24 offen offset:0 sc1 lds
    v_mfma_f32_16x16x32_bf16 v[72:75], v[160:163], v[184:187], v[72:75]
    ds_read_b64_tr_b16 v[146:147], v16 offset:1024
    v_mfma_f32_16x16x32_bf16 v[76:79], v[160:163], v[188:191], v[76:79]
    ds_read_b128 v[132:135], v14 offset:2048
    v_mfma_f32_16x16x32_bf16 v[80:83], v[164:167], v[176:179], v[80:83]
    ds_read_b64_tr_b16 v[148:149], v17 offset:0
    buffer_load_dwordx4 v3, s[12:15], s24 offen offset:1024 sc1 lds
    v_mfma_f32_16x16x32_bf16 v[84:87], v[164:167], v[180:183], v[84:87]
    ds_read_b64_tr_b16 v[150:151], v17 offset:1024
    v_mfma_f32_16x16x32_bf16 v[88:91], v[164:167], v[184:187], v[88:91]
    ds_read_b128 v[136:139], v14 offset:4096
    v_mfma_f32_16x16x32_bf16 v[92:95], v[164:167], v[188:191], v[92:95]
    ds_read_b64_tr_b16 v[152:153], v18 offset:0
    buffer_load_dwordx4 v4, s[12:15], s24 offen offset:2048 sc1 lds
    v_mfma_f32_16x16x32_bf16 v[96:99], v[168:171], v[176:179], v[96:99]
    ds_read_b64_tr_b16 v[154:155], v18 offset:1024
    v_mfma_f32_16x16x32_bf16 v[100:103], v[168:171], v[180:183], v[100:103]
    ds_read_b128 v[140:143], v14 offset:6144
    v_mfma_f32_16x16x32_bf16 v[104:107], v[168:171], v[184:187], v[104:107]
    ds_read_b64_tr_b16 v[156:157], v19 offset:0
    buffer_load_dwordx4 v5, s[12:15], s24 offen offset:3072 sc1 lds
    s_add_u32 m0, s54, s50
    s_add_u32 s24, s24, s30
    s_add_u32 s49, s49, 32768
    v_mfma_f32_16x16x32_bf16 v[108:111], v[168:171], v[188:191], v[108:111]
    ds_read_b64_tr_b16 v[158:159], v19 offset:1024
    v_mfma_f32_16x16x32_bf16 v[112:115], v[172:175], v[176:179], v[112:115]
    buffer_load_dwordx4 v6, s[16:19], s25 offen offset:0 lds
    v_mfma_f32_16x16x32_bf16 v[116:119], v[172:175], v[180:183], v[116:119]
    v_mfma_f32_16x16x32_bf16 v[120:123], v[172:175], v[184:187], v[120:123]
    buffer_load_dwordx4 v7, s[16:19], s25 offen offset:1024 lds
    s_add_u32 s25, s25, s52
    s_add_u32 s50, s50, 16384
    v_mfma_f32_16x16x32_bf16 v[124:127], v[172:175], v[188:191], v[124:127]
    s_cmp_eq_u32 s49, 98304
    s_cselect_b32 s49, 0, s49
    s_cselect_b32 s50, 0, s50
    s_waitcnt lgkmcnt(0)
    v_mfma_f32_16x16x32_bf16 v[64:67], v[128:131], v[144:147], v[64:67]
    ds_read_b128 v[160:163], v15 offset:0
    v_mfma_f32_16x16x32_bf16 v[68:71], v[128:131], v[148:151], v[68:71]
    ds_read_b64_tr_b16 v[176:177], v16 offset:8192
    v_mfma_f32_16x16x32_bf16 v[72:75], v[128:131], v[152:155], v[72:75]
    ds_read_b64_tr_b16 v[178:179], v16 offset:9216
    v_mfma_f32_16x16x32_bf16 v[76:79], v[128:131], v[156:159], v[76:79]
    ds_read_b128 v[164:167], v15 offset:2048
    v_mfma_f32_16x16x32_bf16 v[80:83], v[132:135], v[144:147], v[80:83]
    ds_read_b64_tr_b16 v[180:181], v17 offset:8192
    v_mfma_f32_16x16x32_bf16 v[84:87], v[132:135], v[148:151], v[84:87]
    ds_read_b64_tr_b16 v[182:183], v17 offset:9216
    v_mfma_f32_16x16x32_bf16 v[88:91], v[132:135], v[152:155], v[88:91]
    ds_read_b128 v[168:171], v15 offset:4096
    v_mfma_f32_16x16x32_bf16 v[92:95], v[132:135], v[156:159], v[92:95]
    ds_read_b64_tr_b16 v[184:185], v18 offset:8192
    v_mfma_f32_16x16x32_bf16 v[96:99], v[136:139], v[144:147], v[96:99]
    ds_read_b64_tr_b16 v[186:187], v18 offset:9216
    v_mfma_f32_16x16x32_bf16 v[100:103], v[136:139], v[148:151], v[100:103]
    ds_read_b128 v[172:175], v15 offset:6144
    v_mfma_f32_16x16x32_bf16 v[104:107], v[136:139], v[152:155], v[104:107]
    ds_read_b64_tr_b16 v[188:189], v19 offset:8192
    v_mfma_f32_16x16x32_bf16 v[108:111], v[136:139], v[156:159], v[108:111]
    ds_read_b64_tr_b16 v[190:191], v19 offset:9216
    v_mfma_f32_16x16x32_bf16 v[112:115], v[140:143], v[144:147], v[112:115]
    v_add_u32 v14, s47, v8
    v_add_u32 v15, s47, v9
    v_mfma_f32_16x16x32_bf16 v[116:119], v[140:143], v[148:151], v[116:119]
    v_add_u32 v16, s48, v10
    v_add_u32 v17, s48, v11
    v_mfma_f32_16x16x32_bf16 v[120:123], v[140:143], v[152:155], v[120:123]
    v_add_u32 v18, s48, v12
    v_add_u32 v19, s48, v13
    v_mfma_f32_16x16x32_bf16 v[124:127], v[140:143], v[156:159], v[124:127]
    s_add_u32 s47, s47, 32768
    s_add_u32 s48, s48, 16384
    s_cmp_eq_u32 s47, 98304
    s_cselect_b32 s47, 0, s47
    s_cselect_b32 s48, 0, s48
    s_add_u32 m0, s53, s49
    s_cmp_eq_u32 s44, 1
    s_cbranch_scc1 B_CW1tr
    s_waitcnt vmcnt(6)
B_CW1tr:
    s_waitcnt vmcnt(14) lgkmcnt(0)
    s_barrier
    v_mfma_f32_16x16x32_bf16 v[64:67], v[160:163], v[176:179], v[64:67]
    ds_read_b128 v[128:131], v14 offset:0
    v_mfma_f32_16x16x32_bf16 v[68:71], v[160:163], v[180:183], v[68:71]
    ds_read_b64_tr_b16 v[144:145], v16 offset:0
    buffer_load_dwordx4 v2, s[12:15], s24 offen offset:0 sc1 lds
    v_mfma_f32_16x16x32_bf16 v[72:75], v[160:163], v[184:187], v[72:75]
    ds_read_b64_tr_b16 v[146:147], v16 offset:1024
    v_mfma_f32_16x16x32_bf16 v[76:79], v[160:163], v[188:191], v[76:79]
    ds_read_b128 v[132:135], v14 offset:2048
    v_mfma_f32_16x16x32_bf16 v[80:83], v[164:167], v[176:179], v[80:83]
    ds_read_b64_tr_b16 v[148:149], v17 offset:0
    buffer_load_dwordx4 v3, s[12:15], s24 offen offset:1024 sc1 lds
    v_mfma_f32_16x16x32_bf16 v[84:87], v[164:167], v[180:183], v[84:87]
    ds_read_b64_tr_b16 v[150:151], v17 offset:1024
    v_mfma_f32_16x16x32_bf16 v[88:91], v[164:167], v[184:187], v[88:91]
    ds_read_b128 v[136:139], v14 offset:4096
    v_mfma_f32_16x16x32_bf16 v[92:95], v[164:167], v[188:191], v[92:95]
    ds_read_b64_tr_b16 v[152:153], v18 offset:0
    buffer_load_dwordx4 v4, s[12:15], s24 offen offset:2048 sc1 lds
    v_mfma_f32_16x16x32_bf16 v[96:99], v[168:171], v[176:179], v[96:99]
    ds_read_b64_tr_b16 v[154:155], v18 offset:1024
    v_mfma_f32_16x16x32_bf16 v[100:103], v[168:171], v[180:183], v[100:103]
    ds_read_b128 v[140:143], v14 offset:6144
    v_mfma_f32_16x16x32_bf16 v[104:107], v[168:171], v[184:187], v[104:107]
    ds_read_b64_tr_b16 v[156:157], v19 offset:0
    buffer_load_dwordx4 v5, s[12:15], s24 offen offset:3072 sc1 lds
    s_add_u32 m0, s54, s50
    s_add_u32 s24, s24, s30
    s_add_u32 s49, s49, 32768
    v_mfma_f32_16x16x32_bf16 v[108:111], v[168:171], v[188:191], v[108:111]
    ds_read_b64_tr_b16 v[158:159], v19 offset:1024
    v_mfma_f32_16x16x32_bf16 v[112:115], v[172:175], v[176:179], v[112:115]
    buffer_load_dwordx4 v6, s[16:19], s25 offen offset:0 lds
    v_mfma_f32_16x16x32_bf16 v[116:119], v[172:175], v[180:183], v[116:119]
    v_mfma_f32_16x16x32_bf16 v[120:123], v[172:175], v[184:187], v[120:123]
    buffer_load_dwordx4 v7, s[16:19], s25 offen offset:1024 lds
    s_add_u32 s25, s25, s52
    s_add_u32 s50, s50, 16384
    v_mfma_f32_16x16x32_bf16 v[124:127], v[172:175], v[188:191], v[124:127]
    s_cmp_eq_u32 s49, 98304
    s_cselect_b32 s49, 0, s49
    s_cselect_b32 s50, 0, s50
    s_waitcnt lgkmcnt(0)
    v_mfma_f32_16x16x32_bf16 v[64:67], v[128:131], v[144:147], v[64:67]
    ds_read_b128 v[160:163], v15 offset:0
    v_mfma_f32_16x16x32_bf16 v[68:71], v[128:131], v[148:151], v[68:71]
    ds_read_b64_tr_b16 v[176:177], v16 offset:8192
    v_mfma_f32_16x16x32_bf16 v[72:75], v[128:131], v[152:155], v[72:75]
    ds_read_b64_tr_b16 v[178:179], v16 offset:9216
    v_mfma_f32_16x16x32_bf16 v[76:79], v[128:131], v[156:159], v[76:79]
    ds_read_b128 v[164:167], v15 offset:2048
    v_mfma_f32_16x16x32_bf16 v[80:83], v[132:135], v[144:147], v[80:83]
    ds_read_b64_tr_b16 v[180:181], v17 offset:8192
    v_mfma_f32_16x16x32_bf16 v[84:87], v[132:135], v[148:151], v[84:87]
    ds_read_b64_tr_b16 v[182:183], v17 offset:9216
    v_mfma_f32_16x16x32_bf16 v[88:91], v[132:135], v[152:155], v[88:91]
    ds_read_b128 v[168:171], v15 offset:4096
    v_mfma_f32_16x16x32_bf16 v[92:95], v[132:135], v[156:159], v[92:95]
    ds_read_b64_tr_b16 v[184:185], v18 offset:8192
    v_mfma_f32_16x16x32_bf16 v[96:99], v[136:139], v[144:147], v[96:99]
    ds_read_b64_tr_b16 v[186:187], v18 offset:9216
    v_mfma_f32_16x16x32_bf16 v[100:103], v[136:139], v[148:151], v[100:103]
    ds_read_b128 v[172:175], v15 offset:6144
    v_mfma_f32_16x16x32_bf16 v[104:107], v[136:139], v[152:155], v[104:107]
    ds_read_b64_tr_b16 v[188:189], v19 offset:8192
    v_mfma_f32_16x16x32_bf16 v[108:111], v[136:139], v[156:159], v[108:111]
    ds_read_b64_tr_b16 v[190:191], v19 offset:9216
    v_mfma_f32_16x16x32_bf16 v[112:115], v[140:143], v[144:147], v[112:115]
    v_add_u32 v14, s47, v8
    v_add_u32 v15, s47, v9
    v_mfma_f32_16x16x32_bf16 v[116:119], v[140:143], v[148:151], v[116:119]
    v_add_u32 v16, s48, v10
    v_add_u32 v17, s48, v11
    v_mfma_f32_16x16x32_bf16 v[120:123], v[140:143], v[152:155], v[120:123]
    v_add_u32 v18, s48, v12
    v_add_u32 v19, s48, v13
    v_mfma_f32_16x16x32_bf16 v[124:127], v[140:143], v[156:159], v[124:127]
    s_add_u32 s47, s47, 32768
    s_add_u32 s48, s48, 16384
    s_cmp_eq_u32 s47, 98304
    s_cselect_b32 s47, 0, s47
    s_cselect_b32 s48, 0, s48
    s_add_u32 m0, s53, s49
    s_waitcnt vmcnt(6) lgkmcnt(0)
    s_barrier
    s_cmp_lg_u32 s34, 0
    s_cbranch_scc1 SG_ptr
    s_cmp_eq_u32 s38, 0
    s_cbranch_scc1 SG_ptr
    s_and_b32 s40, s38, 1
    s_add_u32 s40, s40, 1
    v_mov_b32 v1, s40
    s_and_b32 s40, s38, -2
    s_mov_b64 exec, 1
    buffer_atomic_add v1, off, s[8:11], s40
    s_mov_b64 exec, -1
SG_ptr:
    v_mfma_f32_16x16x32_bf16 v[64:67], v[160:163], v[176:179], v[64:67]
    ds_read_b128 v[128:131], v14 offset:0
    v_mfma_f32_16x16x32_bf16 v[68:71], v[160:163], v[180:183], v[68:71]
    ds_read_b64_tr_b16 v[144:145], v16 offset:0
    buffer_load_dwordx4 v2, s[12:15], s24 offen offset:0 sc1 lds
    v_mfma_f32_16x16x32_bf16 v[72:75], v[160:163], v[184:187], v[72:75]
    ds_read_b64_tr_b16 v[146:147], v16 offset:1024
    v_mfma_f32_16x16x32_bf16 v[76:79], v[160:163], v[188:191], v[76:79]
    ds_read_b128 v[132:135], v14 offset:2048
    v_mfma_f32_16x16x32_bf16 v[80:83], v[164:167], v[176:179], v[80:83]
    ds_read_b64_tr_b16 v[148:149], v17 offset:0
    buffer_load_dwordx4 v3, s[12:15], s24 offen offset:1024 sc1 lds
    v_mfma_f32_16x16x32_bf16 v[84:87], v[164:167], v[180:183], v[84:87]
    ds_read_b64_tr_b16 v[150:151], v17 offset:1024
    v_mfma_f32_16x16x32_bf16 v[88:91], v[164:167], v[184:187], v[88:91]
    ds_read_b128 v[136:139], v14 offset:4096
    v_mfma_f32_16x16x32_bf16 v[92:95], v[164:167], v[188:191], v[92:95]
    ds_read_b64_tr_b16 v[152:153], v18 offset:0
    buffer_load_dwordx4 v4, s[12:15], s24 offen offset:2048 sc1 lds
    v_mfma_f32_16x16x32_bf16 v[96:99], v[168:171], v[176:179], v[96:99]
    ds_read_b64_tr_b16 v[154:155], v18 offset:1024
    v_mfma_f32_16x16x32_bf16 v[100:103], v[168:171], v[180:183], v[100:103]
    ds_read_b128 v[140:143], v14 offset:6144
    v_mfma_f32_16x16x32_bf16 v[104:107], v[168:171], v[184:187], v[104:107]
    ds_read_b64_tr_b16 v[156:157], v19 offset:0
    buffer_load_dwordx4 v5, s[12:15], s24 offen offset:3072 sc1 lds
    s_add_u32 m0, s54, s50
    s_add_u32 s24, s24, s30
    s_add_u32 s49, s49, 32768
    v_mfma_f32_16x16x32_bf16 v[108:111], v[168:171], v[188:191], v[108:111]
    ds_read_b64_tr_b16 v[158:159], v19 offset:1024
    v_mfma_f32_16x16x32_bf16 v[112:115], v[172:175], v[176:179], v[112:115]
    buffer_load_dwordx4 v6, s[16:19], s25 offen offset:0 lds
    v_mfma_f32_16x16x32_bf16 v[116:119], v[172:175], v[180:183], v[116:119]
    v_mfma_f32_16x16x32_bf16 v[120:123], v[172:175], v[184:187], v[120:123]
    buffer_load_dwordx4 v7, s[16:19], s25 offen offset:1024 lds
    s_add_u32 s25, s25, s52
    s_add_u32 s50, s50, 16384
    v_mfma_f32_16x16x32_bf16 v[124:127], v[172:175], v[188:191], v[124:127]
    s_cmp_eq_u32 s49, 98304
    s_cselect_b32 s49, 0, s49
    s_cselect_b32 s50, 0, s50
    s_cmp_eq_u32 s5, 3
    s_cselect_b32 s51, 58, 10
    s_mov_b32 s44, 0
B_LOOP_tr:
    s_waitcnt lgkmcnt(0)
    v_mfma_f32_16x16x32_bf16 v[64:67], v[128:131], v[144:147], v[64:67]
    ds_read_b128 v[160:163], v15 offset:0
    v_mfma_f32_16x16x32_bf16 v[68:71], v[128:131], v[148:151], v[68:71]
    ds_read_b64_tr_b16 v[176:177], v16 offset:8192
    v_mfma_f32_16x16x32_bf16 v[72:75], v[128:131], v[152:155], v[72:75]
    ds_read_b64_tr_b16 v[178:179], v16 offset:9216
    v_mfma_f32_16x16x32_bf16 v[76:79], v[128:131], v[156:159], v[76:79]
    ds_read_b128 v[164:167], v15 offset:2048
    v_mfma_f32_16x16x32_bf16 v[80:83], v[132:135], v[144:147], v[80:83]
    ds_read_b64_tr_b16 v[180:181], v17 offset:8192
    v_mfma_f32_16x16x32_bf16 v[84:87], v[132:135], v[148:151], v[84:87]
    ds_read_b64_tr_b16 v[182:183], v17 offset:9216
    v_mfma_f32_16x16x32_bf16 v[88:91], v[132:135], v[152:155], v[88:91]
    ds_read_b128 v[168:171], v15 offset:4096
    v_mfma_f32_16x16x32_bf16 v[92:95], v[132:135], v[156:159], v[92:95]
    ds_read_b64_tr_b16 v[184:185], v18 offset:8192
    v_mfma_f32_16x16x32_bf16 v[96:99], v[136:139], v[144:147], v[96:99]
    ds_read_b64_tr_b16 v[186:187], v18 offset:9216
    v_mfma_f32_16x16x32_bf16 v[100:103], v[136:139], v[148:151], v[100:103]
    ds_read_b128 v[172:175], v15 offset:6144
    v_mfma_f32_16x16x32_bf16 v[104:107], v[136:139], v[152:155], v[104:107]
    ds_read_b64_tr_b16 v[188:189], v19 offset:8192
    v_mfma_f32_16x16x32_bf16 v[108:111], v[136:139], v[156:159], v[108:111]
    ds_read_b64_tr_b16 v[190:191], v19 offset:9216
    v_mfma_f32_16x16x32_bf16 v[112:115], v[140:143], v[144:147], v[112:115]
    v_add_u32 v14, s47, v8
    v_add_u32 v15, s47, v9
    v_mfma_f32_16x16x32_bf16 v[116:119], v[140:143], v[148:151], v[116:119]
    v_add_u32 v16, s48, v10
    v_add_u32 v17, s48, v11
    v_mfma_f32_16x16x32_bf16 v[120:123], v[140:143], v[152:155], v[120:123]
    v_add_u32 v18, s48, v12
    v_add_u32 v19, s48, v13
    v_mfma_f32_16x16x32_bf16 v[124:127], v[140:143], v[156:159], v[124:127]
    s_add_u32 s47, s47, 32768
    s_add_u32 s48, s48, 16384
    s_cmp_eq_u32 s47, 98304
    s_cselect_b32 s47, 0, s47
    s_cselect_b32 s48, 0, s48
    s_add_u32 m0, s53, s49
    s_waitcnt vmcnt(6) lgkmcnt(0)
    s_barrier
    v_mfma_f32_16x16x32_bf16 v[64:67], v[160:163], v[176:179], v[64:67]
    ds_read_b128 v[128:131], v14 offset:0
    v_mfma_f32_16x16x32_bf16 v[68:71], v[160:163], v[180:183], v[68:71]
    ds_read_b64_tr_b16 v[144:145], v16 offset:0
    buffer_load_dwordx4 v2, s[12:15], s24 offen offset:0 sc1 lds
    v_mfma_f32_16x16x32_bf16 v[72:75], v[160:163], v[184:187], v[72:75]
    ds_read_b64_tr_b16 v[146:147], v16 offset:1024
    v_mfma_f32_16x16x32_bf16 v[76:79], v[160:163], v[188:191], v[76:79]
    ds_read_b128 v[132:135], v14 offset:2048
    v_mfma_f32_16x16x32_bf16 v[80:83], v[164:167], v[176:179], v[80:83]
    ds_read_b64_tr_b16 v[148:149], v17 offset:0
    buffer_load_dwordx4 v3, s[12:15], s24 offen offset:1024 sc1 lds
    v_mfma_f32_16x16x32_bf16 v[84:87], v[164:167], v[180:183], v[84:87]
    ds_read_b64_tr_b16 v[150:151], v17 offset:1024
    v_mfma_f32_16x16x32_bf16 v[88:91], v[164:167], v[184:187], v[88:91]
    ds_read_b128 v[136:139], v14 offset:4096
    v_mfma_f32_16x16x32_bf16 v[92:95], v[164:167], v[188:191], v[92:95]
    ds_read_b64_tr_b16 v[152:153], v18 offset:0
    buffer_load_dwordx4 v4, s[12:15], s24 offen offset:2048 sc1 lds
    v_mfma_f32_16x16x32_bf16 v[96:99], v[168:171], v[176:179], v[96:99]
    ds_read_b64_tr_b16 v[154:155], v18 offset:1024
    v_mfma_f32_16x16x32_bf16 v[100:103], v[168:171], v[180:183], v[100:103]
    ds_read_b128 v[140:143], v14 offset:6144
    v_mfma_f32_16x16x32_bf16 v[104:107], v[168:171], v[184:187], v[104:107]
    ds_read_b64_tr_b16 v[156:157], v19 offset:0
    buffer_load_dwordx4 v5, s[12:15], s24 offen offset:3072 sc1 lds
    s_add_u32 m0, s54, s50
    s_add_u32 s24, s24, s30
    s_add_u32 s49, s49, 32768
    v_mfma_f32_16x16x32_bf16 v[108:111], v[168:171], v[188:191], v[108:111]
    ds_read_b64_tr_b16 v[158:159], v19 offset:1024
    v_mfma_f32_16x16x32_bf16 v[112:115], v[172:175], v[176:179], v[112:115]
    buffer_load_dwordx4 v6, s[16:19], s25 offen offset:0 lds
    v_mfma_f32_16x16x32_bf16 v[116:119], v[172:175], v[180:183], v[116:119]
    v_mfma_f32_16x16x32_bf16 v[120:123], v[172:175], v[184:187], v[120:123]
    buffer_load_dwordx4 v7, s[16:19], s25 offen offset:1024 lds
    s_add_u32 s25, s25, s52
    s_add_u32 s50, s50, 16384
    v_mfma_f32_16x16x32_bf16 v[124:127], v[172:175], v[188:191], v[124:127]
    s_cmp_eq_u32 s49, 98304
    s_cselect_b32 s49, 0, s49
    s_cselect_b32 s50, 0, s50
    s_sub_u32 s51, s51, 1
    s_cmp_lg_u32 s51, 0
    s_cbranch_scc1 B_LOOP_tr
    s_cmp_eq_u32 s44, 1
    s_cbranch_scc1 B_EPW_tr
    s_cmp_ge_u32 s86, 2
    s_cbranch_scc1 B_TAIL_tr
    s_cmp_lg_u32 s101, 0
    s_cbranch_scc1 B_TAIL_tr
    s_mov_b32 s12, s88
    s_and_b32 s13, s89, 0xffff
    s_mov_b32 s14, s87
    s_mov_b32 s16, s90
    s_and_b32 s17, s91, 0xffff
    s_mov_b32 s18, s92
    s_mov_b32 s24, s93
    s_mov_b32 s25, s94
    s_mov_b32 s31, s95
    v_mul_lo_u32 v6, v24, s31
    s_lshl_b32 s45, s31, 2
    s_sub_u32 s45, s45, 1024
    s_lshl_b32 s52, s31, 6
    v_add_u32 v6, v6, v25
    v_add_u32 v7, s45, v6
    s_mov_b32 s51, 3
    s_mov_b32 s44, 1
    s_branch B_LOOP_tr
B_TAIL_tr:
    s_waitcnt lgkmcnt(0)
    v_mfma_f32_16x16x32_bf16 v[64:67], v[128:131], v[144:147], v[64:67]
    ds_read_b128 v[160:163], v15 offset:0
    v_mfma_f32_16x16x32_bf16 v[68:71], v[128:131], v[148:151], v[68:71]
    ds_read_b64_tr_b16 v[176:177], v16 offset:8192
    v_mfma_f32_16x16x32_bf16 v[72:75], v[128:131], v[152:155], v[72:75]
    ds_read_b64_tr_b16 v[178:179], v16 offset:9216
    v_mfma_f32_16x16x32_bf16 v[76:79], v[128:131], v[156:159], v[76:79]
    ds_read_b128 v[164:167], v15 offset:2048
    v_mfma_f32_16x16x32_bf16 v[80:83], v[132:135], v[144:147], v[80:83]
    ds_read_b64_tr_b16 v[180:181], v17 offset:8192
    v_mfma_f32_16x16x32_bf16 v[84:87], v[132:135], v[148:151], v[84:87]
    ds_read_b64_tr_b16 v[182:183], v17 offset:9216
    v_mfma_f32_16x16x32_bf16 v[88:91], v[132:135], v[152:155], v[88:91]
    ds_read_b128 v[168:171], v15 offset:4096
    v_mfma_f32_16x16x32_bf16 v[92:95], v[132:135], v[156:159], v[92:95]
    ds_read_b64_tr_b16 v[184:185], v18 offset:8192
    v_mfma_f32_16x16x32_bf16 v[96:99], v[136:139], v[144:147], v[96:99]
    ds_read_b64_tr_b16 v[186:187], v18 offset:9216
    v_mfma_f32_16x16x32_bf16 v[100:103], v[136:139], v[148:151], v[100:103]
    ds_read_b128 v[172:175], v15 offset:6144
    v_mfma_f32_16x16x32_bf16 v[104:107], v[136:139], v[152:155], v[104:107]
    ds_read_b64_tr_b16 v[188:189], v19 offset:8192
    v_mfma_f32_16x16x32_bf16 v[108:111], v[136:139], v[156:159], v[108:111]
    ds_read_b64_tr_b16 v[190:191], v19 offset:9216
    v_mfma_f32_16x16x32_bf16 v[112:115], v[140:143], v[144:147], v[112:115]
    v_add_u32 v14, s47, v8
    v_add_u32 v15, s47, v9
    v_mfma_f32_16x16x32_bf16 v[116:119], v[140:143], v[148:151], v[116:119]
    v_add_u32 v16, s48, v10
    v_add_u32 v17, s48, v11
    v_mfma_f32_16x16x32_bf16 v[120:123], v[140:143], v[152:155], v[120:123]
    v_add_u32 v18, s48, v12
    v_add_u32 v19, s48, v13
    v_mfma_f32_16x16x32_bf16 v[124:127], v[140:143], v[156:159], v[124:127]
    s_add_u32 s47, s47, 32768
    s_add_u32 s48, s48, 16384
    s_cmp_eq_u32 s47, 98304
    s_cselect_b32 s47, 0, s47
    s_cselect_b32 s48, 0, s48
    s_waitcnt vmcnt(6) lgkmcnt(0)
    s_barrier
    v_mfma_f32_16x16x32_bf16 v[64:67], v[160:163], v[176:179], v[64:67]
    ds_read_b128 v[128:131], v14 offset:0
    v_mfma_f32_16x16x32_bf16 v[68:71], v[160:163], v[180:183], v[68:71]
    ds_read_b64_tr_b16 v[144:145], v16 offset:0
    v_mfma_f32_16x16x32_bf16 v[72:75], v[160:163], v[184:187], v[72:75]
    ds_read_b64_tr_b16 v[146:147], v16 offset:1024
    v_mfma_f32_16x16x32_bf16 v[76:79], v[160:163], v[188:191], v[76:79]
    ds_read_b128 v[132:135], v14 offset:2048
    v_mfma_f32_16x16x32_bf16 v[80:83], v[164:167], v[176:179], v[80:83]
    ds_read_b64_tr_b16 v[148:149], v17 offset:0
    v_mfma_f32_16x16x32_bf16 v[84:87], v[164:167], v[180:183], v[84:87]
    ds_read_b64_tr_b16 v[150:151], v17 offset:1024
    v_mfma_f32_16x16x32_bf16 v[88:91], v[164:167], v[184:187], v[88:91]
    ds_read_b128 v[136:139], v14 offset:4096
    v_mfma_f32_16x16x32_bf16 v[92:95], v[164:167], v[188:191], v[92:95]
    ds_read_b64_tr_b16 v[152:153], v18 offset:0
    v_mfma_f32_16x16x32_bf16 v[96:99], v[168:171], v[176:179], v[96:99]
    ds_read_b64_tr_b16 v[154:155], v18 offset:1024
    v_mfma_f32_16x16x32_bf16 v[100:103], v[168:171], v[180:183], v[100:103]
    ds_read_b128 v[140:143], v14 offset:6144
    v_mfma_f32_16x16x32_bf16 v[104:107], v[168:171], v[184:187], v[104:107]
    ds_read_b64_tr_b16 v[156:157], v19 offset:0
    v_mfma_f32_16x16x32_bf16 v[108:111], v[168:171], v[188:191], v[108:111]
    ds_read_b64_tr_b16 v[158:159], v19 offset:1024
    v_mfma_f32_16x16x32_bf16 v[112:115], v[172:175], v[176:179], v[112:115]
    v_mfma_f32_16x16x32_bf16 v[116:119], v[172:175], v[180:183], v[116:119]
    v_mfma_f32_16x16x32_bf16 v[120:123], v[172:175], v[184:187], v[120:123]
    v_mfma_f32_16x16x32_bf16 v[124:127], v[172:175], v[188:191], v[124:127]
    s_waitcnt lgkmcnt(0)
    v_mfma_f32_16x16x32_bf16 v[64:67], v[128:131], v[144:147], v[64:67]
    ds_read_b128 v[160:163], v15 offset:0
    v_mfma_f32_16x16x32_bf16 v[68:71], v[128:131], v[148:151], v[68:71]
    ds_read_b64_tr_b16 v[176:177], v16 offset:8192
    v_mfma_f32_16x16x32_bf16 v[72:75], v[128:131], v[152:155], v[72:75]
    ds_read_b64_tr_b16 v[178:179], v16 offset:9216
    v_mfma_f32_16x16x32_bf16 v[76:79], v[128:131], v[156:159], v[76:79]
    ds_read_b128 v[164:167], v15 offset:2048
    v_mfma_f32_16x16x32_bf16 v[80:83], v[132:135], v[144:147], v[80:83]
    ds_read_b64_tr_b16 v[180:181], v17 offset:8192
    v_mfma_f32_16x16x32_bf16 v[84:87], v[132:135], v[148:151], v[84:87]
    ds_read_b64_tr_b16 v[182:183], v17 offset:9216
    v_mfma_f32_16x16x32_bf16 v[88:91], v[132:135], v[152:155], v[88:91]
    ds_read_b128 v[168:171], v15 offset:4096
    v_mfma_f32_16x16x32_bf16 v[92:95], v[132:135], v[156:159], v[92:95]
    ds_read_b64_tr_b16 v[184:185], v18 offset:8192
    v_mfma_f32_16x16x32_bf16 v[96:99], v[136:139], v[144:147], v[96:99]
    ds_read_b64_tr_b16 v[186:187], v18 offset:9216
    v_mfma_f32_16x16x32_bf16 v[100:103], v[136:139], v[148:151], v[100:103]
    ds_read_b128 v[172:175], v15 offset:6144
    v_mfma_f32_16x16x32_bf16 v[104:107], v[136:139], v[152:155], v[104:107]
    ds_read_b64_tr_b16 v[188:189], v19 offset:8192
    v_mfma_f32_16x16x32_bf16 v[108:111], v[136:139], v[156:159], v[108:111]
    ds_read_b64_tr_b16 v[190:191], v19 offset:9216
    v_mfma_f32_16x16x32_bf16 v[112:115], v[140:143], v[144:147], v[112:115]
    v_add_u32 v14, s47, v8
    v_add_u32 v15, s47, v9
    v_mfma_f32_16x16x32_bf16 v[116:119], v[140:143], v[148:151], v[116:119]
    v_add_u32 v16, s48, v10
    v_add_u32 v17, s48, v11
    v_mfma_f32_16x16x32_bf16 v[120:123], v[140:143], v[152:155], v[120:123]
    v_add_u32 v18, s48, v12
    v_add_u32 v19, s48, v13
    v_mfma_f32_16x16x32_bf16 v[124:127], v[140:143], v[156:159], v[124:127]
    s_add_u32 s47, s47, 32768
    s_add_u32 s48, s48, 16384
    s_cmp_eq_u32 s47, 98304
    s_cselect_b32 s47, 0, s47
    s_cselect_b32 s48, 0, s48
    s_waitcnt vmcnt(0) lgkmcnt(0)
    s_barrier
    v_mfma_f32_16x16x32_bf16 v[64:67], v[160:163], v[176:179], v[64:67]
    ds_read_b128 v[128:131], v14 offset:0
    v_mfma_f32_16x16x32_bf16 v[68:71], v[160:163], v[180:183], v[68:71]
    ds_read_b64_tr_b16 v[144:145], v16 offset:0
    v_mfma_f32_16x16x32_bf16 v[72:75], v[160:163], v[184:187], v[72:75]
    ds_read_b64_tr_b16 v[146:147], v16 offset:1024
    v_mfma_f32_16x16x32_bf16 v[76:79], v[160:163], v[188:191], v[76:79]
    ds_read_b128 v[132:135], v14 offset:2048
    v_mfma_f32_16x16x32_bf16 v[80:83], v[164:167], v[176:179], v[80:83]
    ds_read_b64_tr_b16 v[148:149], v17 offset:0
    v_mfma_f32_16x16x32_bf16 v[84:87], v[164:167], v[180:183], v[84:87]
    ds_read_b64_tr_b16 v[150:151], v17 offset:1024
    v_mfma_f32_16x16x32_bf16 v[88:91], v[164:167], v[184:187], v[88:91]
    ds_read_b128 v[136:139], v14 offset:4096
    v_mfma_f32_16x16x32_bf16 v[92:95], v[164:167], v[188:191], v[92:95]
    ds_read_b64_tr_b16 v[152:153], v18 offset:0
    v_mfma_f32_16x16x32_bf16 v[96:99], v[168:171], v[176:179], v[96:99]
    ds_read_b64_tr_b16 v[154:155], v18 offset:1024
    v_mfma_f32_16x16x32_bf16 v[100:103], v[168:171], v[180:183], v[100:103]
    ds_read_b128 v[140:143], v14 offset:6144
    v_mfma_f32_16x16x32_bf16 v[104:107], v[168:171], v[184:187], v[104:107]
    ds_read_b64_tr_b16 v[156:157], v19 offset:0
    v_mfma_f32_16x16x32_bf16 v[108:111], v[168:171], v[188:191], v[108:111]
    ds_read_b64_tr_b16 v[158:159], v19 offset:1024
    v_mfma_f32_16x16x32_bf16 v[112:115], v[172:175], v[176:179], v[112:115]
    v_mfma_f32_16x16x32_bf16 v[116:119], v[172:175], v[180:183], v[116:119]
    v_mfma_f32_16x16x32_bf16 v[120:123], v[172:175], v[184:187], v[120:123]
    v_mfma_f32_16x16x32_bf16 v[124:127], v[172:175], v[188:191], v[124:127]
    s_waitcnt lgkmcnt(0)
    v_mfma_f32_16x16x32_bf16 v[64:67], v[128:131], v[144:147], v[64:67]
    ds_read_b128 v[160:163], v15 offset:0
    v_mfma_f32_16x16x32_bf16 v[68:71], v[128:131], v[148:151], v[68:71]
    ds_read_b64_tr_b16 v[176:177], v16 offset:8192
    v_mfma_f32_16x16x32_bf16 v[72:75], v[128:131], v[152:155], v[72:75]
    ds_read_b64_tr_b16 v[178:179], v16 offset:9216
    v_mfma_f32_16x16x32_bf16 v[76:79], v[128:131], v[156:159], v[76:79]
    ds_read_b128 v[164:167], v15 offset:2048
    v_mfma_f32_16x16x32_bf16 v[80:83], v[132:135], v[144:147], v[80:83]
    ds_read_b64_tr_b16 v[180:181], v17 offset:8192
    v_mfma_f32_16x16x32_bf16 v[84:87], v[132:135], v[148:151], v[84:87]
    ds_read_b64_tr_b16 v[182:183], v17 offset:9216
    v_mfma_f32_16x16x32_bf16 v[88:91], v[132:135], v[152:155], v[88:91]
    ds_read_b128 v[168:171], v15 offset:4096
    v_mfma_f32_16x16x32_bf16 v[92:95], v[132:135], v[156:159], v[92:95]
    ds_read_b64_tr_b16 v[184:185], v18 offset:8192
    v_mfma_f32_16x16x32_bf16 v[96:99], v[136:139], v[144:147], v[96:99]
    ds_read_b64_tr_b16 v[186:187], v18 offset:9216
    v_mfma_f32_16x16x32_bf16 v[100:103], v[136:139], v[148:151], v[100:103]
    ds_read_b128 v[172:175], v15 offset:6144
    v_mfma_f32_16x16x32_bf16 v[104:107], v[136:139], v[152:155], v[104:107]
    ds_read_b64_tr_b16 v[188:189], v19 offset:8192
    v_mfma_f32_16x16x32_bf16 v[108:111], v[136:139], v[156:159], v[108:111]
    ds_read_b64_tr_b16 v[190:191], v19 offset:9216
    v_mfma_f32_16x16x32_bf16 v[112:115], v[140:143], v[144:147], v[112:115]
    v_mfma_f32_16x16x32_bf16 v[116:119], v[140:143], v[148:151], v[116:119]
    v_mfma_f32_16x16x32_bf16 v[120:123], v[140:143], v[152:155], v[120:123]
    v_mfma_f32_16x16x32_bf16 v[124:127], v[140:143], v[156:159], v[124:127]
    s_waitcnt lgkmcnt(0)
    v_mfma_f32_16x16x32_bf16 v[64:67], v[160:163], v[176:179], v[64:67]
    v_mfma_f32_16x16x32_bf16 v[68:71], v[160:163], v[180:183], v[68:71]
    v_mfma_f32_16x16x32_bf16 v[72:75], v[160:163], v[184:187], v[72:75]
    v_mfma_f32_16x16x32_bf16 v[76:79], v[160:163], v[188:191], v[76:79]
    v_mfma_f32_16x16x32_bf16 v[80:83], v[164:167], v[176:179], v[80:83]
    v_mfma_f32_16x16x32_bf16 v[84:87], v[164:167], v[180:183], v[84:87]
    v_mfma_f32_16x16x32_bf16 v[88:91], v[164:167], v[184:187], v[88:91]
    v_mfma_f32_16x16x32_bf16 v[92:95], v[164:167], v[188:191], v[92:95]
    v_mfma_f32_16x16x32_bf16 v[96:99], v[168:171], v[176:179], v[96:99]
    v_mfma_f32_16x16x32_bf16 v[100:103], v[168:171], v[180:183], v[100:103]
    v_mfma_f32_16x16x32_bf16 v[104:107], v[168:171], v[184:187], v[104:107]
    v_mfma_f32_16x16x32_bf16 v[108:111], v[168:171], v[188:191], v[108:111]
    v_mfma_f32_16x16x32_bf16 v[112:115], v[172:175], v[176:179], v[112:115]
    v_mfma_f32_16x16x32_bf16 v[116:119], v[172:175], v[180:183], v[116:119]
    v_mfma_f32_16x16x32_bf16 v[120:123], v[172:175], v[184:187], v[120:123]
    v_mfma_f32_16x16x32_bf16 v[124:127], v[172:175], v[188:191], v[124:127]
B_EPW_tr:
    s_cmp_lg_u32 s5, 4
    s_cbranch_scc1 B_NAtr
    v_mov_b32 v28, -1
    v_mov_b32 v29, -1
    v_mov_b32 v30, -1
    v_mov_b32 v31, -1
    v_lshlrev_b32 v1, 4, v0
    s_lshl_b32 s40, s34, 12
    s_add_u32 s40, s40, s3
    buffer_store_dwordx4 v[28:31], v1, s[8:11], s40 offen offset:0 sc1
    buffer_store_dwordx4 v[28:31], v1, s[8:11], s40 offen offset:1024 sc1
    buffer_store_dwordx4 v[28:31], v1, s[8:11], s40 offen offset:2048 sc1
    buffer_store_dwordx4 v[28:31], v1, s[8:11], s40 offen offset:3072 sc1
B_NAtr:
    s_lshr_b32 s45, s34, 1
    s_and_b32 s46, s34, 1
    s_lshl_b32 s46, s46, 1
    s_cmp_eq_u32 s5, 4
    s_cselect_b32 s40, 2, 0
    s_xor_b32 s46, s46, s40
    v_mul_lo_u32 v20, v26, s27
    s_mul_i32 s45, s45, 2
    s_mul_i32 s45, s45, s29
    s_mul_i32 s46, s46, s28
    s_add_u32 s26, s26, s45
    s_add_u32 s26, s26, s46
    s_cmp_eq_u32 s27, 16
    s_cselect_b32 s45, 9, 4
    v_lshl_add_u32 v20, v27, s45, v20
    s_lshl_b32 s45, s27, 4
    v_add_u32 v21, s45, v20
    v_cvt_pk_bf16_f32 v160, v64, v65
    v_cvt_pk_bf16_f32 v161, v66, v67
    v_cvt_pk_bf16_f32 v162, v80, v81
    v_cvt_pk_bf16_f32 v163, v82, v83
    v_cvt_pk_bf16_f32 v164, v96, v97
    v_cvt_pk_bf16_f32 v165, v98, v99
    v_cvt_pk_bf16_f32 v166, v112, v113
    v_cvt_pk_bf16_f32 v167, v114, v115
    v_cvt_pk_bf16_f32 v168, v68, v69
    v_cvt_pk_bf16_f32 v169, v70, v71
    v_cvt_pk_bf16_f32 v170, v84, v85
    v_cvt_pk_bf16_f32 v171, v86, v87
    v_cvt_pk_bf16_f32 v172, v100, v101
    v_cvt_pk_bf16_f32 v173, v102, v103
    v_cvt_pk_bf16_f32 v174, v116, v117
    v_cvt_pk_bf16_f32 v175, v118, v119
    v_cvt_pk_bf16_f32 v176, v72, v73
    v_cvt_pk_bf16_f32 v177, v74, v75
    v_cvt_pk_bf16_f32 v178, v88, v89
    v_cvt_pk_bf16_f32 v179, v90, v91
    v_cvt_pk_bf16_f32 v180, v104, v105
    v_cvt_pk_bf16_f32 v181, v106, v107
    v_cvt_pk_bf16_f32 v182, v120, v121
    v_cvt_pk_bf16_f32 v183, v122, v123
    v_cvt_pk_bf16_f32 v184, v76, v77
    v_cvt_pk_bf16_f32 v185, v78, v79
    v_cvt_pk_bf16_f32 v186, v92, v93
    v_cvt_pk_bf16_f32 v187, v94, v95
    v_cvt_pk_bf16_f32 v188, v108, v109
    v_cvt_pk_bf16_f32 v189, v110, v111
    v_cvt_pk_bf16_f32 v190, v124, v125
    v_cvt_pk_bf16_f32 v191, v126, v127
    s_add_u32 s46, s26, s29
    v_permlane16_swap_b32 v160, v162
    v_permlane16_swap_b32 v161, v163
    buffer_store_dwordx4 v[160:163], v20, s[20:23], s26 offen sc1
    v_permlane16_swap_b32 v164, v166
    v_permlane16_swap_b32 v165, v167
    buffer_store_dwordx4 v[164:167], v20, s[20:23], s46 offen sc1
    v_permlane16_swap_b32 v168, v170
    v_permlane16_swap_b32 v169, v171
    buffer_store_dwordx4 v[168:171], v21, s[20:23], s26 offen sc1
    v_permlane16_swap_b32 v172, v174
    v_permlane16_swap_b32 v173, v175
    buffer_store_dwordx4 v[172:175], v21, s[20:23], s46 offen sc1
    s_add_u32 s26, s26, s28
    s_add_u32 s46, s26, s29
    v_permlane16_swap_b32 v176, v178
    v_permlane16_swap_b32 v177, v179
    buffer_store_dwordx4 v[176:179], v20, s[20:23], s26 offen sc1
    v_permlane16_swap_b32 v180, v182
    v_permlane16_swap_b32 v181, v183
    buffer_store_dwordx4 v[180:183], v20, s[20:23], s46 offen sc1
    v_permlane16_swap_b32 v184, v186
    v_permlane16_swap_b32 v185, v187
    buffer_store_dwordx4 v[184:187], v21, s[20:23], s26 offen sc1
    v_permlane16_swap_b32 v188, v190
    v_permlane16_swap_b32 v189, v191
    buffer_store_dwordx4 v[188:191], v21, s[20:23], s46 offen sc1
    s_mov_b32 s38, s37
    s_cmp_eq_u32 s44, 1
    s_cbranch_scc1 B_WARM
    s_branch B_COLD
H_BODY_row:
    s_waitcnt lgkmcnt(0)
    v_mfma_f32_16x16x32_bf16 v[24:27], v[184:187], v[152:155], 0
    ds_read_b64_tr_b16 v[232:233], v10 offset:8192
    v_mfma_f32_16x16x32_bf16 v[28:31], v[188:191], v[152:155], 0
    ds_read_b64_tr_b16 v[234:235], v10 offset:9216
    v_mfma_f32_16x16x32_bf16 v[32:35], v[192:195], v[152:155], 0
    ds_read_b128 v[200:203], v9 offset:0
    v_mfma_f32_16x16x32_bf16 v[36:39], v[196:199], v[152:155], 0
    ds_read_b128 v[204:207], v9 offset:2048
    v_mfma_f32_16x16x32_bf16 v[40:43], v[184:187], v[156:159], 0
    ds_read_b64_tr_b16 v[236:237], v11 offset:8192
    v_mfma_f32_16x16x32_bf16 v[44:47], v[188:191], v[156:159], 0
    ds_read_b64_tr_b16 v[238:239], v11 offset:9216
    v_mfma_f32_16x16x32_bf16 v[48:51], v[192:195], v[156:159], 0
    ds_read_b128 v[208:211], v9 offset:4096
    v_mfma_f32_16x16x32_bf16 v[52:55], v[196:199], v[156:159], 0
    ds_read_b128 v[212:215], v9 offset:6144
    v_mfma_f32_16x16x32_bf16 v[56:59], v[184:187], v[160:163], 0
    ds_read_b64_tr_b16 v[240:241], v12 offset:8192
    v_mfma_f32_16x16x32_bf16 v[60:63], v[188:191], v[160:163], 0
    ds_read_b64_tr_b16 v[242:243], v12 offset:9216
    v_mfma_f32_16x16x32_bf16 v[64:67], v[192:195], v[160:163], 0
    ds_read_b128 v[216:219], v9 offset:8192
    v_mfma_f32_16x16x32_bf16 v[68:71], v[196:199], v[160:163], 0
    ds_read_b128 v[220:223], v9 offset:10240
    v_mfma_f32_16x16x32_bf16 v[72:75], v[184:187], v[164:167], 0
    ds_read_b64_tr_b16 v[244:245], v13 offset:8192
    v_mfma_f32_16x16x32_bf16 v[76:79], v[188:191], v[164:167], 0
    ds_read_b64_tr_b16 v[246:247], v13 offset:9216
    v_mfma_f32_16x16x32_bf16 v[80:83], v[192:195], v[164:167], 0
    ds_read_b128 v[224:227], v9 offset:12288
    v_mfma_f32_16x16x32_bf16 v[84:87], v[196:199], v[164:167], 0
    ds_read_b128 v[228:231], v9 offset:14336
    v_mfma_f32_16x16x32_bf16 v[88:91], v[184:187], v[168:171], 0
    v_mfma_f32_16x16x32_bf16 v[92:95], v[188:191], v[168:171], 0
    v_mfma_f32_16x16x32_bf16 v[96:99], v[192:195], v[168:171], 0
    v_mfma_f32_16x16x32_bf16 v[100:103], v[196:199], v[168:171], 0
    v_mfma_f32_16x16x32_bf16 v[104:107], v[184:187], v[172:175], 0
    v_xor_b32 v8, 0x10000, v8
    v_mfma_f32_16x16x32_bf16 v[108:111], v[188:191], v[172:175], 0
    v_xor_b32 v9, 0x10000, v9
    v_mfma_f32_16x16x32_bf16 v[112:115], v[192:195], v[172:175], 0
    v_xor_b32 v10, 0x10000, v10
    v_mfma_f32_16x16x32_bf16 v[116:119], v[196:199], v[172:175], 0
    v_xor_b32 v11, 0x10000, v11
    v_mfma_f32_16x16x32_bf16 v[120:123], v[184:187], v[176:179], 0
    v_xor_b32 v12, 0x10000, v12
    v_mfma_f32_16x16x32_bf16 v[124:127], v[188:191], v[176:179], 0
    v_xor_b32 v13, 0x10000, v13
    v_mfma_f32_16x16x32_bf16 v[128:131], v[192:195], v[176:179], 0
    v_mfma_f32_16x16x32_bf16 v[132:135], v[196:199], v[176:179], 0
    v_mfma_f32_16x16x32_bf16 v[136:139], v[184:187], v[180:183], 0
    s_add_u32 m0, s53, s49
    s_add_u32 s48, s25, 256
    v_mfma_f32_16x16x32_bf16 v[140:143], v[188:191], v[180:183], 0
    v_mfma_f32_16x16x32_bf16 v[144:147], v[192:195], v[180:183], 0
    v_mfma_f32_16x16x32_bf16 v[148:151], v[196:199], v[180:183], 0
    s_cmp_eq_u32 s44, 1
    s_cbranch_scc1 H_CWrow
    s_waitcnt vmcnt(0)
H_CWrow:
    s_waitcnt vmcnt(16) lgkmcnt(0)
    s_barrier
    v_mfma_f32_16x16x32_bf16 v[24:27], v[232:235], v[200:203], v[24:27]
    buffer_load_dwordx4 v2, s[12:15], s24 offen offset:0 sc1 lds
    v_mfma_f32_16x16x32_bf16 v[28:31], v[236:239], v[200:203], v[28:31]
    ds_read_b64_tr_b16 v[184:185], v10 offset:0
    v_mfma_f32_16x16x32_bf16 v[32:35], v[240:243], v[200:203], v[32:35]
    buffer_load_dwordx4 v3, s[12:15], s24 offen offset:1024 sc1 lds
    v_mfma_f32_16x16x32_bf16 v[36:39], v[244:247], v[200:203], v[36:39]
    ds_read_b64_tr_b16 v[186:187], v10 offset:1024
    v_mfma_f32_16x16x32_bf16 v[40:43], v[232:235], v[204:207], v[40:43]
    buffer_load_dwordx4 v4, s[12:15], s24 offen offset:2048 sc1 lds
    v_mfma_f32_16x16x32_bf16 v[44:47], v[236:239], v[204:207], v[44:47]
    ds_read_b128 v[152:155], v8 offset:0
    v_mfma_f32_16x16x32_bf16 v[48:51], v[240:243], v[204:207], v[48:51]
    buffer_load_dwordx4 v5, s[12:15], s24 offen offset:3072 sc1 lds
    s_add_u32 m0, s54, s49
    s_add_u32 s24, s24, 128
    v_mfma_f32_16x16x32_bf16 v[52:55], v[244:247], v[204:207], v[52:55]
    ds_read_b128 v[156:159], v8 offset:2048
    v_mfma_f32_16x16x32_bf16 v[56:59], v[232:235], v[208:211], v[56:59]
    buffer_load_dwordx4 v6, s[16:19], s25 offen offset:0 lds
    v_mfma_f32_16x16x32_bf16 v[60:63], v[236:239], v[208:211], v[60:63]
    ds_read_b64_tr_b16 v[188:189], v11 offset:0
    v_mfma_f32_16x16x32_bf16 v[64:67], v[240:243], v[208:211], v[64:67]
    buffer_load_dwordx4 v7, s[16:19], s25 offen offset:1024 lds
    s_add_u32 m0, m0, 0x4000
    s_add_u32 s25, s25, s52
    v_mfma_f32_16x16x32_bf16 v[68:71], v[244:247], v[208:211], v[68:71]
    ds_read_b64_tr_b16 v[190:191], v11 offset:1024
    v_mfma_f32_16x16x32_bf16 v[72:75], v[232:235], v[212:215], v[72:75]
    buffer_load_dwordx4 v6, s[16:19], s48 offen offset:0 lds
    v_mfma_f32_16x16x32_bf16 v[76:79], v[236:239], v[212:215], v[76:79]
    ds_read_b128 v[160:163], v8 offset:4096
    v_mfma_f32_16x16x32_bf16 v[80:83], v[240:243], v[212:215], v[80:83]
    buffer_load_dwordx4 v7, s[16:19], s48 offen offset:1024 lds
    s_xor_b32 s49, s49, 0x10000
    v_mfma_f32_16x16x32_bf16 v[84:87], v[244:247], v[212:215], v[84:87]
    ds_read_b128 v[164:167], v8 offset:6144
    v_mfma_f32_16x16x32_bf16 v[88:91], v[232:235], v[216:219], v[88:91]
    ds_read_b64_tr_b16 v[192:193], v12 offset:0
    v_mfma_f32_16x16x32_bf16 v[92:95], v[236:239], v[216:219], v[92:95]
    ds_read_b64_tr_b16 v[194:195], v12 offset:1024
    v_mfma_f32_16x16x32_bf16 v[96:99], v[240:243], v[216:219], v[96:99]
    ds_read_b128 v[168:171], v8 offset:8192
    v_mfma_f32_16x16x32_bf16 v[100:103], v[244:247], v[216:219], v[100:103]
    ds_read_b128 v[172:175], v8 offset:10240
    v_mfma_f32_16x16x32_bf16 v[104:107], v[232:235], v[220:223], v[104:107]
    ds_read_b64_tr_b16 v[196:197], v13 offset:0
    v_mfma_f32_16x16x32_bf16 v[108:111], v[236:239], v[220:223], v[108:111]
    ds_read_b64_tr_b16 v[198:199], v13 offset:1024
    v_mfma_f32_16x16x32_bf16 v[112:115], v[240:243], v[220:223], v[112:115]
    ds_read_b128 v[176:179], v8 offset:12288
    v_mfma_f32_16x16x32_bf16 v[116:119], v[244:247], v[220:223], v[116:119]
    ds_read_b128 v[180:183], v8 offset:14336
    v_mfma_f32_16x16x32_bf16 v[120:123], v[232:235], v[224:227], v[120:123]
    v_mfma_f32_16x16x32_bf16 v[124:127], v[236:239], v[224:227], v[124:127]
    v_mfma_f32_16x16x32_bf16 v[128:131], v[240:243], v[224:227], v[128:131]
    v_mfma_f32_16x16x32_bf16 v[132:135], v[244:247], v[224:227], v[132:135]
    v_mfma_f32_16x16x32_bf16 v[136:139], v[232:235], v[228:231], v[136:139]
    v_mfma_f32_16x16x32_bf16 v[140:143], v[236:239], v[228:231], v[140:143]
    v_mfma_f32_16x16x32_bf16 v[144:147], v[240:243], v[228:231], v[144:147]
    v_mfma_f32_16x16x32_bf16 v[148:151], v[244:247], v[228:231], v[148:151]
    s_waitcnt lgkmcnt(0)
    v_mfma_f32_16x16x32_bf16 v[24:27], v[184:187], v[152:155], v[24:27]
    ds_read_b64_tr_b16 v[232:233], v10 offset:8192
    v_mfma_f32_16x16x32_bf16 v[28:31], v[188:191], v[152:155], v[28:31]
    ds_read_b64_tr_b16 v[234:235], v10 offset:9216
    v_mfma_f32_16x16x32_bf16 v[32:35], v[192:195], v[152:155], v[32:35]
    ds_read_b128 v[200:203], v9 offset:0
    v_mfma_f32_16x16x32_bf16 v[36:39], v[196:199], v[152:155], v[36:39]
    ds_read_b128 v[204:207], v9 offset:2048
    v_mfma_f32_16x16x32_bf16 v[40:43], v[184:187], v[156:159], v[40:43]
    ds_read_b64_tr_b16 v[236:237], v11 offset:8192
    v_mfma_f32_16x16x32_bf16 v[44:47], v[188:191], v[156:159], v[44:47]
    ds_read_b64_tr_b16 v[238:239], v11 offset:9216
    v_mfma_f32_16x16x32_bf16 v[48:51], v[192:195], v[156:159], v[48:51]
    ds_read_b128 v[208:211], v9 offset:4096
    v_mfma_f32_16x16x32_bf16 v[52:55], v[196:199], v[156:159], v[52:55]
    ds_read_b128 v[212:215], v9 offset:6144
    v_mfma_f32_16x16x32_bf16 v[56:59], v[184:187], v[160:163], v[56:59]
    ds_read_b64_tr_b16 v[240:241], v12 offset:8192
    v_mfma_f32_16x16x32_bf16 v[60:63], v[188:191], v[160:163], v[60:63]
    ds_read_b64_tr_b16 v[242:243], v12 offset:9216
    v_mfma_f32_16x16x32_bf16 v[64:67], v[192:195], v[160:163], v[64:67]
    ds_read_b128 v[216:219], v9 offset:8192
    v_mfma_f32_16x16x32_bf16 v[68:71], v[196:199], v[160:163], v[68:71]
    ds_read_b128 v[220:223], v9 offset:10240
    v_mfma_f32_16x16x32_bf16 v[72:75], v[184:187], v[164:167], v[72:75]
    ds_read_b64_tr_b16 v[244:245], v13 offset:8192
    v_mfma_f32_16x16x32_bf16 v[76:79], v[188:191], v[164:167], v[76:79]
    ds_read_b64_tr_b16 v[246:247], v13 offset:9216
    v_mfma_f32_16x16x32_bf16 v[80:83], v[192:195], v[164:167], v[80:83]
    ds_read_b128 v[224:227], v9 offset:12288
    v_mfma_f32_16x16x32_bf16 v[84:87], v[196:199], v[164:167], v[84:87]
    ds_read_b128 v[228:231], v9 offset:14336
    v_mfma_f32_16x16x32_bf16 v[88:91], v[184:187], v[168:171], v[88:91]
    v_mfma_f32_16x16x32_bf16 v[92:95], v[188:191], v[168:171], v[92:95]
    v_mfma_f32_16x16x32_bf16 v[96:99], v[192:195], v[168:171], v[96:99]
    v_mfma_f32_16x16x32_bf16 v[100:103], v[196:199], v[168:171], v[100:103]
    v_mfma_f32_16x16x32_bf16 v[104:107], v[184:187], v[172:175], v[104:107]
    v_xor_b32 v8, 0x10000, v8
    v_mfma_f32_16x16x32_bf16 v[108:111], v[188:191], v[172:175], v[108:111]
    v_xor_b32 v9, 0x10000, v9
    v_mfma_f32_16x16x32_bf16 v[112:115], v[192:195], v[172:175], v[112:115]
    v_xor_b32 v10, 0x10000, v10
    v_mfma_f32_16x16x32_bf16 v[116:119], v[196:199], v[172:175], v[116:119]
    v_xor_b32 v11, 0x10000, v11
    v_mfma_f32_16x16x32_bf16 v[120:123], v[184:187], v[176:179], v[120:123]
    v_xor_b32 v12, 0x10000, v12
    v_mfma_f32_16x16x32_bf16 v[124:127], v[188:191], v[176:179], v[124:127]
    v_xor_b32 v13, 0x10000, v13
    v_mfma_f32_16x16x32_bf16 v[128:131], v[192:195], v[176:179], v[128:131]
    v_mfma_f32_16x16x32_bf16 v[132:135], v[196:199], v[176:179], v[132:135]
    v_mfma_f32_16x16x32_bf16 v[136:139], v[184:187], v[180:183], v[136:139]
    s_add_u32 m0, s53, s49
    s_add_u32 s48, s25, 256
    v_mfma_f32_16x16x32_bf16 v[140:143], v[188:191], v[180:183], v[140:143]
    v_mfma_f32_16x16x32_bf16 v[144:147], v[192:195], v[180:183], v[144:147]
    v_mfma_f32_16x16x32_bf16 v[148:151], v[196:199], v[180:183], v[148:151]
    s_waitcnt vmcnt(0) lgkmcnt(0)
    s_barrier
    s_cmp_lg_u32 s34, 0
    s_cbranch_scc1 SG_hrow
    s_cmp_eq_u32 s38, 0
    s_cbranch_scc1 SG_hrow
    s_and_b32 s40, s38, 1
    s_add_u32 s40, s40, 1
    v_mov_b32 v1, s40
    s_and_b32 s40, s38, -2
    s_mov_b64 exec, 1
    buffer_atomic_add v1, off, s[8:11], s40
    s_mov_b64 exec, -1
SG_hrow:
    v_mfma_f32_16x16x32_bf16 v[24:27], v[232:235], v[200:203], v[24:27]
    buffer_load_dwordx4 v2, s[12:15], s24 offen offset:0 sc1 lds
    v_mfma_f32_16x16x32_bf16 v[28:31], v[236:239], v[200:203], v[28:31]
    ds_read_b64_tr_b16 v[184:185], v10 offset:0
    v_mfma_f32_16x16x32_bf16 v[32:35], v[240:243], v[200:203], v[32:35]
    buffer_load_dwordx4 v3, s[12:15], s24 offen offset:1024 sc1 lds
    v_mfma_f32_16x16x32_bf16 v[36:39], v[244:247], v[200:203], v[36:39]
    ds_read_b64_tr_b16 v[186:187], v10 offset:1024
    v_mfma_f32_16x16x32_bf16 v[40:43], v[232:235], v[204:207], v[40:43]
    buffer_load_dwordx4 v4, s[12:15], s24 offen offset:2048 sc1 lds
    v_mfma_f32_16x16x32_bf16 v[44:47], v[236:239], v[204:207], v[44:47]
    ds_read_b128 v[152:155], v8 offset:0
    v_mfma_f32_16x16x32_bf16 v[48:51], v[240:243], v[204:207], v[48:51]
    buffer_load_dwordx4 v5, s[12:15], s24 offen offset:3072 sc1 lds
    s_add_u32 m0, s54, s49
    s_add_u32 s24, s24, 128
    v_mfma_f32_16x16x32_bf16 v[52:55], v[244:247], v[204:207], v[52:55]
    ds_read_b128 v[156:159], v8 offset:2048
    v_mfma_f32_16x16x32_bf16 v[56:59], v[232:235], v[208:211], v[56:59]
    buffer_load_dwordx4 v6, s[16:19], s25 offen offset:0 lds
    v_mfma_f32_16x16x32_bf16 v[60:63], v[236:239], v[208:211], v[60:63]
    ds_read_b64_tr_b16 v[188:189], v11 offset:0
    v_mfma_f32_16x16x32_bf16 v[64:67], v[240:243], v[208:211], v[64:67]
    buffer_load_dwordx4 v7, s[16:19], s25 offen offset:1024 lds
    s_add_u32 m0, m0, 0x4000
    s_add_u32 s25, s25, s52
    v_mfma_f32_16x16x32_bf16 v[68:71], v[244:247], v[208:211], v[68:71]
    ds_read_b64_tr_b16 v[190:191], v11 offset:1024
    v_mfma_f32_16x16x32_bf16 v[72:75], v[232:235], v[212:215], v[72:75]
    buffer_load_dwordx4 v6, s[16:19], s48 offen offset:0 lds
    v_mfma_f32_16x16x32_bf16 v[76:79], v[236:239], v[212:215], v[76:79]
    ds_read_b128 v[160:163], v8 offset:4096
    v_mfma_f32_16x16x32_bf16 v[80:83], v[240:243], v[212:215], v[80:83]
    buffer_load_dwordx4 v7, s[16:19], s48 offen offset:1024 lds
    s_xor_b32 s49, s49, 0x10000
    v_mfma_f32_16x16x32_bf16 v[84:87], v[244:247], v[212:215], v[84:87]
    ds_read_b128 v[164:167], v8 offset:6144
    v_mfma_f32_16x16x32_bf16 v[88:91], v[232:235], v[216:219], v[88:91]
    ds_read_b64_tr_b16 v[192:193], v12 offset:0
    v_mfma_f32_16x16x32_bf16 v[92:95], v[236:239], v[216:219], v[92:95]
    ds_read_b64_tr_b16 v[194:195], v12 offset:1024
    v_mfma_f32_16x16x32_bf16 v[96:99], v[240:243], v[216:219], v[96:99]
    ds_read_b128 v[168:171], v8 offset:8192
    v_mfma_f32_16x16x32_bf16 v[100:103], v[244:247], v[216:219], v[100:103]
    ds_read_b128 v[172:175], v8 offset:10240
    v_mfma_f32_16x16x32_bf16 v[104:107], v[232:235], v[220:223], v[104:107]
    ds_read_b64_tr_b16 v[196:197], v13 offset:0
    v_mfma_f32_16x16x32_bf16 v[108:111], v[236:239], v[220:223], v[108:111]
    ds_read_b64_tr_b16 v[198:199], v13 offset:1024
    v_mfma_f32_16x16x32_bf16 v[112:115], v[240:243], v[220:223], v[112:115]
    ds_read_b128 v[176:179], v8 offset:12288
    v_mfma_f32_16x16x32_bf16 v[116:119], v[244:247], v[220:223], v[116:119]
    ds_read_b128 v[180:183], v8 offset:14336
    v_mfma_f32_16x16x32_bf16 v[120:123], v[232:235], v[224:227], v[120:123]
    v_mfma_f32_16x16x32_bf16 v[124:127], v[236:239], v[224:227], v[124:127]
    v_mfma_f32_16x16x32_bf16 v[128:131], v[240:243], v[224:227], v[128:131]
    v_mfma_f32_16x16x32_bf16 v[132:135], v[244:247], v[224:227], v[132:135]
    v_mfma_f32_16x16x32_bf16 v[136:139], v[232:235], v[228:231], v[136:139]
    v_mfma_f32_16x16x32_bf16 v[140:143], v[236:239], v[228:231], v[140:143]
    v_mfma_f32_16x16x32_bf16 v[144:147], v[240:243], v[228:231], v[144:147]
    v_mfma_f32_16x16x32_bf16 v[148:151], v[244:247], v[228:231], v[148:151]
    s_mov_b32 s51, 12
    s_mov_b32 s44, 0
    s_mov_b32 s30, 0
    s_lshl_b32 s47, s34, 13
    s_add_u32 s47, s47, s3
    s_cmp_eq_u32 s5, 4
    s_cselect_b32 s50, 4, 99
    s_lshl_b32 s40, s3, 20
    s_lshl_b32 s41, s7, 12
    s_add_u32 s40, s40, s41
    s_add_u32 s40, s40, 0
    s_cmp_eq_u32 s5, 2
    s_cselect_b32 s47, s40, s47
    s_cselect_b32 s27, 0, 0
    v_lshlrev_b32 v22, 6, v0
H_LOOP_row:
    s_waitcnt lgkmcnt(0)
    v_mfma_f32_16x16x32_bf16 v[24:27], v[184:187], v[152:155], v[24:27]
    ds_read_b64_tr_b16 v[232:233], v10 offset:8192
    v_mfma_f32_16x16x32_bf16 v[28:31], v[188:191], v[152:155], v[28:31]
    ds_read_b64_tr_b16 v[234:235], v10 offset:9216
    v_mfma_f32_16x16x32_bf16 v[32:35], v[192:195], v[152:155], v[32:35]
    ds_read_b128 v[200:203], v9 offset:0
    v_mfma_f32_16x16x32_bf16 v[36:39], v[196:199], v[152:155], v[36:39]
    ds_read_b128 v[204:207], v9 offset:2048
    v_mfma_f32_16x16x32_bf16 v[40:43], v[184:187], v[156:159], v[40:43]
    ds_read_b64_tr_b16 v[236:237], v11 offset:8192
    v_mfma_f32_16x16x32_bf16 v[44:47], v[188:191], v[156:159], v[44:47]
    ds_read_b64_tr_b16 v[238:239], v11 offset:9216
    v_mfma_f32_16x16x32_bf16 v[48:51], v[192:195], v[156:159], v[48:51]
    ds_read_b128 v[208:211], v9 offset:4096
    v_mfma_f32_16x16x32_bf16 v[52:55], v[196:199], v[156:159], v[52:55]
    ds_read_b128 v[212:215], v9 offset:6144
    v_mfma_f32_16x16x32_bf16 v[56:59], v[184:187], v[160:163], v[56:59]
    ds_read_b64_tr_b16 v[240:241], v12 offset:8192
    v_mfma_f32_16x16x32_bf16 v[60:63], v[188:191], v[160:163], v[60:63]
    ds_read_b64_tr_b16 v[242:243], v12 offset:9216
    v_mfma_f32_16x16x32_bf16 v[64:67], v[192:195], v[160:163], v[64:67]
    ds_read_b128 v[216:219], v9 offset:8192
    v_mfma_f32_16x16x32_bf16 v[68:71], v[196:199], v[160:163], v[68:71]
    ds_read_b128 v[220:223], v9 offset:10240
    v_mfma_f32_16x16x32_bf16 v[72:75], v[184:187], v[164:167], v[72:75]
    ds_read_b64_tr_b16 v[244:245], v13 offset:8192
    v_mfma_f32_16x16x32_bf16 v[76:79], v[188:191], v[164:167], v[76:79]
    ds_read_b64_tr_b16 v[246:247], v13 offset:9216
    v_mfma_f32_16x16x32_bf16 v[80:83], v[192:195], v[164:167], v[80:83]
    ds_read_b128 v[224:227], v9 offset:12288
    v_mfma_f32_16x16x32_bf16 v[84:87], v[196:199], v[164:167], v[84:87]
    ds_read_b128 v[228:231], v9 offset:14336
    v_mfma_f32_16x16x32_bf16 v[88:91], v[184:187], v[168:171], v[88:91]
    v_mfma_f32_16x16x32_bf16 v[92:95], v[188:191], v[168:171], v[92:95]
    v_mfma_f32_16x16x32_bf16 v[96:99], v[192:195], v[168:171], v[96:99]
    v_mfma_f32_16x16x32_bf16 v[100:103], v[196:199], v[168:171], v[100:103]
    v_mfma_f32_16x16x32_bf16 v[104:107], v[184:187], v[172:175], v[104:107]
    v_xor_b32 v8, 0x10000, v8
    v_mfma_f32_16x16x32_bf16 v[108:111], v[188:191], v[172:175], v[108:111]
    v_xor_b32 v9, 0x10000, v9
    v_mfma_f32_16x16x32_bf16 v[112:115], v[192:195], v[172:175], v[112:115]
    v_xor_b32 v10, 0x10000, v10
    v_mfma_f32_16x16x32_bf16 v[116:119], v[196:199], v[172:175], v[116:119]
    v_xor_b32 v11, 0x10000, v11
    v_mfma_f32_16x16x32_bf16 v[120:123], v[184:187], v[176:179], v[120:123]
    v_xor_b32 v12, 0x10000, v12
    v_mfma_f32_16x16x32_bf16 v[124:127], v[188:191], v[176:179], v[124:127]
    v_xor_b32 v13, 0x10000, v13
    v_mfma_f32_16x16x32_bf16 v[128:131], v[192:195], v[176:179], v[128:131]
    v_mfma_f32_16x16x32_bf16 v[132:135], v[196:199], v[176:179], v[132:135]
    v_mfma_f32_16x16x32_bf16 v[136:139], v[184:187], v[180:183], v[136:139]
    s_add_u32 m0, s53, s49
    s_add_u32 s48, s25, 256
    v_mfma_f32_16x16x32_bf16 v[140:143], v[188:191], v[180:183], v[140:143]
    v_mfma_f32_16x16x32_bf16 v[144:147], v[192:195], v[180:183], v[144:147]
    v_mfma_f32_16x16x32_bf16 v[148:151], v[196:199], v[180:183], v[148:151]
    s_cmp_eq_u32 s30, 1
    s_cbranch_scc1 H_HW
    s_waitcnt vmcnt(0)
H_HW:
    s_waitcnt vmcnt(1) lgkmcnt(0)
    s_barrier
    v_mfma_f32_16x16x32_bf16 v[24:27], v[232:235], v[200:203], v[24:27]
    buffer_load_dwordx4 v2, s[12:15], s24 offen offset:0 sc1 lds
    v_mfma_f32_16x16x32_bf16 v[28:31], v[236:239], v[200:203], v[28:31]
    ds_read_b64_tr_b16 v[184:185], v10 offset:0
    v_mfma_f32_16x16x32_bf16 v[32:35], v[240:243], v[200:203], v[32:35]
    buffer_load_dwordx4 v3, s[12:15], s24 offen offset:1024 sc1 lds
    v_mfma_f32_16x16x32_bf16 v[36:39], v[244:247], v[200:203], v[36:39]
    ds_read_b64_tr_b16 v[186:187], v10 offset:1024
    v_mfma_f32_16x16x32_bf16 v[40:43], v[232:235], v[204:207], v[40:43]
    buffer_load_dwordx4 v4, s[12:15], s24 offen offset:2048 sc1 lds
    v_mfma_f32_16x16x32_bf16 v[44:47], v[236:239], v[204:207], v[44:47]
    ds_read_b128 v[152:155], v8 offset:0
    v_mfma_f32_16x16x32_bf16 v[48:51], v[240:243], v[204:207], v[48:51]
    buffer_load_dwordx4 v5, s[12:15], s24 offen offset:3072 sc1 lds
    s_add_u32 m0, s54, s49
    s_add_u32 s24, s24, 128
    v_mfma_f32_16x16x32_bf16 v[52:55], v[244:247], v[204:207], v[52:55]
    ds_read_b128 v[156:159], v8 offset:2048
    v_mfma_f32_16x16x32_bf16 v[56:59], v[232:235], v[208:211], v[56:59]
    buffer_load_dwordx4 v6, s[16:19], s25 offen offset:0 lds
    v_mfma_f32_16x16x32_bf16 v[60:63], v[236:239], v[208:211], v[60:63]
    ds_read_b64_tr_b16 v[188:189], v11 offset:0
    v_mfma_f32_16x16x32_bf16 v[64:67], v[240:243], v[208:211], v[64:67]
    buffer_load_dwordx4 v7, s[16:19], s25 offen offset:1024 lds
    s_add_u32 m0, m0, 0x4000
    s_add_u32 s25, s25, s52
    v_mfma_f32_16x16x32_bf16 v[68:71], v[244:247], v[208:211], v[68:71]
    ds_read_b64_tr_b16 v[190:191], v11 offset:1024
    v_mfma_f32_16x16x32_bf16 v[72:75], v[232:235], v[212:215], v[72:75]
    buffer_load_dwordx4 v6, s[16:19], s48 offen offset:0 lds
    v_mfma_f32_16x16x32_bf16 v[76:79], v[236:239], v[212:215], v[76:79]
    ds_read_b128 v[160:163], v8 offset:4096
    v_mfma_f32_16x16x32_bf16 v[80:83], v[240:243], v[212:215], v[80:83]
    buffer_load_dwordx4 v7, s[16:19], s48 offen offset:1024 lds
    s_xor_b32 s49, s49, 0x10000
    v_mfma_f32_16x16x32_bf16 v[84:87], v[244:247], v[212:215], v[84:87]
    ds_read_b128 v[164:167], v8 offset:6144
    v_mfma_f32_16x16x32_bf16 v[88:91], v[232:235], v[216:219], v[88:91]
    ds_read_b64_tr_b16 v[192:193], v12 offset:0
    v_mfma_f32_16x16x32_bf16 v[92:95], v[236:239], v[216:219], v[92:95]
    ds_read_b64_tr_b16 v[194:195], v12 offset:1024
    v_mfma_f32_16x16x32_bf16 v[96:99], v[240:243], v[216:219], v[96:99]
    ds_read_b128 v[168:171], v8 offset:8192
    v_mfma_f32_16x16x32_bf16 v[100:103], v[244:247], v[216:219], v[100:103]
    ds_read_b128 v[172:175], v8 offset:10240
    v_mfma_f32_16x16x32_bf16 v[104:107], v[232:235], v[220:223], v[104:107]
    ds_read_b64_tr_b16 v[196:197], v13 offset:0
    v_mfma_f32_16x16x32_bf16 v[108:111], v[236:239], v[220:223], v[108:111]
    ds_read_b64_tr_b16 v[198:199], v13 offset:1024
    v_mfma_f32_16x16x32_bf16 v[112:115], v[240:243], v[220:223], v[112:115]
    ds_read_b128 v[176:179], v8 offset:12288
    v_mfma_f32_16x16x32_bf16 v[116:119], v[244:247], v[220:223], v[116:119]
    ds_read_b128 v[180:183], v8 offset:14336
    v_mfma_f32_16x16x32_bf16 v[120:123], v[232:235], v[224:227], v[120:123]
    v_mfma_f32_16x16x32_bf16 v[124:127], v[236:239], v[224:227], v[124:127]
    s_cmp_le_u32 s51, s50
    s_cbranch_scc1 H_NArow
    buffer_store_dwordx4 v[248:251], v21, s[8:11], s47 offen sc1
    s_add_u32 s47, s47, 1024
H_NArow:
    s_cmp_gt_u32 s51, s27
    s_cbranch_scc1 H_NT
    buffer_load_dword v252, v22, s[8:11], s47 offen sc1
    s_add_u32 s47, s47, 0x40000
    s_mov_b32 s30, 1
H_NT:
    v_mfma_f32_16x16x32_bf16 v[128:131], v[240:243], v[224:227], v[128:131]
    v_mfma_f32_16x16x32_bf16 v[132:135], v[244:247], v[224:227], v[132:135]
    v_mfma_f32_16x16x32_bf16 v[136:139], v[232:235], v[228:231], v[136:139]
    v_mfma_f32_16x16x32_bf16 v[140:143], v[236:239], v[228:231], v[140:143]
    v_mfma_f32_16x16x32_bf16 v[144:147], v[240:243], v[228:231], v[144:147]
    v_mfma_f32_16x16x32_bf16 v[148:151], v[244:247], v[228:231], v[148:151]
    s_sub_u32 s51, s51, 1
    s_cmp_lg_u32 s51, 0
    s_cbranch_scc1 H_LOOP_row
    s_cmp_eq_u32 s44, 1
    s_cbranch_scc1 H_EP_row
    s_cmp_eq_u32 s5, 2
    s_cbranch_scc1 B_QA
    s_cmp_lt_u32 s86, 4
    s_cbranch_scc1 H_TAIL_row
    s_mov_b32 s12, s88
    s_and_b32 s13, s89, 0xffff
    s_mov_b32 s14, s87
    s_mov_b32 s16, s90
    s_and_b32 s17, s91, 0xffff
    s_mov_b32 s18, s92
    s_mov_b32 s24, s93
    s_mov_b32 s25, s94
    s_mov_b32 s31, s95
    v_mul_lo_u32 v6, v18, s31
    s_lshl_b32 s45, s31, 2
    s_sub_u32 s45, s45, 1024
    s_lshl_b32 s52, s31, 6
    v_add_u32 v6, v6, v19
    v_add_u32 v7, s45, v6
    s_mov_b32 s51, 2
    s_mov_b32 s44, 1
    s_branch H_LOOP_row
H_TAIL_row:
    s_waitcnt lgkmcnt(0)
    v_mfma_f32_16x16x32_bf16 v[24:27], v[184:187], v[152:155], v[24:27]
    ds_read_b64_tr_b16 v[232:233], v10 offset:8192
    v_mfma_f32_16x16x32_bf16 v[28:31], v[188:191], v[152:155], v[28:31]
    ds_read_b64_tr_b16 v[234:235], v10 offset:9216
    v_mfma_f32_16x16x32_bf16 v[32:35], v[192:195], v[152:155], v[32:35]
    ds_read_b128 v[200:203], v9 offset:0
    v_mfma_f32_16x16x32_bf16 v[36:39], v[196:199], v[152:155], v[36:39]
    ds_read_b128 v[204:207], v9 offset:2048
    v_mfma_f32_16x16x32_bf16 v[40:43], v[184:187], v[156:159], v[40:43]
    ds_read_b64_tr_b16 v[236:237], v11 offset:8192
    v_mfma_f32_16x16x32_bf16 v[44:47], v[188:191], v[156:159], v[44:47]
    ds_read_b64_tr_b16 v[238:239], v11 offset:9216
    v_mfma_f32_16x16x32_bf16 v[48:51], v[192:195], v[156:159], v[48:51]
    ds_read_b128 v[208:211], v9 offset:4096
    v_mfma_f32_16x16x32_bf16 v[52:55], v[196:199], v[156:159], v[52:55]
    ds_read_b128 v[212:215], v9 offset:6144
    v_mfma_f32_16x16x32_bf16 v[56:59], v[184:187], v[160:163], v[56:59]
    ds_read_b64_tr_b16 v[240:241], v12 offset:8192
    v_mfma_f32_16x16x32_bf16 v[60:63], v[188:191], v[160:163], v[60:63]
    ds_read_b64_tr_b16 v[242:243], v12 offset:9216
    v_mfma_f32_16x16x32_bf16 v[64:67], v[192:195], v[160:163], v[64:67]
    ds_read_b128 v[216:219], v9 offset:8192
    v_mfma_f32_16x16x32_bf16 v[68:71], v[196:199], v[160:163], v[68:71]
    ds_read_b128 v[220:223], v9 offset:10240
    v_mfma_f32_16x16x32_bf16 v[72:75], v[184:187], v[164:167], v[72:75]
    ds_read_b64_tr_b16 v[244:245], v13 offset:8192
    v_mfma_f32_16x16x32_bf16 v[76:79], v[188:191], v[164:167], v[76:79]
    ds_read_b64_tr_b16 v[246:247], v13 offset:9216
    v_mfma_f32_16x16x32_bf16 v[80:83], v[192:195], v[164:167], v[80:83]
    ds_read_b128 v[224:227], v9 offset:12288
    v_mfma_f32_16x16x32_bf16 v[84:87], v[196:199], v[164:167], v[84:87]
    ds_read_b128 v[228:231], v9 offset:14336
    v_mfma_f32_16x16x32_bf16 v[88:91], v[184:187], v[168:171], v[88:91]
    v_mfma_f32_16x16x32_bf16 v[92:95], v[188:191], v[168:171], v[92:95]
    v_mfma_f32_16x16x32_bf16 v[96:99], v[192:195], v[168:171], v[96:99]
    v_mfma_f32_16x16x32_bf16 v[100:103], v[196:199], v[168:171], v[100:103]
    v_mfma_f32_16x16x32_bf16 v[104:107], v[184:187], v[172:175], v[104:107]
    v_xor_b32 v8, 0x10000, v8
    v_mfma_f32_16x16x32_bf16 v[108:111], v[188:191], v[172:175], v[108:111]
    v_xor_b32 v9, 0x10000, v9
    v_mfma_f32_16x16x32_bf16 v[112:115], v[192:195], v[172:175], v[112:115]
    v_xor_b32 v10, 0x10000, v10
    v_mfma_f32_16x16x32_bf16 v[116:119], v[196:199], v[172:175], v[116:119]
    v_xor_b32 v11, 0x10000, v11
    v_mfma_f32_16x16x32_bf16 v[120:123], v[184:187], v[176:179], v[120:123]
    v_xor_b32 v12, 0x10000, v12
    v_mfma_f32_16x16x32_bf16 v[124:127], v[188:191], v[176:179], v[124:127]
    v_xor_b32 v13, 0x10000, v13
    v_mfma_f32_16x16x32_bf16 v[128:131], v[192:195], v[176:179], v[128:131]
    v_mfma_f32_16x16x32_bf16 v[132:135], v[196:199], v[176:179], v[132:135]
    v_mfma_f32_16x16x32_bf16 v[136:139], v[184:187], v[180:183], v[136:139]
    v_mfma_f32_16x16x32_bf16 v[140:143], v[188:191], v[180:183], v[140:143]
    v_mfma_f32_16x16x32_bf16 v[144:147], v[192:195], v[180:183], v[144:147]
    v_mfma_f32_16x16x32_bf16 v[148:151], v[196:199], v[180:183], v[148:151]
    s_waitcnt vmcnt(0) lgkmcnt(0)
    s_barrier
    v_mfma_f32_16x16x32_bf16 v[24:27], v[232:235], v[200:203], v[24:27]
    v_mfma_f32_16x16x32_bf16 v[28:31], v[236:239], v[200:203], v[28:31]
    ds_read_b64_tr_b16 v[184:185], v10 offset:0
    v_mfma_f32_16x16x32_bf16 v[32:35], v[240:243], v[200:203], v[32:35]
    v_mfma_f32_16x16x32_bf16 v[36:39], v[244:247], v[200:203], v[36:39]
    ds_read_b64_tr_b16 v[186:187], v10 offset:1024
    v_mfma_f32_16x16x32_bf16 v[40:43], v[232:235], v[204:207], v[40:43]
    v_mfma_f32_16x16x32_bf16 v[44:47], v[236:239], v[204:207], v[44:47]
    ds_read_b128 v[152:155], v8 offset:0
    v_mfma_f32_16x16x32_bf16 v[48:51], v[240:243], v[204:207], v[48:51]
    v_mfma_f32_16x16x32_bf16 v[52:55], v[244:247], v[204:207], v[52:55]
    ds_read_b128 v[156:159], v8 offset:2048
    v_mfma_f32_16x16x32_bf16 v[56:59], v[232:235], v[208:211], v[56:59]
    v_mfma_f32_16x16x32_bf16 v[60:63], v[236:239], v[208:211], v[60:63]
    ds_read_b64_tr_b16 v[188:189], v11 offset:0
    v_mfma_f32_16x16x32_bf16 v[64:67], v[240:243], v[208:211], v[64:67]
    v_mfma_f32_16x16x32_bf16 v[68:71], v[244:247], v[208:211], v[68:71]
    ds_read_b64_tr_b16 v[190:191], v11 offset:1024
    v_mfma_f32_16x16x32_bf16 v[72:75], v[232:235], v[212:215], v[72:75]
    v_mfma_f32_16x16x32_bf16 v[76:79], v[236:239], v[212:215], v[76:79]
    ds_read_b128 v[160:163], v8 offset:4096
    v_mfma_f32_16x16x32_bf16 v[80:83], v[240:243], v[212:215], v[80:83]
    v_mfma_f32_16x16x32_bf16 v[84:87], v[244:247], v[212:215], v[84:87]
    ds_read_b128 v[164:167], v8 offset:6144
    v_mfma_f32_16x16x32_bf16 v[88:91], v[232:235], v[216:219], v[88:91]
    ds_read_b64_tr_b16 v[192:193], v12 offset:0
    v_mfma_f32_16x16x32_bf16 v[92:95], v[236:239], v[216:219], v[92:95]
    ds_read_b64_tr_b16 v[194:195], v12 offset:1024
    v_mfma_f32_16x16x32_bf16 v[96:99], v[240:243], v[216:219], v[96:99]
    ds_read_b128 v[168:171], v8 offset:8192
    v_mfma_f32_16x16x32_bf16 v[100:103], v[244:247], v[216:219], v[100:103]
    ds_read_b128 v[172:175], v8 offset:10240
    v_mfma_f32_16x16x32_bf16 v[104:107], v[232:235], v[220:223], v[104:107]
    ds_read_b64_tr_b16 v[196:197], v13 offset:0
    v_mfma_f32_16x16x32_bf16 v[108:111], v[236:239], v[220:223], v[108:111]
    ds_read_b64_tr_b16 v[198:199], v13 offset:1024
    v_mfma_f32_16x16x32_bf16 v[112:115], v[240:243], v[220:223], v[112:115]
    ds_read_b128 v[176:179], v8 offset:12288
    v_mfma_f32_16x16x32_bf16 v[116:119], v[244:247], v[220:223], v[116:119]
    ds_read_b128 v[180:183], v8 offset:14336
    v_mfma_f32_16x16x32_bf16 v[120:123], v[232:235], v[224:227], v[120:123]
    v_mfma_f32_16x16x32_bf16 v[124:127], v[236:239], v[224:227], v[124:127]
    v_mfma_f32_16x16x32_bf16 v[128:131], v[240:243], v[224:227], v[128:131]
    v_mfma_f32_16x16x32_bf16 v[132:135], v[244:247], v[224:227], v[132:135]
    v_mfma_f32_16x16x32_bf16 v[136:139], v[232:235], v[228:231], v[136:139]
    v_mfma_f32_16x16x32_bf16 v[140:143], v[236:239], v[228:231], v[140:143]
    v_mfma_f32_16x16x32_bf16 v[144:147], v[240:243], v[228:231], v[144:147]
    v_mfma_f32_16x16x32_bf16 v[148:151], v[244:247], v[228:231], v[148:151]
    s_waitcnt lgkmcnt(0)
    v_mfma_f32_16x16x32_bf16 v[24:27], v[184:187], v[152:155], v[24:27]
    ds_read_b64_tr_b16 v[232:233], v10 offset:8192
    v_mfma_f32_16x16x32_bf16 v[28:31], v[188:191], v[152:155], v[28:31]
    ds_read_b64_tr_b16 v[234:235], v10 offset:9216
    v_mfma_f32_16x16x32_bf16 v[32:35], v[192:195], v[152:155], v[32:35]
    ds_read_b128 v[200:203], v9 offset:0
    v_mfma_f32_16x16x32_bf16 v[36:39], v[196:199], v[152:155], v[36:39]
    ds_read_b128 v[204:207], v9 offset:2048
    v_mfma_f32_16x16x32_bf16 v[40:43], v[184:187], v[156:159], v[40:43]
    ds_read_b64_tr_b16 v[236:237], v11 offset:8192
    v_mfma_f32_16x16x32_bf16 v[44:47], v[188:191], v[156:159], v[44:47]
    ds_read_b64_tr_b16 v[238:239], v11 offset:9216
    v_mfma_f32_16x16x32_bf16 v[48:51], v[192:195], v[156:159], v[48:51]
    ds_read_b128 v[208:211], v9 offset:4096
    v_mfma_f32_16x16x32_bf16 v[52:55], v[196:199], v[156:159], v[52:55]
    ds_read_b128 v[212:215], v9 offset:6144
    v_mfma_f32_16x16x32_bf16 v[56:59], v[184:187], v[160:163], v[56:59]
    ds_read_b64_tr_b16 v[240:241], v12 offset:8192
    v_mfma_f32_16x16x32_bf16 v[60:63], v[188:191], v[160:163], v[60:63]
    ds_read_b64_tr_b16 v[242:243], v12 offset:9216
    v_mfma_f32_16x16x32_bf16 v[64:67], v[192:195], v[160:163], v[64:67]
    ds_read_b128 v[216:219], v9 offset:8192
    v_mfma_f32_16x16x32_bf16 v[68:71], v[196:199], v[160:163], v[68:71]
    ds_read_b128 v[220:223], v9 offset:10240
    v_mfma_f32_16x16x32_bf16 v[72:75], v[184:187], v[164:167], v[72:75]
    ds_read_b64_tr_b16 v[244:245], v13 offset:8192
    v_mfma_f32_16x16x32_bf16 v[76:79], v[188:191], v[164:167], v[76:79]
    ds_read_b64_tr_b16 v[246:247], v13 offset:9216
    v_mfma_f32_16x16x32_bf16 v[80:83], v[192:195], v[164:167], v[80:83]
    ds_read_b128 v[224:227], v9 offset:12288
    v_mfma_f32_16x16x32_bf16 v[84:87], v[196:199], v[164:167], v[84:87]
    ds_read_b128 v[228:231], v9 offset:14336
    v_mfma_f32_16x16x32_bf16 v[88:91], v[184:187], v[168:171], v[88:91]
    v_mfma_f32_16x16x32_bf16 v[92:95], v[188:191], v[168:171], v[92:95]
    v_mfma_f32_16x16x32_bf16 v[96:99], v[192:195], v[168:171], v[96:99]
    v_mfma_f32_16x16x32_bf16 v[100:103], v[196:199], v[168:171], v[100:103]
    v_mfma_f32_16x16x32_bf16 v[104:107], v[184:187], v[172:175], v[104:107]
    v_mfma_f32_16x16x32_bf16 v[108:111], v[188:191], v[172:175], v[108:111]
    v_mfma_f32_16x16x32_bf16 v[112:115], v[192:195], v[172:175], v[112:115]
    v_mfma_f32_16x16x32_bf16 v[116:119], v[196:199], v[172:175], v[116:119]
    v_mfma_f32_16x16x32_bf16 v[120:123], v[184:187], v[176:179], v[120:123]
    v_mfma_f32_16x16x32_bf16 v[124:127], v[188:191], v[176:179], v[124:127]
    v_mfma_f32_16x16x32_bf16 v[128:131], v[192:195], v[176:179], v[128:131]
    v_mfma_f32_16x16x32_bf16 v[132:135], v[196:199], v[176:179], v[132:135]
    v_mfma_f32_16x16x32_bf16 v[136:139], v[184:187], v[180:183], v[136:139]
    v_mfma_f32_16x16x32_bf16 v[140:143], v[188:191], v[180:183], v[140:143]
    v_mfma_f32_16x16x32_bf16 v[144:147], v[192:195], v[180:183], v[144:147]
    v_mfma_f32_16x16x32_bf16 v[148:151], v[196:199], v[180:183], v[148:151]
    s_waitcnt lgkmcnt(0)
    v_mfma_f32_16x16x32_bf16 v[24:27], v[232:235], v[200:203], v[24:27]
    v_mfma_f32_16x16x32_bf16 v[28:31], v[236:239], v[200:203], v[28:31]
    v_mfma_f32_16x16x32_bf16 v[32:35], v[240:243], v[200:203], v[32:35]
    v_mfma_f32_16x16x32_bf16 v[36:39], v[244:247], v[200:203], v[36:39]
    v_mfma_f32_16x16x32_bf16 v[40:43], v[232:235], v[204:207], v[40:43]
    v_mfma_f32_16x16x32_bf16 v[44:47], v[236:239], v[204:207], v[44:47]
    v_mfma_f32_16x16x32_bf16 v[48:51], v[240:243], v[204:207], v[48:51]
    v_mfma_f32_16x16x32_bf16 v[52:55], v[244:247], v[204:207], v[52:55]
    v_mfma_f32_16x16x32_bf16 v[56:59], v[232:235], v[208:211], v[56:59]
    v_mfma_f32_16x16x32_bf16 v[60:63], v[236:239], v[208:211], v[60:63]
    v_mfma_f32_16x16x32_bf16 v[64:67], v[240:243], v[208:211], v[64:67]
    v_mfma_f32_16x16x32_bf16 v[68:71], v[244:247], v[208:211], v[68:71]
    v_mfma_f32_16x16x32_bf16 v[72:75], v[232:235], v[212:215], v[72:75]
    v_mfma_f32_16x16x32_bf16 v[76:79], v[236:239], v[212:215], v[76:79]
    v_mfma_f32_16x16x32_bf16 v[80:83], v[240:243], v[212:215], v[80:83]
    v_mfma_f32_16x16x32_bf16 v[84:87], v[244:247], v[212:215], v[84:87]
    v_mfma_f32_16x16x32_bf16 v[88:91], v[232:235], v[216:219], v[88:91]
    v_mfma_f32_16x16x32_bf16 v[92:95], v[236:239], v[216:219], v[92:95]
    v_mfma_f32_16x16x32_bf16 v[96:99], v[240:243], v[216:219], v[96:99]
    v_mfma_f32_16x16x32_bf16 v[100:103], v[244:247], v[216:219], v[100:103]
    v_mfma_f32_16x16x32_bf16 v[104:107], v[232:235], v[220:223], v[104:107]
    v_mfma_f32_16x16x32_bf16 v[108:111], v[236:239], v[220:223], v[108:111]
    v_mfma_f32_16x16x32_bf16 v[112:115], v[240:243], v[220:223], v[112:115]
    v_mfma_f32_16x16x32_bf16 v[116:119], v[244:247], v[220:223], v[116:119]
    v_mfma_f32_16x16x32_bf16 v[120:123], v[232:235], v[224:227], v[120:123]
    v_mfma_f32_16x16x32_bf16 v[124:127], v[236:239], v[224:227], v[124:127]
    v_mfma_f32_16x16x32_bf16 v[128:131], v[240:243], v[224:227], v[128:131]
    v_mfma_f32_16x16x32_bf16 v[132:135], v[244:247], v[224:227], v[132:135]
    v_mfma_f32_16x16x32_bf16 v[136:139], v[232:235], v[228:231], v[136:139]
    v_mfma_f32_16x16x32_bf16 v[140:143], v[236:239], v[228:231], v[140:143]
    v_mfma_f32_16x16x32_bf16 v[144:147], v[240:243], v[228:231], v[144:147]
    v_mfma_f32_16x16x32_bf16 v[148:151], v[244:247], v[228:231], v[148:151]
H_EP_row:
    s_cmp_lg_u32 s5, 1
    s_cbranch_scc1 H_NOSC
    v_mov_b32 v1, 0x3e8293ee
    v_mul_f32 v24, v24, v1
    v_mul_f32 v25, v25, v1
    v_mul_f32 v26, v26, v1
    v_mul_f32 v27, v27, v1
    v_mul_f32 v28, v28, v1
    v_mul_f32 v29, v29, v1
    v_mul_f32 v30, v30, v1
    v_mul_f32 v31, v31, v1
    v_mul_f32 v32, v32, v1
    v_mul_f32 v33, v33, v1
    v_mul_f32 v34, v34, v1
    v_mul_f32 v35, v35, v1
    v_mul_f32 v36, v36, v1
    v_mul_f32 v37, v37, v1
    v_mul_f32 v38, v38, v1
    v_mul_f32 v39, v39, v1
    v_mul_f32 v40, v40, v1
    v_mul_f32 v41, v41, v1
    v_mul_f32 v42, v42, v1
    v_mul_f32 v43, v43, v1
    v_mul_f32 v44, v44, v1
    v_mul_f32 v45, v45, v1
    v_mul_f32 v46, v46, v1
    v_mul_f32 v47, v47, v1
    v_mul_f32 v48, v48, v1
    v_mul_f32 v49, v49, v1
    v_mul_f32 v50, v50, v1
    v_mul_f32 v51, v51, v1
    v_mul_f32 v52, v52, v1
    v_mul_f32 v53, v53, v1
    v_mul_f32 v54, v54, v1
    v_mul_f32 v55, v55, v1
    v_mul_f32 v56, v56, v1
    v_mul_f32 v57, v57, v1
    v_mul_f32 v58, v58, v1
    v_mul_f32 v59, v59, v1
    v_mul_f32 v60, v60, v1
    v_mul_f32 v61, v61, v1
    v_mul_f32 v62, v62, v1
    v_mul_f32 v63, v63, v1
    v_mul_f32 v64, v64, v1
    v_mul_f32 v65, v65, v1
    v_mul_f32 v66, v66, v1
    v_mul_f32 v67, v67, v1
    v_mul_f32 v68, v68, v1
    v_mul_f32 v69, v69, v1
    v_mul_f32 v70, v70, v1
    v_mul_f32 v71, v71, v1
    v_mul_f32 v72, v72, v1
    v_mul_f32 v73, v73, v1
    v_mul_f32 v74, v74, v1
    v_mul_f32 v75, v75, v1
    v_mul_f32 v76, v76, v1
    v_mul_f32 v77, v77, v1
    v_mul_f32 v78, v78, v1
    v_mul_f32 v79, v79, v1
    v_mul_f32 v80, v80, v1
    v_mul_f32 v81, v81, v1
    v_mul_f32 v82, v82, v1
    v_mul_f32 v83, v83, v1
    v_mul_f32 v84, v84, v1
    v_mul_f32 v85, v85, v1
    v_mul_f32 v86, v86, v1
    v_mul_f32 v87, v87, v1
    v_mul_f32 v88, v88, v1
    v_mul_f32 v89, v89, v1
    v_mul_f32 v90, v90, v1
    v_mul_f32 v91, v91, v1
    v_mul_f32 v92, v92, v1
    v_mul_f32 v93, v93, v1
    v_mul_f32 v94, v94, v1
    v_mul_f32 v95, v95, v1
    v_mul_f32 v96, v96, v1
    v_mul_f32 v97, v97, v1
    v_mul_f32 v98, v98, v1
    v_mul_f32 v99, v99, v1
    v_mul_f32 v100, v100, v1
    v_mul_f32 v101, v101, v1
    v_mul_f32 v102, v102, v1
    v_mul_f32 v103, v103, v1
    v_mul_f32 v104, v104, v1
    v_mul_f32 v105, v105, v1
    v_mul_f32 v106, v106, v1
    v_mul_f32 v107, v107, v1
    v_mul_f32 v108, v108, v1
    v_mul_f32 v109, v109, v1
    v_mul_f32 v110, v110, v1
    v_mul_f32 v111, v111, v1
    v_mul_f32 v112, v112, v1
    v_mul_f32 v113, v113, v1
    v_mul_f32 v114, v114, v1
    v_mul_f32 v115, v115, v1
    v_mul_f32 v116, v116, v1
    v_mul_f32 v117, v117, v1
    v_mul_f32 v118, v118, v1
    v_mul_f32 v119, v119, v1
    v_mul_f32 v120, v120, v1
    v_mul_f32 v121, v121, v1
    v_mul_f32 v122, v122, v1
    v_mul_f32 v123, v123, v1
    v_mul_f32 v124, v124, v1
    v_mul_f32 v125, v125, v1
    v_mul_f32 v126, v126, v1
    v_mul_f32 v127, v127, v1
    v_mul_f32 v128, v128, v1
    v_mul_f32 v129, v129, v1
    v_mul_f32 v130, v130, v1
    v_mul_f32 v131, v131, v1
    v_mul_f32 v132, v132, v1
    v_mul_f32 v133, v133, v1
    v_mul_f32 v134, v134, v1
    v_mul_f32 v135, v135, v1
    v_mul_f32 v136, v136, v1
    v_mul_f32 v137, v137, v1
    v_mul_f32 v138, v138, v1
    v_mul_f32 v139, v139, v1
    v_mul_f32 v140, v140, v1
    v_mul_f32 v141, v141, v1
    v_mul_f32 v142, v142, v1
    v_mul_f32 v143, v143, v1
    v_mul_f32 v144, v144, v1
    v_mul_f32 v145, v145, v1
    v_mul_f32 v146, v146, v1
    v_mul_f32 v147, v147, v1
    v_mul_f32 v148, v148, v1
    v_mul_f32 v149, v149, v1
    v_mul_f32 v150, v150, v1
    v_mul_f32 v151, v151, v1
H_NOSC:
    s_lshr_b32 s45, s34, 2
    s_lshl_b32 s45, s45, 2
    s_and_b32 s46, s34, 3
    s_lshl_b32 s46, s46, 1
    s_mul_i32 s45, s45, s28
    s_mul_i32 s46, s46, s29
    s_add_u32 s26, s26, s45
    s_add_u32 s26, s26, s46
    s_add_u32 s46, s26, s29
    v_cvt_pk_bf16_f32 v24, v24, v25
    v_cvt_pk_bf16_f32 v25, v26, v27
    v_cvt_pk_bf16_f32 v26, v28, v29
    v_cvt_pk_bf16_f32 v27, v30, v31
    v_cvt_pk_bf16_f32 v40, v40, v41
    v_cvt_pk_bf16_f32 v41, v42, v43
    v_cvt_pk_bf16_f32 v42, v44, v45
    v_cvt_pk_bf16_f32 v43, v46, v47
    v_cvt_pk_bf16_f32 v32, v32, v33
    v_cvt_pk_bf16_f32 v33, v34, v35
    v_cvt_pk_bf16_f32 v34, v36, v37
    v_cvt_pk_bf16_f32 v35, v38, v39
    v_cvt_pk_bf16_f32 v48, v48, v49
    v_cvt_pk_bf16_f32 v49, v50, v51
    v_cvt_pk_bf16_f32 v50, v52, v53
    v_cvt_pk_bf16_f32 v51, v54, v55
    v_permlane16_swap_b32 v24, v26
    v_permlane16_swap_b32 v25, v27
    buffer_store_dwordx4 v[24:27], v20, s[20:23], s26 offen offset:0 sc1
    v_permlane16_swap_b32 v40, v42
    v_permlane16_swap_b32 v41, v43
    buffer_store_dwordx4 v[40:43], v20, s[20:23], s26 offen offset:256 sc1
    v_permlane16_swap_b32 v32, v34
    v_permlane16_swap_b32 v33, v35
    buffer_store_dwordx4 v[32:35], v20, s[20:23], s46 offen offset:0 sc1
    v_permlane16_swap_b32 v48, v50
    v_permlane16_swap_b32 v49, v51
    buffer_store_dwordx4 v[48:51], v20, s[20:23], s46 offen offset:256 sc1
    s_add_u32 s26, s26, s28
    s_add_u32 s46, s26, s29
    v_cvt_pk_bf16_f32 v56, v56, v57
    v_cvt_pk_bf16_f32 v57, v58, v59
    v_cvt_pk_bf16_f32 v58, v60, v61
    v_cvt_pk_bf16_f32 v59, v62, v63
    v_cvt_pk_bf16_f32 v72, v72, v73
    v_cvt_pk_bf16_f32 v73, v74, v75
    v_cvt_pk_bf16_f32 v74, v76, v77
    v_cvt_pk_bf16_f32 v75, v78, v79
    v_cvt_pk_bf16_f32 v64, v64, v65
    v_cvt_pk_bf16_f32 v65, v66, v67
    v_cvt_pk_bf16_f32 v66, v68, v69
    v_cvt_pk_bf16_f32 v67, v70, v71
    v_cvt_pk_bf16_f32 v80, v80, v81
    v_cvt_pk_bf16_f32 v81, v82, v83
    v_cvt_pk_bf16_f32 v82, v84, v85
    v_cvt_pk_bf16_f32 v83, v86, v87
    v_permlane16_swap_b32 v56, v58
    v_permlane16_swap_b32 v57, v59
    buffer_store_dwordx4 v[56:59], v20, s[20:23], s26 offen offset:0 sc1
    v_permlane16_swap_b32 v72, v74
    v_permlane16_swap_b32 v73, v75
    buffer_store_dwordx4 v[72:75], v20, s[20:23], s26 offen offset:256 sc1
    v_permlane16_swap_b32 v64, v66
    v_permlane16_swap_b32 v65, v67
    buffer_store_dwordx4 v[64:67], v20, s[20:23], s46 offen offset:0 sc1
    v_permlane16_swap_b32 v80, v82
    v_permlane16_swap_b32 v81, v83
    buffer_store_dwordx4 v[80:83], v20, s[20:23], s46 offen offset:256 sc1
    s_add_u32 s26, s26, s28
    s_add_u32 s46, s26, s29
    v_cvt_pk_bf16_f32 v88, v88, v89
    v_cvt_pk_bf16_f32 v89, v90, v91
    v_cvt_pk_bf16_f32 v90, v92, v93
    v_cvt_pk_bf16_f32 v91, v94, v95
    v_cvt_pk_bf16_f32 v104, v104, v105
    v_cvt_pk_bf16_f32 v105, v106, v107
    v_cvt_pk_bf16_f32 v106, v108, v109
    v_cvt_pk_bf16_f32 v107, v110, v111
    v_cvt_pk_bf16_f32 v96, v96, v97
    v_cvt_pk_bf16_f32 v97, v98, v99
    v_cvt_pk_bf16_f32 v98, v100, v101
    v_cvt_pk_bf16_f32 v99, v102, v103
    v_cvt_pk_bf16_f32 v112, v112, v113
    v_cvt_pk_bf16_f32 v113, v114, v115
    v_cvt_pk_bf16_f32 v114, v116, v117
    v_cvt_pk_bf16_f32 v115, v118, v119
    v_permlane16_swap_b32 v88, v90
    v_permlane16_swap_b32 v89, v91
    buffer_store_dwordx4 v[88:91], v20, s[20:23], s26 offen offset:0 sc1
    v_permlane16_swap_b32 v104, v106
    v_permlane16_swap_b32 v105, v107
    buffer_store_dwordx4 v[104:107], v20, s[20:23], s26 offen offset:256 sc1
    v_permlane16_swap_b32 v96, v98
    v_permlane16_swap_b32 v97, v99
    buffer_store_dwordx4 v[96:99], v20, s[20:23], s46 offen offset:0 sc1
    v_permlane16_swap_b32 v112, v114
    v_permlane16_swap_b32 v113, v115
    buffer_store_dwordx4 v[112:115], v20, s[20:23], s46 offen offset:256 sc1
    s_add_u32 s26, s26, s28
    s_add_u32 s46, s26, s29
    v_cvt_pk_bf16_f32 v120, v120, v121
    v_cvt_pk_bf16_f32 v121, v122, v123
    v_cvt_pk_bf16_f32 v122, v124, v125
    v_cvt_pk_bf16_f32 v123, v126, v127
    v_cvt_pk_bf16_f32 v136, v136, v137
    v_cvt_pk_bf16_f32 v137, v138, v139
    v_cvt_pk_bf16_f32 v138, v140, v141
    v_cvt_pk_bf16_f32 v139, v142, v143
    v_cvt_pk_bf16_f32 v128, v128, v129
    v_cvt_pk_bf16_f32 v129, v130, v131
    v_cvt_pk_bf16_f32 v130, v132, v133
    v_cvt_pk_bf16_f32 v131, v134, v135
    v_cvt_pk_bf16_f32 v144, v144, v145
    v_cvt_pk_bf16_f32 v145, v146, v147
    v_cvt_pk_bf16_f32 v146, v148, v149
    v_cvt_pk_bf16_f32 v147, v150, v151
    v_permlane16_swap_b32 v120, v122
    v_permlane16_swap_b32 v121, v123
    buffer_store_dwordx4 v[120:123], v20, s[20:23], s26 offen offset:0 sc1
    v_permlane16_swap_b32 v136, v138
    v_permlane16_swap_b32 v137, v139
    buffer_store_dwordx4 v[136:139], v20, s[20:23], s26 offen offset:256 sc1
    v_permlane16_swap_b32 v128, v130
    v_permlane16_swap_b32 v129, v131
    buffer_store_dwordx4 v[128:131], v20, s[20:23], s46 offen offset:0 sc1
    v_permlane16_swap_b32 v144, v146
    v_permlane16_swap_b32 v145, v147
    buffer_store_dwordx4 v[144:147], v20, s[20:23], s46 offen offset:256 sc1
    s_mov_b32 s38, s37
    s_cmp_eq_u32 s44, 1
    s_cbranch_scc1 B_WARM
    s_branch B_COLD
H_BODY_tr:
    s_waitcnt lgkmcnt(0)
    v_mfma_f32_16x16x32_bf16 v[24:27], v[152:155], v[184:187], 0
    ds_read_b64_tr_b16 v[232:233], v10 offset:8192
    v_mfma_f32_16x16x32_bf16 v[28:31], v[152:155], v[188:191], 0
    ds_read_b64_tr_b16 v[234:235], v10 offset:9216
    v_mfma_f32_16x16x32_bf16 v[32:35], v[152:155], v[192:195], 0
    ds_read_b128 v[200:203], v9 offset:0
    v_mfma_f32_16x16x32_bf16 v[36:39], v[152:155], v[196:199], 0
    ds_read_b128 v[204:207], v9 offset:2048
    v_mfma_f32_16x16x32_bf16 v[40:43], v[156:159], v[184:187], 0
    ds_read_b64_tr_b16 v[236:237], v11 offset:8192
    v_mfma_f32_16x16x32_bf16 v[44:47], v[156:159], v[188:191], 0
    ds_read_b64_tr_b16 v[238:239], v11 offset:9216
    v_mfma_f32_16x16x32_bf16 v[48:51], v[156:159], v[192:195], 0
    ds_read_b128 v[208:211], v9 offset:4096
    v_mfma_f32_16x16x32_bf16 v[52:55], v[156:159], v[196:199], 0
    ds_read_b128 v[212:215], v9 offset:6144
    v_mfma_f32_16x16x32_bf16 v[56:59], v[160:163], v[184:187], 0
    ds_read_b64_tr_b16 v[240:241], v12 offset:8192
    v_mfma_f32_16x16x32_bf16 v[60:63], v[160:163], v[188:191], 0
    ds_read_b64_tr_b16 v[242:243], v12 offset:9216
    v_mfma_f32_16x16x32_bf16 v[64:67], v[160:163], v[192:195], 0
    ds_read_b128 v[216:219], v9 offset:8192
    v_mfma_f32_16x16x32_bf16 v[68:71], v[160:163], v[196:199], 0
    ds_read_b128 v[220:223], v9 offset:10240
    v_mfma_f32_16x16x32_bf16 v[72:75], v[164:167], v[184:187], 0
    ds_read_b64_tr_b16 v[244:245], v13 offset:8192
    v_mfma_f32_16x16x32_bf16 v[76:79], v[164:167], v[188:191], 0
    ds_read_b64_tr_b16 v[246:247], v13 offset:9216
    v_mfma_f32_16x16x32_bf16 v[80:83], v[164:167], v[192:195], 0
    ds_read_b128 v[224:227], v9 offset:12288
    v_mfma_f32_16x16x32_bf16 v[84:87], v[164:167], v[196:199], 0
    ds_read_b128 v[228:231], v9 offset:14336
    v_mfma_f32_16x16x32_bf16 v[88:91], v[168:171], v[184:187], 0
    v_mfma_f32_16x16x32_bf16 v[92:95], v[168:171], v[188:191], 0
    v_mfma_f32_16x16x32_bf16 v[96:99], v[168:171], v[192:195], 0
    v_mfma_f32_16x16x32_bf16 v[100:103], v[168:171], v[196:199], 0
    v_mfma_f32_16x16x32_bf16 v[104:107], v[172:175], v[184:187], 0
    v_xor_b32 v8, 0x10000, v8
    v_mfma_f32_16x16x32_bf16 v[108:111], v[172:175], v[188:191], 0
    v_xor_b32 v9, 0x10000, v9
    v_mfma_f32_16x16x32_bf16 v[112:115], v[172:175], v[192:195], 0
    v_xor_b32 v10, 0x10000, v10
    v_mfma_f32_16x16x32_bf16 v[116:119], v[172:175], v[196:199], 0
    v_xor_b32 v11, 0x10000, v11
    v_mfma_f32_16x16x32_bf16 v[120:123], v[176:179], v[184:187], 0
    v_xor_b32 v12, 0x10000, v12
    v_mfma_f32_16x16x32_bf16 v[124:127], v[176:179], v[188:191], 0
    v_xor_b32 v13, 0x10000, v13
    v_mfma_f32_16x16x32_bf16 v[128:131], v[176:179], v[192:195], 0
    v_mfma_f32_16x16x32_bf16 v[132:135], v[176:179], v[196:199], 0
    v_mfma_f32_16x16x32_bf16 v[136:139], v[180:183], v[184:187], 0
    s_add_u32 m0, s53, s49
    s_add_u32 s48, s25, 256
    v_mfma_f32_16x16x32_bf16 v[140:143], v[180:183], v[188:191], 0
    v_mfma_f32_16x16x32_bf16 v[144:147], v[180:183], v[192:195], 0
    v_mfma_f32_16x16x32_bf16 v[148:151], v[180:183], v[196:199], 0
    s_cmp_eq_u32 s44, 1
    s_cbranch_scc1 H_CWtr
    s_waitcnt vmcnt(0)
H_CWtr:
    s_waitcnt vmcnt(16) lgkmcnt(0)
    s_barrier
    v_mfma_f32_16x16x32_bf16 v[24:27], v[200:203], v[232:235], v[24:27]
    buffer_load_dwordx4 v2, s[12:15], s24 offen offset:0 sc1 lds
    v_mfma_f32_16x16x32_bf16 v[28:31], v[200:203], v[236:239], v[28:31]
    ds_read_b64_tr_b16 v[184:185], v10 offset:0
    v_mfma_f32_16x16x32_bf16 v[32:35], v[200:203], v[240:243], v[32:35]
    buffer_load_dwordx4 v3, s[12:15], s24 offen offset:1024 sc1 lds
    v_mfma_f32_16x16x32_bf16 v[36:39], v[200:203], v[244:247], v[36:39]
    ds_read_b64_tr_b16 v[186:187], v10 offset:1024
    v_mfma_f32_16x16x32_bf16 v[40:43], v[204:207], v[232:235], v[40:43]
    buffer_load_dwordx4 v4, s[12:15], s24 offen offset:2048 sc1 lds
    v_mfma_f32_16x16x32_bf16 v[44:47], v[204:207], v[236:239], v[44:47]
    ds_read_b128 v[152:155], v8 offset:0
    v_mfma_f32_16x16x32_bf16 v[48:51], v[204:207], v[240:243], v[48:51]
    buffer_load_dwordx4 v5, s[12:15], s24 offen offset:3072 sc1 lds
    s_add_u32 m0, s54, s49
    s_add_u32 s24, s24, 128
    v_mfma_f32_16x16x32_bf16 v[52:55], v[204:207], v[244:247], v[52:55]
    ds_read_b128 v[156:159], v8 offset:2048
    v_mfma_f32_16x16x32_bf16 v[56:59], v[208:211], v[232:235], v[56:59]
    buffer_load_dwordx4 v6, s[16:19], s25 offen offset:0 lds
    v_mfma_f32_16x16x32_bf16 v[60:63], v[208:211], v[236:239], v[60:63]
    ds_read_b64_tr_b16 v[188:189], v11 offset:0
    v_mfma_f32_16x16x32_bf16 v[64:67], v[208:211], v[240:243], v[64:67]
    buffer_load_dwordx4 v7, s[16:19], s25 offen offset:1024 lds
    s_add_u32 m0, m0, 0x4000
    s_add_u32 s25, s25, s52
    v_mfma_f32_16x16x32_bf16 v[68:71], v[208:211], v[244:247], v[68:71]
    ds_read_b64_tr_b16 v[190:191], v11 offset:1024
    v_mfma_f32_16x16x32_bf16 v[72:75], v[212:215], v[232:235], v[72:75]
    buffer_load_dwordx4 v6, s[16:19], s48 offen offset:0 lds
    v_mfma_f32_16x16x32_bf16 v[76:79], v[212:215], v[236:239], v[76:79]
    ds_read_b128 v[160:163], v8 offset:4096
    v_mfma_f32_16x16x32_bf16 v[80:83], v[212:215], v[240:243], v[80:83]
    buffer_load_dwordx4 v7, s[16:19], s48 offen offset:1024 lds
    s_xor_b32 s49, s49, 0x10000
    v_mfma_f32_16x16x32_bf16 v[84:87], v[212:215], v[244:247], v[84:87]
    ds_read_b128 v[164:167], v8 offset:6144
    v_mfma_f32_16x16x32_bf16 v[88:91], v[216:219], v[232:235], v[88:91]
    ds_read_b64_tr_b16 v[192:193], v12 offset:0
    v_mfma_f32_16x16x32_bf16 v[92:95], v[216:219], v[236:239], v[92:95]
    ds_read_b64_tr_b16 v[194:195], v12 offset:1024
    v_mfma_f32_16x16x32_bf16 v[96:99], v[216:219], v[240:243], v[96:99]
    ds_read_b128 v[168:171], v8 offset:8192
    v_mfma_f32_16x16x32_bf16 v[100:103], v[216:219], v[244:247], v[100:103]
    ds_read_b128 v[172:175], v8 offset:10240
    v_mfma_f32_16x16x32_bf16 v[104:107], v[220:223], v[232:235], v[104:107]
    ds_read_b64_tr_b16 v[196:197], v13 offset:0
    v_mfma_f32_16x16x32_bf16 v[108:111], v[220:223], v[236:239], v[108:111]
    ds_read_b64_tr_b16 v[198:199], v13 offset:1024
    v_mfma_f32_16x16x32_bf16 v[112:115], v[220:223], v[240:243], v[112:115]
    ds_read_b128 v[176:179], v8 offset:12288
    v_mfma_f32_16x16x32_bf16 v[116:119], v[220:223], v[244:247], v[116:119]
    ds_read_b128 v[180:183], v8 offset:14336
    v_mfma_f32_16x16x32_bf16 v[120:123], v[224:227], v[232:235], v[120:123]
    v_mfma_f32_16x16x32_bf16 v[124:127], v[224:227], v[236:239], v[124:127]
    v_mfma_f32_16x16x32_bf16 v[128:131], v[224:227], v[240:243], v[128:131]
    v_mfma_f32_16x16x32_bf16 v[132:135], v[224:227], v[244:247], v[132:135]
    v_mfma_f32_16x16x32_bf16 v[136:139], v[228:231], v[232:235], v[136:139]
    v_mfma_f32_16x16x32_bf16 v[140:143], v[228:231], v[236:239], v[140:143]
    v_mfma_f32_16x16x32_bf16 v[144:147], v[228:231], v[240:243], v[144:147]
    v_mfma_f32_16x16x32_bf16 v[148:151], v[228:231], v[244:247], v[148:151]
    s_waitcnt lgkmcnt(0)
    v_mfma_f32_16x16x32_bf16 v[24:27], v[152:155], v[184:187], v[24:27]
    ds_read_b64_tr_b16 v[232:233], v10 offset:8192
    v_mfma_f32_16x16x32_bf16 v[28:31], v[152:155], v[188:191], v[28:31]
    ds_read_b64_tr_b16 v[234:235], v10 offset:9216
    v_mfma_f32_16x16x32_bf16 v[32:35], v[152:155], v[192:195], v[32:35]
    ds_read_b128 v[200:203], v9 offset:0
    v_mfma_f32_16x16x32_bf16 v[36:39], v[152:155], v[196:199], v[36:39]
    ds_read_b128 v[204:207], v9 offset:2048
    v_mfma_f32_16x16x32_bf16 v[40:43], v[156:159], v[184:187], v[40:43]
    ds_read_b64_tr_b16 v[236:237], v11 offset:8192
    v_mfma_f32_16x16x32_bf16 v[44:47], v[156:159], v[188:191], v[44:47]
    ds_read_b64_tr_b16 v[238:239], v11 offset:9216
    v_mfma_f32_16x16x32_bf16 v[48:51], v[156:159], v[192:195], v[48:51]
    ds_read_b128 v[208:211], v9 offset:4096
    v_mfma_f32_16x16x32_bf16 v[52:55], v[156:159], v[196:199], v[52:55]
    ds_read_b128 v[212:215], v9 offset:6144
    v_mfma_f32_16x16x32_bf16 v[56:59], v[160:163], v[184:187], v[56:59]
    ds_read_b64_tr_b16 v[240:241], v12 offset:8192
    v_mfma_f32_16x16x32_bf16 v[60:63], v[160:163], v[188:191], v[60:63]
    ds_read_b64_tr_b16 v[242:243], v12 offset:9216
    v_mfma_f32_16x16x32_bf16 v[64:67], v[160:163], v[192:195], v[64:67]
    ds_read_b128 v[216:219], v9 offset:8192
    v_mfma_f32_16x16x32_bf16 v[68:71], v[160:163], v[196:199], v[68:71]
    ds_read_b128 v[220:223], v9 offset:10240
    v_mfma_f32_16x16x32_bf16 v[72:75], v[164:167], v[184:187], v[72:75]
    ds_read_b64_tr_b16 v[244:245], v13 offset:8192
    v_mfma_f32_16x16x32_bf16 v[76:79], v[164:167], v[188:191], v[76:79]
    ds_read_b64_tr_b16 v[246:247], v13 offset:9216
    v_mfma_f32_16x16x32_bf16 v[80:83], v[164:167], v[192:195], v[80:83]
    ds_read_b128 v[224:227], v9 offset:12288
    v_mfma_f32_16x16x32_bf16 v[84:87], v[164:167], v[196:199], v[84:87]
    ds_read_b128 v[228:231], v9 offset:14336
    v_mfma_f32_16x16x32_bf16 v[88:91], v[168:171], v[184:187], v[88:91]
    v_mfma_f32_16x16x32_bf16 v[92:95], v[168:171], v[188:191], v[92:95]
    v_mfma_f32_16x16x32_bf16 v[96:99], v[168:171], v[192:195], v[96:99]
    v_mfma_f32_16x16x32_bf16 v[100:103], v[168:171], v[196:199], v[100:103]
    v_mfma_f32_16x16x32_bf16 v[104:107], v[172:175], v[184:187], v[104:107]
    v_xor_b32 v8, 0x10000, v8
    v_mfma_f32_16x16x32_bf16 v[108:111], v[172:175], v[188:191], v[108:111]
    v_xor_b32 v9, 0x10000, v9
    v_mfma_f32_16x16x32_bf16 v[112:115], v[172:175], v[192:195], v[112:115]
    v_xor_b32 v10, 0x10000, v10
    v_mfma_f32_16x16x32_bf16 v[116:119], v[172:175], v[196:199], v[116:119]
    v_xor_b32 v11, 0x10000, v11
    v_mfma_f32_16x16x32_bf16 v[120:123], v[176:179], v[184:187], v[120:123]
    v_xor_b32 v12, 0x10000, v12
    v_mfma_f32_16x16x32_bf16 v[124:127], v[176:179], v[188:191], v[124:127]
    v_xor_b32 v13, 0x10000, v13
    v_mfma_f32_16x16x32_bf16 v[128:131], v[176:179], v[192:195], v[128:131]
    v_mfma_f32_16x16x32_bf16 v[132:135], v[176:179], v[196:199], v[132:135]
    v_mfma_f32_16x16x32_bf16 v[136:139], v[180:183], v[184:187], v[136:139]
    s_add_u32 m0, s53, s49
    s_add_u32 s48, s25, 256
    v_mfma_f32_16x16x32_bf16 v[140:143], v[180:183], v[188:191], v[140:143]
    v_mfma_f32_16x16x32_bf16 v[144:147], v[180:183], v[192:195], v[144:147]
    v_mfma_f32_16x16x32_bf16 v[148:151], v[180:183], v[196:199], v[148:151]
    s_waitcnt vmcnt(0) lgkmcnt(0)
    s_barrier
    s_cmp_lg_u32 s34, 0
    s_cbranch_scc1 SG_htr
    s_cmp_eq_u32 s38, 0
    s_cbranch_scc1 SG_htr
    s_and_b32 s40, s38, 1
    s_add_u32 s40, s40, 1
    v_mov_b32 v1, s40
    s_and_b32 s40, s38, -2
    s_mov_b64 exec, 1
    buffer_atomic_add v1, off, s[8:11], s40
    s_mov_b64 exec, -1
SG_htr:
    v_mfma_f32_16x16x32_bf16 v[24:27], v[200:203], v[232:235], v[24:27]
    buffer_load_dwordx4 v2, s[12:15], s24 offen offset:0 sc1 lds
    v_mfma_f32_16x16x32_bf16 v[28:31], v[200:203], v[236:239], v[28:31]
    ds_read_b64_tr_b16 v[184:185], v10 offset:0
    v_mfma_f32_16x16x32_bf16 v[32:35], v[200:203], v[240:243], v[32:35]
    buffer_load_dwordx4 v3, s[12:15], s24 offen offset:1024 sc1 lds
    v_mfma_f32_16x16x32_bf16 v[36:39], v[200:203], v[244:247], v[36:39]
    ds_read_b64_tr_b16 v[186:187], v10 offset:1024
    v_mfma_f32_16x16x32_bf16 v[40:43], v[204:207], v[232:235], v[40:43]
    buffer_load_dwordx4 v4, s[12:15], s24 offen offset:2048 sc1 lds
    v_mfma_f32_16x16x32_bf16 v[44:47], v[204:207], v[236:239], v[44:47]
    ds_read_b128 v[152:155], v8 offset:0
    v_mfma_f32_16x16x32_bf16 v[48:51], v[204:207], v[240:243], v[48:51]
    buffer_load_dwordx4 v5, s[12:15], s24 offen offset:3072 sc1 lds
    s_add_u32 m0, s54, s49
    s_add_u32 s24, s24, 128
    v_mfma_f32_16x16x32_bf16 v[52:55], v[204:207], v[244:247], v[52:55]
    ds_read_b128 v[156:159], v8 offset:2048
    v_mfma_f32_16x16x32_bf16 v[56:59], v[208:211], v[232:235], v[56:59]
    buffer_load_dwordx4 v6, s[16:19], s25 offen offset:0 lds
    v_mfma_f32_16x16x32_bf16 v[60:63], v[208:211], v[236:239], v[60:63]
    ds_read_b64_tr_b16 v[188:189], v11 offset:0
    v_mfma_f32_16x16x32_bf16 v[64:67], v[208:211], v[240:243], v[64:67]
    buffer_load_dwordx4 v7, s[16:19], s25 offen offset:1024 lds
    s_add_u32 m0, m0, 0x4000
    s_add_u32 s25, s25, s52
    v_mfma_f32_16x16x32_bf16 v[68:71], v[208:211], v[244:247], v[68:71]
    ds_read_b64_tr_b16 v[190:191], v11 offset:1024
    v_mfma_f32_16x16x32_bf16 v[72:75], v[212:215], v[232:235], v[72:75]
    buffer_load_dwordx4 v6, s[16:19], s48 offen offset:0 lds
    v_mfma_f32_16x16x32_bf16 v[76:79], v[212:215], v[236:239], v[76:79]
    ds_read_b128 v[160:163], v8 offset:4096
    v_mfma_f32_16x16x32_bf16 v[80:83], v[212:215], v[240:243], v[80:83]
    buffer_load_dwordx4 v7, s[16:19], s48 offen offset:1024 lds
    s_xor_b32 s49, s49, 0x10000
    v_mfma_f32_16x16x32_bf16 v[84:87], v[212:215], v[244:247], v[84:87]
    ds_read_b128 v[164:167], v8 offset:6144
    v_mfma_f32_16x16x32_bf16 v[88:91], v[216:219], v[232:235], v[88:91]
    ds_read_b64_tr_b16 v[192:193], v12 offset:0
    v_mfma_f32_16x16x32_bf16 v[92:95], v[216:219], v[236:239], v[92:95]
    ds_read_b64_tr_b16 v[194:195], v12 offset:1024
    v_mfma_f32_16x16x32_bf16 v[96:99], v[216:219], v[240:243], v[96:99]
    ds_read_b128 v[168:171], v8 offset:8192
    v_mfma_f32_16x16x32_bf16 v[100:103], v[216:219], v[244:247], v[100:103]
    ds_read_b128 v[172:175], v8 offset:10240
    v_mfma_f32_16x16x32_bf16 v[104:107], v[220:223], v[232:235], v[104:107]
    ds_read_b64_tr_b16 v[196:197], v13 offset:0
    v_mfma_f32_16x16x32_bf16 v[108:111], v[220:223], v[236:239], v[108:111]
    ds_read_b64_tr_b16 v[198:199], v13 offset:1024
    v_mfma_f32_16x16x32_bf16 v[112:115], v[220:223], v[240:243], v[112:115]
    ds_read_b128 v[176:179], v8 offset:12288
    v_mfma_f32_16x16x32_bf16 v[116:119], v[220:223], v[244:247], v[116:119]
    ds_read_b128 v[180:183], v8 offset:14336
    v_mfma_f32_16x16x32_bf16 v[120:123], v[224:227], v[232:235], v[120:123]
    v_mfma_f32_16x16x32_bf16 v[124:127], v[224:227], v[236:239], v[124:127]
    v_mfma_f32_16x16x32_bf16 v[128:131], v[224:227], v[240:243], v[128:131]
    v_mfma_f32_16x16x32_bf16 v[132:135], v[224:227], v[244:247], v[132:135]
    v_mfma_f32_16x16x32_bf16 v[136:139], v[228:231], v[232:235], v[136:139]
    v_mfma_f32_16x16x32_bf16 v[140:143], v[228:231], v[236:239], v[140:143]
    v_mfma_f32_16x16x32_bf16 v[144:147], v[228:231], v[240:243], v[144:147]
    v_mfma_f32_16x16x32_bf16 v[148:151], v[228:231], v[244:247], v[148:151]
    s_mov_b32 s51, 12
    s_mov_b32 s44, 0
    s_mov_b32 s30, 0
    s_lshl_b32 s47, s34, 13
    s_add_u32 s47, s47, s3
    s_cmp_eq_u32 s5, 4
    s_cselect_b32 s50, 4, 99
H_LOOP_tr:
    s_waitcnt lgkmcnt(0)
    v_mfma_f32_16x16x32_bf16 v[24:27], v[152:155], v[184:187], v[24:27]
    ds_read_b64_tr_b16 v[232:233], v10 offset:8192
    v_mfma_f32_16x16x32_bf16 v[28:31], v[152:155], v[188:191], v[28:31]
    ds_read_b64_tr_b16 v[234:235], v10 offset:9216
    v_mfma_f32_16x16x32_bf16 v[32:35], v[152:155], v[192:195], v[32:35]
    ds_read_b128 v[200:203], v9 offset:0
    v_mfma_f32_16x16x32_bf16 v[36:39], v[152:155], v[196:199], v[36:39]
    ds_read_b128 v[204:207], v9 offset:2048
    v_mfma_f32_16x16x32_bf16 v[40:43], v[156:159], v[184:187], v[40:43]
    ds_read_b64_tr_b16 v[236:237], v11 offset:8192
    v_mfma_f32_16x16x32_bf16 v[44:47], v[156:159], v[188:191], v[44:47]
    ds_read_b64_tr_b16 v[238:239], v11 offset:9216
    v_mfma_f32_16x16x32_bf16 v[48:51], v[156:159], v[192:195], v[48:51]
    ds_read_b128 v[208:211], v9 offset:4096
    v_mfma_f32_16x16x32_bf16 v[52:55], v[156:159], v[196:199], v[52:55]
    ds_read_b128 v[212:215], v9 offset:6144
    v_mfma_f32_16x16x32_bf16 v[56:59], v[160:163], v[184:187], v[56:59]
    ds_read_b64_tr_b16 v[240:241], v12 offset:8192
    v_mfma_f32_16x16x32_bf16 v[60:63], v[160:163], v[188:191], v[60:63]
    ds_read_b64_tr_b16 v[242:243], v12 offset:9216
    v_mfma_f32_16x16x32_bf16 v[64:67], v[160:163], v[192:195], v[64:67]
    ds_read_b128 v[216:219], v9 offset:8192
    v_mfma_f32_16x16x32_bf16 v[68:71], v[160:163], v[196:199], v[68:71]
    ds_read_b128 v[220:223], v9 offset:10240
    v_mfma_f32_16x16x32_bf16 v[72:75], v[164:167], v[184:187], v[72:75]
    ds_read_b64_tr_b16 v[244:245], v13 offset:8192
    v_mfma_f32_16x16x32_bf16 v[76:79], v[164:167], v[188:191], v[76:79]
    ds_read_b64_tr_b16 v[246:247], v13 offset:9216
    v_mfma_f32_16x16x32_bf16 v[80:83], v[164:167], v[192:195], v[80:83]
    ds_read_b128 v[224:227], v9 offset:12288
    v_mfma_f32_16x16x32_bf16 v[84:87], v[164:167], v[196:199], v[84:87]
    ds_read_b128 v[228:231], v9 offset:14336
    v_mfma_f32_16x16x32_bf16 v[88:91], v[168:171], v[184:187], v[88:91]
    v_mfma_f32_16x16x32_bf16 v[92:95], v[168:171], v[188:191], v[92:95]
    v_mfma_f32_16x16x32_bf16 v[96:99], v[168:171], v[192:195], v[96:99]
    v_mfma_f32_16x16x32_bf16 v[100:103], v[168:171], v[196:199], v[100:103]
    v_mfma_f32_16x16x32_bf16 v[104:107], v[172:175], v[184:187], v[104:107]
    v_xor_b32 v8, 0x10000, v8
    v_mfma_f32_16x16x32_bf16 v[108:111], v[172:175], v[188:191], v[108:111]
    v_xor_b32 v9, 0x10000, v9
    v_mfma_f32_16x16x32_bf16 v[112:115], v[172:175], v[192:195], v[112:115]
    v_xor_b32 v10, 0x10000, v10
    v_mfma_f32_16x16x32_bf16 v[116:119], v[172:175], v[196:199], v[116:119]
    v_xor_b32 v11, 0x10000, v11
    v_mfma_f32_16x16x32_bf16 v[120:123], v[176:179], v[184:187], v[120:123]
    v_xor_b32 v12, 0x10000, v12
    v_mfma_f32_16x16x32_bf16 v[124:127], v[176:179], v[188:191], v[124:127]
    v_xor_b32 v13, 0x10000, v13
    v_mfma_f32_16x16x32_bf16 v[128:131], v[176:179], v[192:195], v[128:131]
    v_mfma_f32_16x16x32_bf16 v[132:135], v[176:179], v[196:199], v[132:135]
    v_mfma_f32_16x16x32_bf16 v[136:139], v[180:183], v[184:187], v[136:139]
    s_add_u32 m0, s53, s49
    s_add_u32 s48, s25, 256
    v_mfma_f32_16x16x32_bf16 v[140:143], v[180:183], v[188:191], v[140:143]
    v_mfma_f32_16x16x32_bf16 v[144:147], v[180:183], v[192:195], v[144:147]
    v_mfma_f32_16x16x32_bf16 v[148:151], v[180:183], v[196:199], v[148:151]
    s_waitcnt vmcnt(0) lgkmcnt(0)
    s_barrier
    v_mfma_f32_16x16x32_bf16 v[24:27], v[200:203], v[232:235], v[24:27]
    buffer_load_dwordx4 v2, s[12:15], s24 offen offset:0 sc1 lds
    v_mfma_f32_16x16x32_bf16 v[28:31], v[200:203], v[236:239], v[28:31]
    ds_read_b64_tr_b16 v[184:185], v10 offset:0
    v_mfma_f32_16x16x32_bf16 v[32:35], v[200:203], v[240:243], v[32:35]
    buffer_load_dwordx4 v3, s[12:15], s24 offen offset:1024 sc1 lds
    v_mfma_f32_16x16x32_bf16 v[36:39], v[200:203], v[244:247], v[36:39]
    ds_read_b64_tr_b16 v[186:187], v10 offset:1024
    v_mfma_f32_16x16x32_bf16 v[40:43], v[204:207], v[232:235], v[40:43]
    buffer_load_dwordx4 v4, s[12:15], s24 offen offset:2048 sc1 lds
    v_mfma_f32_16x16x32_bf16 v[44:47], v[204:207], v[236:239], v[44:47]
    ds_read_b128 v[152:155], v8 offset:0
    v_mfma_f32_16x16x32_bf16 v[48:51], v[204:207], v[240:243], v[48:51]
    buffer_load_dwordx4 v5, s[12:15], s24 offen offset:3072 sc1 lds
    s_add_u32 m0, s54, s49
    s_add_u32 s24, s24, 128
    v_mfma_f32_16x16x32_bf16 v[52:55], v[204:207], v[244:247], v[52:55]
    ds_read_b128 v[156:159], v8 offset:2048
    v_mfma_f32_16x16x32_bf16 v[56:59], v[208:211], v[232:235], v[56:59]
    buffer_load_dwordx4 v6, s[16:19], s25 offen offset:0 lds
    v_mfma_f32_16x16x32_bf16 v[60:63], v[208:211], v[236:239], v[60:63]
    ds_read_b64_tr_b16 v[188:189], v11 offset:0
    v_mfma_f32_16x16x32_bf16 v[64:67], v[208:211], v[240:243], v[64:67]
    buffer_load_dwordx4 v7, s[16:19], s25 offen offset:1024 lds
    s_add_u32 m0, m0, 0x4000
    s_add_u32 s25, s25, s52
    v_mfma_f32_16x16x32_bf16 v[68:71], v[208:211], v[244:247], v[68:71]
    ds_read_b64_tr_b16 v[190:191], v11 offset:1024
    v_mfma_f32_16x16x32_bf16 v[72:75], v[212:215], v[232:235], v[72:75]
    buffer_load_dwordx4 v6, s[16:19], s48 offen offset:0 lds
    v_mfma_f32_16x16x32_bf16 v[76:79], v[212:215], v[236:239], v[76:79]
    ds_read_b128 v[160:163], v8 offset:4096
    v_mfma_f32_16x16x32_bf16 v[80:83], v[212:215], v[240:243], v[80:83]
    buffer_load_dwordx4 v7, s[16:19], s48 offen offset:1024 lds
    s_xor_b32 s49, s49, 0x10000
    v_mfma_f32_16x16x32_bf16 v[84:87], v[212:215], v[244:247], v[84:87]
    ds_read_b128 v[164:167], v8 offset:6144
    v_mfma_f32_16x16x32_bf16 v[88:91], v[216:219], v[232:235], v[88:91]
    ds_read_b64_tr_b16 v[192:193], v12 offset:0
    v_mfma_f32_16x16x32_bf16 v[92:95], v[216:219], v[236:239], v[92:95]
    ds_read_b64_tr_b16 v[194:195], v12 offset:1024
    v_mfma_f32_16x16x32_bf16 v[96:99], v[216:219], v[240:243], v[96:99]
    ds_read_b128 v[168:171], v8 offset:8192
    v_mfma_f32_16x16x32_bf16 v[100:103], v[216:219], v[244:247], v[100:103]
    ds_read_b128 v[172:175], v8 offset:10240
    v_mfma_f32_16x16x32_bf16 v[104:107], v[220:223], v[232:235], v[104:107]
    ds_read_b64_tr_b16 v[196:197], v13 offset:0
    v_mfma_f32_16x16x32_bf16 v[108:111], v[220:223], v[236:239], v[108:111]
    ds_read_b64_tr_b16 v[198:199], v13 offset:1024
    v_mfma_f32_16x16x32_bf16 v[112:115], v[220:223], v[240:243], v[112:115]
    ds_read_b128 v[176:179], v8 offset:12288
    v_mfma_f32_16x16x32_bf16 v[116:119], v[220:223], v[244:247], v[116:119]
    ds_read_b128 v[180:183], v8 offset:14336
    v_mfma_f32_16x16x32_bf16 v[120:123], v[224:227], v[232:235], v[120:123]
    v_mfma_f32_16x16x32_bf16 v[124:127], v[224:227], v[236:239], v[124:127]
    s_cmp_le_u32 s51, s50
    s_cbranch_scc1 H_NAtr
    buffer_store_dwordx4 v[248:251], v21, s[8:11], s47 offen sc1
    s_add_u32 s47, s47, 1024
H_NAtr:
    v_mfma_f32_16x16x32_bf16 v[128:131], v[224:227], v[240:243], v[128:131]
    v_mfma_f32_16x16x32_bf16 v[132:135], v[224:227], v[244:247], v[132:135]
    v_mfma_f32_16x16x32_bf16 v[136:139], v[228:231], v[232:235], v[136:139]
    v_mfma_f32_16x16x32_bf16 v[140:143], v[228:231], v[236:239], v[140:143]
    v_mfma_f32_16x16x32_bf16 v[144:147], v[228:231], v[240:243], v[144:147]
    v_mfma_f32_16x16x32_bf16 v[148:151], v[228:231], v[244:247], v[148:151]
    s_sub_u32 s51, s51, 1
    s_cmp_lg_u32 s51, 0
    s_cbranch_scc1 H_LOOP_tr
    s_cmp_eq_u32 s44, 1
    s_cbranch_scc1 H_EP_tr
    s_cmp_lt_u32 s86, 4
    s_cbranch_scc1 H_TAIL_tr
    s_mov_b32 s12, s88
    s_and_b32 s13, s89, 0xffff
    s_mov_b32 s14, s87
    s_mov_b32 s16, s90
    s_and_b32 s17, s91, 0xffff
    s_mov_b32 s18, s92
    s_mov_b32 s24, s93
    s_mov_b32 s25, s94
    s_mov_b32 s31, s95
    v_mul_lo_u32 v6, v18, s31
    s_lshl_b32 s45, s31, 2
    s_sub_u32 s45, s45, 1024
    s_lshl_b32 s52, s31, 6
    v_add_u32 v6, v6, v19
    v_add_u32 v7, s45, v6
    s_mov_b32 s51, 2
    s_mov_b32 s44, 1
    s_branch H_LOOP_tr
H_TAIL_tr:
    s_waitcnt lgkmcnt(0)
    v_mfma_f32_16x16x32_bf16 v[24:27], v[152:155], v[184:187], v[24:27]
    ds_read_b64_tr_b16 v[232:233], v10 offset:8192
    v_mfma_f32_16x16x32_bf16 v[28:31], v[152:155], v[188:191], v[28:31]
    ds_read_b64_tr_b16 v[234:235], v10 offset:9216
    v_mfma_f32_16x16x32_bf16 v[32:35], v[152:155], v[192:195], v[32:35]
    ds_read_b128 v[200:203], v9 offset:0
    v_mfma_f32_16x16x32_bf16 v[36:39], v[152:155], v[196:199], v[36:39]
    ds_read_b128 v[204:207], v9 offset:2048
    v_mfma_f32_16x16x32_bf16 v[40:43], v[156:159], v[184:187], v[40:43]
    ds_read_b64_tr_b16 v[236:237], v11 offset:8192
    v_mfma_f32_16x16x32_bf16 v[44:47], v[156:159], v[188:191], v[44:47]
    ds_read_b64_tr_b16 v[238:239], v11 offset:9216
    v_mfma_f32_16x16x32_bf16 v[48:51], v[156:159], v[192:195], v[48:51]
    ds_read_b128 v[208:211], v9 offset:4096
    v_mfma_f32_16x16x32_bf16 v[52:55], v[156:159], v[196:199], v[52:55]
    ds_read_b128 v[212:215], v9 offset:6144
    v_mfma_f32_16x16x32_bf16 v[56:59], v[160:163], v[184:187], v[56:59]
    ds_read_b64_tr_b16 v[240:241], v12 offset:8192
    v_mfma_f32_16x16x32_bf16 v[60:63], v[160:163], v[188:191], v[60:63]
    ds_read_b64_tr_b16 v[242:243], v12 offset:9216
    v_mfma_f32_16x16x32_bf16 v[64:67], v[160:163], v[192:195], v[64:67]
    ds_read_b128 v[216:219], v9 offset:8192
    v_mfma_f32_16x16x32_bf16 v[68:71], v[160:163], v[196:199], v[68:71]
    ds_read_b128 v[220:223], v9 offset:10240
    v_mfma_f32_16x16x32_bf16 v[72:75], v[164:167], v[184:187], v[72:75]
    ds_read_b64_tr_b16 v[244:245], v13 offset:8192
    v_mfma_f32_16x16x32_bf16 v[76:79], v[164:167], v[188:191], v[76:79]
    ds_read_b64_tr_b16 v[246:247], v13 offset:9216
    v_mfma_f32_16x16x32_bf16 v[80:83], v[164:167], v[192:195], v[80:83]
    ds_read_b128 v[224:227], v9 offset:12288
    v_mfma_f32_16x16x32_bf16 v[84:87], v[164:167], v[196:199], v[84:87]
    ds_read_b128 v[228:231], v9 offset:14336
    v_mfma_f32_16x16x32_bf16 v[88:91], v[168:171], v[184:187], v[88:91]
    v_mfma_f32_16x16x32_bf16 v[92:95], v[168:171], v[188:191], v[92:95]
    v_mfma_f32_16x16x32_bf16 v[96:99], v[168:171], v[192:195], v[96:99]
    v_mfma_f32_16x16x32_bf16 v[100:103], v[168:171], v[196:199], v[100:103]
    v_mfma_f32_16x16x32_bf16 v[104:107], v[172:175], v[184:187], v[104:107]
    v_xor_b32 v8, 0x10000, v8
    v_mfma_f32_16x16x32_bf16 v[108:111], v[172:175], v[188:191], v[108:111]
    v_xor_b32 v9, 0x10000, v9
    v_mfma_f32_16x16x32_bf16 v[112:115], v[172:175], v[192:195], v[112:115]
    v_xor_b32 v10, 0x10000, v10
    v_mfma_f32_16x16x32_bf16 v[116:119], v[172:175], v[196:199], v[116:119]
    v_xor_b32 v11, 0x10000, v11
    v_mfma_f32_16x16x32_bf16 v[120:123], v[176:179], v[184:187], v[120:123]
    v_xor_b32 v12, 0x10000, v12
    v_mfma_f32_16x16x32_bf16 v[124:127], v[176:179], v[188:191], v[124:127]
    v_xor_b32 v13, 0x10000, v13
    v_mfma_f32_16x16x32_bf16 v[128:131], v[176:179], v[192:195], v[128:131]
    v_mfma_f32_16x16x32_bf16 v[132:135], v[176:179], v[196:199], v[132:135]
    v_mfma_f32_16x16x32_bf16 v[136:139], v[180:183], v[184:187], v[136:139]
    v_mfma_f32_16x16x32_bf16 v[140:143], v[180:183], v[188:191], v[140:143]
    v_mfma_f32_16x16x32_bf16 v[144:147], v[180:183], v[192:195], v[144:147]
    v_mfma_f32_16x16x32_bf16 v[148:151], v[180:183], v[196:199], v[148:151]
    s_waitcnt vmcnt(0) lgkmcnt(0)
    s_barrier
    v_mfma_f32_16x16x32_bf16 v[24:27], v[200:203], v[232:235], v[24:27]
    v_mfma_f32_16x16x32_bf16 v[28:31], v[200:203], v[236:239], v[28:31]
    ds_read_b64_tr_b16 v[184:185], v10 offset:0
    v_mfma_f32_16x16x32_bf16 v[32:35], v[200:203], v[240:243], v[32:35]
    v_mfma_f32_16x16x32_bf16 v[36:39], v[200:203], v[244:247], v[36:39]
    ds_read_b64_tr_b16 v[186:187], v10 offset:1024
    v_mfma_f32_16x16x32_bf16 v[40:43], v[204:207], v[232:235], v[40:43]
    v_mfma_f32_16x16x32_bf16 v[44:47], v[204:207], v[236:239], v[44:47]
    ds_read_b128 v[152:155], v8 offset:0
    v_mfma_f32_16x16x32_bf16 v[48:51], v[204:207], v[240:243], v[48:51]
    v_mfma_f32_16x16x32_bf16 v[52:55], v[204:207], v[244:247], v[52:55]
    ds_read_b128 v[156:159], v8 offset:2048
    v_mfma_f32_16x16x32_bf16 v[56:59], v[208:211], v[232:235], v[56:59]
    v_mfma_f32_16x16x32_bf16 v[60:63], v[208:211], v[236:239], v[60:63]
    ds_read_b64_tr_b16 v[188:189], v11 offset:0
    v_mfma_f32_16x16x32_bf16 v[64:67], v[208:211], v[240:243], v[64:67]
    v_mfma_f32_16x16x32_bf16 v[68:71], v[208:211], v[244:247], v[68:71]
    ds_read_b64_tr_b16 v[190:191], v11 offset:1024
    v_mfma_f32_16x16x32_bf16 v[72:75], v[212:215], v[232:235], v[72:75]
    v_mfma_f32_16x16x32_bf16 v[76:79], v[212:215], v[236:239], v[76:79]
    ds_read_b128 v[160:163], v8 offset:4096
    v_mfma_f32_16x16x32_bf16 v[80:83], v[212:215], v[240:243], v[80:83]
    v_mfma_f32_16x16x32_bf16 v[84:87], v[212:215], v[244:247], v[84:87]
    ds_read_b128 v[164:167], v8 offset:6144
    v_mfma_f32_16x16x32_bf16 v[88:91], v[216:219], v[232:235], v[88:91]
    ds_read_b64_tr_b16 v[192:193], v12 offset:0
    v_mfma_f32_16x16x32_bf16 v[92:95], v[216:219], v[236:239], v[92:95]
    ds_read_b64_tr_b16 v[194:195], v12 offset:1024
    v_mfma_f32_16x16x32_bf16 v[96:99], v[216:219], v[240:243], v[96:99]
    ds_read_b128 v[168:171], v8 offset:8192
    v_mfma_f32_16x16x32_bf16 v[100:103], v[216:219], v[244:247], v[100:103]
    ds_read_b128 v[172:175], v8 offset:10240
    v_mfma_f32_16x16x32_bf16 v[104:107], v[220:223], v[232:235], v[104:107]
    ds_read_b64_tr_b16 v[196:197], v13 offset:0
    v_mfma_f32_16x16x32_bf16 v[108:111], v[220:223], v[236:239], v[108:111]
    ds_read_b64_tr_b16 v[198:199], v13 offset:1024
    v_mfma_f32_16x16x32_bf16 v[112:115], v[220:223], v[240:243], v[112:115]
    ds_read_b128 v[176:179], v8 offset:12288
    v_mfma_f32_16x16x32_bf16 v[116:119], v[220:223], v[244:247], v[116:119]
    ds_read_b128 v[180:183], v8 offset:14336
    v_mfma_f32_16x16x32_bf16 v[120:123], v[224:227], v[232:235], v[120:123]
    v_mfma_f32_16x16x32_bf16 v[124:127], v[224:227], v[236:239], v[124:127]
    v_mfma_f32_16x16x32_bf16 v[128:131], v[224:227], v[240:243], v[128:131]
    v_mfma_f32_16x16x32_bf16 v[132:135], v[224:227], v[244:247], v[132:135]
    v_mfma_f32_16x16x32_bf16 v[136:139], v[228:231], v[232:235], v[136:139]
    v_mfma_f32_16x16x32_bf16 v[140:143], v[228:231], v[236:239], v[140:143]
    v_mfma_f32_16x16x32_bf16 v[144:147], v[228:231], v[240:243], v[144:147]
    v_mfma_f32_16x16x32_bf16 v[148:151], v[228:231], v[244:247], v[148:151]
    s_waitcnt lgkmcnt(0)
    v_mfma_f32_16x16x32_bf16 v[24:27], v[152:155], v[184:187], v[24:27]
    ds_read_b64_tr_b16 v[232:233], v10 offset:8192
    v_mfma_f32_16x16x32_bf16 v[28:31], v[152:155], v[188:191], v[28:31]
    ds_read_b64_tr_b16 v[234:235], v10 offset:9216
    v_mfma_f32_16x16x32_bf16 v[32:35], v[152:155], v[192:195], v[32:35]
    ds_read_b128 v[200:203], v9 offset:0
    v_mfma_f32_16x16x32_bf16 v[36:39], v[152:155], v[196:199], v[36:39]
    ds_read_b128 v[204:207], v9 offset:2048
    v_mfma_f32_16x16x32_bf16 v[40:43], v[156:159], v[184:187], v[40:43]
    ds_read_b64_tr_b16 v[236:237], v11 offset:8192
    v_mfma_f32_16x16x32_bf16 v[44:47], v[156:159], v[188:191], v[44:47]
    ds_read_b64_tr_b16 v[238:239], v11 offset:9216
    v_mfma_f32_16x16x32_bf16 v[48:51], v[156:159], v[192:195], v[48:51]
    ds_read_b128 v[208:211], v9 offset:4096
    v_mfma_f32_16x16x32_bf16 v[52:55], v[156:159], v[196:199], v[52:55]
    ds_read_b128 v[212:215], v9 offset:6144
    v_mfma_f32_16x16x32_bf16 v[56:59], v[160:163], v[184:187], v[56:59]
    ds_read_b64_tr_b16 v[240:241], v12 offset:8192
    v_mfma_f32_16x16x32_bf16 v[60:63], v[160:163], v[188:191], v[60:63]
    ds_read_b64_tr_b16 v[242:243], v12 offset:9216
    v_mfma_f32_16x16x32_bf16 v[64:67], v[160:163], v[192:195], v[64:67]
    ds_read_b128 v[216:219], v9 offset:8192
    v_mfma_f32_16x16x32_bf16 v[68:71], v[160:163], v[196:199], v[68:71]
    ds_read_b128 v[220:223], v9 offset:10240
    v_mfma_f32_16x16x32_bf16 v[72:75], v[164:167], v[184:187], v[72:75]
    ds_read_b64_tr_b16 v[244:245], v13 offset:8192
    v_mfma_f32_16x16x32_bf16 v[76:79], v[164:167], v[188:191], v[76:79]
    ds_read_b64_tr_b16 v[246:247], v13 offset:9216
    v_mfma_f32_16x16x32_bf16 v[80:83], v[164:167], v[192:195], v[80:83]
    ds_read_b128 v[224:227], v9 offset:12288
    v_mfma_f32_16x16x32_bf16 v[84:87], v[164:167], v[196:199], v[84:87]
    ds_read_b128 v[228:231], v9 offset:14336
    v_mfma_f32_16x16x32_bf16 v[88:91], v[168:171], v[184:187], v[88:91]
    v_mfma_f32_16x16x32_bf16 v[92:95], v[168:171], v[188:191], v[92:95]
    v_mfma_f32_16x16x32_bf16 v[96:99], v[168:171], v[192:195], v[96:99]
    v_mfma_f32_16x16x32_bf16 v[100:103], v[168:171], v[196:199], v[100:103]
    v_mfma_f32_16x16x32_bf16 v[104:107], v[172:175], v[184:187], v[104:107]
    v_mfma_f32_16x16x32_bf16 v[108:111], v[172:175], v[188:191], v[108:111]
    v_mfma_f32_16x16x32_bf16 v[112:115], v[172:175], v[192:195], v[112:115]
    v_mfma_f32_16x16x32_bf16 v[116:119], v[172:175], v[196:199], v[116:119]
    v_mfma_f32_16x16x32_bf16 v[120:123], v[176:179], v[184:187], v[120:123]
    v_mfma_f32_16x16x32_bf16 v[124:127], v[176:179], v[188:191], v[124:127]
    v_mfma_f32_16x16x32_bf16 v[128:131], v[176:179], v[192:195], v[128:131]
    v_mfma_f32_16x16x32_bf16 v[132:135], v[176:179], v[196:199], v[132:135]
    v_mfma_f32_16x16x32_bf16 v[136:139], v[180:183], v[184:187], v[136:139]
    v_mfma_f32_16x16x32_bf16 v[140:143], v[180:183], v[188:191], v[140:143]
    v_mfma_f32_16x16x32_bf16 v[144:147], v[180:183], v[192:195], v[144:147]
    v_mfma_f32_16x16x32_bf16 v[148:151], v[180:183], v[196:199], v[148:151]
    s_waitcnt lgkmcnt(0)
    v_mfma_f32_16x16x32_bf16 v[24:27], v[200:203], v[232:235], v[24:27]
    v_mfma_f32_16x16x32_bf16 v[28:31], v[200:203], v[236:239], v[28:31]
    v_mfma_f32_16x16x32_bf16 v[32:35], v[200:203], v[240:243], v[32:35]
    v_mfma_f32_16x16x32_bf16 v[36:39], v[200:203], v[244:247], v[36:39]
    v_mfma_f32_16x16x32_bf16 v[40:43], v[204:207], v[232:235], v[40:43]
    v_mfma_f32_16x16x32_bf16 v[44:47], v[204:207], v[236:239], v[44:47]
    v_mfma_f32_16x16x32_bf16 v[48:51], v[204:207], v[240:243], v[48:51]
    v_mfma_f32_16x16x32_bf16 v[52:55], v[204:207], v[244:247], v[52:55]
    v_mfma_f32_16x16x32_bf16 v[56:59], v[208:211], v[232:235], v[56:59]
    v_mfma_f32_16x16x32_bf16 v[60:63], v[208:211], v[236:239], v[60:63]
    v_mfma_f32_16x16x32_bf16 v[64:67], v[208:211], v[240:243], v[64:67]
    v_mfma_f32_16x16x32_bf16 v[68:71], v[208:211], v[244:247], v[68:71]
    v_mfma_f32_16x16x32_bf16 v[72:75], v[212:215], v[232:235], v[72:75]
    v_mfma_f32_16x16x32_bf16 v[76:79], v[212:215], v[236:239], v[76:79]
    v_mfma_f32_16x16x32_bf16 v[80:83], v[212:215], v[240:243], v[80:83]
    v_mfma_f32_16x16x32_bf16 v[84:87], v[212:215], v[244:247], v[84:87]
    v_mfma_f32_16x16x32_bf16 v[88:91], v[216:219], v[232:235], v[88:91]
    v_mfma_f32_16x16x32_bf16 v[92:95], v[216:219], v[236:239], v[92:95]
    v_mfma_f32_16x16x32_bf16 v[96:99], v[216:219], v[240:243], v[96:99]
    v_mfma_f32_16x16x32_bf16 v[100:103], v[216:219], v[244:247], v[100:103]
    v_mfma_f32_16x16x32_bf16 v[104:107], v[220:223], v[232:235], v[104:107]
    v_mfma_f32_16x16x32_bf16 v[108:111], v[220:223], v[236:239], v[108:111]
    v_mfma_f32_16x16x32_bf16 v[112:115], v[220:223], v[240:243], v[112:115]
    v_mfma_f32_16x16x32_bf16 v[116:119], v[220:223], v[244:247], v[116:119]
    v_mfma_f32_16x16x32_bf16 v[120:123], v[224:227], v[232:235], v[120:123]
    v_mfma_f32_16x16x32_bf16 v[124:127], v[224:227], v[236:239], v[124:127]
    v_mfma_f32_16x16x32_bf16 v[128:131], v[224:227], v[240:243], v[128:131]
    v_mfma_f32_16x16x32_bf16 v[132:135], v[224:227], v[244:247], v[132:135]
    v_mfma_f32_16x16x32_bf16 v[136:139], v[228:231], v[232:235], v[136:139]
    v_mfma_f32_16x16x32_bf16 v[140:143], v[228:231], v[236:239], v[140:143]
    v_mfma_f32_16x16x32_bf16 v[144:147], v[228:231], v[240:243], v[144:147]
    v_mfma_f32_16x16x32_bf16 v[148:151], v[228:231], v[244:247], v[148:151]
H_EP_tr:
    s_lshr_b32 s45, s34, 2
    s_lshl_b32 s45, s45, 2
    s_and_b32 s46, s34, 3
    s_lshl_b32 s46, s46, 1
    s_cmp_eq_u32 s5, 4
    s_cselect_b32 s40, 2, 0
    s_xor_b32 s46, s46, s40
    s_mul_i32 s45, s45, s29
    s_mul_i32 s46, s46, s28
    s_add_u32 s26, s26, s45
    s_add_u32 s26, s26, s46
    s_add_u32 s46, s26, s28
    v_cvt_pk_bf16_f32 v24, v24, v25
    v_cvt_pk_bf16_f32 v25, v26, v27
    v_cvt_pk_bf16_f32 v26, v40, v41
    v_cvt_pk_bf16_f32 v27, v42, v43
    v_cvt_pk_bf16_f32 v28, v28, v29
    v_cvt_pk_bf16_f32 v29, v30, v31
    v_cvt_pk_bf16_f32 v30, v44, v45
    v_cvt_pk_bf16_f32 v31, v46, v47
    v_cvt_pk_bf16_f32 v32, v32, v33
    v_cvt_pk_bf16_f32 v33, v34, v35
    v_cvt_pk_bf16_f32 v34, v48, v49
    v_cvt_pk_bf16_f32 v35, v50, v51
    v_cvt_pk_bf16_f32 v36, v36, v37
    v_cvt_pk_bf16_f32 v37, v38, v39
    v_cvt_pk_bf16_f32 v38, v52, v53
    v_cvt_pk_bf16_f32 v39, v54, v55
    v_permlane16_swap_b32 v24, v26
    v_permlane16_swap_b32 v25, v27
    buffer_store_dwordx4 v[24:27], v20, s[20:23], s26 offen offset:0 sc1
    v_permlane16_swap_b32 v28, v30
    v_permlane16_swap_b32 v29, v31
    buffer_store_dwordx4 v[28:31], v20, s[20:23], s26 offen offset:256 sc1
    v_permlane16_swap_b32 v32, v34
    v_permlane16_swap_b32 v33, v35
    buffer_store_dwordx4 v[32:35], v20, s[20:23], s46 offen offset:0 sc1
    v_permlane16_swap_b32 v36, v38
    v_permlane16_swap_b32 v37, v39
    buffer_store_dwordx4 v[36:39], v20, s[20:23], s46 offen offset:256 sc1
    s_add_u32 s26, s26, s29
    s_add_u32 s46, s26, s28
    v_cvt_pk_bf16_f32 v56, v56, v57
    v_cvt_pk_bf16_f32 v57, v58, v59
    v_cvt_pk_bf16_f32 v58, v72, v73
    v_cvt_pk_bf16_f32 v59, v74, v75
    v_cvt_pk_bf16_f32 v60, v60, v61
    v_cvt_pk_bf16_f32 v61, v62, v63
    v_cvt_pk_bf16_f32 v62, v76, v77
    v_cvt_pk_bf16_f32 v63, v78, v79
    v_cvt_pk_bf16_f32 v64, v64, v65
    v_cvt_pk_bf16_f32 v65, v66, v67
    v_cvt_pk_bf16_f32 v66, v80, v81
    v_cvt_pk_bf16_f32 v67, v82, v83
    v_cvt_pk_bf16_f32 v68, v68, v69
    v_cvt_pk_bf16_f32 v69, v70, v71
    v_cvt_pk_bf16_f32 v70, v84, v85
    v_cvt_pk_bf16_f32 v71, v86, v87
    v_permlane16_swap_b32 v56, v58
    v_permlane16_swap_b32 v57, v59
    buffer_store_dwordx4 v[56:59], v20, s[20:23], s26 offen offset:0 sc1
    v_permlane16_swap_b32 v60, v62
    v_permlane16_swap_b32 v61, v63
    buffer_store_dwordx4 v[60:63], v20, s[20:23], s26 offen offset:256 sc1
    v_permlane16_swap_b32 v64, v66
    v_permlane16_swap_b32 v65, v67
    buffer_store_dwordx4 v[64:67], v20, s[20:23], s46 offen offset:0 sc1
    v_permlane16_swap_b32 v68, v70
    v_permlane16_swap_b32 v69, v71
    buffer_store_dwordx4 v[68:71], v20, s[20:23], s46 offen offset:256 sc1
    s_add_u32 s26, s26, s29
    s_add_u32 s46, s26, s28
    v_cvt_pk_bf16_f32 v88, v88, v89
    v_cvt_pk_bf16_f32 v89, v90, v91
    v_cvt_pk_bf16_f32 v90, v104, v105
    v_cvt_pk_bf16_f32 v91, v106, v107
    v_cvt_pk_bf16_f32 v92, v92, v93
    v_cvt_pk_bf16_f32 v93, v94, v95
    v_cvt_pk_bf16_f32 v94, v108, v109
    v_cvt_pk_bf16_f32 v95, v110, v111
    v_cvt_pk_bf16_f32 v96, v96, v97
    v_cvt_pk_bf16_f32 v97, v98, v99
    v_cvt_pk_bf16_f32 v98, v112, v113
    v_cvt_pk_bf16_f32 v99, v114, v115
    v_cvt_pk_bf16_f32 v100, v100, v101
    v_cvt_pk_bf16_f32 v101, v102, v103
    v_cvt_pk_bf16_f32 v102, v116, v117
    v_cvt_pk_bf16_f32 v103, v118, v119
    v_permlane16_swap_b32 v88, v90
    v_permlane16_swap_b32 v89, v91
    buffer_store_dwordx4 v[88:91], v20, s[20:23], s26 offen offset:0 sc1
    v_permlane16_swap_b32 v92, v94
    v_permlane16_swap_b32 v93, v95
    buffer_store_dwordx4 v[92:95], v20, s[20:23], s26 offen offset:256 sc1
    v_permlane16_swap_b32 v96, v98
    v_permlane16_swap_b32 v97, v99
    buffer_store_dwordx4 v[96:99], v20, s[20:23], s46 offen offset:0 sc1
    v_permlane16_swap_b32 v100, v102
    v_permlane16_swap_b32 v101, v103
    buffer_store_dwordx4 v[100:103], v20, s[20:23], s46 offen offset:256 sc1
    s_add_u32 s26, s26, s29
    s_add_u32 s46, s26, s28
    v_cvt_pk_bf16_f32 v120, v120, v121
    v_cvt_pk_bf16_f32 v121, v122, v123
    v_cvt_pk_bf16_f32 v122, v136, v137
    v_cvt_pk_bf16_f32 v123, v138, v139
    v_cvt_pk_bf16_f32 v124, v124, v125
    v_cvt_pk_bf16_f32 v125, v126, v127
    v_cvt_pk_bf16_f32 v126, v140, v141
    v_cvt_pk_bf16_f32 v127, v142, v143
    v_cvt_pk_bf16_f32 v128, v128, v129
    v_cvt_pk_bf16_f32 v129, v130, v131
    v_cvt_pk_bf16_f32 v130, v144, v145
    v_cvt_pk_bf16_f32 v131, v146, v147
    v_cvt_pk_bf16_f32 v132, v132, v133
    v_cvt_pk_bf16_f32 v133, v134, v135
    v_cvt_pk_bf16_f32 v134, v148, v149
    v_cvt_pk_bf16_f32 v135, v150, v151
    v_permlane16_swap_b32 v120, v122
    v_permlane16_swap_b32 v121, v123
    buffer_store_dwordx4 v[120:123], v20, s[20:23], s26 offen offset:0 sc1
    v_permlane16_swap_b32 v124, v126
    v_permlane16_swap_b32 v125, v127
    buffer_store_dwordx4 v[124:127], v20, s[20:23], s26 offen offset:256 sc1
    v_permlane16_swap_b32 v128, v130
    v_permlane16_swap_b32 v129, v131
    buffer_store_dwordx4 v[128:131], v20, s[20:23], s46 offen offset:0 sc1
    v_permlane16_swap_b32 v132, v134
    v_permlane16_swap_b32 v133, v135
    buffer_store_dwordx4 v[132:135], v20, s[20:23], s46 offen offset:256 sc1
    s_mov_b32 s38, s37
    s_cmp_eq_u32 s44, 1
    s_cbranch_scc1 B_WARM
    s_branch B_COLD
B_QA:
    s_lshr_b32 s40, s7, 3
    s_lshl_b32 s40, s40, 7
    s_add_u32 s40, s40, 98566144
    s_mov_b32 s41, 0
    s_cmp_lt_u32 s7, 8
    s_cselect_b32 s42, 128, 64
    s_cmp_eq_u32 s42, s72
    s_cbranch_scc1 B_QA_G
B_QA_W:
    buffer_load_dword v1, off, s[8:11], s40 sc1
    s_add_u32 s41, s41, 1
    s_cmp_gt_u32 s41, 60000
    s_cbranch_scc1 C_DONE
    s_cmp_lt_u32 s7, 8
    s_cselect_b32 s42, 128, 64
    s_waitcnt vmcnt(0)
    v_cmp_eq_u32 vcc, s42, v1
    s_cbranch_vccnz B_QA_G
    s_sleep 8
    s_branch B_QA_W
B_QA_G:
    s_cmp_eq_u32 s36, 4
    s_cbranch_scc1 H_QA
    v_bfe_u32 v28, v0, 2, 2
    v_lshlrev_b32 v28, 3, v28
    v_and_b32 v29, 3, v0
    v_add_u32 v28, v28, v29
    v_lshrrev_b32 v29, 4, v0
    v_lshlrev_b32 v29, 9, v29
    v_lshl_add_u32 v28, v28, 4, v29
    s_lshl_b32 s40, s3, 20
    s_lshl_b32 s41, s7, 12
    s_add_u32 s40, s40, s41
    s_add_u32 s40, s40, 0
    buffer_load_dwordx4 v[192:195], v28, s[8:11], s40 offen offset:0 sc1
    buffer_load_dwordx4 v[208:211], v28, s[8:11], s40 offen offset:64 sc1
    buffer_load_dwordx4 v[240:243], v28, s[8:11], s40 offen offset:2048 sc1
    buffer_load_dwordx4 v[244:247], v28, s[8:11], s40 offen offset:2112 sc1
    s_add_u32 s40, s40, 0x40000
    buffer_load_dwordx4 v[196:199], v28, s[8:11], s40 offen offset:0 sc1
    buffer_load_dwordx4 v[212:215], v28, s[8:11], s40 offen offset:64 sc1
    buffer_load_dwordx4 v[248:251], v28, s[8:11], s40 offen offset:2048 sc1
    buffer_load_dwordx4 v[252:255], v28, s[8:11], s40 offen offset:2112 sc1
    s_add_u32 s40, s40, 0x40000
    buffer_load_dwordx4 v[200:203], v28, s[8:11], s40 offen offset:0 sc1
    buffer_load_dwordx4 v[216:219], v28, s[8:11], s40 offen offset:64 sc1
    buffer_load_dwordx4 v[224:227], v28, s[8:11], s40 offen offset:2048 sc1
    buffer_load_dwordx4 v[228:231], v28, s[8:11], s40 offen offset:2112 sc1
    s_add_u32 s40, s40, 0x40000
    buffer_load_dwordx4 v[204:207], v28, s[8:11], s40 offen offset:0 sc1
    buffer_load_dwordx4 v[220:223], v28, s[8:11], s40 offen offset:64 sc1
    buffer_load_dwordx4 v[232:235], v28, s[8:11], s40 offen offset:2048 sc1
    buffer_load_dwordx4 v[236:239], v28, s[8:11], s40 offen offset:2112 sc1
    s_waitcnt lgkmcnt(0)
    v_mfma_f32_16x16x32_bf16 v[64:67], v[144:147], v[128:131], v[64:67]
    ds_read_b128 v[160:163], v15 offset:0
    v_mfma_f32_16x16x32_bf16 v[68:71], v[148:151], v[128:131], v[68:71]
    ds_read_b64_tr_b16 v[176:177], v16 offset:8192
    v_mfma_f32_16x16x32_bf16 v[72:75], v[152:155], v[128:131], v[72:75]
    ds_read_b64_tr_b16 v[178:179], v16 offset:9216
    v_mfma_f32_16x16x32_bf16 v[76:79], v[156:159], v[128:131], v[76:79]
    ds_read_b128 v[164:167], v15 offset:2048
    v_mfma_f32_16x16x32_bf16 v[80:83], v[144:147], v[132:135], v[80:83]
    ds_read_b64_tr_b16 v[180:181], v17 offset:8192
    v_mfma_f32_16x16x32_bf16 v[84:87], v[148:151], v[132:135], v[84:87]
    ds_read_b64_tr_b16 v[182:183], v17 offset:9216
    v_mfma_f32_16x16x32_bf16 v[88:91], v[152:155], v[132:135], v[88:91]
    ds_read_b128 v[168:171], v15 offset:4096
    v_mfma_f32_16x16x32_bf16 v[92:95], v[156:159], v[132:135], v[92:95]
    ds_read_b64_tr_b16 v[184:185], v18 offset:8192
    v_mfma_f32_16x16x32_bf16 v[96:99], v[144:147], v[136:139], v[96:99]
    ds_read_b64_tr_b16 v[186:187], v18 offset:9216
    v_mfma_f32_16x16x32_bf16 v[100:103], v[148:151], v[136:139], v[100:103]
    ds_read_b128 v[172:175], v15 offset:6144
    v_mfma_f32_16x16x32_bf16 v[104:107], v[152:155], v[136:139], v[104:107]
    ds_read_b64_tr_b16 v[188:189], v19 offset:8192
    v_mfma_f32_16x16x32_bf16 v[108:111], v[156:159], v[136:139], v[108:111]
    ds_read_b64_tr_b16 v[190:191], v19 offset:9216
    v_mfma_f32_16x16x32_bf16 v[112:115], v[144:147], v[140:143], v[112:115]
    v_add_u32 v14, s47, v8
    v_add_u32 v15, s47, v9
    v_mfma_f32_16x16x32_bf16 v[116:119], v[148:151], v[140:143], v[116:119]
    v_add_u32 v16, s48, v10
    v_add_u32 v17, s48, v11
    v_mfma_f32_16x16x32_bf16 v[120:123], v[152:155], v[140:143], v[120:123]
    v_add_u32 v18, s48, v12
    v_add_u32 v19, s48, v13
    v_mfma_f32_16x16x32_bf16 v[124:127], v[156:159], v[140:143], v[124:127]
    s_add_u32 s47, s47, 32768
    s_add_u32 s48, s48, 16384
    s_cmp_eq_u32 s47, 98304
    s_cselect_b32 s47, 0, s47
    s_cselect_b32 s48, 0, s48
    s_waitcnt vmcnt(22) lgkmcnt(0)
    s_barrier
    v_mfma_f32_16x16x32_bf16 v[64:67], v[176:179], v[160:163], v[64:67]
    ds_read_b128 v[128:131], v14 offset:0
    v_mfma_f32_16x16x32_bf16 v[68:71], v[180:183], v[160:163], v[68:71]
    ds_read_b64_tr_b16 v[144:145], v16 offset:0
    v_mfma_f32_16x16x32_bf16 v[72:75], v[184:187], v[160:163], v[72:75]
    ds_read_b64_tr_b16 v[146:147], v16 offset:1024
    v_mfma_f32_16x16x32_bf16 v[76:79], v[188:191], v[160:163], v[76:79]
    ds_read_b128 v[132:135], v14 offset:2048
    v_mfma_f32_16x16x32_bf16 v[80:83], v[176:179], v[164:167], v[80:83]
    ds_read_b64_tr_b16 v[148:149], v17 offset:0
    v_mfma_f32_16x16x32_bf16 v[84:87], v[180:183], v[164:167], v[84:87]
    ds_read_b64_tr_b16 v[150:151], v17 offset:1024
    v_mfma_f32_16x16x32_bf16 v[88:91], v[184:187], v[164:167], v[88:91]
    ds_read_b128 v[136:139], v14 offset:4096
    v_mfma_f32_16x16x32_bf16 v[92:95], v[188:191], v[164:167], v[92:95]
    ds_read_b64_tr_b16 v[152:153], v18 offset:0
    v_mfma_f32_16x16x32_bf16 v[96:99], v[176:179], v[168:171], v[96:99]
    ds_read_b64_tr_b16 v[154:155], v18 offset:1024
    v_mfma_f32_16x16x32_bf16 v[100:103], v[180:183], v[168:171], v[100:103]
    ds_read_b128 v[140:143], v14 offset:6144
    v_mfma_f32_16x16x32_bf16 v[104:107], v[184:187], v[168:171], v[104:107]
    ds_read_b64_tr_b16 v[156:157], v19 offset:0
    v_mfma_f32_16x16x32_bf16 v[108:111], v[188:191], v[168:171], v[108:111]
    ds_read_b64_tr_b16 v[158:159], v19 offset:1024
    v_mfma_f32_16x16x32_bf16 v[112:115], v[176:179], v[172:175], v[112:115]
    v_mfma_f32_16x16x32_bf16 v[116:119], v[180:183], v[172:175], v[116:119]
    v_mfma_f32_16x16x32_bf16 v[120:123], v[184:187], v[172:175], v[120:123]
    v_mfma_f32_16x16x32_bf16 v[124:127], v[188:191], v[172:175], v[124:127]
    s_waitcnt lgkmcnt(0)
    v_mfma_f32_16x16x32_bf16 v[64:67], v[144:147], v[128:131], v[64:67]
    ds_read_b128 v[160:163], v15 offset:0
    v_mfma_f32_16x16x32_bf16 v[68:71], v[148:151], v[128:131], v[68:71]
    ds_read_b64_tr_b16 v[176:177], v16 offset:8192
    v_mfma_f32_16x16x32_bf16 v[72:75], v[152:155], v[128:131], v[72:75]
    ds_read_b64_tr_b16 v[178:179], v16 offset:9216
    v_mfma_f32_16x16x32_bf16 v[76:79], v[156:159], v[128:131], v[76:79]
    ds_read_b128 v[164:167], v15 offset:2048
    v_mfma_f32_16x16x32_bf16 v[80:83], v[144:147], v[132:135], v[80:83]
    ds_read_b64_tr_b16 v[180:181], v17 offset:8192
    v_mfma_f32_16x16x32_bf16 v[84:87], v[148:151], v[132:135], v[84:87]
    ds_read_b64_tr_b16 v[182:183], v17 offset:9216
    v_mfma_f32_16x16x32_bf16 v[88:91], v[152:155], v[132:135], v[88:91]
    ds_read_b128 v[168:171], v15 offset:4096
    v_mfma_f32_16x16x32_bf16 v[92:95], v[156:159], v[132:135], v[92:95]
    ds_read_b64_tr_b16 v[184:185], v18 offset:8192
    v_mfma_f32_16x16x32_bf16 v[96:99], v[144:147], v[136:139], v[96:99]
    ds_read_b64_tr_b16 v[186:187], v18 offset:9216
    v_mfma_f32_16x16x32_bf16 v[100:103], v[148:151], v[136:139], v[100:103]
    ds_read_b128 v[172:175], v15 offset:6144
    v_mfma_f32_16x16x32_bf16 v[104:107], v[152:155], v[136:139], v[104:107]
    ds_read_b64_tr_b16 v[188:189], v19 offset:8192
    v_mfma_f32_16x16x32_bf16 v[108:111], v[156:159], v[136:139], v[108:111]
    ds_read_b64_tr_b16 v[190:191], v19 offset:9216
    v_mfma_f32_16x16x32_bf16 v[112:115], v[144:147], v[140:143], v[112:115]
    v_add_u32 v14, s47, v8
    v_add_u32 v15, s47, v9
    v_mfma_f32_16x16x32_bf16 v[116:119], v[148:151], v[140:143], v[116:119]
    v_add_u32 v16, s48, v10
    v_add_u32 v17, s48, v11
    v_mfma_f32_16x16x32_bf16 v[120:123], v[152:155], v[140:143], v[120:123]
    v_add_u32 v18, s48, v12
    v_add_u32 v19, s48, v13
    v_mfma_f32_16x16x32_bf16 v[124:127], v[156:159], v[140:143], v[124:127]
    s_add_u32 s47, s47, 32768
    s_add_u32 s48, s48, 16384
    s_cmp_eq_u32 s47, 98304
    s_cselect_b32 s47, 0, s47
    s_cselect_b32 s48, 0, s48
    s_waitcnt vmcnt(16) lgkmcnt(0)
    s_barrier
    v_mfma_f32_16x16x32_bf16 v[64:67], v[176:179], v[160:163], v[64:67]
    ds_read_b128 v[128:131], v14 offset:0
    v_mfma_f32_16x16x32_bf16 v[68:71], v[180:183], v[160:163], v[68:71]
    ds_read_b64_tr_b16 v[144:145], v16 offset:0
    v_mfma_f32_16x16x32_bf16 v[72:75], v[184:187], v[160:163], v[72:75]
    ds_read_b64_tr_b16 v[146:147], v16 offset:1024
    v_mfma_f32_16x16x32_bf16 v[76:79], v[188:191], v[160:163], v[76:79]
    ds_read_b128 v[132:135], v14 offset:2048
    v_mfma_f32_16x16x32_bf16 v[80:83], v[176:179], v[164:167], v[80:83]
    ds_read_b64_tr_b16 v[148:149], v17 offset:0
    v_mfma_f32_16x16x32_bf16 v[84:87], v[180:183], v[164:167], v[84:87]
    ds_read_b64_tr_b16 v[150:151], v17 offset:1024
    v_mfma_f32_16x16x32_bf16 v[88:91], v[184:187], v[164:167], v[88:91]
    ds_read_b128 v[136:139], v14 offset:4096
    v_mfma_f32_16x16x32_bf16 v[92:95], v[188:191], v[164:167], v[92:95]
    ds_read_b64_tr_b16 v[152:153], v18 offset:0
    v_mfma_f32_16x16x32_bf16 v[96:99], v[176:179], v[168:171], v[96:99]
    ds_read_b64_tr_b16 v[154:155], v18 offset:1024
    v_mfma_f32_16x16x32_bf16 v[100:103], v[180:183], v[168:171], v[100:103]
    ds_read_b128 v[140:143], v14 offset:6144
    v_mfma_f32_16x16x32_bf16 v[104:107], v[184:187], v[168:171], v[104:107]
    ds_read_b64_tr_b16 v[156:157], v19 offset:0
    v_mfma_f32_16x16x32_bf16 v[108:111], v[188:191], v[168:171], v[108:111]
    ds_read_b64_tr_b16 v[158:159], v19 offset:1024
    v_mfma_f32_16x16x32_bf16 v[112:115], v[176:179], v[172:175], v[112:115]
    v_mfma_f32_16x16x32_bf16 v[116:119], v[180:183], v[172:175], v[116:119]
    v_mfma_f32_16x16x32_bf16 v[120:123], v[184:187], v[172:175], v[120:123]
    v_mfma_f32_16x16x32_bf16 v[124:127], v[188:191], v[172:175], v[124:127]
    s_waitcnt lgkmcnt(0)
    v_mfma_f32_16x16x32_bf16 v[64:67], v[144:147], v[128:131], v[64:67]
    ds_read_b128 v[160:163], v15 offset:0
    v_mfma_f32_16x16x32_bf16 v[68:71], v[148:151], v[128:131], v[68:71]
    ds_read_b64_tr_b16 v[176:177], v16 offset:8192
    v_mfma_f32_16x16x32_bf16 v[72:75], v[152:155], v[128:131], v[72:75]
    ds_read_b64_tr_b16 v[178:179], v16 offset:9216
    v_mfma_f32_16x16x32_bf16 v[76:79], v[156:159], v[128:131], v[76:79]
    ds_read_b128 v[164:167], v15 offset:2048
    v_mfma_f32_16x16x32_bf16 v[80:83], v[144:147], v[132:135], v[80:83]
    ds_read_b64_tr_b16 v[180:181], v17 offset:8192
    v_mfma_f32_16x16x32_bf16 v[84:87], v[148:151], v[132:135], v[84:87]
    ds_read_b64_tr_b16 v[182:183], v17 offset:9216
    v_mfma_f32_16x16x32_bf16 v[88:91], v[152:155], v[132:135], v[88:91]
    ds_read_b128 v[168:171], v15 offset:4096
    v_mfma_f32_16x16x32_bf16 v[92:95], v[156:159], v[132:135], v[92:95]
    ds_read_b64_tr_b16 v[184:185], v18 offset:8192
    v_mfma_f32_16x16x32_bf16 v[96:99], v[144:147], v[136:139], v[96:99]
    ds_read_b64_tr_b16 v[186:187], v18 offset:9216
    v_mfma_f32_16x16x32_bf16 v[100:103], v[148:151], v[136:139], v[100:103]
    ds_read_b128 v[172:175], v15 offset:6144
    v_mfma_f32_16x16x32_bf16 v[104:107], v[152:155], v[136:139], v[104:107]
    ds_read_b64_tr_b16 v[188:189], v19 offset:8192
    v_mfma_f32_16x16x32_bf16 v[108:111], v[156:159], v[136:139], v[108:111]
    ds_read_b64_tr_b16 v[190:191], v19 offset:9216
    v_mfma_f32_16x16x32_bf16 v[112:115], v[144:147], v[140:143], v[112:115]
    v_mfma_f32_16x16x32_bf16 v[116:119], v[148:151], v[140:143], v[116:119]
    v_mfma_f32_16x16x32_bf16 v[120:123], v[152:155], v[140:143], v[120:123]
    v_mfma_f32_16x16x32_bf16 v[124:127], v[156:159], v[140:143], v[124:127]
    s_waitcnt lgkmcnt(0)
    v_mfma_f32_16x16x32_bf16 v[64:67], v[176:179], v[160:163], v[64:67]
    v_mfma_f32_16x16x32_bf16 v[68:71], v[180:183], v[160:163], v[68:71]
    v_mfma_f32_16x16x32_bf16 v[72:75], v[184:187], v[160:163], v[72:75]
    v_mfma_f32_16x16x32_bf16 v[76:79], v[188:191], v[160:163], v[76:79]
    v_mfma_f32_16x16x32_bf16 v[80:83], v[176:179], v[164:167], v[80:83]
    v_mfma_f32_16x16x32_bf16 v[84:87], v[180:183], v[164:167], v[84:87]
    v_mfma_f32_16x16x32_bf16 v[88:91], v[184:187], v[164:167], v[88:91]
    v_mfma_f32_16x16x32_bf16 v[92:95], v[188:191], v[164:167], v[92:95]
    v_mfma_f32_16x16x32_bf16 v[96:99], v[176:179], v[168:171], v[96:99]
    v_mfma_f32_16x16x32_bf16 v[100:103], v[180:183], v[168:171], v[100:103]
    v_mfma_f32_16x16x32_bf16 v[104:107], v[184:187], v[168:171], v[104:107]
    v_mfma_f32_16x16x32_bf16 v[108:111], v[188:191], v[168:171], v[108:111]
    v_mfma_f32_16x16x32_bf16 v[112:115], v[176:179], v[172:175], v[112:115]
    v_mfma_f32_16x16x32_bf16 v[116:119], v[180:183], v[172:175], v[116:119]
    v_mfma_f32_16x16x32_bf16 v[120:123], v[184:187], v[172:175], v[120:123]
    v_mfma_f32_16x16x32_bf16 v[124:127], v[188:191], v[172:175], v[124:127]
    s_barrier
    s_lshl_b32 s45, s34, 14
    v_lshlrev_b32 v20, 4, v0
    v_add_u32 v20, s45, v20
    v_cvt_pk_bf16_f32 v160, v64, v65
    v_cvt_pk_bf16_f32 v161, v66, v67
    v_cvt_pk_bf16_f32 v162, v68, v69
    v_cvt_pk_bf16_f32 v163, v70, v71
    v_cvt_pk_bf16_f32 v164, v72, v73
    v_cvt_pk_bf16_f32 v165, v74, v75
    v_cvt_pk_bf16_f32 v166, v76, v77
    v_cvt_pk_bf16_f32 v167, v78, v79
    v_cvt_pk_bf16_f32 v168, v80, v81
    v_cvt_pk_bf16_f32 v169, v82, v83
    v_cvt_pk_bf16_f32 v170, v84, v85
    v_cvt_pk_bf16_f32 v171, v86, v87
    v_cvt_pk_bf16_f32 v172, v88, v89
    v_cvt_pk_bf16_f32 v173, v90, v91
    v_cvt_pk_bf16_f32 v174, v92, v93
    v_cvt_pk_bf16_f32 v175, v94, v95
    v_cvt_pk_bf16_f32 v176, v96, v97
    v_cvt_pk_bf16_f32 v177, v98, v99
    v_cvt_pk_bf16_f32 v178, v100, v101
    v_cvt_pk_bf16_f32 v179, v102, v103
    v_cvt_pk_bf16_f32 v180, v104, v105
    v_cvt_pk_bf16_f32 v181, v106, v107
    v_cvt_pk_bf16_f32 v182, v108, v109
    v_cvt_pk_bf16_f32 v183, v110, v111
    v_cvt_pk_bf16_f32 v184, v112, v113
    v_cvt_pk_bf16_f32 v185, v114, v115
    v_cvt_pk_bf16_f32 v186, v116, v117
    v_cvt_pk_bf16_f32 v187, v118, v119
    v_cvt_pk_bf16_f32 v188, v120, v121
    v_cvt_pk_bf16_f32 v189, v122, v123
    v_cvt_pk_bf16_f32 v190, v124, v125
    v_cvt_pk_bf16_f32 v191, v126, v127
    v_permlane16_swap_b32 v160, v162
    v_permlane16_swap_b32 v161, v163
    ds_write_b128 v20, v[160:163] offset:0
    v_permlane16_swap_b32 v164, v166
    v_permlane16_swap_b32 v165, v167
    ds_write_b128 v20, v[164:167] offset:1024
    v_permlane16_swap_b32 v168, v170
    v_permlane16_swap_b32 v169, v171
    ds_write_b128 v20, v[168:171] offset:2048
    v_permlane16_swap_b32 v172, v174
    v_permlane16_swap_b32 v173, v175
    ds_write_b128 v20, v[172:175] offset:3072
    v_permlane16_swap_b32 v176, v178
    v_permlane16_swap_b32 v177, v179
    ds_write_b128 v20, v[176:179] offset:4096
    v_permlane16_swap_b32 v180, v182
    v_permlane16_swap_b32 v181, v183
    ds_write_b128 v20, v[180:183] offset:5120
    v_permlane16_swap_b32 v184, v186
    v_permlane16_swap_b32 v185, v187
    ds_write_b128 v20, v[184:187] offset:6144
    v_permlane16_swap_b32 v188, v190
    v_permlane16_swap_b32 v189, v191
    ds_write_b128 v20, v[188:191] offset:7168
    s_lshr_b32 s53, s34, 1
    s_lshl_b32 s53, s53, 15
    s_and_b32 s40, s34, 1
    s_lshl_b32 s40, s40, 12
    s_add_u32 s53, s53, s40
    s_mov_b32 s54, 1
    s_branch B_QA_S
H_QA:
    s_waitcnt lgkmcnt(0)
    v_mfma_f32_16x16x32_bf16 v[24:27], v[184:187], v[152:155], v[24:27]
    ds_read_b64_tr_b16 v[232:233], v10 offset:8192
    v_mfma_f32_16x16x32_bf16 v[28:31], v[188:191], v[152:155], v[28:31]
    ds_read_b64_tr_b16 v[234:235], v10 offset:9216
    v_mfma_f32_16x16x32_bf16 v[32:35], v[192:195], v[152:155], v[32:35]
    ds_read_b128 v[200:203], v9 offset:0
    v_mfma_f32_16x16x32_bf16 v[36:39], v[196:199], v[152:155], v[36:39]
    ds_read_b128 v[204:207], v9 offset:2048
    v_mfma_f32_16x16x32_bf16 v[40:43], v[184:187], v[156:159], v[40:43]
    ds_read_b64_tr_b16 v[236:237], v11 offset:8192
    v_mfma_f32_16x16x32_bf16 v[44:47], v[188:191], v[156:159], v[44:47]
    ds_read_b64_tr_b16 v[238:239], v11 offset:9216
    v_mfma_f32_16x16x32_bf16 v[48:51], v[192:195], v[156:159], v[48:51]
    ds_read_b128 v[208:211], v9 offset:4096
    v_mfma_f32_16x16x32_bf16 v[52:55], v[196:199], v[156:159], v[52:55]
    ds_read_b128 v[212:215], v9 offset:6144
    v_mfma_f32_16x16x32_bf16 v[56:59], v[184:187], v[160:163], v[56:59]
    ds_read_b64_tr_b16 v[240:241], v12 offset:8192
    v_mfma_f32_16x16x32_bf16 v[60:63], v[188:191], v[160:163], v[60:63]
    ds_read_b64_tr_b16 v[242:243], v12 offset:9216
    v_mfma_f32_16x16x32_bf16 v[64:67], v[192:195], v[160:163], v[64:67]
    ds_read_b128 v[216:219], v9 offset:8192
    v_mfma_f32_16x16x32_bf16 v[68:71], v[196:199], v[160:163], v[68:71]
    ds_read_b128 v[220:223], v9 offset:10240
    v_mfma_f32_16x16x32_bf16 v[72:75], v[184:187], v[164:167], v[72:75]
    ds_read_b64_tr_b16 v[244:245], v13 offset:8192
    v_mfma_f32_16x16x32_bf16 v[76:79], v[188:191], v[164:167], v[76:79]
    ds_read_b64_tr_b16 v[246:247], v13 offset:9216
    v_mfma_f32_16x16x32_bf16 v[80:83], v[192:195], v[164:167], v[80:83]
    ds_read_b128 v[224:227], v9 offset:12288
    v_mfma_f32_16x16x32_bf16 v[84:87], v[196:199], v[164:167], v[84:87]
    ds_read_b128 v[228:231], v9 offset:14336
    v_mfma_f32_16x16x32_bf16 v[88:91], v[184:187], v[168:171], v[88:91]
    v_mfma_f32_16x16x32_bf16 v[92:95], v[188:191], v[168:171], v[92:95]
    v_mfma_f32_16x16x32_bf16 v[96:99], v[192:195], v[168:171], v[96:99]
    v_mfma_f32_16x16x32_bf16 v[100:103], v[196:199], v[168:171], v[100:103]
    v_mfma_f32_16x16x32_bf16 v[104:107], v[184:187], v[172:175], v[104:107]
    v_xor_b32 v8, 0x10000, v8
    v_mfma_f32_16x16x32_bf16 v[108:111], v[188:191], v[172:175], v[108:111]
    v_xor_b32 v9, 0x10000, v9
    v_mfma_f32_16x16x32_bf16 v[112:115], v[192:195], v[172:175], v[112:115]
    v_xor_b32 v10, 0x10000, v10
    v_mfma_f32_16x16x32_bf16 v[116:119], v[196:199], v[172:175], v[116:119]
    v_xor_b32 v11, 0x10000, v11
    v_mfma_f32_16x16x32_bf16 v[120:123], v[184:187], v[176:179], v[120:123]
    v_xor_b32 v12, 0x10000, v12
    v_mfma_f32_16x16x32_bf16 v[124:127], v[188:191], v[176:179], v[124:127]
    v_xor_b32 v13, 0x10000, v13
    v_mfma_f32_16x16x32_bf16 v[128:131], v[192:195], v[176:179], v[128:131]
    v_mfma_f32_16x16x32_bf16 v[132:135], v[196:199], v[176:179], v[132:135]
    v_mfma_f32_16x16x32_bf16 v[136:139], v[184:187], v[180:183], v[136:139]
    v_mfma_f32_16x16x32_bf16 v[140:143], v[188:191], v[180:183], v[140:143]
    v_mfma_f32_16x16x32_bf16 v[144:147], v[192:195], v[180:183], v[144:147]
    v_mfma_f32_16x16x32_bf16 v[148:151], v[196:199], v[180:183], v[148:151]
    s_waitcnt vmcnt(0) lgkmcnt(0)
    s_barrier
    v_mfma_f32_16x16x32_bf16 v[24:27], v[232:235], v[200:203], v[24:27]
    v_mfma_f32_16x16x32_bf16 v[28:31], v[236:239], v[200:203], v[28:31]
    ds_read_b64_tr_b16 v[184:185], v10 offset:0
    v_mfma_f32_16x16x32_bf16 v[32:35], v[240:243], v[200:203], v[32:35]
    v_mfma_f32_16x16x32_bf16 v[36:39], v[244:247], v[200:203], v[36:39]
    ds_read_b64_tr_b16 v[186:187], v10 offset:1024
    v_mfma_f32_16x16x32_bf16 v[40:43], v[232:235], v[204:207], v[40:43]
    v_mfma_f32_16x16x32_bf16 v[44:47], v[236:239], v[204:207], v[44:47]
    ds_read_b128 v[152:155], v8 offset:0
    v_mfma_f32_16x16x32_bf16 v[48:51], v[240:243], v[204:207], v[48:51]
    v_mfma_f32_16x16x32_bf16 v[52:55], v[244:247], v[204:207], v[52:55]
    ds_read_b128 v[156:159], v8 offset:2048
    v_mfma_f32_16x16x32_bf16 v[56:59], v[232:235], v[208:211], v[56:59]
    v_mfma_f32_16x16x32_bf16 v[60:63], v[236:239], v[208:211], v[60:63]
    ds_read_b64_tr_b16 v[188:189], v11 offset:0
    v_mfma_f32_16x16x32_bf16 v[64:67], v[240:243], v[208:211], v[64:67]
    v_mfma_f32_16x16x32_bf16 v[68:71], v[244:247], v[208:211], v[68:71]
    ds_read_b64_tr_b16 v[190:191], v11 offset:1024
    v_mfma_f32_16x16x32_bf16 v[72:75], v[232:235], v[212:215], v[72:75]
    v_mfma_f32_16x16x32_bf16 v[76:79], v[236:239], v[212:215], v[76:79]
    ds_read_b128 v[160:163], v8 offset:4096
    v_mfma_f32_16x16x32_bf16 v[80:83], v[240:243], v[212:215], v[80:83]
    v_mfma_f32_16x16x32_bf16 v[84:87], v[244:247], v[212:215], v[84:87]
    ds_read_b128 v[164:167], v8 offset:6144
    v_mfma_f32_16x16x32_bf16 v[88:91], v[232:235], v[216:219], v[88:91]
    ds_read_b64_tr_b16 v[192:193], v12 offset:0
    v_mfma_f32_16x16x32_bf16 v[92:95], v[236:239], v[216:219], v[92:95]
    ds_read_b64_tr_b16 v[194:195], v12 offset:1024
    v_mfma_f32_16x16x32_bf16 v[96:99], v[240:243], v[216:219], v[96:99]
    ds_read_b128 v[168:171], v8 offset:8192
    v_mfma_f32_16x16x32_bf16 v[100:103], v[244:247], v[216:219], v[100:103]
    ds_read_b128 v[172:175], v8 offset:10240
    v_mfma_f32_16x16x32_bf16 v[104:107], v[232:235], v[220:223], v[104:107]
    ds_read_b64_tr_b16 v[196:197], v13 offset:0
    v_mfma_f32_16x16x32_bf16 v[108:111], v[236:239], v[220:223], v[108:111]
    ds_read_b64_tr_b16 v[198:199], v13 offset:1024
    v_mfma_f32_16x16x32_bf16 v[112:115], v[240:243], v[220:223], v[112:115]
    ds_read_b128 v[176:179], v8 offset:12288
    v_mfma_f32_16x16x32_bf16 v[116:119], v[244:247], v[220:223], v[116:119]
    ds_read_b128 v[180:183], v8 offset:14336
    v_mfma_f32_16x16x32_bf16 v[120:123], v[232:235], v[224:227], v[120:123]
    v_mfma_f32_16x16x32_bf16 v[124:127], v[236:239], v[224:227], v[124:127]
    v_mfma_f32_16x16x32_bf16 v[128:131], v[240:243], v[224:227], v[128:131]
    v_mfma_f32_16x16x32_bf16 v[132:135], v[244:247], v[224:227], v[132:135]
    v_mfma_f32_16x16x32_bf16 v[136:139], v[232:235], v[228:231], v[136:139]
    v_mfma_f32_16x16x32_bf16 v[140:143], v[236:239], v[228:231], v[140:143]
    v_mfma_f32_16x16x32_bf16 v[144:147], v[240:243], v[228:231], v[144:147]
    v_mfma_f32_16x16x32_bf16 v[148:151], v[244:247], v[228:231], v[148:151]
    s_waitcnt lgkmcnt(0)
    v_mfma_f32_16x16x32_bf16 v[24:27], v[184:187], v[152:155], v[24:27]
    ds_read_b64_tr_b16 v[232:233], v10 offset:8192
    v_mfma_f32_16x16x32_bf16 v[28:31], v[188:191], v[152:155], v[28:31]
    ds_read_b64_tr_b16 v[234:235], v10 offset:9216
    v_mfma_f32_16x16x32_bf16 v[32:35], v[192:195], v[152:155], v[32:35]
    ds_read_b128 v[200:203], v9 offset:0
    v_mfma_f32_16x16x32_bf16 v[36:39], v[196:199], v[152:155], v[36:39]
    ds_read_b128 v[204:207], v9 offset:2048
    v_mfma_f32_16x16x32_bf16 v[40:43], v[184:187], v[156:159], v[40:43]
    ds_read_b64_tr_b16 v[236:237], v11 offset:8192
    v_mfma_f32_16x16x32_bf16 v[44:47], v[188:191], v[156:159], v[44:47]
    ds_read_b64_tr_b16 v[238:239], v11 offset:9216
    v_mfma_f32_16x16x32_bf16 v[48:51], v[192:195], v[156:159], v[48:51]
    ds_read_b128 v[208:211], v9 offset:4096
    v_mfma_f32_16x16x32_bf16 v[52:55], v[196:199], v[156:159], v[52:55]
    ds_read_b128 v[212:215], v9 offset:6144
    v_mfma_f32_16x16x32_bf16 v[56:59], v[184:187], v[160:163], v[56:59]
    ds_read_b64_tr_b16 v[240:241], v12 offset:8192
    v_mfma_f32_16x16x32_bf16 v[60:63], v[188:191], v[160:163], v[60:63]
    ds_read_b64_tr_b16 v[242:243], v12 offset:9216
    v_mfma_f32_16x16x32_bf16 v[64:67], v[192:195], v[160:163], v[64:67]
    ds_read_b128 v[216:219], v9 offset:8192
    v_mfma_f32_16x16x32_bf16 v[68:71], v[196:199], v[160:163], v[68:71]
    ds_read_b128 v[220:223], v9 offset:10240
    v_mfma_f32_16x16x32_bf16 v[72:75], v[184:187], v[164:167], v[72:75]
    ds_read_b64_tr_b16 v[244:245], v13 offset:8192
    v_mfma_f32_16x16x32_bf16 v[76:79], v[188:191], v[164:167], v[76:79]
    ds_read_b64_tr_b16 v[246:247], v13 offset:9216
    v_mfma_f32_16x16x32_bf16 v[80:83], v[192:195], v[164:167], v[80:83]
    ds_read_b128 v[224:227], v9 offset:12288
    v_mfma_f32_16x16x32_bf16 v[84:87], v[196:199], v[164:167], v[84:87]
    ds_read_b128 v[228:231], v9 offset:14336
    v_mfma_f32_16x16x32_bf16 v[88:91], v[184:187], v[168:171], v[88:91]
    v_mfma_f32_16x16x32_bf16 v[92:95], v[188:191], v[168:171], v[92:95]
    v_mfma_f32_16x16x32_bf16 v[96:99], v[192:195], v[168:171], v[96:99]
    v_mfma_f32_16x16x32_bf16 v[100:103], v[196:199], v[168:171], v[100:103]
    v_mfma_f32_16x16x32_bf16 v[104:107], v[184:187], v[172:175], v[104:107]
    v_mfma_f32_16x16x32_bf16 v[108:111], v[188:191], v[172:175], v[108:111]
    v_mfma_f32_16x16x32_bf16 v[112:115], v[192:195], v[172:175], v[112:115]
    v_mfma_f32_16x16x32_bf16 v[116:119], v[196:199], v[172:175], v[116:119]
    v_mfma_f32_16x16x32_bf16 v[120:123], v[184:187], v[176:179], v[120:123]
    v_mfma_f32_16x16x32_bf16 v[124:127], v[188:191], v[176:179], v[124:127]
    v_mfma_f32_16x16x32_bf16 v[128:131], v[192:195], v[176:179], v[128:131]
    v_mfma_f32_16x16x32_bf16 v[132:135], v[196:199], v[176:179], v[132:135]
    v_mfma_f32_16x16x32_bf16 v[136:139], v[184:187], v[180:183], v[136:139]
    v_mfma_f32_16x16x32_bf16 v[140:143], v[188:191], v[180:183], v[140:143]
    v_mfma_f32_16x16x32_bf16 v[144:147], v[192:195], v[180:183], v[144:147]
    v_mfma_f32_16x16x32_bf16 v[148:151], v[196:199], v[180:183], v[148:151]
    s_waitcnt lgkmcnt(0)
    v_mfma_f32_16x16x32_bf16 v[24:27], v[232:235], v[200:203], v[24:27]
    v_mfma_f32_16x16x32_bf16 v[28:31], v[236:239], v[200:203], v[28:31]
    v_mfma_f32_16x16x32_bf16 v[32:35], v[240:243], v[200:203], v[32:35]
    v_mfma_f32_16x16x32_bf16 v[36:39], v[244:247], v[200:203], v[36:39]
    v_mfma_f32_16x16x32_bf16 v[40:43], v[232:235], v[204:207], v[40:43]
    v_mfma_f32_16x16x32_bf16 v[44:47], v[236:239], v[204:207], v[44:47]
    v_mfma_f32_16x16x32_bf16 v[48:51], v[240:243], v[204:207], v[48:51]
    v_mfma_f32_16x16x32_bf16 v[52:55], v[244:247], v[204:207], v[52:55]
    v_mfma_f32_16x16x32_bf16 v[56:59], v[232:235], v[208:211], v[56:59]
    v_mfma_f32_16x16x32_bf16 v[60:63], v[236:239], v[208:211], v[60:63]
    v_mfma_f32_16x16x32_bf16 v[64:67], v[240:243], v[208:211], v[64:67]
    v_mfma_f32_16x16x32_bf16 v[68:71], v[244:247], v[208:211], v[68:71]
    v_mfma_f32_16x16x32_bf16 v[72:75], v[232:235], v[212:215], v[72:75]
    v_mfma_f32_16x16x32_bf16 v[76:79], v[236:239], v[212:215], v[76:79]
    v_mfma_f32_16x16x32_bf16 v[80:83], v[240:243], v[212:215], v[80:83]
    v_mfma_f32_16x16x32_bf16 v[84:87], v[244:247], v[212:215], v[84:87]
    v_mfma_f32_16x16x32_bf16 v[88:91], v[232:235], v[216:219], v[88:91]
    v_mfma_f32_16x16x32_bf16 v[92:95], v[236:239], v[216:219], v[92:95]
    v_mfma_f32_16x16x32_bf16 v[96:99], v[240:243], v[216:219], v[96:99]
    v_mfma_f32_16x16x32_bf16 v[100:103], v[244:247], v[216:219], v[100:103]
    v_mfma_f32_16x16x32_bf16 v[104:107], v[232:235], v[220:223], v[104:107]
    v_mfma_f32_16x16x32_bf16 v[108:111], v[236:239], v[220:223], v[108:111]
    v_mfma_f32_16x16x32_bf16 v[112:115], v[240:243], v[220:223], v[112:115]
    v_mfma_f32_16x16x32_bf16 v[116:119], v[244:247], v[220:223], v[116:119]
    v_mfma_f32_16x16x32_bf16 v[120:123], v[232:235], v[224:227], v[120:123]
    v_mfma_f32_16x16x32_bf16 v[124:127], v[236:239], v[224:227], v[124:127]
    v_mfma_f32_16x16x32_bf16 v[128:131], v[240:243], v[224:227], v[128:131]
    v_mfma_f32_16x16x32_bf16 v[132:135], v[244:247], v[224:227], v[132:135]
    v_mfma_f32_16x16x32_bf16 v[136:139], v[232:235], v[228:231], v[136:139]
    v_mfma_f32_16x16x32_bf16 v[140:143], v[236:239], v[228:231], v[140:143]
    v_mfma_f32_16x16x32_bf16 v[144:147], v[240:243], v[228:231], v[144:147]
    v_mfma_f32_16x16x32_bf16 v[148:151], v[244:247], v[228:231], v[148:151]
    s_barrier
    s_lshl_b32 s45, s34, 14
    v_lshlrev_b32 v14, 4, v0
    v_add_u32 v14, s45, v14
    v_cvt_pk_bf16_f32 v24, v24, v25
    v_cvt_pk_bf16_f32 v25, v26, v27
    v_cvt_pk_bf16_f32 v26, v28, v29
    v_cvt_pk_bf16_f32 v27, v30, v31
    v_cvt_pk_bf16_f32 v32, v32, v33
    v_cvt_pk_bf16_f32 v33, v34, v35
    v_cvt_pk_bf16_f32 v34, v36, v37
    v_cvt_pk_bf16_f32 v35, v38, v39
    v_cvt_pk_bf16_f32 v40, v40, v41
    v_cvt_pk_bf16_f32 v41, v42, v43
    v_cvt_pk_bf16_f32 v42, v44, v45
    v_cvt_pk_bf16_f32 v43, v46, v47
    v_cvt_pk_bf16_f32 v48, v48, v49
    v_cvt_pk_bf16_f32 v49, v50, v51
    v_cvt_pk_bf16_f32 v50, v52, v53
    v_cvt_pk_bf16_f32 v51, v54, v55
    v_permlane16_swap_b32 v24, v26
    v_permlane16_swap_b32 v25, v27
    ds_write_b128 v14, v[24:27] offset:0
    v_permlane16_swap_b32 v32, v34
    v_permlane16_swap_b32 v33, v35
    ds_write_b128 v14, v[32:35] offset:1024
    v_permlane16_swap_b32 v40, v42
    v_permlane16_swap_b32 v41, v43
    ds_write_b128 v14, v[40:43] offset:2048
    v_permlane16_swap_b32 v48, v50
    v_permlane16_swap_b32 v49, v51
    ds_write_b128 v14, v[48:51] offset:3072
    v_cvt_pk_bf16_f32 v56, v56, v57
    v_cvt_pk_bf16_f32 v57, v58, v59
    v_cvt_pk_bf16_f32 v58, v60, v61
    v_cvt_pk_bf16_f32 v59, v62, v63
    v_cvt_pk_bf16_f32 v64, v64, v65
    v_cvt_pk_bf16_f32 v65, v66, v67
    v_cvt_pk_bf16_f32 v66, v68, v69
    v_cvt_pk_bf16_f32 v67, v70, v71
    v_cvt_pk_bf16_f32 v72, v72, v73
    v_cvt_pk_bf16_f32 v73, v74, v75
    v_cvt_pk_bf16_f32 v74, v76, v77
    v_cvt_pk_bf16_f32 v75, v78, v79
    v_cvt_pk_bf16_f32 v80, v80, v81
    v_cvt_pk_bf16_f32 v81, v82, v83
    v_cvt_pk_bf16_f32 v82, v84, v85
    v_cvt_pk_bf16_f32 v83, v86, v87
    v_permlane16_swap_b32 v56, v58
    v_permlane16_swap_b32 v57, v59
    ds_write_b128 v14, v[56:59] offset:4096
    v_permlane16_swap_b32 v64, v66
    v_permlane16_swap_b32 v65, v67
    ds_write_b128 v14, v[64:67] offset:5120
    v_permlane16_swap_b32 v72, v74
    v_permlane16_swap_b32 v73, v75
    ds_write_b128 v14, v[72:75] offset:6144
    v_permlane16_swap_b32 v80, v82
    v_permlane16_swap_b32 v81, v83
    ds_write_b128 v14, v[80:83] offset:7168
    v_cvt_pk_bf16_f32 v88, v88, v89
    v_cvt_pk_bf16_f32 v89, v90, v91
    v_cvt_pk_bf16_f32 v90, v92, v93
    v_cvt_pk_bf16_f32 v91, v94, v95
    v_cvt_pk_bf16_f32 v96, v96, v97
    v_cvt_pk_bf16_f32 v97, v98, v99
    v_cvt_pk_bf16_f32 v98, v100, v101
    v_cvt_pk_bf16_f32 v99, v102, v103
    v_cvt_pk_bf16_f32 v104, v104, v105
    v_cvt_pk_bf16_f32 v105, v106, v107
    v_cvt_pk_bf16_f32 v106, v108, v109
    v_cvt_pk_bf16_f32 v107, v110, v111
    v_cvt_pk_bf16_f32 v112, v112, v113
    v_cvt_pk_bf16_f32 v113, v114, v115
    v_cvt_pk_bf16_f32 v114, v116, v117
    v_cvt_pk_bf16_f32 v115, v118, v119
    v_permlane16_swap_b32 v88, v90
    v_permlane16_swap_b32 v89, v91
    ds_write_b128 v14, v[88:91] offset:8192
    v_permlane16_swap_b32 v96, v98
    v_permlane16_swap_b32 v97, v99
    ds_write_b128 v14, v[96:99] offset:9216
    v_permlane16_swap_b32 v104, v106
    v_permlane16_swap_b32 v105, v107
    ds_write_b128 v14, v[104:107] offset:10240
    v_permlane16_swap_b32 v112, v114
    v_permlane16_swap_b32 v113, v115
    ds_write_b128 v14, v[112:115] offset:11264
    v_cvt_pk_bf16_f32 v120, v120, v121
    v_cvt_pk_bf16_f32 v121, v122, v123
    v_cvt_pk_bf16_f32 v122, v124, v125
    v_cvt_pk_bf16_f32 v123, v126, v127
    v_cvt_pk_bf16_f32 v128, v128, v129
    v_cvt_pk_bf16_f32 v129, v130, v131
    v_cvt_pk_bf16_f32 v130, v132, v133
    v_cvt_pk_bf16_f32 v131, v134, v135
    v_cvt_pk_bf16_f32 v136, v136, v137
    v_cvt_pk_bf16_f32 v137, v138, v139
    v_cvt_pk_bf16_f32 v138, v140, v141
    v_cvt_pk_bf16_f32 v139, v142, v143
    v_cvt_pk_bf16_f32 v144, v144, v145
    v_cvt_pk_bf16_f32 v145, v146, v147
    v_cvt_pk_bf16_f32 v146, v148, v149
    v_cvt_pk_bf16_f32 v147, v150, v151
    v_permlane16_swap_b32 v120, v122
    v_permlane16_swap_b32 v121, v123
    ds_write_b128 v14, v[120:123] offset:12288
    v_permlane16_swap_b32 v128, v130
    v_permlane16_swap_b32 v129, v131
    ds_write_b128 v14, v[128:131] offset:13312
    v_permlane16_swap_b32 v136, v138
    v_permlane16_swap_b32 v137, v139
    ds_write_b128 v14, v[136:139] offset:14336
    v_permlane16_swap_b32 v144, v146
    v_permlane16_swap_b32 v145, v147
    ds_write_b128 v14, v[144:147] offset:15360
    v_bfe_u32 v28, v0, 2, 2
    v_lshlrev_b32 v28, 3, v28
    v_and_b32 v29, 3, v0
    v_add_u32 v28, v28, v29
    v_lshrrev_b32 v29, 4, v0
    v_lshlrev_b32 v29, 9, v29
    v_lshl_add_u32 v28, v28, 4, v29
    s_lshl_b32 s40, s3, 20
    s_lshl_b32 s41, s7, 12
    s_add_u32 s40, s40, s41
    s_add_u32 s40, s40, 0
    buffer_load_dwordx4 v[192:195], v28, s[8:11], s40 offen offset:0 sc1
    buffer_load_dwordx4 v[208:211], v28, s[8:11], s40 offen offset:64 sc1
    buffer_load_dwordx4 v[240:243], v28, s[8:11], s40 offen offset:2048 sc1
    buffer_load_dwordx4 v[244:247], v28, s[8:11], s40 offen offset:2112 sc1
    s_add_u32 s40, s40, 0x40000
    buffer_load_dwordx4 v[196:199], v28, s[8:11], s40 offen offset:0 sc1
    buffer_load_dwordx4 v[212:215], v28, s[8:11], s40 offen offset:64 sc1
    buffer_load_dwordx4 v[248:251], v28, s[8:11], s40 offen offset:2048 sc1
    buffer_load_dwordx4 v[252:255], v28, s[8:11], s40 offen offset:2112 sc1
    s_add_u32 s40, s40, 0x40000
    buffer_load_dwordx4 v[200:203], v28, s[8:11], s40 offen offset:0 sc1
    buffer_load_dwordx4 v[216:219], v28, s[8:11], s40 offen offset:64 sc1
    buffer_load_dwordx4 v[224:227], v28, s[8:11], s40 offen offset:2048 sc1
    buffer_load_dwordx4 v[228:231], v28, s[8:11], s40 offen offset:2112 sc1
    s_add_u32 s40, s40, 0x40000
    buffer_load_dwordx4 v[204:207], v28, s[8:11], s40 offen offset:0 sc1
    buffer_load_dwordx4 v[220:223], v28, s[8:11], s40 offen offset:64 sc1
    buffer_load_dwordx4 v[232:235], v28, s[8:11], s40 offen offset:2048 sc1
    buffer_load_dwordx4 v[236:239], v28, s[8:11], s40 offen offset:2112 sc1
    s_lshr_b32 s53, s34, 2
    s_lshl_b32 s53, s53, 16
    s_and_b32 s40, s34, 3
    s_lshl_b32 s40, s40, 12
    s_add_u32 s53, s53, s40
    s_mov_b32 s54, 2
B_QA_S:
    s_mov_b32 s47, s54
    s_waitcnt lgkmcnt(0)
    s_barrier
B_QA_L:
    v_and_b32 v1, 15, v0
    v_lshrrev_b32 v2, 4, v0
    v_lshlrev_b32 v3, 4, v2
    v_bfe_u32 v4, v0, 2, 2
    v_lshlrev_b32 v4, 3, v4
    v_and_b32 v5, 3, v0
    v_add_u32 v4, v4, v5
    v_lshlrev_b32 v5, 9, v2
    v_lshl_add_u32 v5, v1, 4, v5
    v_and_b32 v7, 7, v0
    v_lshlrev_b32 v7, 4, v7
    v_lshl_add_u32 v7, v2, 7, v7
    v_and_b32 v13, 1, v2
    v_lshlrev_b32 v13, 3, v13
    v_lshl_add_u32 v13, v4, 4, v13
    v_lshrrev_b32 v6, 1, v2
    v_and_b32 v12, 1, v2
    v_lshl_or_b32 v6, v12, 1, v6
    v_lshl_add_u32 v6, v6, 4, v1
    v_lshlrev_b32 v6, 4, v6
    v_add_u32 v6, s53, v6
    ds_read_b128 v[16:19], v6 offset:0
    ds_read_b128 v[20:23], v6 offset:1024
    ds_read_b128 v[24:27], v6 offset:16384
    ds_read_b128 v[28:31], v6 offset:17408
    ds_read_b128 v[32:35], v6 offset:2048
    ds_read_b128 v[36:39], v6 offset:3072
    ds_read_b128 v[40:43], v6 offset:18432
    ds_read_b128 v[44:47], v6 offset:19456
    s_lshl_b32 s42, s3, 18
    s_lshl_b32 s40, s7, 10
    s_add_u32 s42, s42, s40
    s_add_u32 s42, s42, 67108864
    s_lshl_b32 s43, s7, 18
    s_lshl_b32 s40, s3, 13
    s_add_u32 s43, s43, s40
    s_add_u32 s43, s43, 50331648
    s_mov_b32 s48, 0x3e0293ee
    v_mov_b32 v180, 0x3f803f80
    v_mov_b32 v181, 0x3f803f80
    v_mov_b32 v182, 0x3f803f80
    v_mov_b32 v183, 0x3f803f80
    v_lshlrev_b32 v14, 3, v2
    v_sub_u32 v14, v1, v14
    v_mov_b32 v15, 0xff800000
    s_cmp_lg_u32 s54, s47
    s_cbranch_scc1 A2_W2
    s_waitcnt vmcnt(0)
A2_W2:
    s_waitcnt vmcnt(8) lgkmcnt(0)
    v_mfma_f32_16x16x32_bf16 v[80:83], v[192:195], v[16:19], 0
    v_mfma_f32_16x16x32_bf16 v[84:87], v[208:211], v[16:19], 0
    v_mfma_f32_16x16x32_bf16 v[92:95], v[192:195], v[32:35], 0
    v_mfma_f32_16x16x32_bf16 v[96:99], v[208:211], v[32:35], 0
    v_mfma_f32_16x16x32_bf16 v[80:83], v[196:199], v[20:23], v[80:83]
    v_mfma_f32_16x16x32_bf16 v[84:87], v[212:215], v[20:23], v[84:87]
    v_mfma_f32_16x16x32_bf16 v[92:95], v[196:199], v[36:39], v[92:95]
    v_mfma_f32_16x16x32_bf16 v[96:99], v[212:215], v[36:39], v[96:99]
    v_mfma_f32_16x16x32_bf16 v[80:83], v[200:203], v[24:27], v[80:83]
    v_mfma_f32_16x16x32_bf16 v[84:87], v[216:219], v[24:27], v[84:87]
    v_mfma_f32_16x16x32_bf16 v[92:95], v[200:203], v[40:43], v[92:95]
    v_mfma_f32_16x16x32_bf16 v[96:99], v[216:219], v[40:43], v[96:99]
    v_mfma_f32_16x16x32_bf16 v[80:83], v[204:207], v[28:31], v[80:83]
    v_mfma_f32_16x16x32_bf16 v[84:87], v[220:223], v[28:31], v[84:87]
    v_mfma_f32_16x16x32_bf16 v[92:95], v[204:207], v[44:47], v[92:95]
    v_mfma_f32_16x16x32_bf16 v[96:99], v[220:223], v[44:47], v[96:99]
    s_lshr_b32 s45, s3, 3
    s_lshl_b32 s45, s45, 7
    s_add_u32 s46, s7, 1
    s_lshl_b32 s46, s46, 5
    s_cmp_ge_u32 s7, 63
    s_cselect_b32 s46, 32, s46
    s_cselect_b32 s50, 512, 0
    s_add_u32 s45, s45, s50
    s_add_u32 s45, s45, 98569216
    s_mov_b32 s49, 0
    s_cmp_lg_u32 s54, s47
    s_cbranch_scc1 A2_E1
    buffer_load_dword v12, off, s[8:11], s45 sc1
    s_waitcnt vmcnt(0)
    v_cmp_le_u32 vcc, s46, v12
    s_cbranch_vccz A2_E0
A2_E1:
    buffer_load_dwordx4 v[48:51], v7, s[8:11], s42 offen sc1
    buffer_load_dwordx2 v[72:73], v13, s[8:11], s42 offen offset:512 sc1
    buffer_load_dwordx2 v[74:75], v13, s[8:11], s42 offen offset:576 sc1
    s_add_u32 s42, s42, 0x10000
    buffer_load_dwordx4 v[52:55], v7, s[8:11], s42 offen sc1
    buffer_load_dwordx2 v[76:77], v13, s[8:11], s42 offen offset:512 sc1
    buffer_load_dwordx2 v[78:79], v13, s[8:11], s42 offen offset:576 sc1
    s_add_u32 s42, s42, 0x10000
    buffer_load_dwordx4 v[56:59], v7, s[8:11], s42 offen sc1
    buffer_load_dwordx2 v[64:65], v13, s[8:11], s42 offen offset:512 sc1
    buffer_load_dwordx2 v[66:67], v13, s[8:11], s42 offen offset:576 sc1
    s_add_u32 s42, s42, 0x10000
    buffer_load_dwordx4 v[60:63], v7, s[8:11], s42 offen sc1
    buffer_load_dwordx2 v[68:69], v13, s[8:11], s42 offen offset:512 sc1
    buffer_load_dwordx2 v[70:71], v13, s[8:11], s42 offen offset:576 sc1
    s_cmp_eq_u32 s54, 1
    s_cbranch_scc1 A2_NKa
    v_bfe_u32 v10, v0, 2, 2
    v_lshlrev_b32 v10, 3, v10
    v_and_b32 v11, 3, v0
    v_add_u32 v10, v10, v11
    v_lshrrev_b32 v11, 4, v0
    v_lshlrev_b32 v11, 9, v11
    v_lshl_add_u32 v10, v10, 4, v11
    s_lshl_b32 s40, s3, 20
    s_lshl_b32 s41, s7, 12
    s_add_u32 s40, s40, s41
    s_add_u32 s40, s40, 1048576
    buffer_load_dwordx4 v[192:195], v10, s[8:11], s40 offen offset:0 sc1
    buffer_load_dwordx4 v[208:211], v10, s[8:11], s40 offen offset:64 sc1
    s_add_u32 s40, s40, 0x40000
    buffer_load_dwordx4 v[196:199], v10, s[8:11], s40 offen offset:0 sc1
    buffer_load_dwordx4 v[212:215], v10, s[8:11], s40 offen offset:64 sc1
    s_add_u32 s40, s40, 0x40000
    buffer_load_dwordx4 v[200:203], v10, s[8:11], s40 offen offset:0 sc1
    buffer_load_dwordx4 v[216:219], v10, s[8:11], s40 offen offset:64 sc1
    s_add_u32 s40, s40, 0x40000
    buffer_load_dwordx4 v[204:207], v10, s[8:11], s40 offen offset:0 sc1
    buffer_load_dwordx4 v[220:223], v10, s[8:11], s40 offen offset:64 sc1
A2_NKa:
    s_mov_b32 s49, 1
A2_E0:
    v_cmp_le_i32 vcc, 0, v14
    s_nop 1
    v_cndmask_b32 v80, v15, v80, vcc
    v_cmp_le_i32 vcc, 1, v14
    s_nop 1
    v_cndmask_b32 v81, v15, v81, vcc
    v_cmp_le_i32 vcc, 2, v14
    s_nop 1
    v_cndmask_b32 v82, v15, v82, vcc
    v_cmp_le_i32 vcc, 3, v14
    s_nop 1
    v_cndmask_b32 v83, v15, v83, vcc
    v_cmp_le_i32 vcc, 4, v14
    s_nop 1
    v_cndmask_b32 v84, v15, v84, vcc
    v_cmp_le_i32 vcc, 5, v14
    s_nop 1
    v_cndmask_b32 v85, v15, v85, vcc
    v_cmp_le_i32 vcc, 6, v14
    s_nop 1
    v_cndmask_b32 v86, v15, v86, vcc
    v_cmp_le_i32 vcc, 7, v14
    s_nop 1
    v_cndmask_b32 v87, v15, v87, vcc
    v_max3_f32 v2, v80, v81, v82
    v_max3_f32 v2, v2, v83, v84
    v_max3_f32 v2, v2, v85, v86
    v_max_f32 v2, v2, v87
    v_mov_b32 v8, v2
    s_nop 1
    v_permlane16_swap_b32 v2, v8
    v_max_f32 v2, v2, v8
    v_mov_b32 v8, v2
    s_nop 1
    v_permlane32_swap_b32 v2, v8
    v_max_f32 v2, v2, v8
    v_mul_f32 v2, s48, v2
    v_fma_f32 v80, v80, s48, -v2
    v_fma_f32 v81, v81, s48, -v2
    v_fma_f32 v82, v82, s48, -v2
    v_fma_f32 v83, v83, s48, -v2
    v_fma_f32 v84, v84, s48, -v2
    v_fma_f32 v85, v85, s48, -v2
    v_fma_f32 v86, v86, s48, -v2
    v_fma_f32 v87, v87, s48, -v2
    v_exp_f32 v80, v80
    v_exp_f32 v81, v81
    v_exp_f32 v82, v82
    v_exp_f32 v83, v83
    v_exp_f32 v84, v84
    v_exp_f32 v85, v85
    v_exp_f32 v86, v86
    v_exp_f32 v87, v87
    v_cvt_pk_bf16_f32 v168, v80, v81
    v_cvt_pk_bf16_f32 v169, v82, v83
    v_cvt_pk_bf16_f32 v170, v84, v85
    v_cvt_pk_bf16_f32 v171, v86, v87
    s_nop 1
    v_mfma_f32_16x16x32_bf16 v[184:187], v[180:183], v[168:171], 0
    v_mfma_f32_16x16x32_bf16 v[104:107], v[224:227], v[168:171], 0
    v_mfma_f32_16x16x32_bf16 v[108:111], v[228:231], v[168:171], 0
    v_mfma_f32_16x16x32_bf16 v[112:115], v[232:235], v[168:171], 0
    v_mfma_f32_16x16x32_bf16 v[116:119], v[236:239], v[168:171], 0
    v_mfma_f32_16x16x32_bf16 v[120:123], v[240:243], v[168:171], 0
    v_mfma_f32_16x16x32_bf16 v[124:127], v[244:247], v[168:171], 0
    v_mfma_f32_16x16x32_bf16 v[128:131], v[248:251], v[168:171], 0
    v_mfma_f32_16x16x32_bf16 v[132:135], v[252:255], v[168:171], 0
    v_cmp_le_i32 vcc, -16, v14
    s_nop 1
    v_cndmask_b32 v92, v15, v92, vcc
    v_cmp_le_i32 vcc, -15, v14
    s_nop 1
    v_cndmask_b32 v93, v15, v93, vcc
    v_cmp_le_i32 vcc, -14, v14
    s_nop 1
    v_cndmask_b32 v94, v15, v94, vcc
    v_cmp_le_i32 vcc, -13, v14
    s_nop 1
    v_cndmask_b32 v95, v15, v95, vcc
    v_cmp_le_i32 vcc, -12, v14
    s_nop 1
    v_cndmask_b32 v96, v15, v96, vcc
    v_cmp_le_i32 vcc, -11, v14
    s_nop 1
    v_cndmask_b32 v97, v15, v97, vcc
    v_cmp_le_i32 vcc, -10, v14
    s_nop 1
    v_cndmask_b32 v98, v15, v98, vcc
    v_cmp_le_i32 vcc, -9, v14
    s_nop 1
    v_cndmask_b32 v99, v15, v99, vcc
    v_max3_f32 v3, v92, v93, v94
    v_max3_f32 v3, v3, v95, v96
    v_max3_f32 v3, v3, v97, v98
    v_max_f32 v3, v3, v99
    v_mov_b32 v8, v3
    s_nop 1
    v_permlane16_swap_b32 v3, v8
    v_max_f32 v3, v3, v8
    v_mov_b32 v8, v3
    s_nop 1
    v_permlane32_swap_b32 v3, v8
    v_max_f32 v3, v3, v8
    v_mul_f32 v3, s48, v3
    v_fma_f32 v92, v92, s48, -v3
    v_fma_f32 v93, v93, s48, -v3
    v_fma_f32 v94, v94, s48, -v3
    v_fma_f32 v95, v95, s48, -v3
    v_fma_f32 v96, v96, s48, -v3
    v_fma_f32 v97, v97, s48, -v3
    v_fma_f32 v98, v98, s48, -v3
    v_fma_f32 v99, v99, s48, -v3
    v_exp_f32 v92, v92
    v_exp_f32 v93, v93
    v_exp_f32 v94, v94
    v_exp_f32 v95, v95
    v_exp_f32 v96, v96
    v_exp_f32 v97, v97
    v_exp_f32 v98, v98
    v_exp_f32 v99, v99
    v_cvt_pk_bf16_f32 v172, v92, v93
    v_cvt_pk_bf16_f32 v173, v94, v95
    v_cvt_pk_bf16_f32 v174, v96, v97
    v_cvt_pk_bf16_f32 v175, v98, v99
    s_nop 1
    v_mfma_f32_16x16x32_bf16 v[188:191], v[180:183], v[172:175], 0
    v_mfma_f32_16x16x32_bf16 v[136:139], v[224:227], v[172:175], 0
    v_mfma_f32_16x16x32_bf16 v[140:143], v[228:231], v[172:175], 0
    v_mfma_f32_16x16x32_bf16 v[144:147], v[232:235], v[172:175], 0
    v_mfma_f32_16x16x32_bf16 v[148:151], v[236:239], v[172:175], 0
    v_mfma_f32_16x16x32_bf16 v[152:155], v[240:243], v[172:175], 0
    v_mfma_f32_16x16x32_bf16 v[156:159], v[244:247], v[172:175], 0
    v_mfma_f32_16x16x32_bf16 v[160:163], v[248:251], v[172:175], 0
    v_mfma_f32_16x16x32_bf16 v[164:167], v[252:255], v[172:175], 0
    s_cmp_eq_u32 s49, 1
    s_cbranch_scc1 A2_HAVE
    s_mov_b32 s50, 0
A2_W:
    buffer_load_dword v12, off, s[8:11], s45 sc1
    s_add_u32 s50, s50, 1
    s_cmp_gt_u32 s50, 60000
    s_cbranch_scc1 C_DONE
    s_waitcnt vmcnt(0)
    v_cmp_le_u32 vcc, s46, v12
    s_cbranch_vccnz A2_GO
    s_sleep 4
    s_cmp_ge_u32 s7, 62
    s_cbranch_scc1 A2_W
    s_sleep 10
    s_branch A2_W
A2_GO:
    buffer_load_dwordx4 v[48:51], v7, s[8:11], s42 offen sc1
    buffer_load_dwordx2 v[72:73], v13, s[8:11], s42 offen offset:512 sc1
    buffer_load_dwordx2 v[74:75], v13, s[8:11], s42 offen offset:576 sc1
    s_add_u32 s42, s42, 0x10000
    buffer_load_dwordx4 v[52:55], v7, s[8:11], s42 offen sc1
    buffer_load_dwordx2 v[76:77], v13, s[8:11], s42 offen offset:512 sc1
    buffer_load_dwordx2 v[78:79], v13, s[8:11], s42 offen offset:576 sc1
    s_add_u32 s42, s42, 0x10000
    buffer_load_dwordx4 v[56:59], v7, s[8:11], s42 offen sc1
    buffer_load_dwordx2 v[64:65], v13, s[8:11], s42 offen offset:512 sc1
    buffer_load_dwordx2 v[66:67], v13, s[8:11], s42 offen offset:576 sc1
    s_add_u32 s42, s42, 0x10000
    buffer_load_dwordx4 v[60:63], v7, s[8:11], s42 offen sc1
    buffer_load_dwordx2 v[68:69], v13, s[8:11], s42 offen offset:512 sc1
    buffer_load_dwordx2 v[70:71], v13, s[8:11], s42 offen offset:576 sc1
    s_cmp_eq_u32 s54, 1
    s_cbranch_scc1 A2_NKb
    v_bfe_u32 v10, v0, 2, 2
    v_lshlrev_b32 v10, 3, v10
    v_and_b32 v11, 3, v0
    v_add_u32 v10, v10, v11
    v_lshrrev_b32 v11, 4, v0
    v_lshlrev_b32 v11, 9, v11
    v_lshl_add_u32 v10, v10, 4, v11
    s_lshl_b32 s40, s3, 20
    s_lshl_b32 s41, s7, 12
    s_add_u32 s40, s40, s41
    s_add_u32 s40, s40, 1048576
    buffer_load_dwordx4 v[192:195], v10, s[8:11], s40 offen offset:0 sc1
    buffer_load_dwordx4 v[208:211], v10, s[8:11], s40 offen offset:64 sc1
    s_add_u32 s40, s40, 0x40000
    buffer_load_dwordx4 v[196:199], v10, s[8:11], s40 offen offset:0 sc1
    buffer_load_dwordx4 v[212:215], v10, s[8:11], s40 offen offset:64 sc1
    s_add_u32 s40, s40, 0x40000
    buffer_load_dwordx4 v[200:203], v10, s[8:11], s40 offen offset:0 sc1
    buffer_load_dwordx4 v[216:219], v10, s[8:11], s40 offen offset:64 sc1
    s_add_u32 s40, s40, 0x40000
    buffer_load_dwordx4 v[204:207], v10, s[8:11], s40 offen offset:0 sc1
    buffer_load_dwordx4 v[220:223], v10, s[8:11], s40 offen offset:64 sc1
A2_NKb:
A2_HAVE:
    s_cmp_lg_u32 s54, 1
    s_cbranch_scc1 A2_W8
    s_waitcnt vmcnt(0)
A2_W8:
    s_waitcnt vmcnt(8)
    v_mfma_f32_16x16x32_bf16 v[88:91], v[48:51], v[16:19], 0
    v_mfma_f32_16x16x32_bf16 v[100:103], v[48:51], v[32:35], 0
    v_mfma_f32_16x16x32_bf16 v[88:91], v[52:55], v[20:23], v[88:91]
    v_mfma_f32_16x16x32_bf16 v[100:103], v[52:55], v[36:39], v[100:103]
    v_mfma_f32_16x16x32_bf16 v[88:91], v[56:59], v[24:27], v[88:91]
    v_mfma_f32_16x16x32_bf16 v[100:103], v[56:59], v[40:43], v[100:103]
    v_mfma_f32_16x16x32_bf16 v[88:91], v[60:63], v[28:31], v[88:91]
    v_mfma_f32_16x16x32_bf16 v[100:103], v[60:63], v[44:47], v[100:103]
    s_mov_b32 s50, -1
    s_mov_b32 s51, 0
    s_nop 4
    v_fma_f32 v88, v88, s48, -v2
    v_fma_f32 v89, v89, s48, -v2
    v_fma_f32 v90, v90, s48, -v2
    v_fma_f32 v91, v91, s48, -v2
    v_cndmask_b32 v88, v15, v88, s[50:51]
    v_cndmask_b32 v89, v15, v89, s[50:51]
    v_cndmask_b32 v90, v15, v90, s[50:51]
    v_cndmask_b32 v91, v15, v91, s[50:51]
    v_max3_f32 v2, v88, v89, v90
    v_max3_f32 v2, v2, v91, 0
    v_cmp_lt_f32 vcc, 0x41f00000, v2
    s_cbranch_vccz A2_SAFE0
    v_mov_b32 v8, v2
    s_nop 1
    v_permlane16_swap_b32 v2, v8
    v_max_f32 v2, v2, v8
    v_mov_b32 v8, v2
    s_nop 1
    v_permlane32_swap_b32 v2, v8
    v_max_f32 v2, v2, v8
    v_sub_f32 v88, v88, v2
    v_sub_f32 v89, v89, v2
    v_sub_f32 v90, v90, v2
    v_sub_f32 v91, v91, v2
    v_exp_f32 v2, -v2
    s_nop 0
    v_mul_f32 v104, v104, v2
    v_mul_f32 v105, v105, v2
    v_mul_f32 v106, v106, v2
    v_mul_f32 v107, v107, v2
    v_mul_f32 v108, v108, v2
    v_mul_f32 v109, v109, v2
    v_mul_f32 v110, v110, v2
    v_mul_f32 v111, v111, v2
    v_mul_f32 v112, v112, v2
    v_mul_f32 v113, v113, v2
    v_mul_f32 v114, v114, v2
    v_mul_f32 v115, v115, v2
    v_mul_f32 v116, v116, v2
    v_mul_f32 v117, v117, v2
    v_mul_f32 v118, v118, v2
    v_mul_f32 v119, v119, v2
    v_mul_f32 v120, v120, v2
    v_mul_f32 v121, v121, v2
    v_mul_f32 v122, v122, v2
    v_mul_f32 v123, v123, v2
    v_mul_f32 v124, v124, v2
    v_mul_f32 v125, v125, v2
    v_mul_f32 v126, v126, v2
    v_mul_f32 v127, v127, v2
    v_mul_f32 v128, v128, v2
    v_mul_f32 v129, v129, v2
    v_mul_f32 v130, v130, v2
    v_mul_f32 v131, v131, v2
    v_mul_f32 v132, v132, v2
    v_mul_f32 v133, v133, v2
    v_mul_f32 v134, v134, v2
    v_mul_f32 v135, v135, v2
    v_mul_f32 v184, v184, v2
    v_mul_f32 v185, v185, v2
    v_mul_f32 v186, v186, v2
    v_mul_f32 v187, v187, v2
A2_SAFE0:
    v_exp_f32 v88, v88
    v_exp_f32 v89, v89
    v_exp_f32 v90, v90
    v_exp_f32 v91, v91
    v_cvt_pk_bf16_f32 v176, v88, v89
    v_cvt_pk_bf16_f32 v177, v90, v91
    s_nop 1
    v_mfma_f32_16x16x16_bf16 v[184:187], v[180:181], v[176:177], v[184:187]
    v_mfma_f32_16x16x16_bf16 v[104:107], v[64:65], v[176:177], v[104:107]
    v_mfma_f32_16x16x16_bf16 v[108:111], v[66:67], v[176:177], v[108:111]
    v_mfma_f32_16x16x16_bf16 v[112:115], v[68:69], v[176:177], v[112:115]
    v_mfma_f32_16x16x16_bf16 v[116:119], v[70:71], v[176:177], v[116:119]
    v_mfma_f32_16x16x16_bf16 v[120:123], v[72:73], v[176:177], v[120:123]
    v_mfma_f32_16x16x16_bf16 v[124:127], v[74:75], v[176:177], v[124:127]
    v_mfma_f32_16x16x16_bf16 v[128:131], v[76:77], v[176:177], v[128:131]
    v_mfma_f32_16x16x16_bf16 v[132:135], v[78:79], v[176:177], v[132:135]
    v_fma_f32 v100, v100, s48, -v3
    v_fma_f32 v101, v101, s48, -v3
    v_fma_f32 v102, v102, s48, -v3
    v_fma_f32 v103, v103, s48, -v3
    v_cndmask_b32 v100, v15, v100, s[50:51]
    v_cndmask_b32 v101, v15, v101, s[50:51]
    v_cndmask_b32 v102, v15, v102, s[50:51]
    v_cndmask_b32 v103, v15, v103, s[50:51]
    v_max3_f32 v3, v100, v101, v102
    v_max3_f32 v3, v3, v103, 0
    v_cmp_lt_f32 vcc, 0x41f00000, v3
    s_cbranch_vccz A2_SAFE1
    v_mov_b32 v8, v3
    s_nop 1
    v_permlane16_swap_b32 v3, v8
    v_max_f32 v3, v3, v8
    v_mov_b32 v8, v3
    s_nop 1
    v_permlane32_swap_b32 v3, v8
    v_max_f32 v3, v3, v8
    v_sub_f32 v100, v100, v3
    v_sub_f32 v101, v101, v3
    v_sub_f32 v102, v102, v3
    v_sub_f32 v103, v103, v3
    v_exp_f32 v3, -v3
    s_nop 0
    v_mul_f32 v136, v136, v3
    v_mul_f32 v137, v137, v3
    v_mul_f32 v138, v138, v3
    v_mul_f32 v139, v139, v3
    v_mul_f32 v140, v140, v3
    v_mul_f32 v141, v141, v3
    v_mul_f32 v142, v142, v3
    v_mul_f32 v143, v143, v3
    v_mul_f32 v144, v144, v3
    v_mul_f32 v145, v145, v3
    v_mul_f32 v146, v146, v3
    v_mul_f32 v147, v147, v3
    v_mul_f32 v148, v148, v3
    v_mul_f32 v149, v149, v3
    v_mul_f32 v150, v150, v3
    v_mul_f32 v151, v151, v3
    v_mul_f32 v152, v152, v3
    v_mul_f32 v153, v153, v3
    v_mul_f32 v154, v154, v3
    v_mul_f32 v155, v155, v3
    v_mul_f32 v156, v156, v3
    v_mul_f32 v157, v157, v3
    v_mul_f32 v158, v158, v3
    v_mul_f32 v159, v159, v3
    v_mul_f32 v160, v160, v3
    v_mul_f32 v161, v161, v3
    v_mul_f32 v162, v162, v3
    v_mul_f32 v163, v163, v3
    v_mul_f32 v164, v164, v3
    v_mul_f32 v165, v165, v3
    v_mul_f32 v166, v166, v3
    v_mul_f32 v167, v167, v3
    v_mul_f32 v188, v188, v3
    v_mul_f32 v189, v189, v3
    v_mul_f32 v190, v190, v3
    v_mul_f32 v191, v191, v3
A2_SAFE1:
    v_exp_f32 v100, v100
    v_exp_f32 v101, v101
    v_exp_f32 v102, v102
    v_exp_f32 v103, v103
    v_cvt_pk_bf16_f32 v178, v100, v101
    v_cvt_pk_bf16_f32 v179, v102, v103
    s_nop 1
    v_mfma_f32_16x16x16_bf16 v[188:191], v[180:181], v[178:179], v[188:191]
    v_mfma_f32_16x16x16_bf16 v[136:139], v[64:65], v[178:179], v[136:139]
    v_mfma_f32_16x16x16_bf16 v[140:143], v[66:67], v[178:179], v[140:143]
    v_mfma_f32_16x16x16_bf16 v[144:147], v[68:69], v[178:179], v[144:147]
    v_mfma_f32_16x16x16_bf16 v[148:151], v[70:71], v[178:179], v[148:151]
    v_mfma_f32_16x16x16_bf16 v[152:155], v[72:73], v[178:179], v[152:155]
    v_mfma_f32_16x16x16_bf16 v[156:159], v[74:75], v[178:179], v[156:159]
    v_mfma_f32_16x16x16_bf16 v[160:163], v[76:77], v[178:179], v[160:163]
    v_mfma_f32_16x16x16_bf16 v[164:167], v[78:79], v[178:179], v[164:167]
    s_cmp_eq_u32 s54, 1
    s_cbranch_scc1 A2_NV
    v_bfe_u32 v10, v0, 2, 2
    v_lshlrev_b32 v10, 3, v10
    v_and_b32 v11, 3, v0
    v_add_u32 v10, v10, v11
    v_lshrrev_b32 v11, 4, v0
    v_lshlrev_b32 v11, 9, v11
    v_lshl_add_u32 v10, v10, 4, v11
    s_lshl_b32 s40, s3, 20
    s_lshl_b32 s41, s7, 12
    s_add_u32 s40, s40, s41
    s_add_u32 s40, s40, 1048576
    buffer_load_dwordx4 v[240:243], v10, s[8:11], s40 offen offset:2048 sc1
    buffer_load_dwordx4 v[244:247], v10, s[8:11], s40 offen offset:2112 sc1
    s_add_u32 s40, s40, 0x40000
    buffer_load_dwordx4 v[248:251], v10, s[8:11], s40 offen offset:2048 sc1
    buffer_load_dwordx4 v[252:255], v10, s[8:11], s40 offen offset:2112 sc1
    s_add_u32 s40, s40, 0x40000
    buffer_load_dwordx4 v[224:227], v10, s[8:11], s40 offen offset:2048 sc1
    buffer_load_dwordx4 v[228:231], v10, s[8:11], s40 offen offset:2112 sc1
    s_add_u32 s40, s40, 0x40000
    buffer_load_dwordx4 v[232:235], v10, s[8:11], s40 offen offset:2048 sc1
    buffer_load_dwordx4 v[236:239], v10, s[8:11], s40 offen offset:2112 sc1
A2_NV:
    s_add_u32 s40, s43, 4096
    v_rcp_f32 v8, v184
    s_nop 0
    v_mul_f32 v104, v104, v8
    v_mul_f32 v105, v105, v8
    v_mul_f32 v106, v106, v8
    v_mul_f32 v107, v107, v8
    v_mul_f32 v108, v108, v8
    v_mul_f32 v109, v109, v8
    v_mul_f32 v110, v110, v8
    v_mul_f32 v111, v111, v8
    v_mul_f32 v112, v112, v8
    v_mul_f32 v113, v113, v8
    v_mul_f32 v114, v114, v8
    v_mul_f32 v115, v115, v8
    v_mul_f32 v116, v116, v8
    v_mul_f32 v117, v117, v8
    v_mul_f32 v118, v118, v8
    v_mul_f32 v119, v119, v8
    v_mul_f32 v120, v120, v8
    v_mul_f32 v121, v121, v8
    v_mul_f32 v122, v122, v8
    v_mul_f32 v123, v123, v8
    v_mul_f32 v124, v124, v8
    v_mul_f32 v125, v125, v8
    v_mul_f32 v126, v126, v8
    v_mul_f32 v127, v127, v8
    v_mul_f32 v128, v128, v8
    v_mul_f32 v129, v129, v8
    v_mul_f32 v130, v130, v8
    v_mul_f32 v131, v131, v8
    v_mul_f32 v132, v132, v8
    v_mul_f32 v133, v133, v8
    v_mul_f32 v134, v134, v8
    v_mul_f32 v135, v135, v8
    v_cvt_pk_bf16_f32 v16, v104, v105
    v_cvt_pk_bf16_f32 v17, v106, v107
    v_cvt_pk_bf16_f32 v18, v108, v109
    v_cvt_pk_bf16_f32 v19, v110, v111
    v_cvt_pk_bf16_f32 v20, v112, v113
    v_cvt_pk_bf16_f32 v21, v114, v115
    v_cvt_pk_bf16_f32 v22, v116, v117
    v_cvt_pk_bf16_f32 v23, v118, v119
    v_cvt_pk_bf16_f32 v24, v120, v121
    v_cvt_pk_bf16_f32 v25, v122, v123
    v_cvt_pk_bf16_f32 v26, v124, v125
    v_cvt_pk_bf16_f32 v27, v126, v127
    v_cvt_pk_bf16_f32 v28, v128, v129
    v_cvt_pk_bf16_f32 v29, v130, v131
    v_cvt_pk_bf16_f32 v30, v132, v133
    v_cvt_pk_bf16_f32 v31, v134, v135
    buffer_store_dwordx4 v[16:19], v5, s[8:11], s43 offen offset:0 sc1
    buffer_store_dwordx4 v[20:23], v5, s[8:11], s43 offen offset:2048 sc1
    buffer_store_dwordx4 v[24:27], v5, s[8:11], s40 offen offset:0 sc1
    buffer_store_dwordx4 v[28:31], v5, s[8:11], s40 offen offset:2048 sc1
    v_rcp_f32 v8, v188
    s_nop 0
    v_mul_f32 v136, v136, v8
    v_mul_f32 v137, v137, v8
    v_mul_f32 v138, v138, v8
    v_mul_f32 v139, v139, v8
    v_mul_f32 v140, v140, v8
    v_mul_f32 v141, v141, v8
    v_mul_f32 v142, v142, v8
    v_mul_f32 v143, v143, v8
    v_mul_f32 v144, v144, v8
    v_mul_f32 v145, v145, v8
    v_mul_f32 v146, v146, v8
    v_mul_f32 v147, v147, v8
    v_mul_f32 v148, v148, v8
    v_mul_f32 v149, v149, v8
    v_mul_f32 v150, v150, v8
    v_mul_f32 v151, v151, v8
    v_mul_f32 v152, v152, v8
    v_mul_f32 v153, v153, v8
    v_mul_f32 v154, v154, v8
    v_mul_f32 v155, v155, v8
    v_mul_f32 v156, v156, v8
    v_mul_f32 v157, v157, v8
    v_mul_f32 v158, v158, v8
    v_mul_f32 v159, v159, v8
    v_mul_f32 v160, v160, v8
    v_mul_f32 v161, v161, v8
    v_mul_f32 v162, v162, v8
    v_mul_f32 v163, v163, v8
    v_mul_f32 v164, v164, v8
    v_mul_f32 v165, v165, v8
    v_mul_f32 v166, v166, v8
    v_mul_f32 v167, v167, v8
    v_cvt_pk_bf16_f32 v32, v136, v137
    v_cvt_pk_bf16_f32 v33, v138, v139
    v_cvt_pk_bf16_f32 v34, v140, v141
    v_cvt_pk_bf16_f32 v35, v142, v143
    v_cvt_pk_bf16_f32 v36, v144, v145
    v_cvt_pk_bf16_f32 v37, v146, v147
    v_cvt_pk_bf16_f32 v38, v148, v149
    v_cvt_pk_bf16_f32 v39, v150, v151
    v_cvt_pk_bf16_f32 v40, v152, v153
    v_cvt_pk_bf16_f32 v41, v154, v155
    v_cvt_pk_bf16_f32 v42, v156, v157
    v_cvt_pk_bf16_f32 v43, v158, v159
    v_cvt_pk_bf16_f32 v44, v160, v161
    v_cvt_pk_bf16_f32 v45, v162, v163
    v_cvt_pk_bf16_f32 v46, v164, v165
    v_cvt_pk_bf16_f32 v47, v166, v167
    buffer_store_dwordx4 v[32:35], v5, s[8:11], s43 offen offset:256 sc1
    buffer_store_dwordx4 v[36:39], v5, s[8:11], s43 offen offset:2304 sc1
    buffer_store_dwordx4 v[40:43], v5, s[8:11], s40 offen offset:256 sc1
    buffer_store_dwordx4 v[44:47], v5, s[8:11], s40 offen offset:2304 sc1
    s_cmp_lg_u32 s54, 1
    s_cbranch_scc1 A2_NS
    s_lshl_b32 s40, s7, 7
    s_add_u32 s40, s40, 98574336
    v_mov_b32 v1, s47
    s_waitcnt vmcnt(0)
    s_mov_b64 exec, 1
    buffer_atomic_add v1, off, s[8:11], s40
    s_mov_b64 exec, -1
A2_NS:
    s_add_u32 s3, s3, 1
    s_add_u32 s53, s53, 0x8000
    s_sub_u32 s54, s54, 1
    s_cmp_lg_u32 s54, 0
    s_cbranch_scc1 B_QA_L
    s_mov_b32 s38, 0
    s_branch B_COLD
A3_ENTRY:
    s_barrier
    s_getpc_b64 s[0:1]
A3_PC:
    s_add_u32 s0, s0, SEGS-A3_PC
    s_addc_u32 s1, s1, 0
    s_lshl_b32 s42, s58, 7
    v_and_b32 v9, 31, v0
    v_lshlrev_b32 v9, 2, v9
    v_add_u32 v9, s42, v9
    global_load_dword v9, v9, s[0:1]
    s_waitcnt vmcnt(0)
    v_readfirstlane_b32 s42, v9
    s_cmp_ge_u32 s42, 64
    s_cbranch_scc1 A3_DONE
    s_lshl_b32 s47, s34, 20
    s_lshl_b32 s48, s57, 6
    s_add_u32 s47, s47, s48
    s_add_u32 s48, s47, 0x80000
    s_mov_b32 s12, s70
    s_and_b32 s13, s71, 0xffff
    s_mov_b32 s14, 0x800000
    s_mov_b32 s15, 0x20000
    v_lshrrev_b32 v4, 2, v0
    s_mov_b32 s45, 2048
    v_mul_lo_u32 v4, v4, s45
    v_and_b32 v6, 3, v0
    v_lshl_add_u32 v4, v6, 4, v4
    s_mov_b32 s46, s47
    buffer_load_dwordx4 v[128:131], v4, s[12:15], s46 offen
    s_add_u32 s46, s46, 32768
    buffer_load_dwordx4 v[132:135], v4, s[12:15], s46 offen
    s_add_u32 s46, s46, 32768
    buffer_load_dwordx4 v[136:139], v4, s[12:15], s46 offen
    s_add_u32 s46, s46, 32768
    buffer_load_dwordx4 v[140:143], v4, s[12:15], s46 offen
    s_add_u32 s46, s46, 32768
    buffer_load_dwordx4 v[144:147], v4, s[12:15], s46 offen
    s_add_u32 s46, s46, 32768
    buffer_load_dwordx4 v[148:151], v4, s[12:15], s46 offen
    s_add_u32 s46, s46, 32768
    buffer_load_dwordx4 v[152:155], v4, s[12:15], s46 offen
    s_add_u32 s46, s46, 32768
    buffer_load_dwordx4 v[156:159], v4, s[12:15], s46 offen
    s_add_u32 s46, s46, 32768
    buffer_load_dwordx4 v[160:163], v4, s[12:15], s46 offen
    s_add_u32 s46, s46, 32768
    buffer_load_dwordx4 v[164:167], v4, s[12:15], s46 offen
    s_add_u32 s46, s46, 32768
    buffer_load_dwordx4 v[168:171], v4, s[12:15], s46 offen
    s_add_u32 s46, s46, 32768
    buffer_load_dwordx4 v[172:175], v4, s[12:15], s46 offen
    s_add_u32 s46, s46, 32768
    buffer_load_dwordx4 v[176:179], v4, s[12:15], s46 offen
    s_add_u32 s46, s46, 32768
    buffer_load_dwordx4 v[180:183], v4, s[12:15], s46 offen
    s_add_u32 s46, s46, 32768
    buffer_load_dwordx4 v[184:187], v4, s[12:15], s46 offen
    s_add_u32 s46, s46, 32768
    buffer_load_dwordx4 v[188:191], v4, s[12:15], s46 offen
    s_mov_b32 s12, s70
    s_and_b32 s13, s71, 0xffff
    s_mov_b32 s14, 0x800000
    s_mov_b32 s15, 0x20000
    v_lshrrev_b32 v4, 2, v0
    s_mov_b32 s45, 2048
    v_mul_lo_u32 v4, v4, s45
    v_and_b32 v6, 3, v0
    v_lshl_add_u32 v4, v6, 4, v4
    s_mov_b32 s46, s48
    buffer_load_dwordx4 v[192:195], v4, s[12:15], s46 offen
    s_add_u32 s46, s46, 32768
    buffer_load_dwordx4 v[196:199], v4, s[12:15], s46 offen
    s_add_u32 s46, s46, 32768
    buffer_load_dwordx4 v[200:203], v4, s[12:15], s46 offen
    s_add_u32 s46, s46, 32768
    buffer_load_dwordx4 v[204:207], v4, s[12:15], s46 offen
    s_add_u32 s46, s46, 32768
    buffer_load_dwordx4 v[208:211], v4, s[12:15], s46 offen
    s_add_u32 s46, s46, 32768
    buffer_load_dwordx4 v[212:215], v4, s[12:15], s46 offen
    s_add_u32 s46, s46, 32768
    buffer_load_dwordx4 v[216:219], v4, s[12:15], s46 offen
    s_add_u32 s46, s46, 32768
    buffer_load_dwordx4 v[220:223], v4, s[12:15], s46 offen
    s_add_u32 s46, s46, 32768
    buffer_load_dwordx4 v[224:227], v4, s[12:15], s46 offen
    s_add_u32 s46, s46, 32768
    buffer_load_dwordx4 v[228:231], v4, s[12:15], s46 offen
    s_add_u32 s46, s46, 32768
    buffer_load_dwordx4 v[232:235], v4, s[12:15], s46 offen
    s_add_u32 s46, s46, 32768
    buffer_load_dwordx4 v[236:239], v4, s[12:15], s46 offen
    s_add_u32 s46, s46, 32768
    buffer_load_dwordx4 v[240:243], v4, s[12:15], s46 offen
    s_add_u32 s46, s46, 32768
    buffer_load_dwordx4 v[244:247], v4, s[12:15], s46 offen
    s_add_u32 s46, s46, 32768
    buffer_load_dwordx4 v[248:251], v4, s[12:15], s46 offen
    s_add_u32 s46, s46, 32768
    buffer_load_dwordx4 v[252:255], v4, s[12:15], s46 offen
    s_lshl_b32 s45, s34, 14
    v_lshlrev_b32 v5, 4, v0
    v_add_u32 v5, s45, v5
    v_lshrrev_b32 v4, 4, v0
    v_lshlrev_b32 v4, 9, v4
    v_bfe_u32 v6, v0, 2, 2
    v_lshl_add_u32 v4, v6, 6, v4
    v_and_b32 v6, 3, v0
    v_lshl_add_u32 v4, v6, 4, v4
    v_add_u32 v4, s45, v4
    s_waitcnt vmcnt(16)
    ds_write_b128 v5, v[128:131] offset:0
    ds_write_b128 v5, v[132:135] offset:1024
    ds_write_b128 v5, v[136:139] offset:2048
    ds_write_b128 v5, v[140:143] offset:3072
    ds_write_b128 v5, v[144:147] offset:4096
    ds_write_b128 v5, v[148:151] offset:5120
    ds_write_b128 v5, v[152:155] offset:6144
    ds_write_b128 v5, v[156:159] offset:7168
    ds_write_b128 v5, v[160:163] offset:8192
    ds_write_b128 v5, v[164:167] offset:9216
    ds_write_b128 v5, v[168:171] offset:10240
    ds_write_b128 v5, v[172:175] offset:11264
    ds_write_b128 v5, v[176:179] offset:12288
    ds_write_b128 v5, v[180:183] offset:13312
    ds_write_b128 v5, v[184:187] offset:14336
    ds_write_b128 v5, v[188:191] offset:15360
    s_waitcnt lgkmcnt(0)
    ds_read_b64_tr_b16 v[128:129], v4 offset:0
    ds_read_b64_tr_b16 v[130:131], v4 offset:256
    ds_read_b64_tr_b16 v[132:133], v4 offset:8
    ds_read_b64_tr_b16 v[134:135], v4 offset:264
    ds_read_b64_tr_b16 v[136:137], v4 offset:2048
    ds_read_b64_tr_b16 v[138:139], v4 offset:2304
    ds_read_b64_tr_b16 v[140:141], v4 offset:2056
    ds_read_b64_tr_b16 v[142:143], v4 offset:2312
    s_waitcnt lgkmcnt(0)
    ds_read_b64_tr_b16 v[144:145], v4 offset:4096
    ds_read_b64_tr_b16 v[146:147], v4 offset:4352
    ds_read_b64_tr_b16 v[148:149], v4 offset:4104
    ds_read_b64_tr_b16 v[150:151], v4 offset:4360
    ds_read_b64_tr_b16 v[152:153], v4 offset:6144
    ds_read_b64_tr_b16 v[154:155], v4 offset:6400
    ds_read_b64_tr_b16 v[156:157], v4 offset:6152
    ds_read_b64_tr_b16 v[158:159], v4 offset:6408
    s_waitcnt lgkmcnt(0)
    ds_read_b64_tr_b16 v[160:161], v4 offset:8192
    ds_read_b64_tr_b16 v[162:163], v4 offset:8448
    ds_read_b64_tr_b16 v[164:165], v4 offset:8200
    ds_read_b64_tr_b16 v[166:167], v4 offset:8456
    ds_read_b64_tr_b16 v[168:169], v4 offset:10240
    ds_read_b64_tr_b16 v[170:171], v4 offset:10496
    ds_read_b64_tr_b16 v[172:173], v4 offset:10248
    ds_read_b64_tr_b16 v[174:175], v4 offset:10504
    s_waitcnt lgkmcnt(0)
    ds_read_b64_tr_b16 v[176:177], v4 offset:12288
    ds_read_b64_tr_b16 v[178:179], v4 offset:12544
    ds_read_b64_tr_b16 v[180:181], v4 offset:12296
    ds_read_b64_tr_b16 v[182:183], v4 offset:12552
    ds_read_b64_tr_b16 v[184:185], v4 offset:14336
    ds_read_b64_tr_b16 v[186:187], v4 offset:14592
    ds_read_b64_tr_b16 v[188:189], v4 offset:14344
    ds_read_b64_tr_b16 v[190:191], v4 offset:14600
    s_waitcnt lgkmcnt(0)
    s_waitcnt vmcnt(0)
    ds_write_b128 v5, v[192:195] offset:0
    ds_write_b128 v5, v[196:199] offset:1024
    ds_write_b128 v5, v[200:203] offset:2048
    ds_write_b128 v5, v[204:207] offset:3072
    ds_write_b128 v5, v[208:211] offset:4096
    ds_write_b128 v5, v[212:215] offset:5120
    ds_write_b128 v5, v[216:219] offset:6144
    ds_write_b128 v5, v[220:223] offset:7168
    ds_write_b128 v5, v[224:227] offset:8192
    ds_write_b128 v5, v[228:231] offset:9216
    ds_write_b128 v5, v[232:235] offset:10240
    ds_write_b128 v5, v[236:239] offset:11264
    ds_write_b128 v5, v[240:243] offset:12288
    ds_write_b128 v5, v[244:247] offset:13312
    ds_write_b128 v5, v[248:251] offset:14336
    ds_write_b128 v5, v[252:255] offset:15360
    s_waitcnt lgkmcnt(0)
    ds_read_b64_tr_b16 v[192:193], v4 offset:0
    ds_read_b64_tr_b16 v[194:195], v4 offset:256
    ds_read_b64_tr_b16 v[196:197], v4 offset:8
    ds_read_b64_tr_b16 v[198:199], v4 offset:264
    ds_read_b64_tr_b16 v[200:201], v4 offset:2048
    ds_read_b64_tr_b16 v[202:203], v4 offset:2304
    ds_read_b64_tr_b16 v[204:205], v4 offset:2056
    ds_read_b64_tr_b16 v[206:207], v4 offset:2312
    s_waitcnt lgkmcnt(0)
    ds_read_b64_tr_b16 v[208:209], v4 offset:4096
    ds_read_b64_tr_b16 v[210:211], v4 offset:4352
    ds_read_b64_tr_b16 v[212:213], v4 offset:4104
    ds_read_b64_tr_b16 v[214:215], v4 offset:4360
    ds_read_b64_tr_b16 v[216:217], v4 offset:6144
    ds_read_b64_tr_b16 v[218:219], v4 offset:6400
    ds_read_b64_tr_b16 v[220:221], v4 offset:6152
    ds_read_b64_tr_b16 v[222:223], v4 offset:6408
    s_waitcnt lgkmcnt(0)
    ds_read_b64_tr_b16 v[224:225], v4 offset:8192
    ds_read_b64_tr_b16 v[226:227], v4 offset:8448
    ds_read_b64_tr_b16 v[228:229], v4 offset:8200
    ds_read_b64_tr_b16 v[230:231], v4 offset:8456
    ds_read_b64_tr_b16 v[232:233], v4 offset:10240
    ds_read_b64_tr_b16 v[234:235], v4 offset:10496
    ds_read_b64_tr_b16 v[236:237], v4 offset:10248
    ds_read_b64_tr_b16 v[238:239], v4 offset:10504
    s_waitcnt lgkmcnt(0)
    ds_read_b64_tr_b16 v[240:241], v4 offset:12288
    ds_read_b64_tr_b16 v[242:243], v4 offset:12544
    ds_read_b64_tr_b16 v[244:245], v4 offset:12296
    ds_read_b64_tr_b16 v[246:247], v4 offset:12552
    ds_read_b64_tr_b16 v[248:249], v4 offset:14336
    ds_read_b64_tr_b16 v[250:251], v4 offset:14592
    ds_read_b64_tr_b16 v[252:253], v4 offset:14344
    ds_read_b64_tr_b16 v[254:255], v4 offset:14600
    s_waitcnt lgkmcnt(0)
    s_mov_b32 s20, s80
    s_and_b32 s21, s81, 0xffff
    s_mov_b32 s22, 0x800000
    s_mov_b32 s23, 0x20000
    v_and_b32 v1, 15, v0
    v_lshrrev_b32 v2, 4, v0
    v_lshlrev_b32 v3, 9, v2
    v_lshl_add_u32 v3, v1, 4, v3
    v_lshlrev_b32 v4, 4, v0
    s_lshl_b32 s42, s34, 12
    v_add_u32 v5, s42, v4
    s_lshl_b32 s42, s34, 10
    v_add_u32 v6, s42, v4
    s_lshr_b32 s42, s34, 1
    s_lshl_b32 s42, s42, 16
    s_and_b32 s43, s34, 1
    s_lshl_b32 s43, s43, 3
    s_add_u32 s42, s42, s43
    s_lshl_b32 s43, s57, 6
    s_add_u32 s42, s42, s43
    v_lshlrev_b32 v7, 12, v1
    v_lshl_add_u32 v7, v2, 4, v7
    v_add_u32 v7, s42, v7
    v_lshlrev_b32 v8, 7, v9
    v_add_u32 v8, 98574336, v8
    s_lshl_b32 s51, s34, 15
    s_add_u32 s51, s51, 50331648
    s_mov_b32 s49, 0
    s_barrier
A3_COLD:
    v_readlane_b32 s40, v9, s49
    s_cmp_ge_u32 s40, 64
    s_cbranch_scc1 A3_DONE
    s_mov_b32 s44, 0
A3_W:
    buffer_load_dword v10, v8, s[8:11], 0 offen sc1
    s_waitcnt vmcnt(0)
    v_cmp_eq_u32 s[52:53], 32, v10
    s_bitcmp1_b32 s52, s49
    s_cbranch_scc1 A3_RDY
    s_lshl_b32 s42, s40, 7
    s_add_u32 s42, s42, 98574336
A3_W1:
    s_sleep 16
    buffer_load_dword v10, off, s[8:11], s42 sc1
    s_add_u32 s44, s44, 1
    s_cmp_gt_u32 s44, 60000
    s_cbranch_scc1 C_DONE
    s_waitcnt vmcnt(0)
    v_cmp_eq_u32 vcc, 32, v10
    s_cbranch_vccz A3_W1
A3_RDY:
    s_lshl_b32 s41, s40, 18
    s_add_u32 s41, s41, s51
    buffer_load_dwordx4 v[32:35], v3, s[8:11], s41 offen offset:0 sc1
    buffer_load_dwordx4 v[36:39], v3, s[8:11], s41 offen offset:256 sc1
    buffer_load_dwordx4 v[40:43], v3, s[8:11], s41 offen offset:2048 sc1
    buffer_load_dwordx4 v[44:47], v3, s[8:11], s41 offen offset:2304 sc1
    s_add_u32 s41, s41, 4096
    buffer_load_dwordx4 v[48:51], v3, s[8:11], s41 offen offset:0 sc1
    buffer_load_dwordx4 v[52:55], v3, s[8:11], s41 offen offset:256 sc1
    buffer_load_dwordx4 v[56:59], v3, s[8:11], s41 offen offset:2048 sc1
    buffer_load_dwordx4 v[60:63], v3, s[8:11], s41 offen offset:2304 sc1
    s_add_u32 s41, s41, 4096
    buffer_load_dwordx4 v[64:67], v3, s[8:11], s41 offen offset:0 sc1
    buffer_load_dwordx4 v[68:71], v3, s[8:11], s41 offen offset:256 sc1
    buffer_load_dwordx4 v[72:75], v3, s[8:11], s41 offen offset:2048 sc1
    buffer_load_dwordx4 v[76:79], v3, s[8:11], s41 offen offset:2304 sc1
    s_add_u32 s41, s41, 4096
    buffer_load_dwordx4 v[80:83], v3, s[8:11], s41 offen offset:0 sc1
    buffer_load_dwordx4 v[84:87], v3, s[8:11], s41 offen offset:256 sc1
    buffer_load_dwordx4 v[88:91], v3, s[8:11], s41 offen offset:2048 sc1
    buffer_load_dwordx4 v[92:95], v3, s[8:11], s41 offen offset:2304 sc1
    s_add_u32 s41, s41, 4096
A3_BODY:
    s_waitcnt vmcnt(14)
    v_mfma_f32_16x16x32_bf16 v[16:19], v[128:131], v[32:35], 0
    v_mfma_f32_16x16x32_bf16 v[20:23], v[132:135], v[32:35], 0
    v_mfma_f32_16x16x32_bf16 v[24:27], v[128:131], v[36:39], 0
    v_mfma_f32_16x16x32_bf16 v[28:31], v[132:135], v[36:39], 0
    buffer_load_dwordx4 v[32:35], v3, s[8:11], s41 offen offset:0 sc1
    buffer_load_dwordx4 v[36:39], v3, s[8:11], s41 offen offset:256 sc1
    s_waitcnt vmcnt(14)
    v_mfma_f32_16x16x32_bf16 v[16:19], v[136:139], v[40:43], v[16:19]
    v_mfma_f32_16x16x32_bf16 v[20:23], v[140:143], v[40:43], v[20:23]
    v_mfma_f32_16x16x32_bf16 v[24:27], v[136:139], v[44:47], v[24:27]
    v_mfma_f32_16x16x32_bf16 v[28:31], v[140:143], v[44:47], v[28:31]
    buffer_load_dwordx4 v[40:43], v3, s[8:11], s41 offen offset:2048 sc1
    buffer_load_dwordx4 v[44:47], v3, s[8:11], s41 offen offset:2304 sc1
    s_add_u32 s41, s41, 4096
    s_waitcnt vmcnt(14)
    v_mfma_f32_16x16x32_bf16 v[16:19], v[144:147], v[48:51], v[16:19]
    v_mfma_f32_16x16x32_bf16 v[20:23], v[148:151], v[48:51], v[20:23]
    v_mfma_f32_16x16x32_bf16 v[24:27], v[144:147], v[52:55], v[24:27]
    v_mfma_f32_16x16x32_bf16 v[28:31], v[148:151], v[52:55], v[28:31]
    buffer_load_dwordx4 v[48:51], v3, s[8:11], s41 offen offset:0 sc1
    buffer_load_dwordx4 v[52:55], v3, s[8:11], s41 offen offset:256 sc1
    s_waitcnt vmcnt(14)
    v_mfma_f32_16x16x32_bf16 v[16:19], v[152:155], v[56:59], v[16:19]
    v_mfma_f32_16x16x32_bf16 v[20:23], v[156:159], v[56:59], v[20:23]
    v_mfma_f32_16x16x32_bf16 v[24:27], v[152:155], v[60:63], v[24:27]
    v_mfma_f32_16x16x32_bf16 v[28:31], v[156:159], v[60:63], v[28:31]
    buffer_load_dwordx4 v[56:59], v3, s[8:11], s41 offen offset:2048 sc1
    buffer_load_dwordx4 v[60:63], v3, s[8:11], s41 offen offset:2304 sc1
    s_add_u32 s41, s41, 4096
    s_waitcnt vmcnt(14)
    v_mfma_f32_16x16x32_bf16 v[16:19], v[160:163], v[64:67], v[16:19]
    v_mfma_f32_16x16x32_bf16 v[20:23], v[164:167], v[64:67], v[20:23]
    v_mfma_f32_16x16x32_bf16 v[24:27], v[160:163], v[68:71], v[24:27]
    v_mfma_f32_16x16x32_bf16 v[28:31], v[164:167], v[68:71], v[28:31]
    buffer_load_dwordx4 v[64:67], v3, s[8:11], s41 offen offset:0 sc1
    buffer_load_dwordx4 v[68:71], v3, s[8:11], s41 offen offset:256 sc1
    s_waitcnt vmcnt(14)
    v_mfma_f32_16x16x32_bf16 v[16:19], v[168:171], v[72:75], v[16:19]
    v_mfma_f32_16x16x32_bf16 v[20:23], v[172:175], v[72:75], v[20:23]
    v_mfma_f32_16x16x32_bf16 v[24:27], v[168:171], v[76:79], v[24:27]
    v_mfma_f32_16x16x32_bf16 v[28:31], v[172:175], v[76:79], v[28:31]
    buffer_load_dwordx4 v[72:75], v3, s[8:11], s41 offen offset:2048 sc1
    buffer_load_dwordx4 v[76:79], v3, s[8:11], s41 offen offset:2304 sc1
    s_add_u32 s41, s41, 4096
    s_waitcnt vmcnt(14)
    v_mfma_f32_16x16x32_bf16 v[16:19], v[176:179], v[80:83], v[16:19]
    v_mfma_f32_16x16x32_bf16 v[20:23], v[180:183], v[80:83], v[20:23]
    v_mfma_f32_16x16x32_bf16 v[24:27], v[176:179], v[84:87], v[24:27]
    v_mfma_f32_16x16x32_bf16 v[28:31], v[180:183], v[84:87], v[28:31]
    buffer_load_dwordx4 v[80:83], v3, s[8:11], s41 offen offset:0 sc1
    buffer_load_dwordx4 v[84:87], v3, s[8:11], s41 offen offset:256 sc1
    s_waitcnt vmcnt(14)
    v_mfma_f32_16x16x32_bf16 v[16:19], v[184:187], v[88:91], v[16:19]
    v_mfma_f32_16x16x32_bf16 v[20:23], v[188:191], v[88:91], v[20:23]
    v_mfma_f32_16x16x32_bf16 v[24:27], v[184:187], v[92:95], v[24:27]
    v_mfma_f32_16x16x32_bf16 v[28:31], v[188:191], v[92:95], v[28:31]
    buffer_load_dwordx4 v[88:91], v3, s[8:11], s41 offen offset:2048 sc1
    buffer_load_dwordx4 v[92:95], v3, s[8:11], s41 offen offset:2304 sc1
    s_add_u32 s41, s41, 4096
    s_add_u32 s49, s49, 1
    s_bitcmp1_b32 s52, s49
    s_cselect_b32 s50, 1, 0
    s_cbranch_scc0 A3_DRAIN
    v_readlane_b32 s43, v9, s49
    s_lshl_b32 s41, s43, 18
    s_add_u32 s41, s41, s51
    s_waitcnt vmcnt(14)
    v_mfma_f32_16x16x32_bf16 v[16:19], v[192:195], v[32:35], v[16:19]
    v_mfma_f32_16x16x32_bf16 v[20:23], v[196:199], v[32:35], v[20:23]
    v_mfma_f32_16x16x32_bf16 v[24:27], v[192:195], v[36:39], v[24:27]
    v_mfma_f32_16x16x32_bf16 v[28:31], v[196:199], v[36:39], v[28:31]
    buffer_load_dwordx4 v[32:35], v3, s[8:11], s41 offen offset:0 sc1
    buffer_load_dwordx4 v[36:39], v3, s[8:11], s41 offen offset:256 sc1
    s_waitcnt vmcnt(14)
    v_mfma_f32_16x16x32_bf16 v[16:19], v[200:203], v[40:43], v[16:19]
    v_mfma_f32_16x16x32_bf16 v[20:23], v[204:207], v[40:43], v[20:23]
    v_mfma_f32_16x16x32_bf16 v[24:27], v[200:203], v[44:47], v[24:27]
    v_mfma_f32_16x16x32_bf16 v[28:31], v[204:207], v[44:47], v[28:31]
    buffer_load_dwordx4 v[40:43], v3, s[8:11], s41 offen offset:2048 sc1
    buffer_load_dwordx4 v[44:47], v3, s[8:11], s41 offen offset:2304 sc1
    s_add_u32 s41, s41, 4096
    s_waitcnt vmcnt(14)
    v_mfma_f32_16x16x32_bf16 v[16:19], v[208:211], v[48:51], v[16:19]
    v_mfma_f32_16x16x32_bf16 v[20:23], v[212:215], v[48:51], v[20:23]
    v_mfma_f32_16x16x32_bf16 v[24:27], v[208:211], v[52:55], v[24:27]
    v_mfma_f32_16x16x32_bf16 v[28:31], v[212:215], v[52:55], v[28:31]
    buffer_load_dwordx4 v[48:51], v3, s[8:11], s41 offen offset:0 sc1
    buffer_load_dwordx4 v[52:55], v3, s[8:11], s41 offen offset:256 sc1
    s_waitcnt vmcnt(14)
    v_mfma_f32_16x16x32_bf16 v[16:19], v[216:219], v[56:59], v[16:19]
    v_mfma_f32_16x16x32_bf16 v[20:23], v[220:223], v[56:59], v[20:23]
    v_mfma_f32_16x16x32_bf16 v[24:27], v[216:219], v[60:63], v[24:27]
    v_mfma_f32_16x16x32_bf16 v[28:31], v[220:223], v[60:63], v[28:31]
    buffer_load_dwordx4 v[56:59], v3, s[8:11], s41 offen offset:2048 sc1
    buffer_load_dwordx4 v[60:63], v3, s[8:11], s41 offen offset:2304 sc1
    s_add_u32 s41, s41, 4096
    s_waitcnt vmcnt(14)
    v_mfma_f32_16x16x32_bf16 v[16:19], v[224:227], v[64:67], v[16:19]
    v_mfma_f32_16x16x32_bf16 v[20:23], v[228:231], v[64:67], v[20:23]
    v_mfma_f32_16x16x32_bf16 v[24:27], v[224:227], v[68:71], v[24:27]
    v_mfma_f32_16x16x32_bf16 v[28:31], v[228:231], v[68:71], v[28:31]
    buffer_load_dwordx4 v[64:67], v3, s[8:11], s41 offen offset:0 sc1
    buffer_load_dwordx4 v[68:71], v3, s[8:11], s41 offen offset:256 sc1
    s_waitcnt vmcnt(14)
    v_mfma_f32_16x16x32_bf16 v[16:19], v[232:235], v[72:75], v[16:19]
    v_mfma_f32_16x16x32_bf16 v[20:23], v[236:239], v[72:75], v[20:23]
    v_mfma_f32_16x16x32_bf16 v[24:27], v[232:235], v[76:79], v[24:27]
    v_mfma_f32_16x16x32_bf16 v[28:31], v[236:239], v[76:79], v[28:31]
    buffer_load_dwordx4 v[72:75], v3, s[8:11], s41 offen offset:2048 sc1
    buffer_load_dwordx4 v[76:79], v3, s[8:11], s41 offen offset:2304 sc1
    s_add_u32 s41, s41, 4096
    s_waitcnt vmcnt(14)
    v_mfma_f32_16x16x32_bf16 v[16:19], v[240:243], v[80:83], v[16:19]
    v_mfma_f32_16x16x32_bf16 v[20:23], v[244:247], v[80:83], v[20:23]
    v_mfma_f32_16x16x32_bf16 v[24:27], v[240:243], v[84:87], v[24:27]
    v_mfma_f32_16x16x32_bf16 v[28:31], v[244:247], v[84:87], v[28:31]
    buffer_load_dwordx4 v[80:83], v3, s[8:11], s41 offen offset:0 sc1
    buffer_load_dwordx4 v[84:87], v3, s[8:11], s41 offen offset:256 sc1
    s_waitcnt vmcnt(14)
    v_mfma_f32_16x16x32_bf16 v[16:19], v[248:251], v[88:91], v[16:19]
    v_mfma_f32_16x16x32_bf16 v[20:23], v[252:255], v[88:91], v[20:23]
    v_mfma_f32_16x16x32_bf16 v[24:27], v[248:251], v[92:95], v[24:27]
    v_mfma_f32_16x16x32_bf16 v[28:31], v[252:255], v[92:95], v[28:31]
    buffer_load_dwordx4 v[88:91], v3, s[8:11], s41 offen offset:2048 sc1
    buffer_load_dwordx4 v[92:95], v3, s[8:11], s41 offen offset:2304 sc1
    s_add_u32 s41, s41, 4096
    s_branch A3_RED
A3_DRAIN:
    s_waitcnt vmcnt(14)
    v_mfma_f32_16x16x32_bf16 v[16:19], v[192:195], v[32:35], v[16:19]
    v_mfma_f32_16x16x32_bf16 v[20:23], v[196:199], v[32:35], v[20:23]
    v_mfma_f32_16x16x32_bf16 v[24:27], v[192:195], v[36:39], v[24:27]
    v_mfma_f32_16x16x32_bf16 v[28:31], v[196:199], v[36:39], v[28:31]
    s_waitcnt vmcnt(12)
    v_mfma_f32_16x16x32_bf16 v[16:19], v[200:203], v[40:43], v[16:19]
    v_mfma_f32_16x16x32_bf16 v[20:23], v[204:207], v[40:43], v[20:23]
    v_mfma_f32_16x16x32_bf16 v[24:27], v[200:203], v[44:47], v[24:27]
    v_mfma_f32_16x16x32_bf16 v[28:31], v[204:207], v[44:47], v[28:31]
    s_waitcnt vmcnt(10)
    v_mfma_f32_16x16x32_bf16 v[16:19], v[208:211], v[48:51], v[16:19]
    v_mfma_f32_16x16x32_bf16 v[20:23], v[212:215], v[48:51], v[20:23]
    v_mfma_f32_16x16x32_bf16 v[24:27], v[208:211], v[52:55], v[24:27]
    v_mfma_f32_16x16x32_bf16 v[28:31], v[212:215], v[52:55], v[28:31]
    s_waitcnt vmcnt(8)
    v_mfma_f32_16x16x32_bf16 v[16:19], v[216:219], v[56:59], v[16:19]
    v_mfma_f32_16x16x32_bf16 v[20:23], v[220:223], v[56:59], v[20:23]
    v_mfma_f32_16x16x32_bf16 v[24:27], v[216:219], v[60:63], v[24:27]
    v_mfma_f32_16x16x32_bf16 v[28:31], v[220:223], v[60:63], v[28:31]
    s_waitcnt vmcnt(6)
    v_mfma_f32_16x16x32_bf16 v[16:19], v[224:227], v[64:67], v[16:19]
    v_mfma_f32_16x16x32_bf16 v[20:23], v[228:231], v[64:67], v[20:23]
    v_mfma_f32_16x16x32_bf16 v[24:27], v[224:227], v[68:71], v[24:27]
    v_mfma_f32_16x16x32_bf16 v[28:31], v[228:231], v[68:71], v[28:31]
    s_waitcnt vmcnt(4)
    v_mfma_f32_16x16x32_bf16 v[16:19], v[232:235], v[72:75], v[16:19]
    v_mfma_f32_16x16x32_bf16 v[20:23], v[236:239], v[72:75], v[20:23]
    v_mfma_f32_16x16x32_bf16 v[24:27], v[232:235], v[76:79], v[24:27]
    v_mfma_f32_16x16x32_bf16 v[28:31], v[236:239], v[76:79], v[28:31]
    s_waitcnt vmcnt(2)
    v_mfma_f32_16x16x32_bf16 v[16:19], v[240:243], v[80:83], v[16:19]
    v_mfma_f32_16x16x32_bf16 v[20:23], v[244:247], v[80:83], v[20:23]
    v_mfma_f32_16x16x32_bf16 v[24:27], v[240:243], v[84:87], v[24:27]
    v_mfma_f32_16x16x32_bf16 v[28:31], v[244:247], v[84:87], v[28:31]
    s_waitcnt vmcnt(0)
    v_mfma_f32_16x16x32_bf16 v[16:19], v[248:251], v[88:91], v[16:19]
    v_mfma_f32_16x16x32_bf16 v[20:23], v[252:255], v[88:91], v[20:23]
    v_mfma_f32_16x16x32_bf16 v[24:27], v[248:251], v[92:95], v[24:27]
    v_mfma_f32_16x16x32_bf16 v[28:31], v[252:255], v[92:95], v[28:31]
A3_RED:
    s_nop 4
    ds_write_b128 v5, v[16:19] offset:0
    ds_write_b128 v5, v[20:23] offset:1024
    ds_write_b128 v5, v[24:27] offset:2048
    ds_write_b128 v5, v[28:31] offset:3072
    v_xor_b32 v5, 0x8000, v5
    s_waitcnt lgkmcnt(0)
    s_barrier
    s_cmp_ge_u32 s34, 4
    s_cbranch_scc1 A3_NR
    ds_read_b128 v[96:99], v6 offset:0
    ds_read_b128 v[100:103], v6 offset:4096
    ds_read_b128 v[104:107], v6 offset:8192
    ds_read_b128 v[108:111], v6 offset:12288
    ds_read_b128 v[112:115], v6 offset:16384
    ds_read_b128 v[116:119], v6 offset:20480
    ds_read_b128 v[120:123], v6 offset:24576
    ds_read_b128 v[124:127], v6 offset:28672
    v_xor_b32 v6, 0x8000, v6
    s_waitcnt lgkmcnt(6)
    v_add_f32 v96, v96, v100
    v_add_f32 v97, v97, v101
    v_add_f32 v98, v98, v102
    v_add_f32 v99, v99, v103
    s_waitcnt lgkmcnt(5)
    v_add_f32 v96, v96, v104
    v_add_f32 v97, v97, v105
    v_add_f32 v98, v98, v106
    v_add_f32 v99, v99, v107
    s_waitcnt lgkmcnt(4)
    v_add_f32 v96, v96, v108
    v_add_f32 v97, v97, v109
    v_add_f32 v98, v98, v110
    v_add_f32 v99, v99, v111
    s_waitcnt lgkmcnt(3)
    v_add_f32 v96, v96, v112
    v_add_f32 v97, v97, v113
    v_add_f32 v98, v98, v114
    v_add_f32 v99, v99, v115
    s_waitcnt lgkmcnt(2)
    v_add_f32 v96, v96, v116
    v_add_f32 v97, v97, v117
    v_add_f32 v98, v98, v118
    v_add_f32 v99, v99, v119
    s_waitcnt lgkmcnt(1)
    v_add_f32 v96, v96, v120
    v_add_f32 v97, v97, v121
    v_add_f32 v98, v98, v122
    v_add_f32 v99, v99, v123
    s_waitcnt lgkmcnt(0)
    v_add_f32 v96, v96, v124
    v_add_f32 v97, v97, v125
    v_add_f32 v98, v98, v126
    v_add_f32 v99, v99, v127
    v_cvt_pk_bf16_f32 v100, v96, v97
    v_cvt_pk_bf16_f32 v101, v98, v99
    s_lshl_b32 s42, s40, 17
    buffer_store_dwordx2 v[100:101], v7, s[20:23], s42 offen
A3_NR:
    s_cmp_eq_u32 s50, 0
    s_cbranch_scc1 A3_COLD
    s_mov_b32 s40, s43
    s_branch A3_BODY
A3_DONE:
C_DONE:
    s_endpgm
.p2align 6
.type JOBS,@object
JOBS:
.long 0x820, 0x910, 0x870, 0xb40, 0x200, 0x23a, 0x430, 0x704, 0x704, 0x704, 0x704, 0x704, 0x704, 0x704, 0x704, 0x704
.long 0x822, 0x911, 0x872, 0xb42, 0x201, 0x23b, 0x431, 0x705, 0x705, 0x705, 0x705, 0x705, 0x705, 0x705, 0x705, 0x705
.long 0x824, 0x912, 0x874, 0xb44, 0x202, 0x23c, 0x400, 0x706, 0x706, 0x706, 0x706, 0x706, 0x706, 0x706, 0x706, 0x706
.long 0x826, 0x913, 0x876, 0xb46, 0x203, 0x23d, 0x401, 0x707, 0x707, 0x707, 0x707, 0x707, 0x707, 0x707, 0x707, 0x707
.long 0x828, 0x914, 0x878, 0x500, 0x234, 0x408, 0x3e2, 0x7e0, 0x7e0, 0x7e0, 0x7e0, 0x7e0, 0x7e0, 0x7e0, 0x7e0, 0x7e0
.long 0x82a, 0x915, 0x87a, 0x501, 0x235, 0x409, 0x3e3, 0x7e0, 0x7e0, 0x7e0, 0x7e0, 0x7e0, 0x7e0, 0x7e0, 0x7e0, 0x7e0
.long 0x82c, 0x916, 0x87c, 0x220, 0x22e, 0x510, 0x438, 0x7e0, 0x7e0, 0x7e0, 0x7e0, 0x7e0, 0x7e0, 0x7e0, 0x7e0, 0x7e0
.long 0x82e, 0x917, 0x87e, 0x221, 0x22f, 0x511, 0x439, 0x7e0, 0x7e0, 0x7e0, 0x7e0, 0x7e0, 0x7e0, 0x7e0, 0x7e0, 0x7e0
.long 0x10, 0xa00, 0x900, 0x848, 0x210, 0x20e, 0x204, 0x23e, 0x3e0, 0x7e0, 0x7e0, 0x7e0, 0x7e0, 0x7e0, 0x7e0, 0x7e0
.long 0x11, 0xa01, 0x901, 0x84a, 0x211, 0x20f, 0x205, 0x23f, 0x3e1, 0x7e0, 0x7e0, 0x7e0, 0x7e0, 0x7e0, 0x7e0, 0x7e0
.long 0x12, 0xa02, 0x902, 0x84c, 0x212, 0x228, 0x206, 0x3c0, 0x720, 0x720, 0x720, 0x720, 0x720, 0x720, 0x720, 0x720
.long 0x13, 0xa03, 0x903, 0x84e, 0x213, 0x229, 0x207, 0x3c1, 0x721, 0x721, 0x721, 0x721, 0x721, 0x721, 0x721, 0x721
.long 0x14, 0xa04, 0x904, 0xb20, 0x226, 0x21c, 0x236, 0x420, 0x3e4, 0x7e0, 0x7e0, 0x7e0, 0x7e0, 0x7e0, 0x7e0, 0x7e0
.long 0x15, 0xa05, 0x905, 0xb22, 0x227, 0x21d, 0x237, 0x421, 0x3e5, 0x7e0, 0x7e0, 0x7e0, 0x7e0, 0x7e0, 0x7e0, 0x7e0
.long 0x16, 0xa06, 0x906, 0xb24, 0x208, 0x21e, 0x238, 0x410, 0x3e6, 0x7e0, 0x7e0, 0x7e0, 0x7e0, 0x7e0, 0x7e0, 0x7e0
.long 0x17, 0xa07, 0x907, 0xb26, 0x209, 0x21f, 0x239, 0x411, 0x3e7, 0x7e0, 0x7e0, 0x7e0, 0x7e0, 0x7e0, 0x7e0, 0x7e0
.long 0x18, 0xa08, 0x920, 0x860, 0x214, 0x22a, 0xba0, 0x418, 0x700, 0x700, 0x700, 0x700, 0x700, 0x700, 0x700, 0x700
.long 0x19, 0xa09, 0x921, 0x862, 0x215, 0x22b, 0xba2, 0x419, 0x701, 0x701, 0x701, 0x701, 0x701, 0x701, 0x701, 0x701
.long 0x1a, 0xa0a, 0x922, 0x864, 0x216, 0x22c, 0xba4, 0x428, 0x702, 0x702, 0x702, 0x702, 0x702, 0x702, 0x702, 0x702
.long 0x1b, 0xa0b, 0x923, 0x866, 0x217, 0x22d, 0xba6, 0x429, 0x703, 0x703, 0x703, 0x703, 0x703, 0x703, 0x703, 0x703
.long 0x1c, 0xa0c, 0x924, 0x868, 0xb60, 0xb80, 0x3c6, 0x722, 0x722, 0x722, 0x722, 0x722, 0x722, 0x722, 0x722, 0x722
.long 0x1d, 0xa0d, 0x925, 0x86a, 0xb62, 0xb82, 0x3c7, 0x723, 0x723, 0x723, 0x723, 0x723, 0x723, 0x723, 0x723, 0x723
.long 0x1e, 0xa0e, 0x926, 0x86c, 0xb64, 0xb84, 0x520, 0x7e0, 0x7e0, 0x7e0, 0x7e0, 0x7e0, 0x7e0, 0x7e0, 0x7e0, 0x7e0
.long 0x1f, 0xa0f, 0x927, 0x86e, 0xb66, 0xb86, 0x521, 0x7e0, 0x7e0, 0x7e0, 0x7e0, 0x7e0, 0x7e0, 0x7e0, 0x7e0, 0x7e0
.long 0x830, 0xb00, 0x858, 0x20a, 0x508, 0x650, 0x7e0, 0x7e0, 0x7e0, 0x7e0, 0x7e0, 0x7e0, 0x7e0, 0x7e0, 0x7e0, 0x7e0
.long 0x832, 0xb02, 0x85a, 0x20b, 0x509, 0x651, 0x7e0, 0x7e0, 0x7e0, 0x7e0, 0x7e0, 0x7e0, 0x7e0, 0x7e0, 0x7e0, 0x7e0
.long 0x834, 0xb04, 0x85c, 0x20c, 0x518, 0x658, 0x7e0, 0x7e0, 0x7e0, 0x7e0, 0x7e0, 0x7e0, 0x7e0, 0x7e0, 0x7e0, 0x7e0
.long 0x836, 0xb06, 0x85e, 0x20d, 0x519, 0x659, 0x7e0, 0x7e0, 0x7e0, 0x7e0, 0x7e0, 0x7e0, 0x7e0, 0x7e0, 0x7e0, 0x7e0
.long 0x838, 0x840, 0x850, 0x222, 0x218, 0x230, 0x3c2, 0x724, 0x724, 0x724, 0x724, 0x724, 0x724, 0x724, 0x724, 0x724
.long 0x83a, 0x842, 0x852, 0x223, 0x219, 0x231, 0x3c3, 0x725, 0x725, 0x725, 0x725, 0x725, 0x725, 0x725, 0x725, 0x725
.long 0x83c, 0x844, 0x854, 0x224, 0x21a, 0x232, 0x3c4, 0x726, 0x726, 0x726, 0x726, 0x726, 0x726, 0x726, 0x726, 0x726
.long 0x83e, 0x846, 0x856, 0x225, 0x21b, 0x233, 0x3c5, 0x727, 0x727, 0x727, 0x727, 0x727, 0x727, 0x727, 0x727, 0x727
.long 0x820, 0x910, 0x870, 0xb48, 0x200, 0x23a, 0x432, 0x70c, 0x70c, 0x70c, 0x70c, 0x70c, 0x70c, 0x70c, 0x70c, 0x70c
.long 0x822, 0x911, 0x872, 0xb4a, 0x201, 0x23b, 0x433, 0x70d, 0x70d, 0x70d, 0x70d, 0x70d, 0x70d, 0x70d, 0x70d, 0x70d
.long 0x824, 0x912, 0x874, 0xb4c, 0x202, 0x23c, 0x402, 0x70e, 0x70e, 0x70e, 0x70e, 0x70e, 0x70e, 0x70e, 0x70e, 0x70e
.long 0x826, 0x913, 0x876, 0xb4e, 0x203, 0x23d, 0x403, 0x70f, 0x70f, 0x70f, 0x70f, 0x70f, 0x70f, 0x70f, 0x70f, 0x70f
.long 0x828, 0x914, 0x878, 0x502, 0x234, 0x40a, 0x3ea, 0x7e0, 0x7e0, 0x7e0, 0x7e0, 0x7e0, 0x7e0, 0x7e0, 0x7e0, 0x7e0
.long 0x82a, 0x915, 0x87a, 0x503, 0x235, 0x40b, 0x3eb, 0x7e0, 0x7e0, 0x7e0, 0x7e0, 0x7e0, 0x7e0, 0x7e0, 0x7e0, 0x7e0
.long 0x82c, 0x916, 0x87c, 0x220, 0x22e, 0x512, 0x43a, 0x7e0, 0x7e0, 0x7e0, 0x7e0, 0x7e0, 0x7e0, 0x7e0, 0x7e0, 0x7e0
.long 0x82e, 0x917, 0x87e, 0x221, 0x22f, 0x513, 0x43b, 0x7e0, 0x7e0, 0x7e0, 0x7e0, 0x7e0, 0x7e0, 0x7e0, 0x7e0, 0x7e0
.long 0x10, 0xa00, 0x900, 0x848, 0x210, 0x20e, 0x204, 0x23e, 0x3e8, 0x7e0, 0x7e0, 0x7e0, 0x7e0, 0x7e0, 0x7e0, 0x7e0
.long 0x11, 0xa01, 0x901, 0x84a, 0x211, 0x20f, 0x205, 0x23f, 0x3e9, 0x7e0, 0x7e0, 0x7e0, 0x7e0, 0x7e0, 0x7e0, 0x7e0
.long 0x12, 0xa02, 0x902, 0x84c, 0x212, 0x228, 0x206, 0x3c8, 0x728, 0x728, 0x728, 0x728, 0x728, 0x728, 0x728, 0x728
.long 0x13, 0xa03, 0x903, 0x84e, 0x213, 0x229, 0x207, 0x3c9, 0x729, 0x729, 0x729, 0x729, 0x729, 0x729, 0x729, 0x729
.long 0x14, 0xa04, 0x904, 0xb28, 0x226, 0x21c, 0x236, 0x422, 0x3ec, 0x7e0, 0x7e0, 0x7e0, 0x7e0, 0x7e0, 0x7e0, 0x7e0
.long 0x15, 0xa05, 0x905, 0xb2a, 0x227, 0x21d, 0x237, 0x423, 0x3ed, 0x7e0, 0x7e0, 0x7e0, 0x7e0, 0x7e0, 0x7e0, 0x7e0
.long 0x16, 0xa06, 0x906, 0xb2c, 0x208, 0x21e, 0x238, 0x412, 0x3ee, 0x7e0, 0x7e0, 0x7e0, 0x7e0, 0x7e0, 0x7e0, 0x7e0
.long 0x17, 0xa07, 0x907, 0xb2e, 0x209, 0x21f, 0x239, 0x413, 0x3ef, 0x7e0, 0x7e0, 0x7e0, 0x7e0, 0x7e0, 0x7e0, 0x7e0
.long 0x18, 0xa08, 0x920, 0x860, 0x214, 0x22a, 0xba8, 0x41a, 0x708, 0x708, 0x708, 0x708, 0x708, 0x708, 0x708, 0x708
.long 0x19, 0xa09, 0x921, 0x862, 0x215, 0x22b, 0xbaa, 0x41b, 0x709, 0x709, 0x709, 0x709, 0x709, 0x709, 0x709, 0x709
.long 0x1a, 0xa0a, 0x922, 0x864, 0x216, 0x22c, 0xbac, 0x42a, 0x70a, 0x70a, 0x70a, 0x70a, 0x70a, 0x70a, 0x70a, 0x70a
.long 0x1b, 0xa0b, 0x923, 0x866, 0x217, 0x22d, 0xbae, 0x42b, 0x70b, 0x70b, 0x70b, 0x70b, 0x70b, 0x70b, 0x70b, 0x70b
.long 0x1c, 0xa0c, 0x924, 0x868, 0xb68, 0xb88, 0x3ce, 0x72a, 0x72a, 0x72a, 0x72a, 0x72a, 0x72a, 0x72a, 0x72a, 0x72a
.long 0x1d, 0xa0d, 0x925, 0x86a, 0xb6a, 0xb8a, 0x3cf, 0x72b, 0x72b, 0x72b, 0x72b, 0x72b, 0x72b, 0x72b, 0x72b, 0x72b
.long 0x1e, 0xa0e, 0x926, 0x86c, 0xb6c, 0xb8c, 0x522, 0x7e0, 0x7e0, 0x7e0, 0x7e0, 0x7e0, 0x7e0, 0x7e0, 0x7e0, 0x7e0
.long 0x1f, 0xa0f, 0x927, 0x86e, 0xb6e, 0xb8e, 0x523, 0x7e0, 0x7e0, 0x7e0, 0x7e0, 0x7e0, 0x7e0, 0x7e0, 0x7e0, 0x7e0
.long 0x830, 0xb08, 0x858, 0x20a, 0x50a, 0x652, 0x7e0, 0x7e0, 0x7e0, 0x7e0, 0x7e0, 0x7e0, 0x7e0, 0x7e0, 0x7e0, 0x7e0
.long 0x832, 0xb0a, 0x85a, 0x20b, 0x50b, 0x653, 0x7e0, 0x7e0, 0x7e0, 0x7e0, 0x7e0, 0x7e0, 0x7e0, 0x7e0, 0x7e0, 0x7e0
.long 0x834, 0xb0c, 0x85c, 0x20c, 0x51a, 0x65a, 0x7e0, 0x7e0, 0x7e0, 0x7e0, 0x7e0, 0x7e0, 0x7e0, 0x7e0, 0x7e0, 0x7e0
.long 0x836, 0xb0e, 0x85e, 0x20d, 0x51b, 0x65b, 0x7e0, 0x7e0, 0x7e0, 0x7e0, 0x7e0, 0x7e0, 0x7e0, 0x7e0, 0x7e0, 0x7e0
.long 0x838, 0x840, 0x850, 0x222, 0x218, 0x230, 0x3ca, 0x72c, 0x72c, 0x72c, 0x72c, 0x72c, 0x72c, 0x72c, 0x72c, 0x72c
.long 0x83a, 0x842, 0x852, 0x223, 0x219, 0x231, 0x3cb, 0x72d, 0x72d, 0x72d, 0x72d, 0x72d, 0x72d, 0x72d, 0x72d, 0x72d
.long 0x83c, 0x844, 0x854, 0x224, 0x21a, 0x232, 0x3cc, 0x72e, 0x72e, 0x72e, 0x72e, 0x72e, 0x72e, 0x72e, 0x72e, 0x72e
.long 0x83e, 0x846, 0x856, 0x225, 0x21b, 0x233, 0x3cd, 0x72f, 0x72f, 0x72f, 0x72f, 0x72f, 0x72f, 0x72f, 0x72f, 0x72f
.long 0x820, 0x910, 0x870, 0xb50, 0x200, 0x23a, 0x434, 0x714, 0x714, 0x714, 0x714, 0x714, 0x714, 0x714, 0x714, 0x714
.long 0x822, 0x911, 0x872, 0xb52, 0x201, 0x23b, 0x435, 0x715, 0x715, 0x715, 0x715, 0x715, 0x715, 0x715, 0x715, 0x715
.long 0x824, 0x912, 0x874, 0xb54, 0x202, 0x23c, 0x404, 0x716, 0x716, 0x716, 0x716, 0x716, 0x716, 0x716, 0x716, 0x716
.long 0x826, 0x913, 0x876, 0xb56, 0x203, 0x23d, 0x405, 0x717, 0x717, 0x717, 0x717, 0x717, 0x717, 0x717, 0x717, 0x717
.long 0x828, 0x914, 0x878, 0x504, 0x234, 0x40c, 0x3f2, 0x7e0, 0x7e0, 0x7e0, 0x7e0, 0x7e0, 0x7e0, 0x7e0, 0x7e0, 0x7e0
.long 0x82a, 0x915, 0x87a, 0x505, 0x235, 0x40d, 0x3f3, 0x7e0, 0x7e0, 0x7e0, 0x7e0, 0x7e0, 0x7e0, 0x7e0, 0x7e0, 0x7e0
.long 0x82c, 0x916, 0x87c, 0x220, 0x22e, 0x514, 0x43c, 0x7e0, 0x7e0, 0x7e0, 0x7e0, 0x7e0, 0x7e0, 0x7e0, 0x7e0, 0x7e0
.long 0x82e, 0x917, 0x87e, 0x221, 0x22f, 0x515, 0x43d, 0x7e0, 0x7e0, 0x7e0, 0x7e0, 0x7e0, 0x7e0, 0x7e0, 0x7e0, 0x7e0
.long 0x10, 0xa00, 0x900, 0x848, 0x210, 0x20e, 0x204, 0x23e, 0x3f0, 0x7e0, 0x7e0, 0x7e0, 0x7e0, 0x7e0, 0x7e0, 0x7e0
.long 0x11, 0xa01, 0x901, 0x84a, 0x211, 0x20f, 0x205, 0x23f, 0x3f1, 0x7e0, 0x7e0, 0x7e0, 0x7e0, 0x7e0, 0x7e0, 0x7e0
.long 0x12, 0xa02, 0x902, 0x84c, 0x212, 0x228, 0x206, 0x3d0, 0x730, 0x730, 0x730, 0x730, 0x730, 0x730, 0x730, 0x730
.long 0x13, 0xa03, 0x903, 0x84e, 0x213, 0x229, 0x207, 0x3d1, 0x731, 0x731, 0x731, 0x731, 0x731, 0x731, 0x731, 0x731
.long 0x14, 0xa04, 0x904, 0xb30, 0x226, 0x21c, 0x236, 0x424, 0x3f4, 0x7e0, 0x7e0, 0x7e0, 0x7e0, 0x7e0, 0x7e0, 0x7e0
.long 0x15, 0xa05, 0x905, 0xb32, 0x227, 0x21d, 0x237, 0x425, 0x3f5, 0x7e0, 0x7e0, 0x7e0, 0x7e0, 0x7e0, 0x7e0, 0x7e0
.long 0x16, 0xa06, 0x906, 0xb34, 0x208, 0x21e, 0x238, 0x414, 0x3f6, 0x7e0, 0x7e0, 0x7e0, 0x7e0, 0x7e0, 0x7e0, 0x7e0
.long 0x17, 0xa07, 0x907, 0xb36, 0x209, 0x21f, 0x239, 0x415, 0x3f7, 0x7e0, 0x7e0, 0x7e0, 0x7e0, 0x7e0, 0x7e0, 0x7e0
.long 0x18, 0xa08, 0x920, 0x860, 0x214, 0x22a, 0xbb0, 0x41c, 0x710, 0x710, 0x710, 0x710, 0x710, 0x710, 0x710, 0x710
.long 0x19, 0xa09, 0x921, 0x862, 0x215, 0x22b, 0xbb2, 0x41d, 0x711, 0x711, 0x711, 0x711, 0x711, 0x711, 0x711, 0x711
.long 0x1a, 0xa0a, 0x922, 0x864, 0x216, 0x22c, 0xbb4, 0x42c, 0x712, 0x712, 0x712, 0x712, 0x712, 0x712, 0x712, 0x712
.long 0x1b, 0xa0b, 0x923, 0x866, 0x217, 0x22d, 0xbb6, 0x42d, 0x713, 0x713, 0x713, 0x713, 0x713, 0x713, 0x713, 0x713
.long 0x1c, 0xa0c, 0x924, 0x868, 0xb70, 0xb90, 0x3d6, 0x732, 0x732, 0x732, 0x732, 0x732, 0x732, 0x732, 0x732, 0x732
.long 0x1d, 0xa0d, 0x925, 0x86a, 0xb72, 0xb92, 0x3d7, 0x733, 0x733, 0x733, 0x733, 0x733, 0x733, 0x733, 0x733, 0x733
.long 0x1e, 0xa0e, 0x926, 0x86c, 0xb74, 0xb94, 0x524, 0x7e0, 0x7e0, 0x7e0, 0x7e0, 0x7e0, 0x7e0, 0x7e0, 0x7e0, 0x7e0
.long 0x1f, 0xa0f, 0x927, 0x86e, 0xb76, 0xb96, 0x525, 0x7e0, 0x7e0, 0x7e0, 0x7e0, 0x7e0, 0x7e0, 0x7e0, 0x7e0, 0x7e0
.long 0x830, 0xb10, 0x858, 0x20a, 0x50c, 0x654, 0x7e0, 0x7e0, 0x7e0, 0x7e0, 0x7e0, 0x7e0, 0x7e0, 0x7e0, 0x7e0, 0x7e0
.long 0x832, 0xb12, 0x85a, 0x20b, 0x50d, 0x655, 0x7e0, 0x7e0, 0x7e0, 0x7e0, 0x7e0, 0x7e0, 0x7e0, 0x7e0, 0x7e0, 0x7e0
.long 0x834, 0xb14, 0x85c, 0x20c, 0x51c, 0x65c, 0x7e0, 0x7e0, 0x7e0, 0x7e0, 0x7e0, 0x7e0, 0x7e0, 0x7e0, 0x7e0, 0x7e0
.long 0x836, 0xb16, 0x85e, 0x20d, 0x51d, 0x65d, 0x7e0, 0x7e0, 0x7e0, 0x7e0, 0x7e0, 0x7e0, 0x7e0, 0x7e0, 0x7e0, 0x7e0
.long 0x838, 0x840, 0x850, 0x222, 0x218, 0x230, 0x3d2, 0x734, 0x734, 0x734, 0x734, 0x734, 0x734, 0x734, 0x734, 0x734
.long 0x83a, 0x842, 0x852, 0x223, 0x219, 0x231, 0x3d3, 0x735, 0x735, 0x735, 0x735, 0x735, 0x735, 0x735, 0x735, 0x735
.long 0x83c, 0x844, 0x854, 0x224, 0x21a, 0x232, 0x3d4, 0x736, 0x736, 0x736, 0x736, 0x736, 0x736, 0x736, 0x736, 0x736
.long 0x83e, 0x846, 0x856, 0x225, 0x21b, 0x233, 0x3d5, 0x737, 0x737, 0x737, 0x737, 0x737, 0x737, 0x737, 0x737, 0x737
.long 0x820, 0x910, 0x870, 0xb58, 0x200, 0x23a, 0x436, 0x71c, 0x71c, 0x71c, 0x71c, 0x71c, 0x71c, 0x71c, 0x71c, 0x71c
.long 0x822, 0x911, 0x872, 0xb5a, 0x201, 0x23b, 0x437, 0x71d, 0x71d, 0x71d, 0x71d, 0x71d, 0x71d, 0x71d, 0x71d, 0x71d
.long 0x824, 0x912, 0x874, 0xb5c, 0x202, 0x23c, 0x406, 0x71e, 0x71e, 0x71e, 0x71e, 0x71e, 0x71e, 0x71e, 0x71e, 0x71e
.long 0x826, 0x913, 0x876, 0xb5e, 0x203, 0x23d, 0x407, 0x71f, 0x71f, 0x71f, 0x71f, 0x71f, 0x71f, 0x71f, 0x71f, 0x71f
.long 0x828, 0x914, 0x878, 0x506, 0x234, 0x40e, 0x3fa, 0x7e0, 0x7e0, 0x7e0, 0x7e0, 0x7e0, 0x7e0, 0x7e0, 0x7e0, 0x7e0
.long 0x82a, 0x915, 0x87a, 0x507, 0x235, 0x40f, 0x3fb, 0x7e0, 0x7e0, 0x7e0, 0x7e0, 0x7e0, 0x7e0, 0x7e0, 0x7e0, 0x7e0
.long 0x82c, 0x916, 0x87c, 0x220, 0x22e, 0x516, 0x43e, 0x7e0, 0x7e0, 0x7e0, 0x7e0, 0x7e0, 0x7e0, 0x7e0, 0x7e0, 0x7e0
.long 0x82e, 0x917, 0x87e, 0x221, 0x22f, 0x517, 0x43f, 0x7e0, 0x7e0, 0x7e0, 0x7e0, 0x7e0, 0x7e0, 0x7e0, 0x7e0, 0x7e0
.long 0x10, 0xa00, 0x900, 0x848, 0x210, 0x20e, 0x204, 0x23e, 0x3f8, 0x7e0, 0x7e0, 0x7e0, 0x7e0, 0x7e0, 0x7e0, 0x7e0
.long 0x11, 0xa01, 0x901, 0x84a, 0x211, 0x20f, 0x205, 0x23f, 0x3f9, 0x7e0, 0x7e0, 0x7e0, 0x7e0, 0x7e0, 0x7e0, 0x7e0
.long 0x12, 0xa02, 0x902, 0x84c, 0x212, 0x228, 0x206, 0x3d8, 0x738, 0x738, 0x738, 0x738, 0x738, 0x738, 0x738, 0x738
.long 0x13, 0xa03, 0x903, 0x84e, 0x213, 0x229, 0x207, 0x3d9, 0x739, 0x739, 0x739, 0x739, 0x739, 0x739, 0x739, 0x739
.long 0x14, 0xa04, 0x904, 0xb38, 0x226, 0x21c, 0x236, 0x426, 0x3fc, 0x7e0, 0x7e0, 0x7e0, 0x7e0, 0x7e0, 0x7e0, 0x7e0
.long 0x15, 0xa05, 0x905, 0xb3a, 0x227, 0x21d, 0x237, 0x427, 0x3fd, 0x7e0, 0x7e0, 0x7e0, 0x7e0, 0x7e0, 0x7e0, 0x7e0
.long 0x16, 0xa06, 0x906, 0xb3c, 0x208, 0x21e, 0x238, 0x416, 0x3fe, 0x7e0, 0x7e0, 0x7e0, 0x7e0, 0x7e0, 0x7e0, 0x7e0
.long 0x17, 0xa07, 0x907, 0xb3e, 0x209, 0x21f, 0x239, 0x417, 0x3ff, 0x7e0, 0x7e0, 0x7e0, 0x7e0, 0x7e0, 0x7e0, 0x7e0
.long 0x18, 0xa08, 0x920, 0x860, 0x214, 0x22a, 0xbb8, 0x41e, 0x718, 0x718, 0x718, 0x718, 0x718, 0x718, 0x718, 0x718
.long 0x19, 0xa09, 0x921, 0x862, 0x215, 0x22b, 0xbba, 0x41f, 0x719, 0x719, 0x719, 0x719, 0x719, 0x719, 0x719, 0x719
.long 0x1a, 0xa0a, 0x922, 0x864, 0x216, 0x22c, 0xbbc, 0x42e, 0x71a, 0x71a, 0x71a, 0x71a, 0x71a, 0x71a, 0x71a, 0x71a
.long 0x1b, 0xa0b, 0x923, 0x866, 0x217, 0x22d, 0xbbe, 0x42f, 0x71b, 0x71b, 0x71b, 0x71b, 0x71b, 0x71b, 0x71b, 0x71b
.long 0x1c, 0xa0c, 0x924, 0x868, 0xb78, 0xb98, 0x3de, 0x73a, 0x73a, 0x73a, 0x73a, 0x73a, 0x73a, 0x73a, 0x73a, 0x73a
.long 0x1d, 0xa0d, 0x925, 0x86a, 0xb7a, 0xb9a, 0x3df, 0x73b, 0x73b, 0x73b, 0x73b, 0x73b, 0x73b, 0x73b, 0x73b, 0x73b
.long 0x1e, 0xa0e, 0x926, 0x86c, 0xb7c, 0xb9c, 0x526, 0x7e0, 0x7e0, 0x7e0, 0x7e0, 0x7e0, 0x7e0, 0x7e0, 0x7e0, 0x7e0
.long 0x1f, 0xa0f, 0x927, 0x86e, 0xb7e, 0xb9e, 0x527, 0x7e0, 0x7e0, 0x7e0, 0x7e0, 0x7e0, 0x7e0, 0x7e0, 0x7e0, 0x7e0
.long 0x830, 0xb18, 0x858, 0x20a, 0x50e, 0x656, 0x7e0, 0x7e0, 0x7e0, 0x7e0, 0x7e0, 0x7e0, 0x7e0, 0x7e0, 0x7e0, 0x7e0
.long 0x832, 0xb1a, 0x85a, 0x20b, 0x50f, 0x657, 0x7e0, 0x7e0, 0x7e0, 0x7e0, 0x7e0, 0x7e0, 0x7e0, 0x7e0, 0x7e0, 0x7e0
.long 0x834, 0xb1c, 0x85c, 0x20c, 0x51e, 0x65e, 0x7e0, 0x7e0, 0x7e0, 0x7e0, 0x7e0, 0x7e0, 0x7e0, 0x7e0, 0x7e0, 0x7e0
.long 0x836, 0xb1e, 0x85e, 0x20d, 0x51f, 0x65f, 0x7e0, 0x7e0, 0x7e0, 0x7e0, 0x7e0, 0x7e0, 0x7e0, 0x7e0, 0x7e0, 0x7e0
.long 0x838, 0x840, 0x850, 0x222, 0x218, 0x230, 0x3da, 0x73c, 0x73c, 0x73c, 0x73c, 0x73c, 0x73c, 0x73c, 0x73c, 0x73c
.long 0x83a, 0x842, 0x852, 0x223, 0x219, 0x231, 0x3db, 0x73d, 0x73d, 0x73d, 0x73d, 0x73d, 0x73d, 0x73d, 0x73d, 0x73d
.long 0x83c, 0x844, 0x854, 0x224, 0x21a, 0x232, 0x3dc, 0x73e, 0x73e, 0x73e, 0x73e, 0x73e, 0x73e, 0x73e, 0x73e, 0x73e
.long 0x83e, 0x846, 0x856, 0x225, 0x21b, 0x233, 0x3dd, 0x73f, 0x73f, 0x73f, 0x73f, 0x73f, 0x73f, 0x73f, 0x73f, 0x73f
.size JOBS, 8192
.type SEGS,@object
SEGS:
.long 48, 49, 51, 53, 55, 57, 59, 64, 64, 64, 64, 64, 64, 64, 64, 64, 64, 64, 64, 64, 64, 64, 64, 64, 64, 64, 64, 64, 64, 64, 64, 64
.long 50, 52, 54, 56, 58, 64, 64, 64, 64, 64, 64, 64, 64, 64, 64, 64, 64, 64, 64, 64, 64, 64, 64, 64, 64, 64, 64, 64, 64, 64, 64, 64
.long 64, 64, 64, 64, 64, 64, 64, 64, 64, 64, 64, 64, 64, 64, 64, 64, 64, 64, 64, 64, 64, 64, 64, 64, 64, 64, 64, 64, 64, 64, 64, 64
.long 64, 64, 64, 64, 64, 64, 64, 64, 64, 64, 64, 64, 64, 64, 64, 64, 64, 64, 64, 64, 64, 64, 64, 64, 64, 64, 64, 64, 64, 64, 64, 64
.long 64, 64, 64, 64, 64, 64, 64, 64, 64, 64, 64, 64, 64, 64, 64, 64, 64, 64, 64, 64, 64, 64, 64, 64, 64, 64, 64, 64, 64, 64, 64, 64
.long 64, 64, 64, 64, 64, 64, 64, 64, 64, 64, 64, 64, 64, 64, 64, 64, 64, 64, 64, 64, 64, 64, 64, 64, 64, 64, 64, 64, 64, 64, 64, 64
.long 64, 64, 64, 64, 64, 64, 64, 64, 64, 64, 64, 64, 64, 64, 64, 64, 64, 64, 64, 64, 64, 64, 64, 64, 64, 64, 64, 64, 64, 64, 64, 64
.long 64, 64, 64, 64, 64, 64, 64, 64, 64, 64, 64, 64, 64, 64, 64, 64, 64, 64, 64, 64, 64, 64, 64, 64, 64, 64, 64, 64, 64, 64, 64, 64
.size SEGS, 1024
CODE_END:
.section .rodata,"a"
.p2align 6
.amdhsa_kernel concat_heads__memory_aug_recurrent_mem_tr__mha_block__prompt_kernel
  .amdhsa_next_free_vgpr 256
  .amdhsa_next_free_sgpr 102
  .amdhsa_accum_offset 256
  .amdhsa_group_segment_fixed_size 0
  .amdhsa_kernarg_size 104
  .amdhsa_user_sgpr_count 2
  .amdhsa_user_sgpr_kernarg_segment_ptr 1
  .amdhsa_system_sgpr_workgroup_id_x 1
  .amdhsa_float_denorm_mode_32 3
  .amdhsa_float_denorm_mode_16_64 3
.end_amdhsa_kernel
.text
```
